```python
import torch

def _softmax(x, axis=-1):
    return torch.softmax(x, dim=axis)

def _gelu(x):
    return torch.nn.functional.gelu(x, approximate='tanh')

def _silu(x):
    return torch.nn.functional.silu(x)

def _sigmoid(x):
    return torch.sigmoid(x)

def _layernorm(x, axis=-1, eps=1e-05):
    m = x.mean(dim=axis, keepdim=True)
    v = x.var(dim=axis, keepdim=True, unbiased=False)
    return (x - m) / torch.sqrt(v + eps)

def _scatter_add(tgt, idx, src, axis=0):
    return tgt.clone().index_add_(axis, idx, src)

def _segment_sum(src, seg, n):
    out = torch.zeros((n,) + src.shape[1:], dtype=src.dtype)
    return out.index_add_(0, seg, src)

def _pad(x, pw):
    flat = tuple((v for pair in reversed(pw) for v in pair))
    return torch.nn.functional.pad(x, flat)
kernel_name = 'standalone__ragged_sequences_varlen_flash_attn__ragged'

def setup_inputs():

    _w = lambda a: (lambda t: t.to(torch.bfloat16) if t.is_floating_point() else t)(torch.as_tensor(a))
    cu = torch.tensor([0, 899, 1287, 3063, 3381, 3962, 4737, 5351, 7180], dtype=torch.int64)
    T = int(cu[-1])
    Hq, Hkv, D = (16, 4, 128)
    assert Hq % Hkv == 0
    return {'q': _w((lambda *s: torch.randn(*s, dtype=torch.bfloat16) * 0.8)(T, Hq, D)), 'k': _w((lambda *s: torch.randn(*s, dtype=torch.bfloat16) * 0.8)(T, Hkv, D)), 'v': _w((lambda *s: torch.randn(*s, dtype=torch.bfloat16) * 0.05)(T, Hkv, D)), 'cu': _w(cu)}

def reference(q, k, v, cu):
    T, Hq, D = q.shape
    Hkv = k.shape[1]
    rep = Hq // Hkv
    scale = D ** (-0.5)
    outs = []
    for i in range(len(cu) - 1):
        s, e = (int(cu[i]), int(cu[i + 1]))
        L = e - s
        qi = q[s:e].clone()
        ki = (lambda x, n, axis: torch.repeat_interleave(x, n, dim=axis))(k[s:e], rep, axis=1)
        vi = (lambda x, n, axis: torch.repeat_interleave(x, n, dim=axis))(v[s:e], rep, axis=1)
        logits = torch.einsum('qhd,khd->hqk', qi, ki) * scale
        ar = torch.arange(L)
        neg = (lambda x, dt: x.to(dt))(ar[None, :] > ar[:, None], logits.dtype) * -1000000000.0
        p = _softmax(logits + neg[None, :, :], axis=-1)
        outs.append(torch.einsum('hqk,khd->qhd', p, vi))
    return torch.concatenate(outs, axis=0)
```

```asm
; @launch grid=(256,1,1) block=(256,1,1) lds=163840
.amdgcn_target "amdgcn-amd-amdhsa--gfx950"
.text
.globl standalone__ragged_sequences_varlen_flash_attn__ragged_kernel
.p2align 8
.type standalone__ragged_sequences_varlen_flash_attn__ragged_kernel,@function
standalone__ragged_sequences_varlen_flash_attn__ragged_kernel:
    s_cmp_ge_u32 s2, 0x100
    s_cbranch_scc1 L_end
    s_load_dwordx4 s[96:99], s[0:1], 0
    s_load_dwordx4 s[88:91], s[0:1], 16
    s_load_dwordx2 s[40:41], s[0:1], 32
    s_getpc_b64 s[56:57]
L_pc:
    s_mul_i32 s38, s2, 0xa0
    s_add_u32 s38, s38, sched_table-L_pc
    s_add_u32 s56, s56, s38
    s_addc_u32 s57, s57, 0
    s_load_dwordx8 s[48:55], s[56:57], 0
    v_lshrrev_b32 v247, 6, v0
    v_and_b32 v244, 63, v0
    v_readfirstlane_b32 s22, v247
    v_and_b32 v245, 31, v244
    v_lshrrev_b32 v246, 5, v244
    v_lshlrev_b32 v255, 4, v244
    s_mov_b32 s20, 0x3e0293ee
    s_mov_b32 s28, 0xbe0293ee
    s_mov_b32 s21, 0x5d800000
    s_mov_b32 s37, 0
    s_lshr_b32 s44, s22, 1
    s_and_b32 s45, s22, 1
    s_lshl_b32 s47, s44, 15
    s_lshl_b32 s58, s45, 13
    s_add_u32 s47, s47, s58
    s_add_u32 s59, s47, 0x14000
    s_lshl_b32 s38, s22, 13
    s_add_u32 s60, s38, 0x20000
    s_lshl_b32 s38, s45, 1
    s_add_u32 s38, s38, s44
    s_lshl_b32 s77, s38, 8
    s_lshl_b32 s38, s38, 13
    s_add_u32 s61, s38, 0x20000
    s_lshl_b32 s76, s22, 8
    s_lshl_b32 s74, s22, 14
    s_lshl_b32 s79, s44, 16
    s_lshl_b32 s38, s45, 15
    s_add_u32 s75, s79, s38
    s_lshl_b32 s38, s45, 9
    s_lshl_b32 s39, s44, 7
    s_add_u32 s78, s38, s39
    s_lshl_b32 s101, s44, 6
    s_lshl_b32 s38, s45, 14
    s_add_u32 s38, s38, 0x20000
    s_sub_u32 s100, s38, s79
    s_lshl_b32 s38, s22, 12
    s_lshl_b32 s39, s45, 13
    s_add_u32 s39, s39, s79
    s_add_u32 s62, s38, 0
    s_add_u32 s66, s39, 0
    s_add_u32 s70, s39, 0x1000
    s_add_u32 s63, s38, 0x4000
    s_add_u32 s67, s39, 0x4000
    s_add_u32 s71, s39, 0x5000
    s_add_u32 s64, s38, 0x8000
    s_add_u32 s68, s39, 0x8000
    s_add_u32 s72, s39, 0x9000
    s_add_u32 s65, s38, 0xc000
    s_add_u32 s69, s39, 0xc000
    s_add_u32 s73, s39, 0xd000
    v_lshrrev_b32 v247, 4, v244
    v_and_b32 v248, 15, v244
    v_lshlrev_b32 v249, 12, v247
    v_lshl_add_u32 v224, v248, 4, v249
    v_xor_b32 v250, v248, v247
    v_lshl_add_u32 v250, v250, 4, v249
    v_lshlrev_b32 v247, 2, v247
    v_xor_b32 v248, v248, v247
    v_lshl_add_u32 v220, v248, 4, v249
    v_xor_b32 v221, 16, v220
    v_xor_b32 v225, 64, v224
    v_xor_b32 v222, 32, v220
    v_xor_b32 v226, 0x80, v224
    v_xor_b32 v223, 48, v220
    v_xor_b32 v227, 0xc0, v224
    s_waitcnt lgkmcnt(0)
    s_mov_b32 s4, s96
    s_and_b32 s5, s97, 0xffff
    s_mov_b32 s6, 0
    s_mov_b32 s7, 0x20000
    s_mov_b32 s8, s98
    s_and_b32 s9, s99, 0xffff
    s_mov_b32 s10, 0
    s_mov_b32 s11, 0x20000
    s_mov_b32 s12, s88
    s_and_b32 s13, s89, 0xffff
    s_mov_b32 s14, 0
    s_mov_b32 s15, 0x20000
    s_mov_b32 s16, s40
    s_and_b32 s17, s41, 0xffff
    s_mov_b32 s18, 0
    s_mov_b32 s19, 0x20000
    s_bfe_u32 s29, s51, 0x20008
    s_load_dwordx8 s[80:87], s[90:91], 4
    s_mov_b32 s30, 0
    s_mov_b32 s31, 1
    s_mov_b64 s[94:95], s[56:57]
    s_mov_b32 s88, 0
    s_lshl_b32 s93, s22, 15
    s_lshl_b32 s38, s45, 13
    s_add_u32 s38, s38, s79
    s_add_u32 s3, s38, 0xc000
    s_cmp_eq_u32 s29, 0
    s_cbranch_scc1 L_pro_nn_2
    s_cmp_eq_u32 s29, 2
    s_cbranch_scc1 L_pro_ns_1
    s_mov_b32 s10, s52
    s_mov_b32 s14, s52
    s_mov_b32 s6, s50
    s_add_u32 s24, s49, s74
    s_mov_b32 s25, s24
    v_lshrrev_b32 v132, 12, v220
    v_mul_u32_u24 v132, 0x3000, v132
    v_add_u32 v128, v220, v132
    v_add_u32 v129, v221, v132
    v_add_u32 v129, 0xc00, v129
    v_add_u32 v130, v222, v132
    v_add_u32 v130, 0x1800, v130
    v_add_u32 v131, v223, v132
    s_mov_b32 m0, s62
    v_add_u32 v131, 0x2400, v131
    buffer_load_dwordx4 v220, s[8:11], s24 offen offset:0 lds
    v_lshlrev_b32 v247, 2, v246
    v_sub_u32 v243, v245, v247
    v_and_b32 v247, 16, v245
    buffer_load_dwordx4 v221, s[8:11], s24 offen offset:1024 lds
    v_and_b32 v248, 3, v245
    v_lshl_add_u32 v247, v248, 2, v247
    v_bfe_u32 v248, v245, 2, 2
    buffer_load_dwordx4 v222, s[8:11], s24 offen offset:2048 lds
    v_add_u32 v247, v247, v248
    v_lshlrev_b32 v247, 8, v247
    v_and_b32 v248, 15, v245
    buffer_load_dwordx4 v223, s[8:11], s24 offen offset:3072 lds
    s_add_u32 s24, s24, 0x10000
    v_xor_b32 v248, v248, v246
    v_lshl_add_u32 v208, v248, 4, v247
    v_xor_b32 v209, 32, v208
    s_add_u32 s32, s48, s76
    s_mov_b32 s33, s60
    s_mov_b32 m0, s33
    s_add_u32 s33, s33, 0x1000
    buffer_load_dwordx4 v128, s[4:7], s32 offen offset:0 nt lds
    v_xor_b32 v210, 64, v208
    v_xor_b32 v211, 0x60, v208
    v_xor_b32 v212, 0x80, v208
    buffer_load_dwordx4 v129, s[4:7], s32 offen offset:1024 nt lds
    v_xor_b32 v213, 0xa0, v208
    v_xor_b32 v214, 0xc0, v208
    v_xor_b32 v215, 0xe0, v208
    buffer_load_dwordx4 v130, s[4:7], s32 offen offset:2048 nt lds
    v_bfe_u32 v247, v244, 2, 2
    v_lshl_add_u32 v248, v247, 2, v246
    v_lshlrev_b32 v248, 8, v248
    buffer_load_dwordx4 v131, s[4:7], s32 offen offset:3072 nt lds
    v_lshl_add_u32 v248, v247, 6, v248
    v_bfe_u32 v247, v244, 4, 1
    v_lshl_add_u32 v248, v247, 5, v248
    s_mov_b32 m0, s33
    s_add_u32 s32, s32, 0x10000
    buffer_load_dwordx4 v128, s[4:7], s32 offen offset:0 nt lds
    v_and_b32 v247, 3, v244
    v_lshl_add_u32 v216, v247, 3, v248
    v_xor_b32 v217, 64, v216
    buffer_load_dwordx4 v129, s[4:7], s32 offen offset:1024 nt lds
    v_xor_b32 v218, 0x80, v216
    v_xor_b32 v219, 0xc0, v216
    v_mov_b32 v242, 0xff800000
    buffer_load_dwordx4 v130, s[4:7], s32 offen offset:2048 nt lds
    v_lshrrev_b32 v247, 3, v244
    v_and_b32 v248, 7, v244
    v_xor_b32 v248, v248, v247
    buffer_load_dwordx4 v131, s[4:7], s32 offen offset:3072 nt lds
    v_lshlrev_b32 v247, 12, v247
    v_lshl_add_u32 v251, v248, 4, v247
    v_lshrrev_b32 v247, 1, v244
    s_add_u32 s32, s32, 0x10000
    s_sub_u32 s33, s59, 0x4000
    s_mov_b32 m0, s33
    s_add_u32 s33, s33, 0x1000
    buffer_load_dwordx4 v128, s[4:7], s32 offen offset:0 nt lds
    v_and_b32 v248, 1, v244
    v_lshlrev_b32 v247, 10, v247
    v_lshl_add_u32 v252, v248, 7, v247
    buffer_load_dwordx4 v129, s[4:7], s32 offen offset:1024 nt lds
    v_lshlrev_b32 v247, 8, v245
    v_and_b32 v248, 7, v245
    v_lshl_add_u32 v247, v246, 3, v247
    buffer_load_dwordx4 v130, s[4:7], s32 offen offset:2048 nt lds
    v_lshl_add_u32 v253, v248, 4, v247
    v_accvgpr_write_b32 a240, 0
    v_accvgpr_write_b32 a241, 0
    buffer_load_dwordx4 v131, s[4:7], s32 offen offset:3072 nt lds
    v_accvgpr_write_b32 a242, 0
    v_accvgpr_write_b32 a243, 0
    s_mov_b32 m0, s33
    s_add_u32 s32, s32, 0x10000
    buffer_load_dwordx4 v128, s[4:7], s32 offen offset:0 nt lds
    buffer_load_dwordx4 v129, s[4:7], s32 offen offset:1024 nt lds
    buffer_load_dwordx4 v130, s[4:7], s32 offen offset:2048 nt lds
    buffer_load_dwordx4 v131, s[4:7], s32 offen offset:3072 nt lds
    s_branch L_pro_ne_3
L_pro_ns_1:
    s_mov_b32 s10, s52
    s_mov_b32 s14, s52
    s_mov_b32 s6, s50
    s_add_u32 s24, s49, s75
    s_mov_b32 s25, s24
    v_lshrrev_b32 v132, 12, v220
    v_mul_u32_u24 v132, 0x3000, v132
    v_add_u32 v128, v220, v132
    v_add_u32 v129, v221, v132
    v_add_u32 v129, 0xc00, v129
    v_add_u32 v130, v222, v132
    v_add_u32 v130, 0x1800, v130
    v_add_u32 v131, v223, v132
    v_add_u32 v131, 0x2400, v131
    s_mov_b32 m0, s66
    s_add_u32 s26, s24, 0x4000
    buffer_load_dwordx4 v220, s[8:11], s24 offen offset:0 lds
    v_lshlrev_b32 v247, 2, v246
    v_sub_u32 v243, v245, v247
    v_and_b32 v247, 16, v245
    buffer_load_dwordx4 v221, s[8:11], s24 offen offset:1024 lds
    v_and_b32 v248, 3, v245
    v_lshl_add_u32 v247, v248, 2, v247
    v_bfe_u32 v248, v245, 2, 2
    buffer_load_dwordx4 v222, s[8:11], s24 offen offset:2048 lds
    v_add_u32 v247, v247, v248
    v_lshlrev_b32 v247, 8, v247
    v_and_b32 v248, 15, v245
    buffer_load_dwordx4 v223, s[8:11], s24 offen offset:3072 lds
    v_xor_b32 v248, v248, v246
    v_lshl_add_u32 v208, v248, 4, v247
    v_xor_b32 v209, 32, v208
    s_mov_b32 m0, s70
    s_add_u32 s24, s24, 0x20000
    buffer_load_dwordx4 v220, s[8:11], s26 offen offset:0 lds
    v_xor_b32 v210, 64, v208
    v_xor_b32 v211, 0x60, v208
    v_xor_b32 v212, 0x80, v208
    buffer_load_dwordx4 v221, s[8:11], s26 offen offset:1024 lds
    v_xor_b32 v213, 0xa0, v208
    v_xor_b32 v214, 0xc0, v208
    v_xor_b32 v215, 0xe0, v208
    buffer_load_dwordx4 v222, s[8:11], s26 offen offset:2048 lds
    v_bfe_u32 v247, v244, 2, 2
    v_lshl_add_u32 v248, v247, 2, v246
    v_lshlrev_b32 v248, 8, v248
    buffer_load_dwordx4 v223, s[8:11], s26 offen offset:3072 lds
    v_lshl_add_u32 v248, v247, 6, v248
    v_bfe_u32 v247, v244, 4, 1
    v_lshl_add_u32 v248, v247, 5, v248
    s_add_u32 s32, s48, s77
    s_mov_b32 s33, s61
    s_mov_b32 m0, s33
    s_add_u32 s33, s33, 0x1000
    buffer_load_dwordx4 v128, s[4:7], s32 offen offset:0 nt lds
    v_and_b32 v247, 3, v244
    v_lshl_add_u32 v216, v247, 3, v248
    v_xor_b32 v217, 64, v216
    buffer_load_dwordx4 v129, s[4:7], s32 offen offset:1024 nt lds
    v_xor_b32 v218, 0x80, v216
    v_xor_b32 v219, 0xc0, v216
    v_mov_b32 v242, 0xff800000
    buffer_load_dwordx4 v130, s[4:7], s32 offen offset:2048 nt lds
    v_lshrrev_b32 v247, 3, v244
    v_and_b32 v248, 7, v244
    v_xor_b32 v248, v248, v247
    buffer_load_dwordx4 v131, s[4:7], s32 offen offset:3072 nt lds
    v_lshlrev_b32 v247, 12, v247
    v_lshl_add_u32 v251, v248, 4, v247
    v_lshrrev_b32 v247, 1, v244
    s_mov_b32 m0, s33
    s_add_u32 s32, s32, 0x10000
    buffer_load_dwordx4 v128, s[4:7], s32 offen offset:0 nt lds
    v_and_b32 v248, 1, v244
    v_lshlrev_b32 v247, 10, v247
    v_lshl_add_u32 v252, v248, 7, v247
    buffer_load_dwordx4 v129, s[4:7], s32 offen offset:1024 nt lds
    v_lshlrev_b32 v247, 8, v245
    v_and_b32 v248, 7, v245
    v_lshl_add_u32 v247, v246, 3, v247
    buffer_load_dwordx4 v130, s[4:7], s32 offen offset:2048 nt lds
    v_lshl_add_u32 v253, v248, 4, v247
    v_accvgpr_write_b32 a240, 0
    v_accvgpr_write_b32 a241, 0
    buffer_load_dwordx4 v131, s[4:7], s32 offen offset:3072 nt lds
    v_accvgpr_write_b32 a242, 0
    v_accvgpr_write_b32 a243, 0
    s_branch L_pro_ne_3
L_pro_nn_2:
    v_lshlrev_b32 v247, 2, v246
    v_sub_u32 v243, v245, v247
    v_and_b32 v247, 16, v245
    v_and_b32 v248, 3, v245
    v_lshl_add_u32 v247, v248, 2, v247
    v_bfe_u32 v248, v245, 2, 2
    v_add_u32 v247, v247, v248
    v_lshlrev_b32 v247, 8, v247
    v_and_b32 v248, 15, v245
    v_xor_b32 v248, v248, v246
    v_lshl_add_u32 v208, v248, 4, v247
    v_xor_b32 v209, 32, v208
    v_xor_b32 v210, 64, v208
    v_xor_b32 v211, 0x60, v208
    v_xor_b32 v212, 0x80, v208
    v_xor_b32 v213, 0xa0, v208
    v_xor_b32 v214, 0xc0, v208
    v_xor_b32 v215, 0xe0, v208
    v_bfe_u32 v247, v244, 2, 2
    v_lshl_add_u32 v248, v247, 2, v246
    v_lshlrev_b32 v248, 8, v248
    v_lshl_add_u32 v248, v247, 6, v248
    v_bfe_u32 v247, v244, 4, 1
    v_lshl_add_u32 v248, v247, 5, v248
    v_and_b32 v247, 3, v244
    v_lshl_add_u32 v216, v247, 3, v248
    v_xor_b32 v217, 64, v216
    v_xor_b32 v218, 0x80, v216
    v_xor_b32 v219, 0xc0, v216
    v_mov_b32 v242, 0xff800000
    v_lshrrev_b32 v247, 3, v244
    v_and_b32 v248, 7, v244
    v_xor_b32 v248, v248, v247
    v_lshlrev_b32 v247, 12, v247
    v_lshl_add_u32 v251, v248, 4, v247
    v_lshrrev_b32 v247, 1, v244
    v_and_b32 v248, 1, v244
    v_lshlrev_b32 v247, 10, v247
    v_lshl_add_u32 v252, v248, 7, v247
    v_lshlrev_b32 v247, 8, v245
    v_and_b32 v248, 7, v245
    v_lshl_add_u32 v247, v246, 3, v247
    v_lshl_add_u32 v253, v248, 4, v247
    v_accvgpr_write_b32 a240, 0
    v_accvgpr_write_b32 a241, 0
    v_accvgpr_write_b32 a242, 0
    v_accvgpr_write_b32 a243, 0
L_pro_ne_3:
    s_cmp_eq_u32 s29, 0
    s_cbranch_scc1 L_fin
    s_cmp_eq_u32 s29, 2
    s_cbranch_scc1 L_entryp_1
    s_branch L_entryp_0
L_entry_0:
L_entryp_0:
    s_mov_b32 s39, s37
    s_mov_b32 s37, 0
    v_xor_b32 v208, s39, v208
    v_xor_b32 v209, s39, v209
    v_xor_b32 v210, s39, v210
    v_xor_b32 v211, s39, v211
    v_xor_b32 v212, s39, v212
    v_xor_b32 v213, s39, v213
    v_xor_b32 v214, s39, v214
    v_xor_b32 v215, s39, v215
    v_xor_b32 v216, s39, v216
    v_xor_b32 v217, s39, v217
    v_xor_b32 v218, s39, v218
    v_xor_b32 v219, s39, v219
    s_waitcnt vmcnt(8) lgkmcnt(0)
    s_barrier
    ds_read_b128 a[80:83], v208 offset:0
    v_add_u32 v132, s60, v208
    ds_read_b128 a[84:87], v209 offset:0
    ds_read_b128 a[16:19], v132 offset:0
    ds_read_b128 a[88:91], v210 offset:0
    v_add_u32 v133, s60, v209
    ds_read_b128 a[92:95], v211 offset:0
    ds_read_b128 a[20:23], v133 offset:0
    ds_read_b128 a[96:99], v212 offset:0
    v_add_u32 v134, s60, v210
    ds_read_b128 a[100:103], v213 offset:0
    ds_read_b128 a[24:27], v134 offset:0
    ds_read_b128 a[104:107], v214 offset:0
    v_add_u32 v135, s60, v211
    ds_read_b128 a[108:111], v215 offset:0
    ds_read_b128 a[28:31], v135 offset:0
    ds_read_b128 a[112:115], v208 offset:8192
    v_add_u32 v132, s60, v212
    ds_read_b128 a[116:119], v209 offset:8192
    ds_read_b128 a[32:35], v132 offset:0
    ds_read_b128 a[120:123], v210 offset:8192
    v_add_u32 v133, s60, v213
    ds_read_b128 a[124:127], v211 offset:8192
    ds_read_b128 a[36:39], v133 offset:0
    ds_read_b128 a[128:131], v212 offset:8192
    v_add_u32 v134, s60, v214
    ds_read_b128 a[132:135], v213 offset:8192
    ds_read_b128 a[40:43], v134 offset:0
    ds_read_b128 a[136:139], v214 offset:8192
    v_add_u32 v135, s60, v215
    ds_read_b128 a[140:143], v215 offset:8192
    ds_read_b128 a[44:47], v135 offset:0
    s_xor_b32 s38, s80, 0x383
    s_xor_b32 s39, s81, 0x507
    s_or_b32 s38, s38, s39
    s_xor_b32 s39, s82, 0xbf7
    s_or_b32 s38, s38, s39
    s_xor_b32 s39, s83, 0xd35
    s_or_b32 s38, s38, s39
    s_xor_b32 s39, s84, 0xf7a
    s_or_b32 s38, s38, s39
    s_xor_b32 s39, s85, 0x1281
    s_or_b32 s38, s38, s39
    s_xor_b32 s39, s86, 0x14e7
    s_or_b32 s38, s38, s39
    s_xor_b32 s39, s87, 0x1c0c
    s_or_b32 s38, s38, s39
    s_cmp_lg_u32 s38, 0
    s_cbranch_scc1 L_generic
    s_and_b32 s23, s51, 0xff
    s_bfe_u32 s29, s51, 0x20010
    s_mov_b32 s34, 0
    s_mov_b32 s35, 32
    s_and_b32 s92, s54, 0xff
    s_max_u32 s92, s92, 1
    s_and_b32 s90, s54, 0xffffff00
    s_mov_b32 s91, s55
    s_mov_b32 m0, s64
    s_waitcnt lgkmcnt(14)
    v_mfma_f32_32x32x16_bf16 v[112:127], a[80:83], a[16:19], 0
    buffer_load_dwordx4 v224, s[12:15], s25 offen offset:0 lds
    v_mfma_f32_32x32x16_bf16 v[112:127], a[84:87], a[20:23], v[112:127]
    v_mfma_f32_32x32x16_bf16 v[112:127], a[88:91], a[24:27], v[112:127]
    buffer_load_dwordx4 v225, s[12:15], s25 offen offset:1024 lds
    s_waitcnt lgkmcnt(12)
    v_mfma_f32_32x32x16_bf16 v[112:127], a[92:95], a[28:31], v[112:127]
    s_waitcnt lgkmcnt(9)
    v_mfma_f32_32x32x16_bf16 v[112:127], a[96:99], a[32:35], v[112:127]
    buffer_load_dwordx4 v226, s[12:15], s25 offen offset:2048 lds
    s_waitcnt lgkmcnt(6)
    v_mfma_f32_32x32x16_bf16 v[112:127], a[100:103], a[36:39], v[112:127]
    s_waitcnt lgkmcnt(3)
    v_mfma_f32_32x32x16_bf16 v[112:127], a[104:107], a[40:43], v[112:127]
    buffer_load_dwordx4 v227, s[12:15], s25 offen offset:3072 lds
    s_add_u32 s25, s25, 0x10000
    s_waitcnt lgkmcnt(0)
    v_mfma_f32_32x32x16_bf16 v[112:127], a[108:111], a[44:47], v[112:127]
    s_mov_b32 m0, s63
    v_mfma_f32_32x32x16_bf16 v[128:143], a[112:115], a[16:19], 0
    buffer_load_dwordx4 v220, s[8:11], s24 offen offset:0 lds
    v_mfma_f32_32x32x16_bf16 v[128:143], a[116:119], a[20:23], v[128:143]
    v_mfma_f32_32x32x16_bf16 v[128:143], a[120:123], a[24:27], v[128:143]
    buffer_load_dwordx4 v221, s[8:11], s24 offen offset:1024 lds
    v_mfma_f32_32x32x16_bf16 v[128:143], a[124:127], a[28:31], v[128:143]
    v_mfma_f32_32x32x16_bf16 v[128:143], a[128:131], a[32:35], v[128:143]
    buffer_load_dwordx4 v222, s[8:11], s24 offen offset:2048 lds
    v_mfma_f32_32x32x16_bf16 v[128:143], a[132:135], a[36:39], v[128:143]
    v_mfma_f32_32x32x16_bf16 v[128:143], a[136:139], a[40:43], v[128:143]
    buffer_load_dwordx4 v223, s[8:11], s24 offen offset:3072 lds
    s_add_u32 s24, s24, 0x10000
    v_mfma_f32_32x32x16_bf16 v[128:143], a[140:143], a[44:47], v[128:143]
    s_mov_b32 m0, s65
    v_mfma_f32_32x32x16_bf16 v[64:79], a[240:243], a[240:243], 0
    buffer_load_dwordx4 v224, s[12:15], s25 offen offset:0 lds
    s_cmp_eq_u32 s23, 1
    s_cbranch_scc1 L_mask_4
L_maskb_5:
    v_max3_f32 v244, v112, v113, v114
    v_max3_f32 v244, v244, v115, v116
    v_max3_f32 v244, v244, v117, v118
    v_max3_f32 v244, v244, v119, v120
    v_max3_f32 v244, v244, v121, v122
    v_max3_f32 v244, v244, v123, v124
    v_max3_f32 v244, v244, v125, v126
    v_max_f32 v244, v244, v127
    v_max3_f32 v245, v128, v129, v130
    v_max3_f32 v245, v245, v131, v132
    v_max3_f32 v245, v245, v133, v134
    v_max3_f32 v245, v245, v135, v136
    v_max3_f32 v245, v245, v137, v138
    v_max3_f32 v245, v245, v139, v140
    v_max3_f32 v245, v245, v141, v142
    v_mfma_f32_32x32x16_bf16 v[80:95], a[240:243], a[240:243], 0
    s_waitcnt vmcnt(9)
    s_sub_u32 s47, s59, 0x4000
    v_add_u32 v188, s47, v208
    ds_read_b128 a[48:51], v188 offset:0
    v_add_u32 v189, s47, v209
    ds_read_b128 a[52:55], v189 offset:0
    v_add_u32 v190, s47, v210
    ds_read_b128 a[56:59], v190 offset:0
    v_add_u32 v191, s47, v211
    ds_read_b128 a[60:63], v191 offset:0
    v_add_u32 v188, s47, v212
    ds_read_b128 a[64:67], v188 offset:0
    v_add_u32 v189, s47, v213
    ds_read_b128 a[68:71], v189 offset:0
    v_add_u32 v190, s47, v214
    ds_read_b128 a[72:75], v190 offset:0
    v_add_u32 v191, s47, v215
    ds_read_b128 a[76:79], v191 offset:0
    v_max3_f32 v244, v244, v245, v143
    v_mov_b32 v245, v244
    v_mfma_f32_32x32x16_bf16 v[96:111], a[240:243], a[240:243], 0
    buffer_load_dwordx4 v225, s[12:15], s25 offen offset:1024 lds
    s_nop 1
    v_permlane32_swap_b32 v244, v245
    v_max_f32 v244, v244, v245
    v_mul_f32 v236, s28, v244
    v_fma_f32 v232, v112, s20, v236
    v_fma_f32 v233, v113, s20, v236
    v_exp_f32 v232, v232
    v_exp_f32 v233, v233
    v_fma_f32 v234, v114, s20, v236
    v_fma_f32 v235, v115, s20, v236
    v_exp_f32 v234, v234
    v_add_f32 v238, v232, v233
    v_exp_f32 v235, v235
    v_mfma_f32_32x32x16_bf16 a[0:15], a[240:243], a[240:243], 0
    s_nop 0
    v_cvt_pk_bf16_f32 v176, v232, v233
    v_fma_f32 v232, v116, s20, v236
    v_fma_f32 v233, v117, s20, v236
    v_exp_f32 v232, v232
    v_add_f32 v238, v238, v234
    v_exp_f32 v233, v233
    v_add_f32 v238, v238, v235
    v_cvt_pk_bf16_f32 v177, v234, v235
    v_fma_f32 v234, v118, s20, v236
    v_fma_f32 v235, v119, s20, v236
    v_exp_f32 v234, v234
    v_add_f32 v238, v238, v232
    v_exp_f32 v235, v235
    s_waitcnt lgkmcnt(7)
    v_mfma_f32_32x32x16_bf16 v[144:159], a[80:83], a[48:51], 0
    buffer_load_dwordx4 v226, s[12:15], s25 offen offset:2048 lds
    v_add_f32 v238, v238, v233
    v_cvt_pk_bf16_f32 v178, v232, v233
    v_fma_f32 v232, v120, s20, v236
    v_fma_f32 v233, v121, s20, v236
    v_exp_f32 v232, v232
    s_waitcnt lgkmcnt(6)
    v_mfma_f32_32x32x16_bf16 v[144:159], a[84:87], a[52:55], v[144:159]
    v_add_f32 v238, v238, v234
    v_exp_f32 v233, v233
    v_add_f32 v238, v238, v235
    v_cvt_pk_bf16_f32 v179, v234, v235
    v_fma_f32 v234, v122, s20, v236
    v_fma_f32 v235, v123, s20, v236
    s_waitcnt lgkmcnt(5)
    v_mfma_f32_32x32x16_bf16 v[144:159], a[88:91], a[56:59], v[144:159]
    buffer_load_dwordx4 v227, s[12:15], s25 offen offset:3072 lds
    s_add_u32 s25, s25, 0x10000
    v_exp_f32 v234, v234
    v_add_f32 v238, v238, v232
    v_exp_f32 v235, v235
    s_waitcnt lgkmcnt(4)
    v_mfma_f32_32x32x16_bf16 v[144:159], a[92:95], a[60:63], v[144:159]
    v_add_f32 v238, v238, v233
    v_cvt_pk_bf16_f32 v180, v232, v233
    v_fma_f32 v232, v124, s20, v236
    v_fma_f32 v233, v125, s20, v236
    v_exp_f32 v232, v232
    v_add_f32 v238, v238, v234
    s_waitcnt lgkmcnt(3)
    v_mfma_f32_32x32x16_bf16 v[144:159], a[96:99], a[64:67], v[144:159]
    s_waitcnt vmcnt(8) lgkmcnt(0)
    s_barrier
    ds_read_b64_tr_b16 a[144:145], v216 offset:32768
    ds_read_b64_tr_b16 a[146:147], v216 offset:33280
    ds_read_b64_tr_b16 a[148:149], v217 offset:32768
    v_exp_f32 v233, v233
    v_add_f32 v238, v238, v235
    v_mfma_f32_32x32x16_bf16 v[144:159], a[100:103], a[68:71], v[144:159]
    ds_read_b64_tr_b16 a[150:151], v217 offset:33280
    ds_read_b64_tr_b16 a[152:153], v218 offset:32768
    s_mov_b32 m0, s62
    ds_read_b64_tr_b16 a[154:155], v218 offset:33280
    buffer_load_dwordx4 v220, s[8:11], s24 offen offset:0 lds
    v_cvt_pk_bf16_f32 v181, v234, v235
    v_fma_f32 v234, v126, s20, v236
    v_mfma_f32_32x32x16_bf16 v[144:159], a[104:107], a[72:75], v[144:159]
    ds_read_b64_tr_b16 a[156:157], v219 offset:32768
    ds_read_b64_tr_b16 a[158:159], v219 offset:33280
    v_fma_f32 v235, v127, s20, v236
    v_exp_f32 v234, v234
    v_add_f32 v238, v238, v232
    v_mfma_f32_32x32x16_bf16 v[144:159], a[108:111], a[76:79], v[144:159]
    ds_read_b64_tr_b16 a[160:161], v216 offset:36864
    ds_read_b64_tr_b16 a[162:163], v216 offset:37376
    ds_read_b64_tr_b16 a[164:165], v217 offset:36864
    buffer_load_dwordx4 v221, s[8:11], s24 offen offset:1024 lds
    v_exp_f32 v235, v235
    v_add_f32 v238, v238, v233
    v_cvt_pk_bf16_f32 v182, v232, v233
    v_mfma_f32_32x32x16_bf16 v[160:175], a[112:115], a[48:51], 0
    ds_read_b64_tr_b16 a[166:167], v217 offset:37376
    ds_read_b64_tr_b16 a[168:169], v218 offset:36864
    ds_read_b64_tr_b16 a[170:171], v218 offset:37376
    v_fma_f32 v232, v128, s20, v236
    v_fma_f32 v233, v129, s20, v236
    v_exp_f32 v232, v232
    v_mfma_f32_32x32x16_bf16 v[160:175], a[116:119], a[52:55], v[160:175]
    ds_read_b64_tr_b16 a[172:173], v219 offset:36864
    ds_read_b64_tr_b16 a[174:175], v219 offset:37376
    v_add_f32 v238, v238, v234
    v_exp_f32 v233, v233
    v_add_f32 v238, v238, v235
    v_cvt_pk_bf16_f32 v183, v234, v235
    v_mfma_f32_32x32x16_bf16 v[160:175], a[120:123], a[56:59], v[160:175]
    ds_read_b64_tr_b16 a[176:177], v216 offset:40960
    ds_read_b64_tr_b16 a[178:179], v216 offset:41472
    ds_read_b64_tr_b16 a[180:181], v217 offset:40960
    buffer_load_dwordx4 v222, s[8:11], s24 offen offset:2048 lds
    v_fma_f32 v234, v130, s20, v236
    v_fma_f32 v235, v131, s20, v236
    v_mfma_f32_32x32x16_bf16 v[160:175], a[124:127], a[60:63], v[160:175]
    ds_read_b64_tr_b16 a[182:183], v217 offset:41472
    ds_read_b64_tr_b16 a[184:185], v218 offset:40960
    ds_read_b64_tr_b16 a[186:187], v218 offset:41472
    v_exp_f32 v234, v234
    v_add_f32 v238, v238, v232
    v_exp_f32 v235, v235
    v_mfma_f32_32x32x16_bf16 v[160:175], a[128:131], a[64:67], v[160:175]
    ds_read_b64_tr_b16 a[188:189], v219 offset:40960
    ds_read_b64_tr_b16 a[190:191], v219 offset:41472
    v_add_f32 v238, v238, v233
    v_cvt_pk_bf16_f32 v184, v232, v233
    v_fma_f32 v232, v132, s20, v236
    v_fma_f32 v233, v133, s20, v236
    v_mfma_f32_32x32x16_bf16 v[160:175], a[132:135], a[68:71], v[160:175]
    ds_read_b64_tr_b16 a[192:193], v216 offset:45056
    ds_read_b64_tr_b16 a[194:195], v216 offset:45568
    ds_read_b64_tr_b16 a[196:197], v217 offset:45056
    buffer_load_dwordx4 v223, s[8:11], s24 offen offset:3072 lds
    s_add_u32 s24, s24, 0x10000
    v_exp_f32 v232, v232
    v_add_f32 v238, v238, v234
    v_mfma_f32_32x32x16_bf16 v[160:175], a[136:139], a[72:75], v[160:175]
    ds_read_b64_tr_b16 a[198:199], v217 offset:45568
    ds_read_b64_tr_b16 a[200:201], v218 offset:45056
    ds_read_b64_tr_b16 a[202:203], v218 offset:45568
    v_exp_f32 v233, v233
    v_add_f32 v238, v238, v235
    v_cvt_pk_bf16_f32 v185, v234, v235
    v_mfma_f32_32x32x16_bf16 v[160:175], a[140:143], a[76:79], v[160:175]
    ds_read_b64_tr_b16 a[204:205], v219 offset:45056
    ds_read_b64_tr_b16 a[206:207], v219 offset:45568
    v_fma_f32 v234, v134, s20, v236
    v_fma_f32 v235, v135, s20, v236
    v_exp_f32 v234, v234
    v_add_f32 v238, v238, v232
    v_exp_f32 v235, v235
    v_add_f32 v238, v238, v233
    v_cvt_pk_bf16_f32 v186, v232, v233
    v_fma_f32 v232, v136, s20, v236
    s_waitcnt vmcnt(8) lgkmcnt(0)
    s_barrier
    v_mfma_f32_32x32x16_bf16 v[0:15], a[144:147], v[176:179], 0
    ds_read_b128 a[80:83], v208 offset:16384
    v_fma_f32 v233, v137, s20, v236
    v_exp_f32 v232, v232
    v_add_f32 v238, v238, v234
    v_exp_f32 v233, v233
    v_add_f32 v238, v238, v235
    v_cvt_pk_bf16_f32 v187, v234, v235
    v_fma_f32 v234, v138, s20, v236
    v_mfma_f32_32x32x16_bf16 v[16:31], a[148:151], v[176:179], 0
    ds_read_b128 a[84:87], v209 offset:16384
    v_fma_f32 v235, v139, s20, v236
    v_exp_f32 v234, v234
    v_add_f32 v238, v238, v232
    v_exp_f32 v235, v235
    v_add_f32 v238, v238, v233
    v_cvt_pk_bf16_f32 v188, v232, v233
    v_mfma_f32_32x32x16_bf16 v[32:47], a[152:155], v[176:179], 0
    ds_read_b128 a[88:91], v210 offset:16384
    v_fma_f32 v232, v140, s20, v236
    v_fma_f32 v233, v141, s20, v236
    v_exp_f32 v232, v232
    v_add_f32 v238, v238, v234
    v_exp_f32 v233, v233
    v_add_f32 v238, v238, v235
    v_cvt_pk_bf16_f32 v189, v234, v235
    v_mfma_f32_32x32x16_bf16 v[48:63], a[156:159], v[176:179], 0
    ds_read_b128 a[92:95], v211 offset:16384
    v_fma_f32 v234, v142, s20, v236
    v_fma_f32 v235, v143, s20, v236
    v_exp_f32 v234, v234
    v_add_f32 v238, v238, v232
    v_exp_f32 v235, v235
    v_add_f32 v238, v238, v233
    v_cvt_pk_bf16_f32 v190, v232, v233
    v_mfma_f32_32x32x16_bf16 v[0:15], a[160:163], v[180:183], v[0:15]
    ds_read_b128 a[96:99], v212 offset:16384
    v_add_f32 v238, v238, v234
    v_add_f32 v238, v238, v235
    v_cvt_pk_bf16_f32 v191, v234, v235
    s_cmp_eq_u32 s23, 1
    s_cbranch_scc1 L_mask_6
L_maskb_7:
    v_max3_f32 v244, v144, v145, v146
    v_max3_f32 v244, v244, v147, v148
    v_max3_f32 v244, v244, v149, v150
    v_max3_f32 v244, v244, v151, v152
    v_mfma_f32_32x32x16_bf16 v[16:31], a[164:167], v[180:183], v[16:31]
    ds_read_b128 a[100:103], v213 offset:16384
    v_max3_f32 v244, v244, v153, v154
    v_max3_f32 v244, v244, v155, v156
    v_max3_f32 v244, v244, v157, v158
    v_max_f32 v244, v244, v159
    v_max3_f32 v245, v160, v161, v162
    v_max3_f32 v245, v245, v163, v164
    v_max3_f32 v245, v245, v165, v166
    v_max3_f32 v245, v245, v167, v168
    v_max3_f32 v245, v245, v169, v170
    v_mfma_f32_32x32x16_bf16 v[32:47], a[168:171], v[180:183], v[32:47]
    ds_read_b128 a[104:107], v214 offset:16384
    v_max3_f32 v245, v245, v171, v172
    v_max3_f32 v245, v245, v173, v174
    v_max3_f32 v244, v244, v245, v175
    v_mov_b32 v245, v244
    s_nop 1
    v_permlane32_swap_b32 v244, v245
    v_max_f32 v244, v244, v245
    v_mul_f32 v237, s28, v244
    v_mfma_f32_32x32x16_bf16 v[48:63], a[172:175], v[180:183], v[48:63]
    ds_read_b128 a[108:111], v215 offset:16384
    v_fma_f32 v232, v144, s20, v237
    v_fma_f32 v233, v145, s20, v237
    v_exp_f32 v232, v232
    v_exp_f32 v233, v233
    v_fma_f32 v234, v146, s20, v237
    v_fma_f32 v235, v147, s20, v237
    v_mfma_f32_32x32x16_bf16 v[0:15], a[176:179], v[184:187], v[0:15]
    ds_read_b128 a[112:115], v208 offset:24576
    v_exp_f32 v234, v234
    v_add_f32 v239, v232, v233
    v_exp_f32 v235, v235
    s_nop 0
    v_cvt_pk_bf16_f32 v192, v232, v233
    v_fma_f32 v232, v148, s20, v237
    v_fma_f32 v233, v149, s20, v237
    v_mfma_f32_32x32x16_bf16 v[16:31], a[180:183], v[184:187], v[16:31]
    ds_read_b128 a[116:119], v209 offset:24576
    v_exp_f32 v232, v232
    v_add_f32 v239, v239, v234
    v_exp_f32 v233, v233
    v_add_f32 v239, v239, v235
    v_cvt_pk_bf16_f32 v193, v234, v235
    v_fma_f32 v234, v150, s20, v237
    v_fma_f32 v235, v151, s20, v237
    v_mfma_f32_32x32x16_bf16 v[32:47], a[184:187], v[184:187], v[32:47]
    ds_read_b128 a[120:123], v210 offset:24576
    v_exp_f32 v234, v234
    v_add_f32 v239, v239, v232
    v_exp_f32 v235, v235
    v_add_f32 v239, v239, v233
    v_cvt_pk_bf16_f32 v194, v232, v233
    v_fma_f32 v232, v152, s20, v237
    v_mfma_f32_32x32x16_bf16 v[48:63], a[188:191], v[184:187], v[48:63]
    ds_read_b128 a[124:127], v211 offset:24576
    v_fma_f32 v233, v153, s20, v237
    v_exp_f32 v232, v232
    v_add_f32 v239, v239, v234
    v_exp_f32 v233, v233
    v_add_f32 v239, v239, v235
    v_cvt_pk_bf16_f32 v195, v234, v235
    v_fma_f32 v234, v154, s20, v237
    v_mfma_f32_32x32x16_bf16 v[0:15], a[192:195], v[188:191], v[0:15]
    ds_read_b128 a[128:131], v212 offset:24576
    v_fma_f32 v235, v155, s20, v237
    v_exp_f32 v234, v234
    v_add_f32 v239, v239, v232
    v_exp_f32 v235, v235
    v_add_f32 v239, v239, v233
    v_cvt_pk_bf16_f32 v196, v232, v233
    v_fma_f32 v232, v156, s20, v237
    v_mfma_f32_32x32x16_bf16 v[16:31], a[196:199], v[188:191], v[16:31]
    ds_read_b128 a[132:135], v213 offset:24576
    v_fma_f32 v233, v157, s20, v237
    v_exp_f32 v232, v232
    v_add_f32 v239, v239, v234
    v_exp_f32 v233, v233
    v_add_f32 v239, v239, v235
    v_cvt_pk_bf16_f32 v197, v234, v235
    v_fma_f32 v234, v158, s20, v237
    v_mfma_f32_32x32x16_bf16 v[32:47], a[200:203], v[188:191], v[32:47]
    ds_read_b128 a[136:139], v214 offset:24576
    v_fma_f32 v235, v159, s20, v237
    v_exp_f32 v234, v234
    v_add_f32 v239, v239, v232
    v_exp_f32 v235, v235
    v_add_f32 v239, v239, v233
    v_cvt_pk_bf16_f32 v198, v232, v233
    v_mfma_f32_32x32x16_bf16 v[48:63], a[204:207], v[188:191], v[48:63]
    ds_read_b128 a[140:143], v215 offset:24576
    v_fma_f32 v232, v160, s20, v237
    v_fma_f32 v233, v161, s20, v237
    v_exp_f32 v232, v232
    v_add_f32 v239, v239, v234
    v_exp_f32 v233, v233
    v_add_f32 v239, v239, v235
    v_cvt_pk_bf16_f32 v199, v234, v235
    s_mov_b32 s89, s50
    s_add_u32 s36, s48, s76
    s_lshl_b32 s31, s31, 1
    s_load_dwordx8 s[48:55], s[56:57], 32
    s_add_u32 s56, s56, 32
    s_addc_u32 s57, s57, 0
    s_sub_u32 s23, s23, 1
    s_cmp_eq_u32 s23, 0
    s_cbranch_scc1 L_drain_0
    s_cmp_eq_u32 s23, s92
    s_cbranch_scc1 L_trig_1
.p2align 6
L_mid1_0:
    s_waitcnt lgkmcnt(8)
    v_mfma_f32_32x32x16_bf16 v[112:127], a[80:83], a[16:19], 0
    v_fma_f32 v234, v162, s20, v237
    v_fma_f32 v235, v163, s20, v237
    v_exp_f32 v234, v234
    v_add_f32 v239, v239, v232
    v_mfma_f32_32x32x16_bf16 v[112:127], a[84:87], a[20:23], v[112:127]
    v_exp_f32 v235, v235
    v_add_f32 v239, v239, v233
    v_cvt_pk_bf16_f32 v200, v232, v233
    v_fma_f32 v232, v164, s20, v237
    v_mfma_f32_32x32x16_bf16 v[112:127], a[88:91], a[24:27], v[112:127]
    v_fma_f32 v233, v165, s20, v237
    v_exp_f32 v232, v232
    v_add_f32 v239, v239, v234
    v_add_f32 v239, v239, v235
    s_mov_b32 m0, s64
    v_mfma_f32_32x32x16_bf16 v[112:127], a[92:95], a[28:31], v[112:127]
    buffer_load_dwordx4 v224, s[12:15], s25 offen offset:0 lds
    v_exp_f32 v233, v233
    v_cvt_pk_bf16_f32 v201, v234, v235
    v_fma_f32 v234, v166, s20, v237
    v_mfma_f32_32x32x16_bf16 v[112:127], a[96:99], a[32:35], v[112:127]
    v_fma_f32 v235, v167, s20, v237
    v_exp_f32 v234, v234
    v_add_f32 v239, v239, v232
    v_add_f32 v239, v239, v233
    v_mfma_f32_32x32x16_bf16 v[112:127], a[100:103], a[36:39], v[112:127]
    v_exp_f32 v235, v235
    v_cvt_pk_bf16_f32 v202, v232, v233
    v_fma_f32 v232, v168, s20, v237
    v_fma_f32 v233, v169, s20, v237
    v_mfma_f32_32x32x16_bf16 v[112:127], a[104:107], a[40:43], v[112:127]
    buffer_load_dwordx4 v225, s[12:15], s25 offen offset:1024 lds
    v_exp_f32 v232, v232
    v_add_f32 v239, v239, v234
    v_exp_f32 v233, v233
    v_mfma_f32_32x32x16_bf16 v[112:127], a[108:111], a[44:47], v[112:127]
    v_add_f32 v239, v239, v235
    v_cvt_pk_bf16_f32 v203, v234, v235
    v_fma_f32 v234, v170, s20, v237
    v_fma_f32 v235, v171, s20, v237
    v_add_f32 v239, v239, v232
    s_waitcnt lgkmcnt(0)
    v_mfma_f32_32x32x16_bf16 v[128:143], a[112:115], a[16:19], 0
    v_exp_f32 v234, v234
    v_exp_f32 v235, v235
    v_add_f32 v239, v239, v233
    v_mfma_f32_32x32x16_bf16 v[128:143], a[116:119], a[20:23], v[128:143]
    buffer_load_dwordx4 v226, s[12:15], s25 offen offset:2048 lds
    v_cvt_pk_bf16_f32 v204, v232, v233
    v_fma_f32 v232, v172, s20, v237
    v_fma_f32 v233, v173, s20, v237
    v_add_f32 v239, v239, v234
    v_mfma_f32_32x32x16_bf16 v[128:143], a[120:123], a[24:27], v[128:143]
    v_exp_f32 v232, v232
    v_exp_f32 v233, v233
    v_add_f32 v239, v239, v235
    v_mfma_f32_32x32x16_bf16 v[128:143], a[124:127], a[28:31], v[128:143]
    v_cvt_pk_bf16_f32 v205, v234, v235
    v_fma_f32 v234, v174, s20, v237
    v_fma_f32 v235, v175, s20, v237
    v_exp_f32 v234, v234
    v_mfma_f32_32x32x16_bf16 v[128:143], a[128:131], a[32:35], v[128:143]
    v_add_f32 v239, v239, v232
    v_exp_f32 v235, v235
    v_add_f32 v239, v239, v233
    v_cvt_pk_bf16_f32 v206, v232, v233
    v_mfma_f32_32x32x16_bf16 v[128:143], a[132:135], a[36:39], v[128:143]
    buffer_load_dwordx4 v227, s[12:15], s25 offen offset:3072 lds
    s_add_u32 s25, s25, 0x10000
    v_add_f32 v239, v239, v234
    v_add_f32 v239, v239, v235
    v_cvt_pk_bf16_f32 v207, v234, v235
    v_fma_f32 v232, v112, s20, v236
    v_fma_f32 v233, v113, s20, v236
    v_mfma_f32_32x32x16_bf16 v[128:143], a[136:139], a[40:43], v[128:143]
    v_exp_f32 v232, v232
    v_exp_f32 v233, v233
    v_fma_f32 v234, v114, s20, v236
    v_mfma_f32_32x32x16_bf16 v[128:143], a[140:143], a[44:47], v[128:143]
    s_waitcnt vmcnt(5) lgkmcnt(0)
    s_barrier
    v_mfma_f32_32x32x16_bf16 v[64:79], a[144:147], v[192:195], v[64:79]
    v_fma_f32 v235, v115, s20, v236
    v_exp_f32 v234, v234
    v_add_f32 v238, v238, v232
    v_add_f32 v238, v238, v233
    v_mfma_f32_32x32x16_bf16 v[80:95], a[148:151], v[192:195], v[80:95]
    ds_read_b64_tr_b16 a[144:145], v216 offset:49152
    ds_read_b64_tr_b16 a[146:147], v216 offset:49664
    v_exp_f32 v235, v235
    v_cvt_pk_bf16_f32 v176, v232, v233
    v_fma_f32 v232, v116, s20, v236
    v_fma_f32 v233, v117, s20, v236
    v_mfma_f32_32x32x16_bf16 v[96:111], a[152:155], v[192:195], v[96:111]
    ds_read_b64_tr_b16 a[148:149], v217 offset:49152
    v_exp_f32 v232, v232
    v_add_f32 v238, v238, v234
    v_exp_f32 v233, v233
    v_mfma_f32_32x32x16_bf16 a[0:15], a[156:159], v[192:195], a[0:15]
    ds_read_b64_tr_b16 a[150:151], v217 offset:49664
    v_add_f32 v238, v238, v235
    v_cvt_pk_bf16_f32 v177, v234, v235
    v_fma_f32 v234, v118, s20, v236
    v_fma_f32 v235, v119, s20, v236
    v_add_f32 v238, v238, v232
    v_mfma_f32_32x32x16_bf16 v[64:79], a[160:163], v[196:199], v[64:79]
    ds_read_b64_tr_b16 a[152:153], v218 offset:49152
    v_exp_f32 v234, v234
    v_exp_f32 v235, v235
    v_add_f32 v238, v238, v233
    v_mfma_f32_32x32x16_bf16 v[80:95], a[164:167], v[196:199], v[80:95]
    ds_read_b64_tr_b16 a[154:155], v218 offset:49664
    v_cvt_pk_bf16_f32 v178, v232, v233
    v_fma_f32 v232, v120, s20, v236
    v_fma_f32 v233, v121, s20, v236
    v_add_f32 v238, v238, v234
    v_mfma_f32_32x32x16_bf16 v[96:111], a[168:171], v[196:199], v[96:111]
    ds_read_b64_tr_b16 a[156:157], v219 offset:49152
    v_exp_f32 v232, v232
    v_exp_f32 v233, v233
    v_add_f32 v238, v238, v235
    v_mfma_f32_32x32x16_bf16 a[0:15], a[172:175], v[196:199], a[0:15]
    ds_read_b64_tr_b16 a[158:159], v219 offset:49664
    v_cvt_pk_bf16_f32 v179, v234, v235
    v_fma_f32 v234, v122, s20, v236
    v_fma_f32 v235, v123, s20, v236
    v_exp_f32 v234, v234
    v_mfma_f32_32x32x16_bf16 v[64:79], a[176:179], v[200:203], v[64:79]
    ds_read_b64_tr_b16 a[160:161], v216 offset:53248
    ds_read_b64_tr_b16 a[162:163], v216 offset:53760
    v_add_f32 v238, v238, v232
    v_exp_f32 v235, v235
    v_add_f32 v238, v238, v233
    v_cvt_pk_bf16_f32 v180, v232, v233
    s_mov_b32 m0, s63
    v_mfma_f32_32x32x16_bf16 v[80:95], a[180:183], v[200:203], v[80:95]
    buffer_load_dwordx4 v220, s[8:11], s24 offen offset:0 lds
    ds_read_b64_tr_b16 a[164:165], v217 offset:53248
    v_fma_f32 v232, v124, s20, v236
    v_fma_f32 v233, v125, s20, v236
    v_exp_f32 v232, v232
    v_add_f32 v238, v238, v234
    v_mfma_f32_32x32x16_bf16 v[96:111], a[184:187], v[200:203], v[96:111]
    ds_read_b64_tr_b16 a[166:167], v217 offset:53760
    v_exp_f32 v233, v233
    v_add_f32 v238, v238, v235
    v_cvt_pk_bf16_f32 v181, v234, v235
    v_fma_f32 v234, v126, s20, v236
    v_mfma_f32_32x32x16_bf16 a[0:15], a[188:191], v[200:203], a[0:15]
    ds_read_b64_tr_b16 a[168:169], v218 offset:53248
    v_fma_f32 v235, v127, s20, v236
    v_exp_f32 v234, v234
    v_add_f32 v238, v238, v232
    v_mfma_f32_32x32x16_bf16 v[64:79], a[192:195], v[204:207], v[64:79]
    ds_read_b64_tr_b16 a[170:171], v218 offset:53760
    v_exp_f32 v235, v235
    v_add_f32 v238, v238, v233
    v_cvt_pk_bf16_f32 v182, v232, v233
    v_fma_f32 v232, v128, s20, v236
    v_mfma_f32_32x32x16_bf16 v[80:95], a[196:199], v[204:207], v[80:95]
    ds_read_b64_tr_b16 a[172:173], v219 offset:53248
    v_fma_f32 v233, v129, s20, v236
    v_exp_f32 v232, v232
    v_add_f32 v238, v238, v234
    v_add_f32 v238, v238, v235
    v_mfma_f32_32x32x16_bf16 v[96:111], a[200:203], v[204:207], v[96:111]
    ds_read_b64_tr_b16 a[174:175], v219 offset:53760
    v_exp_f32 v233, v233
    v_cvt_pk_bf16_f32 v183, v234, v235
    v_fma_f32 v234, v130, s20, v236
    v_fma_f32 v235, v131, s20, v236
    v_mfma_f32_32x32x16_bf16 a[0:15], a[204:207], v[204:207], a[0:15]
    ds_read_b64_tr_b16 a[176:177], v216 offset:57344
    ds_read_b64_tr_b16 a[178:179], v216 offset:57856
    v_exp_f32 v234, v234
    v_add_f32 v238, v238, v232
    v_exp_f32 v235, v235
    v_mfma_f32_32x32x16_bf16 v[144:159], a[80:83], a[48:51], 0
    ds_read_b64_tr_b16 a[180:181], v217 offset:57344
    v_add_f32 v238, v238, v233
    v_cvt_pk_bf16_f32 v184, v232, v233
    v_fma_f32 v232, v132, s20, v236
    v_fma_f32 v233, v133, s20, v236
    v_add_f32 v238, v238, v234
    v_mfma_f32_32x32x16_bf16 v[144:159], a[84:87], a[52:55], v[144:159]
    ds_read_b64_tr_b16 a[182:183], v217 offset:57856
    v_exp_f32 v232, v232
    v_exp_f32 v233, v233
    v_mfma_f32_32x32x16_bf16 v[144:159], a[88:91], a[56:59], v[144:159]
    ds_read_b64_tr_b16 a[184:185], v218 offset:57344
    v_add_f32 v238, v238, v235
    v_cvt_pk_bf16_f32 v185, v234, v235
    v_fma_f32 v234, v134, s20, v236
    v_fma_f32 v235, v135, s20, v236
    v_add_f32 v238, v238, v232
    v_mfma_f32_32x32x16_bf16 v[144:159], a[92:95], a[60:63], v[144:159]
    ds_read_b64_tr_b16 a[186:187], v218 offset:57856
    v_exp_f32 v234, v234
    v_exp_f32 v235, v235
    v_add_f32 v238, v238, v233
    v_mfma_f32_32x32x16_bf16 v[144:159], a[96:99], a[64:67], v[144:159]
    buffer_load_dwordx4 v221, s[8:11], s24 offen offset:1024 lds
    ds_read_b64_tr_b16 a[188:189], v219 offset:57344
    v_cvt_pk_bf16_f32 v186, v232, v233
    v_fma_f32 v232, v136, s20, v236
    v_fma_f32 v233, v137, s20, v236
    v_exp_f32 v232, v232
    v_mfma_f32_32x32x16_bf16 v[144:159], a[100:103], a[68:71], v[144:159]
    ds_read_b64_tr_b16 a[190:191], v219 offset:57856
    v_add_f32 v238, v238, v234
    v_exp_f32 v233, v233
    v_add_f32 v238, v238, v235
    v_cvt_pk_bf16_f32 v187, v234, v235
    v_mfma_f32_32x32x16_bf16 v[144:159], a[104:107], a[72:75], v[144:159]
    ds_read_b64_tr_b16 a[192:193], v216 offset:61440
    ds_read_b64_tr_b16 a[194:195], v216 offset:61952
    v_fma_f32 v234, v138, s20, v236
    v_fma_f32 v235, v139, s20, v236
    v_exp_f32 v234, v234
    v_add_f32 v238, v238, v232
    v_mfma_f32_32x32x16_bf16 v[144:159], a[108:111], a[76:79], v[144:159]
    ds_read_b64_tr_b16 a[196:197], v217 offset:61440
    v_exp_f32 v235, v235
    v_add_f32 v238, v238, v233
    v_cvt_pk_bf16_f32 v188, v232, v233
    v_mfma_f32_32x32x16_bf16 v[160:175], a[112:115], a[48:51], 0
    ds_read_b64_tr_b16 a[198:199], v217 offset:61952
    v_fma_f32 v232, v140, s20, v236
    v_fma_f32 v233, v141, s20, v236
    v_exp_f32 v232, v232
    v_add_f32 v238, v238, v234
    v_mfma_f32_32x32x16_bf16 v[160:175], a[116:119], a[52:55], v[160:175]
    ds_read_b64_tr_b16 a[200:201], v218 offset:61440
    v_exp_f32 v233, v233
    v_add_f32 v238, v238, v235
    v_cvt_pk_bf16_f32 v189, v234, v235
    v_fma_f32 v234, v142, s20, v236
    v_mfma_f32_32x32x16_bf16 v[160:175], a[120:123], a[56:59], v[160:175]
    ds_read_b64_tr_b16 a[202:203], v218 offset:61952
    v_fma_f32 v235, v143, s20, v236
    v_exp_f32 v234, v234
    v_add_f32 v238, v238, v232
    v_add_f32 v238, v238, v233
    v_mfma_f32_32x32x16_bf16 v[160:175], a[124:127], a[60:63], v[160:175]
    ds_read_b64_tr_b16 a[204:205], v219 offset:61440
    v_exp_f32 v235, v235
    v_cvt_pk_bf16_f32 v190, v232, v233
    v_add_f32 v238, v238, v234
    v_add_f32 v238, v238, v235
    v_mfma_f32_32x32x16_bf16 v[160:175], a[128:131], a[64:67], v[160:175]
    ds_read_b64_tr_b16 a[206:207], v219 offset:61952
    v_cvt_pk_bf16_f32 v191, v234, v235
    v_mfma_f32_32x32x16_bf16 v[160:175], a[132:135], a[68:71], v[160:175]
    v_fma_f32 v232, v144, s20, v237
    v_fma_f32 v233, v145, s20, v237
    v_exp_f32 v232, v232
    v_mfma_f32_32x32x16_bf16 v[160:175], a[136:139], a[72:75], v[160:175]
    buffer_load_dwordx4 v222, s[8:11], s24 offen offset:2048 lds
    v_exp_f32 v233, v233
    v_fma_f32 v234, v146, s20, v237
    v_fma_f32 v235, v147, s20, v237
    v_add_f32 v239, v239, v232
    v_mfma_f32_32x32x16_bf16 v[160:175], a[140:143], a[76:79], v[160:175]
    s_waitcnt vmcnt(7) lgkmcnt(0)
    s_barrier
    v_mfma_f32_32x32x16_bf16 v[0:15], a[144:147], v[176:179], v[0:15]
    ds_read_b128 a[80:83], v208 offset:0
    v_exp_f32 v234, v234
    v_exp_f32 v235, v235
    v_add_f32 v239, v239, v233
    v_mfma_f32_32x32x16_bf16 v[16:31], a[148:151], v[176:179], v[16:31]
    ds_read_b128 a[84:87], v209 offset:0
    v_cvt_pk_bf16_f32 v192, v232, v233
    v_fma_f32 v232, v148, s20, v237
    v_fma_f32 v233, v149, s20, v237
    v_exp_f32 v232, v232
    v_mfma_f32_32x32x16_bf16 v[32:47], a[152:155], v[176:179], v[32:47]
    ds_read_b128 a[88:91], v210 offset:0
    v_add_f32 v239, v239, v234
    v_exp_f32 v233, v233
    v_add_f32 v239, v239, v235
    v_cvt_pk_bf16_f32 v193, v234, v235
    v_mfma_f32_32x32x16_bf16 v[48:63], a[156:159], v[176:179], v[48:63]
    ds_read_b128 a[92:95], v211 offset:0
    v_fma_f32 v234, v150, s20, v237
    v_fma_f32 v235, v151, s20, v237
    v_exp_f32 v234, v234
    v_mfma_f32_32x32x16_bf16 v[0:15], a[160:163], v[180:183], v[0:15]
    ds_read_b128 a[96:99], v212 offset:0
    v_add_f32 v239, v239, v232
    v_exp_f32 v235, v235
    v_add_f32 v239, v239, v233
    v_cvt_pk_bf16_f32 v194, v232, v233
    v_mfma_f32_32x32x16_bf16 v[16:31], a[164:167], v[180:183], v[16:31]
    ds_read_b128 a[100:103], v213 offset:0
    v_fma_f32 v232, v152, s20, v237
    v_fma_f32 v233, v153, s20, v237
    v_exp_f32 v232, v232
    v_add_f32 v239, v239, v234
    v_mfma_f32_32x32x16_bf16 v[32:47], a[168:171], v[180:183], v[32:47]
    ds_read_b128 a[104:107], v214 offset:0
    v_exp_f32 v233, v233
    v_add_f32 v239, v239, v235
    v_cvt_pk_bf16_f32 v195, v234, v235
    v_fma_f32 v234, v154, s20, v237
    v_mfma_f32_32x32x16_bf16 v[48:63], a[172:175], v[180:183], v[48:63]
    ds_read_b128 a[108:111], v215 offset:0
    v_fma_f32 v235, v155, s20, v237
    v_exp_f32 v234, v234
    v_add_f32 v239, v239, v232
    v_add_f32 v239, v239, v233
    v_mfma_f32_32x32x16_bf16 v[0:15], a[176:179], v[184:187], v[0:15]
    ds_read_b128 a[112:115], v208 offset:8192
    v_exp_f32 v235, v235
    v_cvt_pk_bf16_f32 v196, v232, v233
    v_fma_f32 v232, v156, s20, v237
    v_fma_f32 v233, v157, s20, v237
    v_mfma_f32_32x32x16_bf16 v[16:31], a[180:183], v[184:187], v[16:31]
    ds_read_b128 a[116:119], v209 offset:8192
    buffer_load_dwordx4 v223, s[8:11], s24 offen offset:3072 lds
    s_add_u32 s24, s24, 0x10000
    v_exp_f32 v232, v232
    v_add_f32 v239, v239, v234
    v_add_f32 v239, v239, v235
    v_mfma_f32_32x32x16_bf16 v[32:47], a[184:187], v[184:187], v[32:47]
    ds_read_b128 a[120:123], v210 offset:8192
    v_exp_f32 v233, v233
    v_cvt_pk_bf16_f32 v197, v234, v235
    v_fma_f32 v234, v158, s20, v237
    v_fma_f32 v235, v159, s20, v237
    v_mfma_f32_32x32x16_bf16 v[48:63], a[188:191], v[184:187], v[48:63]
    ds_read_b128 a[124:127], v211 offset:8192
    v_exp_f32 v234, v234
    v_add_f32 v239, v239, v232
    v_exp_f32 v235, v235
    v_mfma_f32_32x32x16_bf16 v[0:15], a[192:195], v[188:191], v[0:15]
    ds_read_b128 a[128:131], v212 offset:8192
    v_add_f32 v239, v239, v233
    v_cvt_pk_bf16_f32 v198, v232, v233
    v_fma_f32 v232, v160, s20, v237
    v_fma_f32 v233, v161, s20, v237
    v_add_f32 v239, v239, v234
    v_mfma_f32_32x32x16_bf16 v[16:31], a[196:199], v[188:191], v[16:31]
    ds_read_b128 a[132:135], v213 offset:8192
    v_exp_f32 v232, v232
    v_exp_f32 v233, v233
    v_add_f32 v239, v239, v235
    v_mfma_f32_32x32x16_bf16 v[32:47], a[200:203], v[188:191], v[32:47]
    ds_read_b128 a[136:139], v214 offset:8192
    v_cvt_pk_bf16_f32 v199, v234, v235
    v_mfma_f32_32x32x16_bf16 v[48:63], a[204:207], v[188:191], v[48:63]
    ds_read_b128 a[140:143], v215 offset:8192
    s_sub_u32 s23, s23, 1
    s_cmp_eq_u32 s23, s92
    s_cbranch_scc1 L_trig_0
L_mid0_0:
    s_waitcnt lgkmcnt(8)
    v_mfma_f32_32x32x16_bf16 v[112:127], a[80:83], a[16:19], 0
    v_fma_f32 v234, v162, s20, v237
    v_fma_f32 v235, v163, s20, v237
    v_exp_f32 v234, v234
    v_add_f32 v239, v239, v232
    v_mfma_f32_32x32x16_bf16 v[112:127], a[84:87], a[20:23], v[112:127]
    v_exp_f32 v235, v235
    v_add_f32 v239, v239, v233
    v_cvt_pk_bf16_f32 v200, v232, v233
    v_fma_f32 v232, v164, s20, v237
    v_mfma_f32_32x32x16_bf16 v[112:127], a[88:91], a[24:27], v[112:127]
    v_fma_f32 v233, v165, s20, v237
    v_exp_f32 v232, v232
    v_add_f32 v239, v239, v234
    v_add_f32 v239, v239, v235
    s_mov_b32 m0, s65
    v_mfma_f32_32x32x16_bf16 v[112:127], a[92:95], a[28:31], v[112:127]
    buffer_load_dwordx4 v224, s[12:15], s25 offen offset:0 lds
    v_exp_f32 v233, v233
    v_cvt_pk_bf16_f32 v201, v234, v235
    v_fma_f32 v234, v166, s20, v237
    v_mfma_f32_32x32x16_bf16 v[112:127], a[96:99], a[32:35], v[112:127]
    v_fma_f32 v235, v167, s20, v237
    v_exp_f32 v234, v234
    v_add_f32 v239, v239, v232
    v_add_f32 v239, v239, v233
    v_mfma_f32_32x32x16_bf16 v[112:127], a[100:103], a[36:39], v[112:127]
    v_exp_f32 v235, v235
    v_cvt_pk_bf16_f32 v202, v232, v233
    v_fma_f32 v232, v168, s20, v237
    v_fma_f32 v233, v169, s20, v237
    v_mfma_f32_32x32x16_bf16 v[112:127], a[104:107], a[40:43], v[112:127]
    buffer_load_dwordx4 v225, s[12:15], s25 offen offset:1024 lds
    v_exp_f32 v232, v232
    v_add_f32 v239, v239, v234
    v_exp_f32 v233, v233
    v_mfma_f32_32x32x16_bf16 v[112:127], a[108:111], a[44:47], v[112:127]
    v_add_f32 v239, v239, v235
    v_cvt_pk_bf16_f32 v203, v234, v235
    v_fma_f32 v234, v170, s20, v237
    v_fma_f32 v235, v171, s20, v237
    v_add_f32 v239, v239, v232
    s_waitcnt lgkmcnt(0)
    v_mfma_f32_32x32x16_bf16 v[128:143], a[112:115], a[16:19], 0
    v_exp_f32 v234, v234
    v_exp_f32 v235, v235
    v_add_f32 v239, v239, v233
    v_mfma_f32_32x32x16_bf16 v[128:143], a[116:119], a[20:23], v[128:143]
    buffer_load_dwordx4 v226, s[12:15], s25 offen offset:2048 lds
    v_cvt_pk_bf16_f32 v204, v232, v233
    v_fma_f32 v232, v172, s20, v237
    v_fma_f32 v233, v173, s20, v237
    v_add_f32 v239, v239, v234
    v_mfma_f32_32x32x16_bf16 v[128:143], a[120:123], a[24:27], v[128:143]
    v_exp_f32 v232, v232
    v_exp_f32 v233, v233
    v_add_f32 v239, v239, v235
    v_mfma_f32_32x32x16_bf16 v[128:143], a[124:127], a[28:31], v[128:143]
    v_cvt_pk_bf16_f32 v205, v234, v235
    v_fma_f32 v234, v174, s20, v237
    v_fma_f32 v235, v175, s20, v237
    v_exp_f32 v234, v234
    v_mfma_f32_32x32x16_bf16 v[128:143], a[128:131], a[32:35], v[128:143]
    v_add_f32 v239, v239, v232
    v_exp_f32 v235, v235
    v_add_f32 v239, v239, v233
    v_cvt_pk_bf16_f32 v206, v232, v233
    v_mfma_f32_32x32x16_bf16 v[128:143], a[132:135], a[36:39], v[128:143]
    buffer_load_dwordx4 v227, s[12:15], s25 offen offset:3072 lds
    s_add_u32 s25, s25, 0x10000
    v_add_f32 v239, v239, v234
    v_add_f32 v239, v239, v235
    v_cvt_pk_bf16_f32 v207, v234, v235
    v_fma_f32 v232, v112, s20, v236
    v_fma_f32 v233, v113, s20, v236
    v_mfma_f32_32x32x16_bf16 v[128:143], a[136:139], a[40:43], v[128:143]
    v_exp_f32 v232, v232
    v_exp_f32 v233, v233
    v_fma_f32 v234, v114, s20, v236
    v_mfma_f32_32x32x16_bf16 v[128:143], a[140:143], a[44:47], v[128:143]
    s_waitcnt vmcnt(8) lgkmcnt(0)
    s_barrier
    v_mfma_f32_32x32x16_bf16 v[64:79], a[144:147], v[192:195], v[64:79]
    v_fma_f32 v235, v115, s20, v236
    v_exp_f32 v234, v234
    v_add_f32 v238, v238, v232
    v_add_f32 v238, v238, v233
    v_mfma_f32_32x32x16_bf16 v[80:95], a[148:151], v[192:195], v[80:95]
    ds_read_b64_tr_b16 a[144:145], v216 offset:32768
    ds_read_b64_tr_b16 a[146:147], v216 offset:33280
    v_exp_f32 v235, v235
    v_cvt_pk_bf16_f32 v176, v232, v233
    v_fma_f32 v232, v116, s20, v236
    v_fma_f32 v233, v117, s20, v236
    v_mfma_f32_32x32x16_bf16 v[96:111], a[152:155], v[192:195], v[96:111]
    ds_read_b64_tr_b16 a[148:149], v217 offset:32768
    v_exp_f32 v232, v232
    v_add_f32 v238, v238, v234
    v_exp_f32 v233, v233
    v_mfma_f32_32x32x16_bf16 a[0:15], a[156:159], v[192:195], a[0:15]
    ds_read_b64_tr_b16 a[150:151], v217 offset:33280
    v_add_f32 v238, v238, v235
    v_cvt_pk_bf16_f32 v177, v234, v235
    v_fma_f32 v234, v118, s20, v236
    v_fma_f32 v235, v119, s20, v236
    v_add_f32 v238, v238, v232
    v_mfma_f32_32x32x16_bf16 v[64:79], a[160:163], v[196:199], v[64:79]
    ds_read_b64_tr_b16 a[152:153], v218 offset:32768
    v_exp_f32 v234, v234
    v_exp_f32 v235, v235
    v_add_f32 v238, v238, v233
    v_mfma_f32_32x32x16_bf16 v[80:95], a[164:167], v[196:199], v[80:95]
    ds_read_b64_tr_b16 a[154:155], v218 offset:33280
    v_cvt_pk_bf16_f32 v178, v232, v233
    v_fma_f32 v232, v120, s20, v236
    v_fma_f32 v233, v121, s20, v236
    v_add_f32 v238, v238, v234
    v_mfma_f32_32x32x16_bf16 v[96:111], a[168:171], v[196:199], v[96:111]
    ds_read_b64_tr_b16 a[156:157], v219 offset:32768
    v_exp_f32 v232, v232
    v_exp_f32 v233, v233
    v_add_f32 v238, v238, v235
    v_mfma_f32_32x32x16_bf16 a[0:15], a[172:175], v[196:199], a[0:15]
    ds_read_b64_tr_b16 a[158:159], v219 offset:33280
    v_cvt_pk_bf16_f32 v179, v234, v235
    v_fma_f32 v234, v122, s20, v236
    v_fma_f32 v235, v123, s20, v236
    v_exp_f32 v234, v234
    v_mfma_f32_32x32x16_bf16 v[64:79], a[176:179], v[200:203], v[64:79]
    ds_read_b64_tr_b16 a[160:161], v216 offset:36864
    ds_read_b64_tr_b16 a[162:163], v216 offset:37376
    v_add_f32 v238, v238, v232
    v_exp_f32 v235, v235
    v_add_f32 v238, v238, v233
    v_cvt_pk_bf16_f32 v180, v232, v233
    s_mov_b32 m0, s62
    v_mfma_f32_32x32x16_bf16 v[80:95], a[180:183], v[200:203], v[80:95]
    buffer_load_dwordx4 v220, s[8:11], s24 offen offset:0 lds
    ds_read_b64_tr_b16 a[164:165], v217 offset:36864
    v_fma_f32 v232, v124, s20, v236
    v_fma_f32 v233, v125, s20, v236
    v_exp_f32 v232, v232
    v_add_f32 v238, v238, v234
    v_mfma_f32_32x32x16_bf16 v[96:111], a[184:187], v[200:203], v[96:111]
    ds_read_b64_tr_b16 a[166:167], v217 offset:37376
    v_exp_f32 v233, v233
    v_add_f32 v238, v238, v235
    v_cvt_pk_bf16_f32 v181, v234, v235
    v_fma_f32 v234, v126, s20, v236
    v_mfma_f32_32x32x16_bf16 a[0:15], a[188:191], v[200:203], a[0:15]
    ds_read_b64_tr_b16 a[168:169], v218 offset:36864
    v_fma_f32 v235, v127, s20, v236
    v_exp_f32 v234, v234
    v_add_f32 v238, v238, v232
    v_mfma_f32_32x32x16_bf16 v[64:79], a[192:195], v[204:207], v[64:79]
    ds_read_b64_tr_b16 a[170:171], v218 offset:37376
    v_exp_f32 v235, v235
    v_add_f32 v238, v238, v233
    v_cvt_pk_bf16_f32 v182, v232, v233
    v_fma_f32 v232, v128, s20, v236
    v_mfma_f32_32x32x16_bf16 v[80:95], a[196:199], v[204:207], v[80:95]
    ds_read_b64_tr_b16 a[172:173], v219 offset:36864
    v_fma_f32 v233, v129, s20, v236
    v_exp_f32 v232, v232
    v_add_f32 v238, v238, v234
    v_add_f32 v238, v238, v235
    v_mfma_f32_32x32x16_bf16 v[96:111], a[200:203], v[204:207], v[96:111]
    ds_read_b64_tr_b16 a[174:175], v219 offset:37376
    v_exp_f32 v233, v233
    v_cvt_pk_bf16_f32 v183, v234, v235
    v_fma_f32 v234, v130, s20, v236
    v_fma_f32 v235, v131, s20, v236
    v_mfma_f32_32x32x16_bf16 a[0:15], a[204:207], v[204:207], a[0:15]
    ds_read_b64_tr_b16 a[176:177], v216 offset:40960
    ds_read_b64_tr_b16 a[178:179], v216 offset:41472
    v_exp_f32 v234, v234
    v_add_f32 v238, v238, v232
    v_exp_f32 v235, v235
    v_mfma_f32_32x32x16_bf16 v[144:159], a[80:83], a[48:51], 0
    ds_read_b64_tr_b16 a[180:181], v217 offset:40960
    v_add_f32 v238, v238, v233
    v_cvt_pk_bf16_f32 v184, v232, v233
    v_fma_f32 v232, v132, s20, v236
    v_fma_f32 v233, v133, s20, v236
    v_add_f32 v238, v238, v234
    v_mfma_f32_32x32x16_bf16 v[144:159], a[84:87], a[52:55], v[144:159]
    ds_read_b64_tr_b16 a[182:183], v217 offset:41472
    v_exp_f32 v232, v232
    v_exp_f32 v233, v233
    v_mfma_f32_32x32x16_bf16 v[144:159], a[88:91], a[56:59], v[144:159]
    ds_read_b64_tr_b16 a[184:185], v218 offset:40960
    v_add_f32 v238, v238, v235
    v_cvt_pk_bf16_f32 v185, v234, v235
    v_fma_f32 v234, v134, s20, v236
    v_fma_f32 v235, v135, s20, v236
    v_add_f32 v238, v238, v232
    v_mfma_f32_32x32x16_bf16 v[144:159], a[92:95], a[60:63], v[144:159]
    ds_read_b64_tr_b16 a[186:187], v218 offset:41472
    v_exp_f32 v234, v234
    v_exp_f32 v235, v235
    v_add_f32 v238, v238, v233
    v_mfma_f32_32x32x16_bf16 v[144:159], a[96:99], a[64:67], v[144:159]
    buffer_load_dwordx4 v221, s[8:11], s24 offen offset:1024 lds
    ds_read_b64_tr_b16 a[188:189], v219 offset:40960
    v_cvt_pk_bf16_f32 v186, v232, v233
    v_fma_f32 v232, v136, s20, v236
    v_fma_f32 v233, v137, s20, v236
    v_exp_f32 v232, v232
    v_mfma_f32_32x32x16_bf16 v[144:159], a[100:103], a[68:71], v[144:159]
    ds_read_b64_tr_b16 a[190:191], v219 offset:41472
    v_add_f32 v238, v238, v234
    v_exp_f32 v233, v233
    v_add_f32 v238, v238, v235
    v_cvt_pk_bf16_f32 v187, v234, v235
    v_mfma_f32_32x32x16_bf16 v[144:159], a[104:107], a[72:75], v[144:159]
    ds_read_b64_tr_b16 a[192:193], v216 offset:45056
    ds_read_b64_tr_b16 a[194:195], v216 offset:45568
    v_fma_f32 v234, v138, s20, v236
    v_fma_f32 v235, v139, s20, v236
    v_exp_f32 v234, v234
    v_add_f32 v238, v238, v232
    v_mfma_f32_32x32x16_bf16 v[144:159], a[108:111], a[76:79], v[144:159]
    ds_read_b64_tr_b16 a[196:197], v217 offset:45056
    v_exp_f32 v235, v235
    v_add_f32 v238, v238, v233
    v_cvt_pk_bf16_f32 v188, v232, v233
    v_mfma_f32_32x32x16_bf16 v[160:175], a[112:115], a[48:51], 0
    ds_read_b64_tr_b16 a[198:199], v217 offset:45568
    v_fma_f32 v232, v140, s20, v236
    v_fma_f32 v233, v141, s20, v236
    v_exp_f32 v232, v232
    v_add_f32 v238, v238, v234
    v_mfma_f32_32x32x16_bf16 v[160:175], a[116:119], a[52:55], v[160:175]
    ds_read_b64_tr_b16 a[200:201], v218 offset:45056
    v_exp_f32 v233, v233
    v_add_f32 v238, v238, v235
    v_cvt_pk_bf16_f32 v189, v234, v235
    v_fma_f32 v234, v142, s20, v236
    v_mfma_f32_32x32x16_bf16 v[160:175], a[120:123], a[56:59], v[160:175]
    ds_read_b64_tr_b16 a[202:203], v218 offset:45568
    v_fma_f32 v235, v143, s20, v236
    v_exp_f32 v234, v234
    v_add_f32 v238, v238, v232
    v_add_f32 v238, v238, v233
    v_mfma_f32_32x32x16_bf16 v[160:175], a[124:127], a[60:63], v[160:175]
    ds_read_b64_tr_b16 a[204:205], v219 offset:45056
    v_exp_f32 v235, v235
    v_cvt_pk_bf16_f32 v190, v232, v233
    v_add_f32 v238, v238, v234
    v_add_f32 v238, v238, v235
    v_mfma_f32_32x32x16_bf16 v[160:175], a[128:131], a[64:67], v[160:175]
    ds_read_b64_tr_b16 a[206:207], v219 offset:45568
    v_cvt_pk_bf16_f32 v191, v234, v235
    v_mfma_f32_32x32x16_bf16 v[160:175], a[132:135], a[68:71], v[160:175]
    v_fma_f32 v232, v144, s20, v237
    v_fma_f32 v233, v145, s20, v237
    v_exp_f32 v232, v232
    v_mfma_f32_32x32x16_bf16 v[160:175], a[136:139], a[72:75], v[160:175]
    buffer_load_dwordx4 v222, s[8:11], s24 offen offset:2048 lds
    v_exp_f32 v233, v233
    v_fma_f32 v234, v146, s20, v237
    v_fma_f32 v235, v147, s20, v237
    v_add_f32 v239, v239, v232
    v_mfma_f32_32x32x16_bf16 v[160:175], a[140:143], a[76:79], v[160:175]
    s_waitcnt vmcnt(7) lgkmcnt(0)
    s_barrier
    v_mfma_f32_32x32x16_bf16 v[0:15], a[144:147], v[176:179], v[0:15]
    ds_read_b128 a[80:83], v208 offset:16384
    v_exp_f32 v234, v234
    v_exp_f32 v235, v235
    v_add_f32 v239, v239, v233
    v_mfma_f32_32x32x16_bf16 v[16:31], a[148:151], v[176:179], v[16:31]
    ds_read_b128 a[84:87], v209 offset:16384
    v_cvt_pk_bf16_f32 v192, v232, v233
    v_fma_f32 v232, v148, s20, v237
    v_fma_f32 v233, v149, s20, v237
    v_exp_f32 v232, v232
    v_mfma_f32_32x32x16_bf16 v[32:47], a[152:155], v[176:179], v[32:47]
    ds_read_b128 a[88:91], v210 offset:16384
    v_add_f32 v239, v239, v234
    v_exp_f32 v233, v233
    v_add_f32 v239, v239, v235
    v_cvt_pk_bf16_f32 v193, v234, v235
    v_mfma_f32_32x32x16_bf16 v[48:63], a[156:159], v[176:179], v[48:63]
    ds_read_b128 a[92:95], v211 offset:16384
    v_fma_f32 v234, v150, s20, v237
    v_fma_f32 v235, v151, s20, v237
    v_exp_f32 v234, v234
    v_mfma_f32_32x32x16_bf16 v[0:15], a[160:163], v[180:183], v[0:15]
    ds_read_b128 a[96:99], v212 offset:16384
    v_add_f32 v239, v239, v232
    v_exp_f32 v235, v235
    v_add_f32 v239, v239, v233
    v_cvt_pk_bf16_f32 v194, v232, v233
    v_mfma_f32_32x32x16_bf16 v[16:31], a[164:167], v[180:183], v[16:31]
    ds_read_b128 a[100:103], v213 offset:16384
    v_fma_f32 v232, v152, s20, v237
    v_fma_f32 v233, v153, s20, v237
    v_exp_f32 v232, v232
    v_add_f32 v239, v239, v234
    v_mfma_f32_32x32x16_bf16 v[32:47], a[168:171], v[180:183], v[32:47]
    ds_read_b128 a[104:107], v214 offset:16384
    v_exp_f32 v233, v233
    v_add_f32 v239, v239, v235
    v_cvt_pk_bf16_f32 v195, v234, v235
    v_fma_f32 v234, v154, s20, v237
    v_mfma_f32_32x32x16_bf16 v[48:63], a[172:175], v[180:183], v[48:63]
    ds_read_b128 a[108:111], v215 offset:16384
    v_fma_f32 v235, v155, s20, v237
    v_exp_f32 v234, v234
    v_add_f32 v239, v239, v232
    v_add_f32 v239, v239, v233
    v_mfma_f32_32x32x16_bf16 v[0:15], a[176:179], v[184:187], v[0:15]
    ds_read_b128 a[112:115], v208 offset:24576
    v_exp_f32 v235, v235
    v_cvt_pk_bf16_f32 v196, v232, v233
    v_fma_f32 v232, v156, s20, v237
    v_fma_f32 v233, v157, s20, v237
    v_mfma_f32_32x32x16_bf16 v[16:31], a[180:183], v[184:187], v[16:31]
    ds_read_b128 a[116:119], v209 offset:24576
    buffer_load_dwordx4 v223, s[8:11], s24 offen offset:3072 lds
    s_add_u32 s24, s24, 0x10000
    v_exp_f32 v232, v232
    v_add_f32 v239, v239, v234
    v_add_f32 v239, v239, v235
    v_mfma_f32_32x32x16_bf16 v[32:47], a[184:187], v[184:187], v[32:47]
    ds_read_b128 a[120:123], v210 offset:24576
    v_exp_f32 v233, v233
    v_cvt_pk_bf16_f32 v197, v234, v235
    v_fma_f32 v234, v158, s20, v237
    v_fma_f32 v235, v159, s20, v237
    v_mfma_f32_32x32x16_bf16 v[48:63], a[188:191], v[184:187], v[48:63]
    ds_read_b128 a[124:127], v211 offset:24576
    v_exp_f32 v234, v234
    v_add_f32 v239, v239, v232
    v_exp_f32 v235, v235
    v_mfma_f32_32x32x16_bf16 v[0:15], a[192:195], v[188:191], v[0:15]
    ds_read_b128 a[128:131], v212 offset:24576
    v_add_f32 v239, v239, v233
    v_cvt_pk_bf16_f32 v198, v232, v233
    v_fma_f32 v232, v160, s20, v237
    v_fma_f32 v233, v161, s20, v237
    v_add_f32 v239, v239, v234
    v_mfma_f32_32x32x16_bf16 v[16:31], a[196:199], v[188:191], v[16:31]
    ds_read_b128 a[132:135], v213 offset:24576
    v_exp_f32 v232, v232
    v_exp_f32 v233, v233
    v_add_f32 v239, v239, v235
    v_mfma_f32_32x32x16_bf16 v[32:47], a[200:203], v[188:191], v[32:47]
    ds_read_b128 a[136:139], v214 offset:24576
    v_cvt_pk_bf16_f32 v199, v234, v235
    v_mfma_f32_32x32x16_bf16 v[48:63], a[204:207], v[188:191], v[48:63]
    ds_read_b128 a[140:143], v215 offset:24576
    s_sub_u32 s23, s23, 1
    s_cmp_eq_u32 s23, s92
    s_cbranch_scc1 L_trig_1
    s_branch L_mid1_0
L_ts_0:
    s_and_b32 s23, s51, 0xff
    s_bfe_u32 s29, s51, 0x20010
    s_mov_b32 s34, 0
    s_mov_b32 s35, 32
    s_and_b32 s92, s54, 0xff
    s_max_u32 s92, s92, 1
    s_and_b32 s90, s54, 0xffffff00
    s_mov_b32 s91, s55
    v_mfma_f32_32x32x16_bf16 v[64:79], a[144:147], v[192:195], v[64:79]
    v_mov_b32 v247, v238
    v_mov_b32 v228, v238
    s_nop 1
    v_permlane32_swap_b32 v247, v228
    v_add_f32 v228, v228, v247
    v_cmp_nge_f32 vcc, s21, v228
    s_nop 3
    s_cmp_lg_u64 vcc, 0
    s_cselect_b32 s38, s31, 0
    s_or_b32 s30, s30, s38
    s_mov_b32 m0, s63
    v_mfma_f32_32x32x16_bf16 v[80:95], a[148:151], v[192:195], v[80:95]
    buffer_load_dwordx4 v220, s[8:11], s24 offen offset:0 lds
    v_rcp_f32 v228, v228
    s_nop 0
    v_mov_b32 v247, v239
    v_mov_b32 v229, v239
    s_nop 1
    v_permlane32_swap_b32 v247, v229
    v_add_f32 v229, v229, v247
    v_cmp_nge_f32 vcc, s21, v229
    s_nop 3
    s_cmp_lg_u64 vcc, 0
    s_cselect_b32 s38, s31, 0
    s_or_b32 s30, s30, s38
    v_mfma_f32_32x32x16_bf16 v[96:111], a[152:155], v[192:195], v[96:111]
    v_rcp_f32 v229, v229
    s_nop 0
    v_add_u32 v249, s3, v253
    s_mov_b32 s18, s89
    v_mul_f32 v0, v0, v228
    v_mul_f32 v1, v1, v228
    v_mul_f32 v2, v2, v228
    v_mul_f32 v3, v3, v228
    v_cvt_pk_bf16_f32 v0, v0, v1
    v_cvt_pk_bf16_f32 v1, v2, v3
    v_mfma_f32_32x32x16_bf16 a[0:15], a[156:159], v[192:195], a[0:15]
    v_mul_f32 v32, v32, v228
    v_mul_f32 v33, v33, v228
    v_mul_f32 v34, v34, v228
    v_mul_f32 v35, v35, v228
    v_cvt_pk_bf16_f32 v32, v32, v33
    v_cvt_pk_bf16_f32 v33, v34, v35
    ds_write2_b64 v249, v[0:1], v[32:33] offset0:0 offset1:16
    v_mul_f32 v4, v4, v228
    v_mfma_f32_32x32x16_bf16 v[64:79], a[160:163], v[196:199], v[64:79]
    buffer_load_dwordx4 v221, s[8:11], s24 offen offset:1024 lds
    v_mul_f32 v5, v5, v228
    v_mul_f32 v6, v6, v228
    v_mul_f32 v7, v7, v228
    v_cvt_pk_bf16_f32 v4, v4, v5
    v_cvt_pk_bf16_f32 v5, v6, v7
    v_mul_f32 v36, v36, v228
    v_mul_f32 v37, v37, v228
    v_mul_f32 v38, v38, v228
    v_mul_f32 v39, v39, v228
    v_cvt_pk_bf16_f32 v36, v36, v37
    v_cvt_pk_bf16_f32 v37, v38, v39
    v_xor_b32 v231, 16, v249
    v_mfma_f32_32x32x16_bf16 v[80:95], a[164:167], v[196:199], v[80:95]
    ds_write2_b64 v231, v[4:5], v[36:37] offset0:0 offset1:16
    v_mul_f32 v8, v8, v228
    v_mul_f32 v9, v9, v228
    v_mul_f32 v10, v10, v228
    v_mul_f32 v11, v11, v228
    v_cvt_pk_bf16_f32 v8, v8, v9
    v_cvt_pk_bf16_f32 v9, v10, v11
    v_mul_f32 v40, v40, v228
    v_mul_f32 v41, v41, v228
    v_mfma_f32_32x32x16_bf16 v[96:111], a[168:171], v[196:199], v[96:111]
    v_mul_f32 v42, v42, v228
    v_mul_f32 v43, v43, v228
    v_cvt_pk_bf16_f32 v40, v40, v41
    v_cvt_pk_bf16_f32 v41, v42, v43
    v_xor_b32 v230, 32, v249
    ds_write2_b64 v230, v[8:9], v[40:41] offset0:0 offset1:16
    v_mul_f32 v12, v12, v228
    v_mul_f32 v13, v13, v228
    v_mfma_f32_32x32x16_bf16 a[0:15], a[172:175], v[196:199], a[0:15]
    v_mul_f32 v14, v14, v228
    v_mul_f32 v15, v15, v228
    v_cvt_pk_bf16_f32 v12, v12, v13
    v_cvt_pk_bf16_f32 v13, v14, v15
    v_mul_f32 v44, v44, v228
    v_mul_f32 v45, v45, v228
    v_mul_f32 v46, v46, v228
    v_mul_f32 v47, v47, v228
    v_cvt_pk_bf16_f32 v44, v44, v45
    v_cvt_pk_bf16_f32 v45, v46, v47
    v_xor_b32 v231, 48, v249
    v_mfma_f32_32x32x16_bf16 v[64:79], a[176:179], v[200:203], v[64:79]
    s_waitcnt vmcnt(6) lgkmcnt(0)
    s_barrier
    ds_read_b128 a[80:83], v208 offset:0
    v_add_u32 v132, s60, v208
    ds_read_b128 a[16:19], v132 offset:0
    buffer_load_dwordx4 v222, s[8:11], s24 offen offset:2048 lds
    ds_write2_b64 v231, v[12:13], v[44:45] offset0:0 offset1:16
    v_mul_f32 v16, v16, v228
    v_mul_f32 v17, v17, v228
    v_mul_f32 v18, v18, v228
    v_mul_f32 v19, v19, v228
    v_cvt_pk_bf16_f32 v16, v16, v17
    v_mfma_f32_32x32x16_bf16 v[80:95], a[180:183], v[200:203], v[80:95]
    ds_read_b128 a[84:87], v209 offset:0
    v_add_u32 v133, s60, v209
    ds_read_b128 a[20:23], v133 offset:0
    v_cvt_pk_bf16_f32 v17, v18, v19
    v_mul_f32 v48, v48, v228
    v_mul_f32 v49, v49, v228
    v_mul_f32 v50, v50, v228
    v_mul_f32 v51, v51, v228
    v_cvt_pk_bf16_f32 v48, v48, v49
    v_cvt_pk_bf16_f32 v49, v50, v51
    v_xor_b32 v230, 64, v249
    v_mfma_f32_32x32x16_bf16 v[96:111], a[184:187], v[200:203], v[96:111]
    ds_read_b128 a[88:91], v210 offset:0
    v_add_u32 v134, s60, v210
    ds_read_b128 a[24:27], v134 offset:0
    ds_write2_b64 v230, v[16:17], v[48:49] offset0:0 offset1:16
    v_mul_f32 v20, v20, v228
    v_mul_f32 v21, v21, v228
    v_mul_f32 v22, v22, v228
    v_mul_f32 v23, v23, v228
    v_cvt_pk_bf16_f32 v20, v20, v21
    v_cvt_pk_bf16_f32 v21, v22, v23
    v_mul_f32 v52, v52, v228
    v_mfma_f32_32x32x16_bf16 a[0:15], a[188:191], v[200:203], a[0:15]
    ds_read_b128 a[92:95], v211 offset:0
    v_add_u32 v135, s60, v211
    ds_read_b128 a[28:31], v135 offset:0
    buffer_load_dwordx4 v223, s[8:11], s24 offen offset:3072 lds
    s_add_u32 s24, s24, 0x10000
    v_mul_f32 v53, v53, v228
    v_mul_f32 v54, v54, v228
    v_mul_f32 v55, v55, v228
    v_cvt_pk_bf16_f32 v52, v52, v53
    v_cvt_pk_bf16_f32 v53, v54, v55
    v_xor_b32 v231, 0x50, v249
    v_mfma_f32_32x32x16_bf16 v[64:79], a[192:195], v[204:207], v[64:79]
    ds_read_b128 a[96:99], v212 offset:0
    v_add_u32 v132, s60, v212
    ds_read_b128 a[32:35], v132 offset:0
    ds_write2_b64 v231, v[20:21], v[52:53] offset0:0 offset1:16
    v_mul_f32 v24, v24, v228
    v_mul_f32 v25, v25, v228
    v_mul_f32 v26, v26, v228
    v_mul_f32 v27, v27, v228
    v_cvt_pk_bf16_f32 v24, v24, v25
    v_cvt_pk_bf16_f32 v25, v26, v27
    v_mul_f32 v56, v56, v228
    v_mfma_f32_32x32x16_bf16 v[80:95], a[196:199], v[204:207], v[80:95]
    ds_read_b128 a[100:103], v213 offset:0
    v_add_u32 v133, s60, v213
    ds_read_b128 a[36:39], v133 offset:0
    v_mul_f32 v57, v57, v228
    v_mul_f32 v58, v58, v228
    v_mul_f32 v59, v59, v228
    v_cvt_pk_bf16_f32 v56, v56, v57
    v_cvt_pk_bf16_f32 v57, v58, v59
    v_xor_b32 v230, 0x60, v249
    ds_write2_b64 v230, v[24:25], v[56:57] offset0:0 offset1:16
    v_mfma_f32_32x32x16_bf16 v[96:111], a[200:203], v[204:207], v[96:111]
    ds_read_b128 a[104:107], v214 offset:0
    v_add_u32 v134, s60, v214
    ds_read_b128 a[40:43], v134 offset:0
    v_mul_f32 v28, v28, v228
    v_mul_f32 v29, v29, v228
    v_mul_f32 v30, v30, v228
    v_mul_f32 v31, v31, v228
    v_cvt_pk_bf16_f32 v28, v28, v29
    v_cvt_pk_bf16_f32 v29, v30, v31
    v_mul_f32 v60, v60, v228
    v_mul_f32 v61, v61, v228
    v_mul_f32 v62, v62, v228
    v_mfma_f32_32x32x16_bf16 a[0:15], a[204:207], v[204:207], a[0:15]
    ds_read_b128 a[108:111], v215 offset:0
    v_add_u32 v135, s60, v215
    ds_read_b128 a[44:47], v135 offset:0
    v_mul_f32 v63, v63, v228
    v_cvt_pk_bf16_f32 v60, v60, v61
    v_cvt_pk_bf16_f32 v61, v62, v63
    v_xor_b32 v231, 0x70, v249
    ds_write2_b64 v231, v[28:29], v[60:61] offset0:0 offset1:16
    s_waitcnt lgkmcnt(14)
    v_mfma_f32_32x32x16_bf16 v[112:127], a[80:83], a[16:19], 0
    ds_read_b128 a[112:115], v208 offset:8192
    ds_read_b128 a[116:119], v209 offset:8192
    v_add_u32 v230, s3, v255
    ds_read_b128 a[208:211], v230 offset:0
    ds_read_b128 a[212:215], v230 offset:1024
    ds_read_b128 a[216:219], v230 offset:2048
    ds_read_b128 a[220:223], v230 offset:3072
    ds_read_b128 a[224:227], v230 offset:4096
    ds_read_b128 a[228:231], v230 offset:5120
    ds_read_b128 a[232:235], v230 offset:6144
    ds_read_b128 a[236:239], v230 offset:7168
    s_add_u32 s58, s36, 0
    v_add_u32 v247, s58, v250
    v_xor_b32 v248, 64, v247
    v_mfma_f32_32x32x16_bf16 v[112:127], a[84:87], a[20:23], v[112:127]
    ds_read_b128 a[120:123], v210 offset:8192
    ds_read_b128 a[124:127], v211 offset:8192
    v_add_u32 v248, 0x4000, v248
    v_mul_f32 v64, v64, v229
    v_mul_f32 v65, v65, v229
    v_mul_f32 v66, v66, v229
    v_mul_f32 v67, v67, v229
    v_cvt_pk_bf16_f32 v64, v64, v65
    v_cvt_pk_bf16_f32 v65, v66, v67
    v_mul_f32 v96, v96, v229
    v_mul_f32 v97, v97, v229
    v_mul_f32 v98, v98, v229
    v_mul_f32 v99, v99, v229
    v_cvt_pk_bf16_f32 v96, v96, v97
    v_cvt_pk_bf16_f32 v97, v98, v99
    v_mfma_f32_32x32x16_bf16 v[112:127], a[88:91], a[24:27], v[112:127]
    ds_read_b128 a[128:131], v212 offset:8192
    ds_write2_b64 v249, v[64:65], v[96:97] offset0:0 offset1:16
    v_mul_f32 v68, v68, v229
    v_mul_f32 v69, v69, v229
    v_mul_f32 v70, v70, v229
    v_mul_f32 v71, v71, v229
    v_cvt_pk_bf16_f32 v68, v68, v69
    v_cvt_pk_bf16_f32 v69, v70, v71
    s_waitcnt lgkmcnt(14)
    v_mfma_f32_32x32x16_bf16 v[112:127], a[92:95], a[28:31], v[112:127]
    ds_read_b128 a[132:135], v213 offset:8192
    ds_read_b128 a[136:139], v214 offset:8192
    s_waitcnt lgkmcnt(13)
    buffer_store_dwordx4 a[208:211], v247, s[16:19], 0 offen offset:0 sc0 sc1
    v_add_u32 v247, 0x8000, v247
    v_mul_f32 v100, v100, v229
    v_mul_f32 v101, v101, v229
    v_mul_f32 v102, v102, v229
    v_mul_f32 v103, v103, v229
    v_cvt_pk_bf16_f32 v100, v100, v101
    v_cvt_pk_bf16_f32 v101, v102, v103
    v_mfma_f32_32x32x16_bf16 v[112:127], a[96:99], a[32:35], v[112:127]
    ds_read_b128 a[140:143], v215 offset:8192
    v_xor_b32 v231, 16, v249
    ds_write2_b64 v231, v[68:69], v[100:101] offset0:0 offset1:16
    v_mul_f32 v72, v72, v229
    v_mul_f32 v73, v73, v229
    v_mul_f32 v74, v74, v229
    v_mul_f32 v75, v75, v229
    v_cvt_pk_bf16_f32 v72, v72, v73
    v_mfma_f32_32x32x16_bf16 v[112:127], a[100:103], a[36:39], v[112:127]
    s_waitcnt lgkmcnt(14)
    buffer_store_dwordx4 a[212:215], v248, s[16:19], 0 offen offset:0 sc0 sc1
    v_add_u32 v248, 0x8000, v248
    v_cvt_pk_bf16_f32 v73, v74, v75
    v_mul_f32 v104, v104, v229
    v_mul_f32 v105, v105, v229
    v_mul_f32 v106, v106, v229
    v_mul_f32 v107, v107, v229
    v_cvt_pk_bf16_f32 v104, v104, v105
    v_cvt_pk_bf16_f32 v105, v106, v107
    v_xor_b32 v230, 32, v249
    v_mfma_f32_32x32x16_bf16 v[112:127], a[104:107], a[40:43], v[112:127]
    s_waitcnt vmcnt(6) lgkmcnt(0)
    s_barrier
    s_sub_u32 s47, s59, 0x4000
    v_add_u32 v188, s47, v208
    ds_read_b128 a[48:51], v188 offset:0
    ds_write2_b64 v230, v[72:73], v[104:105] offset0:0 offset1:16
    v_mul_f32 v76, v76, v229
    v_mul_f32 v77, v77, v229
    v_mul_f32 v78, v78, v229
    v_mfma_f32_32x32x16_bf16 v[112:127], a[108:111], a[44:47], v[112:127]
    v_add_u32 v189, s47, v209
    s_mov_b32 m0, s62
    ds_read_b128 a[52:55], v189 offset:0
    buffer_load_dwordx4 v220, s[8:11], s24 offen offset:0 lds
    buffer_store_dwordx4 a[216:219], v247, s[16:19], 0 offen offset:0 sc0 sc1
    v_add_u32 v247, 0x8000, v247
    v_mul_f32 v79, v79, v229
    v_cvt_pk_bf16_f32 v76, v76, v77
    v_cvt_pk_bf16_f32 v77, v78, v79
    v_mul_f32 v108, v108, v229
    v_mul_f32 v109, v109, v229
    v_mfma_f32_32x32x16_bf16 v[128:143], a[112:115], a[16:19], 0
    v_add_u32 v190, s47, v210
    ds_read_b128 a[56:59], v190 offset:0
    v_mul_f32 v110, v110, v229
    v_mul_f32 v111, v111, v229
    v_cvt_pk_bf16_f32 v108, v108, v109
    v_cvt_pk_bf16_f32 v109, v110, v111
    v_xor_b32 v231, 48, v249
    ds_write2_b64 v231, v[76:77], v[108:109] offset0:0 offset1:16
    v_mfma_f32_32x32x16_bf16 v[128:143], a[116:119], a[20:23], v[128:143]
    v_add_u32 v191, s47, v211
    ds_read_b128 a[60:63], v191 offset:0
    v_mul_f32 v80, v80, v229
    v_mul_f32 v81, v81, v229
    v_mul_f32 v82, v82, v229
    v_mul_f32 v83, v83, v229
    v_cvt_pk_bf16_f32 v80, v80, v81
    v_cvt_pk_bf16_f32 v81, v82, v83
    v_accvgpr_read_b32 v66, a0
    v_accvgpr_read_b32 v67, a1
    v_accvgpr_read_b32 v98, a2
    v_accvgpr_read_b32 v99, a3
    v_mul_f32 v66, v66, v229
    v_mul_f32 v67, v67, v229
    v_mfma_f32_32x32x16_bf16 v[128:143], a[120:123], a[24:27], v[128:143]
    v_add_u32 v188, s47, v212
    ds_read_b128 a[64:67], v188 offset:0
    buffer_store_dwordx4 a[220:223], v248, s[16:19], 0 offen offset:0 sc0 sc1
    v_add_u32 v248, 0x8000, v248
    v_mul_f32 v98, v98, v229
    v_mul_f32 v99, v99, v229
    v_cvt_pk_bf16_f32 v66, v66, v67
    v_cvt_pk_bf16_f32 v67, v98, v99
    v_xor_b32 v230, 64, v249
    v_mfma_f32_32x32x16_bf16 v[128:143], a[124:127], a[28:31], v[128:143]
    v_add_u32 v189, s47, v213
    ds_read_b128 a[68:71], v189 offset:0
    ds_write2_b64 v230, v[80:81], v[66:67] offset0:0 offset1:16
    v_mul_f32 v84, v84, v229
    v_mul_f32 v85, v85, v229
    v_mul_f32 v86, v86, v229
    v_mul_f32 v87, v87, v229
    v_cvt_pk_bf16_f32 v84, v84, v85
    v_cvt_pk_bf16_f32 v85, v86, v87
    v_mfma_f32_32x32x16_bf16 v[128:143], a[128:131], a[32:35], v[128:143]
    v_add_u32 v190, s47, v214
    ds_read_b128 a[72:75], v190 offset:0
    ds_read_b64_tr_b16 a[144:145], v216 offset:32768
    ds_read_b64_tr_b16 a[146:147], v216 offset:33280
    buffer_load_dwordx4 v221, s[8:11], s24 offen offset:1024 lds
    buffer_store_dwordx4 a[224:227], v247, s[16:19], 0 offen offset:0 sc0 sc1
    v_add_u32 v247, 0x8000, v247
    v_accvgpr_read_b32 v70, a4
    v_accvgpr_read_b32 v71, a5
    v_accvgpr_read_b32 v102, a6
    v_mfma_f32_32x32x16_bf16 v[128:143], a[132:135], a[36:39], v[128:143]
    v_add_u32 v191, s47, v215
    ds_read_b128 a[76:79], v191 offset:0
    ds_read_b64_tr_b16 a[148:149], v217 offset:32768
    ds_read_b64_tr_b16 a[150:151], v217 offset:33280
    v_accvgpr_read_b32 v103, a7
    v_mul_f32 v70, v70, v229
    v_mul_f32 v71, v71, v229
    v_mul_f32 v102, v102, v229
    v_mul_f32 v103, v103, v229
    v_cvt_pk_bf16_f32 v70, v70, v71
    v_cvt_pk_bf16_f32 v71, v102, v103
    v_xor_b32 v231, 0x50, v249
    v_mfma_f32_32x32x16_bf16 v[128:143], a[136:139], a[40:43], v[128:143]
    ds_read_b64_tr_b16 a[152:153], v218 offset:32768
    ds_read_b64_tr_b16 a[154:155], v218 offset:33280
    buffer_store_dwordx4 a[228:231], v248, s[16:19], 0 offen offset:0 sc0 sc1
    v_add_u32 v248, 0x8000, v248
    ds_write2_b64 v231, v[84:85], v[70:71] offset0:0 offset1:16
    v_mul_f32 v88, v88, v229
    v_mul_f32 v89, v89, v229
    v_mfma_f32_32x32x16_bf16 v[128:143], a[140:143], a[44:47], v[128:143]
    ds_read_b64_tr_b16 a[156:157], v219 offset:32768
    ds_read_b64_tr_b16 a[158:159], v219 offset:33280
    v_mul_f32 v90, v90, v229
    v_mul_f32 v91, v91, v229
    v_cvt_pk_bf16_f32 v88, v88, v89
    v_cvt_pk_bf16_f32 v89, v90, v91
    v_accvgpr_read_b32 v74, a8
    v_accvgpr_read_b32 v75, a9
    v_accvgpr_read_b32 v106, a10
    v_accvgpr_read_b32 v107, a11
    v_mul_f32 v74, v74, v229
    v_mul_f32 v75, v75, v229
    v_mul_f32 v106, v106, v229
    v_mul_f32 v107, v107, v229
    s_waitcnt lgkmcnt(14)
    v_mfma_f32_32x32x16_bf16 v[144:159], a[80:83], a[48:51], 0
    ds_read_b64_tr_b16 a[160:161], v216 offset:36864
    s_cmp_eq_u32 s23, 1
    s_cbranch_scc1 L_mask_8
L_maskb_9:
    v_cvt_pk_bf16_f32 v74, v74, v75
    v_max3_f32 v244, v112, v113, v114
    v_cvt_pk_bf16_f32 v75, v106, v107
    v_max3_f32 v244, v244, v115, v116
    v_max3_f32 v244, v244, v117, v118
    v_xor_b32 v230, 0x60, v249
    v_max3_f32 v244, v244, v119, v120
    ds_write2_b64 v230, v[88:89], v[74:75] offset0:0 offset1:16
    v_mfma_f32_32x32x16_bf16 v[144:159], a[84:87], a[52:55], v[144:159]
    ds_read_b64_tr_b16 a[162:163], v216 offset:37376
    ds_read_b64_tr_b16 a[164:165], v217 offset:36864
    buffer_store_dwordx4 a[232:235], v247, s[16:19], 0 offen offset:0 sc0 sc1
    v_max3_f32 v244, v244, v121, v122
    v_max3_f32 v244, v244, v123, v124
    v_max3_f32 v244, v244, v125, v126
    v_max_f32 v244, v244, v127
    v_max3_f32 v245, v128, v129, v130
    v_mfma_f32_32x32x16_bf16 v[144:159], a[88:91], a[56:59], v[144:159]
    ds_read_b64_tr_b16 a[166:167], v217 offset:37376
    ds_read_b64_tr_b16 a[168:169], v218 offset:36864
    buffer_load_dwordx4 v222, s[8:11], s24 offen offset:2048 lds
    v_max3_f32 v245, v245, v131, v132
    v_max3_f32 v245, v245, v133, v134
    v_max3_f32 v245, v245, v135, v136
    v_max3_f32 v245, v245, v137, v138
    v_max3_f32 v245, v245, v139, v140
    v_max3_f32 v245, v245, v141, v142
    v_max3_f32 v244, v244, v245, v143
    v_mov_b32 v245, v244
    v_mul_f32 v92, v92, v229
    s_nop 1
    v_mfma_f32_32x32x16_bf16 v[144:159], a[92:95], a[60:63], v[144:159]
    ds_read_b64_tr_b16 a[170:171], v218 offset:37376
    ds_read_b64_tr_b16 a[172:173], v219 offset:36864
    buffer_store_dwordx4 a[236:239], v248, s[16:19], 0 offen offset:0 sc0 sc1
    v_mul_f32 v93, v93, v229
    v_permlane32_swap_b32 v244, v245
    v_max_f32 v244, v244, v245
    v_mul_f32 v94, v94, v229
    v_mul_f32 v236, s28, v244
    v_fma_f32 v232, v112, s20, v236
    v_mul_f32 v95, v95, v229
    s_waitcnt lgkmcnt(14)
    v_mfma_f32_32x32x16_bf16 v[144:159], a[96:99], a[64:67], v[144:159]
    ds_read_b64_tr_b16 a[174:175], v219 offset:37376
    v_fma_f32 v233, v113, s20, v236
    v_cvt_pk_bf16_f32 v92, v92, v93
    v_exp_f32 v232, v232
    v_cvt_pk_bf16_f32 v93, v94, v95
    v_exp_f32 v233, v233
    v_accvgpr_read_b32 v78, a12
    v_fma_f32 v234, v114, s20, v236
    v_fma_f32 v235, v115, s20, v236
    v_accvgpr_read_b32 v79, a13
    v_exp_f32 v234, v234
    v_mfma_f32_32x32x16_bf16 v[144:159], a[100:103], a[68:71], v[144:159]
    ds_read_b64_tr_b16 a[176:177], v216 offset:40960
    ds_read_b64_tr_b16 a[178:179], v216 offset:41472
    v_accvgpr_read_b32 v110, a14
    v_add_f32 v238, v232, v233
    v_accvgpr_read_b32 v111, a15
    v_exp_f32 v235, v235
    v_mul_f32 v78, v78, v229
    s_nop 0
    v_cvt_pk_bf16_f32 v176, v232, v233
    v_mul_f32 v79, v79, v229
    v_fma_f32 v232, v116, s20, v236
    v_fma_f32 v233, v117, s20, v236
    v_mul_f32 v110, v110, v229
    v_mfma_f32_32x32x16_bf16 v[144:159], a[104:107], a[72:75], v[144:159]
    ds_read_b64_tr_b16 a[180:181], v217 offset:40960
    ds_read_b64_tr_b16 a[182:183], v217 offset:41472
    v_exp_f32 v232, v232
    v_mul_f32 v111, v111, v229
    v_add_f32 v238, v238, v234
    v_cvt_pk_bf16_f32 v78, v78, v79
    v_exp_f32 v233, v233
    v_cvt_pk_bf16_f32 v79, v110, v111
    v_add_f32 v238, v238, v235
    v_cvt_pk_bf16_f32 v177, v234, v235
    v_xor_b32 v231, 0x70, v249
    v_fma_f32 v234, v118, s20, v236
    v_fma_f32 v235, v119, s20, v236
    v_mfma_f32_32x32x16_bf16 v[144:159], a[108:111], a[76:79], v[144:159]
    ds_read_b64_tr_b16 a[184:185], v218 offset:40960
    ds_read_b64_tr_b16 a[186:187], v218 offset:41472
    ds_write2_b64 v231, v[92:93], v[78:79] offset0:0 offset1:16
    v_exp_f32 v234, v234
    v_add_f32 v238, v238, v232
    v_exp_f32 v235, v235
    v_mfma_f32_32x32x16_bf16 v[160:175], a[112:115], a[48:51], 0
    ds_read_b64_tr_b16 a[188:189], v219 offset:40960
    ds_read_b64_tr_b16 a[190:191], v219 offset:41472
    buffer_load_dwordx4 v223, s[8:11], s24 offen offset:3072 lds
    s_add_u32 s24, s24, 0x10000
    v_add_f32 v238, v238, v233
    v_cvt_pk_bf16_f32 v178, v232, v233
    v_fma_f32 v232, v120, s20, v236
    v_fma_f32 v233, v121, s20, v236
    v_exp_f32 v232, v232
    v_add_f32 v238, v238, v234
    v_exp_f32 v233, v233
    v_add_f32 v238, v238, v235
    v_mfma_f32_32x32x16_bf16 v[160:175], a[116:119], a[52:55], v[160:175]
    ds_read_b64_tr_b16 a[192:193], v216 offset:45056
    v_cvt_pk_bf16_f32 v179, v234, v235
    v_fma_f32 v234, v122, s20, v236
    v_fma_f32 v235, v123, s20, v236
    v_exp_f32 v234, v234
    v_add_f32 v238, v238, v232
    v_exp_f32 v235, v235
    v_add_f32 v238, v238, v233
    v_cvt_pk_bf16_f32 v180, v232, v233
    v_fma_f32 v232, v124, s20, v236
    v_fma_f32 v233, v125, s20, v236
    v_add_u32 v230, s3, v255
    v_mfma_f32_32x32x16_bf16 v[160:175], a[120:123], a[56:59], v[160:175]
    ds_read_b64_tr_b16 a[194:195], v216 offset:45568
    ds_read_b64_tr_b16 a[196:197], v217 offset:45056
    ds_read_b128 a[208:211], v230 offset:0
    ds_read_b128 a[212:215], v230 offset:1024
    ds_read_b128 a[216:219], v230 offset:2048
    ds_read_b128 a[220:223], v230 offset:3072
    ds_read_b128 a[224:227], v230 offset:4096
    ds_read_b128 a[228:231], v230 offset:5120
    ds_read_b128 a[232:235], v230 offset:6144
    ds_read_b128 a[236:239], v230 offset:7168
    s_add_u32 s58, s36, 0x20000
    v_add_u32 v247, s58, v250
    v_xor_b32 v248, 64, v247
    v_add_u32 v248, 0x4000, v248
    v_mfma_f32_32x32x16_bf16 v[160:175], a[124:127], a[60:63], v[160:175]
    ds_read_b64_tr_b16 a[198:199], v217 offset:45568
    ds_read_b64_tr_b16 a[200:201], v218 offset:45056
    v_exp_f32 v232, v232
    v_add_f32 v238, v238, v234
    v_exp_f32 v233, v233
    v_add_f32 v238, v238, v235
    v_cvt_pk_bf16_f32 v181, v234, v235
    v_fma_f32 v234, v126, s20, v236
    v_fma_f32 v235, v127, s20, v236
    v_exp_f32 v234, v234
    v_add_f32 v238, v238, v232
    v_mfma_f32_32x32x16_bf16 v[160:175], a[128:131], a[64:67], v[160:175]
    ds_read_b64_tr_b16 a[202:203], v218 offset:45568
    ds_read_b64_tr_b16 a[204:205], v219 offset:45056
    s_waitcnt lgkmcnt(11)
    buffer_store_dwordx4 a[208:211], v247, s[16:19], 0 offen offset:0 sc0 sc1
    v_add_u32 v247, 0x8000, v247
    v_exp_f32 v235, v235
    v_add_f32 v238, v238, v233
    v_cvt_pk_bf16_f32 v182, v232, v233
    v_fma_f32 v232, v128, s20, v236
    v_fma_f32 v233, v129, s20, v236
    v_exp_f32 v232, v232
    v_mfma_f32_32x32x16_bf16 v[160:175], a[132:135], a[68:71], v[160:175]
    ds_read_b64_tr_b16 a[206:207], v219 offset:45568
    v_add_f32 v238, v238, v234
    v_exp_f32 v233, v233
    v_add_f32 v238, v238, v235
    v_cvt_pk_bf16_f32 v183, v234, v235
    v_fma_f32 v234, v130, s20, v236
    v_fma_f32 v235, v131, s20, v236
    v_exp_f32 v234, v234
    v_add_f32 v238, v238, v232
    v_exp_f32 v235, v235
    v_mfma_f32_32x32x16_bf16 v[160:175], a[136:139], a[72:75], v[160:175]
    s_waitcnt lgkmcnt(11)
    buffer_store_dwordx4 a[212:215], v248, s[16:19], 0 offen offset:0 sc0 sc1
    v_add_u32 v248, 0x8000, v248
    v_add_f32 v238, v238, v233
    v_cvt_pk_bf16_f32 v184, v232, v233
    v_fma_f32 v232, v132, s20, v236
    v_fma_f32 v233, v133, s20, v236
    v_exp_f32 v232, v232
    v_add_f32 v238, v238, v234
    v_exp_f32 v233, v233
    v_mfma_f32_32x32x16_bf16 v[160:175], a[140:143], a[76:79], v[160:175]
    s_waitcnt vmcnt(14) lgkmcnt(0)
    s_barrier
    v_add_f32 v238, v238, v235
    v_cvt_pk_bf16_f32 v185, v234, v235
    v_fma_f32 v234, v134, s20, v236
    v_fma_f32 v235, v135, s20, v236
    v_exp_f32 v234, v234
    v_add_f32 v238, v238, v232
    v_exp_f32 v235, v235
    v_add_f32 v238, v238, v233
    v_cvt_pk_bf16_f32 v186, v232, v233
    v_fma_f32 v232, v136, s20, v236
    v_mfma_f32_32x32x16_bf16 v[0:15], a[144:147], v[176:179], 0
    s_mov_b32 m0, s65
    ds_read_b128 a[80:83], v208 offset:16384
    buffer_load_dwordx4 v224, s[12:15], s25 offen offset:0 lds
    v_fma_f32 v233, v137, s20, v236
    v_exp_f32 v232, v232
    v_add_f32 v238, v238, v234
    v_exp_f32 v233, v233
    v_add_f32 v238, v238, v235
    v_mfma_f32_32x32x16_bf16 v[16:31], a[148:151], v[176:179], 0
    ds_read_b128 a[84:87], v209 offset:16384
    buffer_store_dwordx4 a[216:219], v247, s[16:19], 0 offen offset:0 sc0 sc1
    v_add_u32 v247, 0x8000, v247
    v_cvt_pk_bf16_f32 v187, v234, v235
    v_fma_f32 v234, v138, s20, v236
    v_fma_f32 v235, v139, s20, v236
    v_mfma_f32_32x32x16_bf16 v[32:47], a[152:155], v[176:179], 0
    ds_read_b128 a[88:91], v210 offset:16384
    v_exp_f32 v234, v234
    v_add_f32 v238, v238, v232
    v_exp_f32 v235, v235
    v_add_f32 v238, v238, v233
    v_cvt_pk_bf16_f32 v188, v232, v233
    v_fma_f32 v232, v140, s20, v236
    v_fma_f32 v233, v141, s20, v236
    v_mfma_f32_32x32x16_bf16 v[48:63], a[156:159], v[176:179], 0
    ds_read_b128 a[92:95], v211 offset:16384
    v_exp_f32 v232, v232
    v_add_f32 v238, v238, v234
    v_exp_f32 v233, v233
    v_add_f32 v238, v238, v235
    v_cvt_pk_bf16_f32 v189, v234, v235
    v_fma_f32 v234, v142, s20, v236
    v_mfma_f32_32x32x16_bf16 v[0:15], a[160:163], v[180:183], v[0:15]
    ds_read_b128 a[96:99], v212 offset:16384
    buffer_store_dwordx4 a[220:223], v248, s[16:19], 0 offen offset:0 sc0 sc1
    v_add_u32 v248, 0x8000, v248
    buffer_load_dwordx4 v225, s[12:15], s25 offen offset:1024 lds
    v_fma_f32 v235, v143, s20, v236
    v_exp_f32 v234, v234
    v_mfma_f32_32x32x16_bf16 v[16:31], a[164:167], v[180:183], v[16:31]
    ds_read_b128 a[100:103], v213 offset:16384
    v_add_f32 v238, v238, v232
    v_exp_f32 v235, v235
    v_add_f32 v238, v238, v233
    v_cvt_pk_bf16_f32 v190, v232, v233
    v_add_f32 v238, v238, v234
    v_add_f32 v238, v238, v235
    v_cvt_pk_bf16_f32 v191, v234, v235
    v_mfma_f32_32x32x16_bf16 v[32:47], a[168:171], v[180:183], v[32:47]
    ds_read_b128 a[104:107], v214 offset:16384
    s_cmp_eq_u32 s23, 1
    s_cbranch_scc1 L_mask_10
L_maskb_11:
    v_max3_f32 v244, v144, v145, v146
    v_max3_f32 v244, v244, v147, v148
    v_max3_f32 v244, v244, v149, v150
    v_max3_f32 v244, v244, v151, v152
    v_max3_f32 v244, v244, v153, v154
    v_max3_f32 v244, v244, v155, v156
    v_max3_f32 v244, v244, v157, v158
    v_mfma_f32_32x32x16_bf16 v[48:63], a[172:175], v[180:183], v[48:63]
    ds_read_b128 a[108:111], v215 offset:16384
    buffer_store_dwordx4 a[224:227], v247, s[16:19], 0 offen offset:0 sc0 sc1
    v_add_u32 v247, 0x8000, v247
    v_max_f32 v244, v244, v159
    v_max3_f32 v245, v160, v161, v162
    v_max3_f32 v245, v245, v163, v164
    v_mfma_f32_32x32x16_bf16 v[0:15], a[176:179], v[184:187], v[0:15]
    ds_read_b128 a[112:115], v208 offset:24576
    buffer_load_dwordx4 v226, s[12:15], s25 offen offset:2048 lds
    v_max3_f32 v245, v245, v165, v166
    v_max3_f32 v245, v245, v167, v168
    v_max3_f32 v245, v245, v169, v170
    v_max3_f32 v245, v245, v171, v172
    v_max3_f32 v245, v245, v173, v174
    v_max3_f32 v244, v244, v245, v175
    v_mov_b32 v245, v244
    v_mfma_f32_32x32x16_bf16 v[16:31], a[180:183], v[184:187], v[16:31]
    ds_read_b128 a[116:119], v209 offset:24576
    buffer_store_dwordx4 a[228:231], v248, s[16:19], 0 offen offset:0 sc0 sc1
    v_add_u32 v248, 0x8000, v248
    s_nop 1
    v_permlane32_swap_b32 v244, v245
    v_mfma_f32_32x32x16_bf16 v[32:47], a[184:187], v[184:187], v[32:47]
    ds_read_b128 a[120:123], v210 offset:24576
    v_max_f32 v244, v244, v245
    v_mul_f32 v237, s28, v244
    v_fma_f32 v232, v144, s20, v237
    v_fma_f32 v233, v145, s20, v237
    v_exp_f32 v232, v232
    v_exp_f32 v233, v233
    v_fma_f32 v234, v146, s20, v237
    v_mfma_f32_32x32x16_bf16 v[48:63], a[188:191], v[184:187], v[48:63]
    ds_read_b128 a[124:127], v211 offset:24576
    v_fma_f32 v235, v147, s20, v237
    v_exp_f32 v234, v234
    v_add_f32 v239, v232, v233
    v_exp_f32 v235, v235
    s_nop 0
    v_cvt_pk_bf16_f32 v192, v232, v233
    v_fma_f32 v232, v148, s20, v237
    v_mfma_f32_32x32x16_bf16 v[0:15], a[192:195], v[188:191], v[0:15]
    ds_read_b128 a[128:131], v212 offset:24576
    buffer_store_dwordx4 a[232:235], v247, s[16:19], 0 offen offset:0 sc0 sc1
    buffer_load_dwordx4 v227, s[12:15], s25 offen offset:3072 lds
    s_add_u32 s25, s25, 0x10000
    v_fma_f32 v233, v149, s20, v237
    v_mfma_f32_32x32x16_bf16 v[16:31], a[196:199], v[188:191], v[16:31]
    ds_read_b128 a[132:135], v213 offset:24576
    v_exp_f32 v232, v232
    v_add_f32 v239, v239, v234
    v_exp_f32 v233, v233
    v_add_f32 v239, v239, v235
    v_cvt_pk_bf16_f32 v193, v234, v235
    v_fma_f32 v234, v150, s20, v237
    v_fma_f32 v235, v151, s20, v237
    v_mfma_f32_32x32x16_bf16 v[32:47], a[200:203], v[188:191], v[32:47]
    ds_read_b128 a[136:139], v214 offset:24576
    v_exp_f32 v234, v234
    v_add_f32 v239, v239, v232
    v_exp_f32 v235, v235
    v_add_f32 v239, v239, v233
    v_cvt_pk_bf16_f32 v194, v232, v233
    v_fma_f32 v232, v152, s20, v237
    v_fma_f32 v233, v153, s20, v237
    v_mfma_f32_32x32x16_bf16 v[48:63], a[204:207], v[188:191], v[48:63]
    ds_read_b128 a[140:143], v215 offset:24576
    buffer_store_dwordx4 a[236:239], v248, s[16:19], 0 offen offset:0 sc0 sc1
    v_exp_f32 v232, v232
    v_add_f32 v239, v239, v234
    v_exp_f32 v233, v233
    v_mfma_f32_32x32x16_bf16 v[64:79], a[240:243], a[240:243], 0
    v_add_f32 v239, v239, v235
    v_cvt_pk_bf16_f32 v195, v234, v235
    v_fma_f32 v234, v154, s20, v237
    v_fma_f32 v235, v155, s20, v237
    v_exp_f32 v234, v234
    v_add_f32 v239, v239, v232
    v_exp_f32 v235, v235
    v_mfma_f32_32x32x16_bf16 v[80:95], a[240:243], a[240:243], 0
    v_add_f32 v239, v239, v233
    v_cvt_pk_bf16_f32 v196, v232, v233
    v_fma_f32 v232, v156, s20, v237
    v_fma_f32 v233, v157, s20, v237
    v_exp_f32 v232, v232
    v_add_f32 v239, v239, v234
    v_exp_f32 v233, v233
    v_add_f32 v239, v239, v235
    v_mfma_f32_32x32x16_bf16 v[96:111], a[240:243], a[240:243], 0
    v_cvt_pk_bf16_f32 v197, v234, v235
    v_fma_f32 v234, v158, s20, v237
    v_fma_f32 v235, v159, s20, v237
    v_exp_f32 v234, v234
    v_add_f32 v239, v239, v232
    v_exp_f32 v235, v235
    v_add_f32 v239, v239, v233
    v_mfma_f32_32x32x16_bf16 a[0:15], a[240:243], a[240:243], 0
    v_cvt_pk_bf16_f32 v198, v232, v233
    v_fma_f32 v232, v160, s20, v237
    v_fma_f32 v233, v161, s20, v237
    v_exp_f32 v232, v232
    v_add_f32 v239, v239, v234
    v_exp_f32 v233, v233
    v_add_f32 v239, v239, v235
    v_cvt_pk_bf16_f32 v199, v234, v235
    s_mov_b32 s89, s50
    s_add_u32 s36, s48, s76
    s_lshl_b32 s31, s31, 1
    s_load_dwordx8 s[48:55], s[56:57], 32
    s_add_u32 s56, s56, 32
    s_addc_u32 s57, s57, 0
    s_sub_u32 s23, s23, 1
    s_cmp_eq_u32 s23, 0
    s_cbranch_scc1 L_drain_0
    s_cmp_eq_u32 s23, s92
    s_cbranch_scc1 L_trig_1
    s_branch L_mid1_0
L_trig_0:
    s_cmp_lg_u32 s23, 1
    s_cbranch_scc1 L_event_0
L_lastsel_0:
    s_cmp_eq_u32 s29, 2
    s_cbranch_scc1 L_last_01
    s_waitcnt lgkmcnt(8)
    v_mfma_f32_32x32x16_bf16 v[112:127], a[80:83], a[16:19], 0
    v_fma_f32 v234, v162, s20, v237
    v_fma_f32 v235, v163, s20, v237
    v_exp_f32 v234, v234
    v_add_f32 v239, v239, v232
    v_exp_f32 v235, v235
    v_add_f32 v239, v239, v233
    v_mfma_f32_32x32x16_bf16 v[112:127], a[84:87], a[20:23], v[112:127]
    s_waitcnt vmcnt(0) lgkmcnt(0)
    s_barrier
    s_mov_b32 s10, s52
    s_mov_b32 s14, s52
    s_mov_b32 s6, s50
    s_add_u32 s24, s49, s74
    s_mov_b32 s25, s24
    v_cvt_pk_bf16_f32 v200, v232, v233
    v_fma_f32 v232, v164, s20, v237
    v_mfma_f32_32x32x16_bf16 v[112:127], a[88:91], a[24:27], v[112:127]
    v_lshrrev_b32 v132, 12, v220
    v_mul_u32_u24 v132, 0x3000, v132
    v_add_u32 v128, v220, v132
    v_add_u32 v129, v221, v132
    v_add_u32 v129, 0xc00, v129
    v_add_u32 v130, v222, v132
    v_add_u32 v130, 0x1800, v130
    v_add_u32 v131, v223, v132
    v_add_u32 v131, 0x2400, v131
    v_mfma_f32_32x32x16_bf16 v[112:127], a[92:95], a[28:31], v[112:127]
    s_add_u32 s32, s48, s76
    s_mov_b32 s33, s60
    s_mov_b32 m0, s33
    s_add_u32 s33, s33, 0x1000
    buffer_load_dwordx4 v128, s[4:7], s32 offen offset:0 nt lds
    v_fma_f32 v233, v165, s20, v237
    v_exp_f32 v232, v232
    v_add_f32 v239, v239, v234
    v_mfma_f32_32x32x16_bf16 v[112:127], a[96:99], a[32:35], v[112:127]
    buffer_load_dwordx4 v129, s[4:7], s32 offen offset:1024 nt lds
    v_exp_f32 v233, v233
    v_add_f32 v239, v239, v235
    v_cvt_pk_bf16_f32 v201, v234, v235
    v_fma_f32 v234, v166, s20, v237
    v_fma_f32 v235, v167, s20, v237
    v_mfma_f32_32x32x16_bf16 v[112:127], a[100:103], a[36:39], v[112:127]
    v_exp_f32 v234, v234
    v_add_f32 v239, v239, v232
    v_exp_f32 v235, v235
    v_add_f32 v239, v239, v233
    v_cvt_pk_bf16_f32 v202, v232, v233
    v_fma_f32 v232, v168, s20, v237
    v_mfma_f32_32x32x16_bf16 v[112:127], a[104:107], a[40:43], v[112:127]
    buffer_load_dwordx4 v130, s[4:7], s32 offen offset:2048 nt lds
    v_fma_f32 v233, v169, s20, v237
    v_exp_f32 v232, v232
    v_add_f32 v239, v239, v234
    v_exp_f32 v233, v233
    v_add_f32 v239, v239, v235
    v_mfma_f32_32x32x16_bf16 v[112:127], a[108:111], a[44:47], v[112:127]
    buffer_load_dwordx4 v131, s[4:7], s32 offen offset:3072 nt lds
    v_cvt_pk_bf16_f32 v203, v234, v235
    v_fma_f32 v234, v170, s20, v237
    v_fma_f32 v235, v171, s20, v237
    v_exp_f32 v234, v234
    v_add_f32 v239, v239, v232
    v_mfma_f32_32x32x16_bf16 v[144:159], a[80:83], a[48:51], 0
    v_exp_f32 v235, v235
    v_add_f32 v239, v239, v233
    v_cvt_pk_bf16_f32 v204, v232, v233
    v_fma_f32 v232, v172, s20, v237
    v_fma_f32 v233, v173, s20, v237
    v_exp_f32 v232, v232
    v_mfma_f32_32x32x16_bf16 v[144:159], a[84:87], a[52:55], v[144:159]
    s_mov_b32 m0, s33
    s_add_u32 s32, s32, 0x10000
    buffer_load_dwordx4 v128, s[4:7], s32 offen offset:0 nt lds
    v_add_f32 v239, v239, v234
    v_exp_f32 v233, v233
    v_add_f32 v239, v239, v235
    v_cvt_pk_bf16_f32 v205, v234, v235
    v_mfma_f32_32x32x16_bf16 v[144:159], a[88:91], a[56:59], v[144:159]
    buffer_load_dwordx4 v129, s[4:7], s32 offen offset:1024 nt lds
    v_fma_f32 v234, v174, s20, v237
    v_fma_f32 v235, v175, s20, v237
    v_exp_f32 v234, v234
    v_add_f32 v239, v239, v232
    v_exp_f32 v235, v235
    v_mfma_f32_32x32x16_bf16 v[144:159], a[92:95], a[60:63], v[144:159]
    v_add_f32 v239, v239, v233
    v_cvt_pk_bf16_f32 v206, v232, v233
    v_add_f32 v239, v239, v234
    v_add_f32 v239, v239, v235
    v_cvt_pk_bf16_f32 v207, v234, v235
    v_cmp_gt_i32 vcc, 0, v243
    v_cmp_gt_i32 s[40:41], 1, v243
    v_cmp_gt_i32 s[42:43], 2, v243
    v_mfma_f32_32x32x16_bf16 v[144:159], a[96:99], a[64:67], v[144:159]
    buffer_load_dwordx4 v130, s[4:7], s32 offen offset:2048 nt lds
    v_cndmask_b32 v112, v112, v242, vcc
    v_cmp_gt_i32 vcc, 3, v243
    v_cndmask_b32 v113, v113, v242, s[40:41]
    v_cmp_gt_i32 s[40:41], 8, v243
    v_cndmask_b32 v114, v114, v242, s[42:43]
    v_cmp_gt_i32 s[42:43], 9, v243
    v_cndmask_b32 v115, v115, v242, vcc
    v_mfma_f32_32x32x16_bf16 v[144:159], a[100:103], a[68:71], v[144:159]
    buffer_load_dwordx4 v131, s[4:7], s32 offen offset:3072 nt lds
    v_cmp_gt_i32 vcc, 10, v243
    v_cndmask_b32 v116, v116, v242, s[40:41]
    v_cmp_gt_i32 s[40:41], 11, v243
    v_cndmask_b32 v117, v117, v242, s[42:43]
    v_cmp_gt_i32 s[42:43], 16, v243
    v_cndmask_b32 v118, v118, v242, vcc
    v_cmp_gt_i32 vcc, 17, v243
    v_mfma_f32_32x32x16_bf16 v[144:159], a[104:107], a[72:75], v[144:159]
    v_cndmask_b32 v119, v119, v242, s[40:41]
    v_cmp_gt_i32 s[40:41], 18, v243
    v_cndmask_b32 v120, v120, v242, s[42:43]
    v_cmp_gt_i32 s[42:43], 19, v243
    v_cndmask_b32 v121, v121, v242, vcc
    v_cmp_gt_i32 vcc, 24, v243
    v_cndmask_b32 v122, v122, v242, s[40:41]
    v_cmp_gt_i32 s[40:41], 25, v243
    v_mfma_f32_32x32x16_bf16 v[144:159], a[108:111], a[76:79], v[144:159]
    s_add_u32 s32, s32, 0x10000
    s_sub_u32 s33, s59, 0x4000
    s_mov_b32 m0, s33
    s_add_u32 s33, s33, 0x1000
    buffer_load_dwordx4 v128, s[4:7], s32 offen offset:0 nt lds
    v_cndmask_b32 v123, v123, v242, s[42:43]
    v_cmp_gt_i32 s[42:43], 26, v243
    v_cndmask_b32 v124, v124, v242, vcc
    v_cmp_gt_i32 vcc, 27, v243
    v_mfma_f32_32x32x16_bf16 v[64:79], a[144:147], v[192:195], v[64:79]
    buffer_load_dwordx4 v129, s[4:7], s32 offen offset:1024 nt lds
    v_cndmask_b32 v125, v125, v242, s[40:41]
    s_nop 0
    v_cndmask_b32 v126, v126, v242, s[42:43]
    s_nop 0
    v_cndmask_b32 v127, v127, v242, vcc
    v_fma_f32 v232, v112, s20, v236
    v_fma_f32 v233, v113, s20, v236
    v_mfma_f32_32x32x16_bf16 v[80:95], a[148:151], v[192:195], v[80:95]
    ds_read_b64_tr_b16 a[144:145], v216 offset:32768
    v_exp_f32 v232, v232
    v_exp_f32 v233, v233
    v_fma_f32 v234, v114, s20, v236
    v_fma_f32 v235, v115, s20, v236
    v_mfma_f32_32x32x16_bf16 v[96:111], a[152:155], v[192:195], v[96:111]
    buffer_load_dwordx4 v130, s[4:7], s32 offen offset:2048 nt lds
    ds_read_b64_tr_b16 a[146:147], v216 offset:33280
    v_exp_f32 v234, v234
    v_add_f32 v238, v238, v232
    v_exp_f32 v235, v235
    v_add_f32 v238, v238, v233
    v_mfma_f32_32x32x16_bf16 a[0:15], a[156:159], v[192:195], a[0:15]
    buffer_load_dwordx4 v131, s[4:7], s32 offen offset:3072 nt lds
    ds_read_b64_tr_b16 a[148:149], v217 offset:32768
    v_cvt_pk_bf16_f32 v176, v232, v233
    v_fma_f32 v232, v116, s20, v236
    v_fma_f32 v233, v117, s20, v236
    v_exp_f32 v232, v232
    v_add_f32 v238, v238, v234
    v_mfma_f32_32x32x16_bf16 v[64:79], a[160:163], v[196:199], v[64:79]
    ds_read_b64_tr_b16 a[150:151], v217 offset:33280
    v_exp_f32 v233, v233
    v_add_f32 v238, v238, v235
    v_cvt_pk_bf16_f32 v177, v234, v235
    v_fma_f32 v234, v118, s20, v236
    v_fma_f32 v235, v119, s20, v236
    v_mfma_f32_32x32x16_bf16 v[80:95], a[164:167], v[196:199], v[80:95]
    s_mov_b32 m0, s33
    s_add_u32 s32, s32, 0x10000
    buffer_load_dwordx4 v128, s[4:7], s32 offen offset:0 nt lds
    ds_read_b64_tr_b16 a[152:153], v218 offset:32768
    v_exp_f32 v234, v234
    v_add_f32 v238, v238, v232
    v_mfma_f32_32x32x16_bf16 v[96:111], a[168:171], v[196:199], v[96:111]
    buffer_load_dwordx4 v129, s[4:7], s32 offen offset:1024 nt lds
    ds_read_b64_tr_b16 a[154:155], v218 offset:33280
    v_exp_f32 v235, v235
    v_add_f32 v238, v238, v233
    v_cvt_pk_bf16_f32 v178, v232, v233
    v_fma_f32 v232, v120, s20, v236
    v_fma_f32 v233, v121, s20, v236
    v_mfma_f32_32x32x16_bf16 a[0:15], a[172:175], v[196:199], a[0:15]
    ds_read_b64_tr_b16 a[156:157], v219 offset:32768
    v_exp_f32 v232, v232
    v_add_f32 v238, v238, v234
    v_exp_f32 v233, v233
    v_add_f32 v238, v238, v235
    v_cvt_pk_bf16_f32 v179, v234, v235
    v_mfma_f32_32x32x16_bf16 v[160:175], a[112:115], a[48:51], 0
    buffer_load_dwordx4 v130, s[4:7], s32 offen offset:2048 nt lds
    ds_read_b64_tr_b16 a[158:159], v219 offset:33280
    v_fma_f32 v234, v122, s20, v236
    v_fma_f32 v235, v123, s20, v236
    v_exp_f32 v234, v234
    v_add_f32 v238, v238, v232
    v_mfma_f32_32x32x16_bf16 v[160:175], a[116:119], a[52:55], v[160:175]
    buffer_load_dwordx4 v131, s[4:7], s32 offen offset:3072 nt lds
    ds_read_b64_tr_b16 a[160:161], v216 offset:36864
    v_exp_f32 v235, v235
    v_add_f32 v238, v238, v233
    v_cvt_pk_bf16_f32 v180, v232, v233
    v_fma_f32 v232, v124, s20, v236
    v_fma_f32 v233, v125, s20, v236
    v_mfma_f32_32x32x16_bf16 v[160:175], a[120:123], a[56:59], v[160:175]
    ds_read_b64_tr_b16 a[162:163], v216 offset:37376
    v_exp_f32 v232, v232
    v_add_f32 v238, v238, v234
    v_exp_f32 v233, v233
    v_add_f32 v238, v238, v235
    v_cvt_pk_bf16_f32 v181, v234, v235
    s_mov_b32 m0, s62
    v_mfma_f32_32x32x16_bf16 v[160:175], a[124:127], a[60:63], v[160:175]
    buffer_load_dwordx4 v220, s[8:11], s24 offen offset:0 lds
    ds_read_b64_tr_b16 a[164:165], v217 offset:36864
    v_fma_f32 v234, v126, s20, v236
    v_fma_f32 v235, v127, s20, v236
    v_exp_f32 v234, v234
    v_add_f32 v238, v238, v232
    v_mfma_f32_32x32x16_bf16 v[160:175], a[128:131], a[64:67], v[160:175]
    ds_read_b64_tr_b16 a[166:167], v217 offset:37376
    v_exp_f32 v235, v235
    v_add_f32 v238, v238, v233
    v_cvt_pk_bf16_f32 v182, v232, v233
    v_add_f32 v238, v238, v234
    v_add_f32 v238, v238, v235
    v_cvt_pk_bf16_f32 v183, v234, v235
    v_mfma_f32_32x32x16_bf16 v[160:175], a[132:135], a[68:71], v[160:175]
    ds_read_b64_tr_b16 a[168:169], v218 offset:36864
    v_fma_f32 v232, v144, s20, v237
    v_fma_f32 v233, v145, s20, v237
    v_exp_f32 v232, v232
    v_exp_f32 v233, v233
    v_fma_f32 v234, v146, s20, v237
    v_mfma_f32_32x32x16_bf16 v[160:175], a[136:139], a[72:75], v[160:175]
    buffer_load_dwordx4 v221, s[8:11], s24 offen offset:1024 lds
    ds_read_b64_tr_b16 a[170:171], v218 offset:37376
    v_fma_f32 v235, v147, s20, v237
    v_exp_f32 v234, v234
    v_add_f32 v239, v239, v232
    v_exp_f32 v235, v235
    v_mfma_f32_32x32x16_bf16 v[160:175], a[140:143], a[76:79], v[160:175]
    ds_read_b64_tr_b16 a[172:173], v219 offset:36864
    v_add_f32 v239, v239, v233
    v_cvt_pk_bf16_f32 v192, v232, v233
    v_fma_f32 v232, v148, s20, v237
    v_fma_f32 v233, v149, s20, v237
    v_exp_f32 v232, v232
    v_add_f32 v239, v239, v234
    v_mfma_f32_32x32x16_bf16 v[64:79], a[176:179], v[200:203], v[64:79]
    ds_read_b64_tr_b16 a[174:175], v219 offset:37376
    v_exp_f32 v233, v233
    v_add_f32 v239, v239, v235
    v_cvt_pk_bf16_f32 v193, v234, v235
    v_fma_f32 v234, v150, s20, v237
    v_fma_f32 v235, v151, s20, v237
    v_mfma_f32_32x32x16_bf16 v[80:95], a[180:183], v[200:203], v[80:95]
    buffer_load_dwordx4 v222, s[8:11], s24 offen offset:2048 lds
    ds_read_b64_tr_b16 a[176:177], v216 offset:40960
    ds_read_b64_tr_b16 a[178:179], v216 offset:41472
    v_exp_f32 v234, v234
    v_add_f32 v239, v239, v232
    v_exp_f32 v235, v235
    v_mfma_f32_32x32x16_bf16 v[96:111], a[184:187], v[200:203], v[96:111]
    ds_read_b64_tr_b16 a[180:181], v217 offset:40960
    ds_read_b64_tr_b16 a[182:183], v217 offset:41472
    v_add_f32 v239, v239, v233
    v_cvt_pk_bf16_f32 v194, v232, v233
    v_fma_f32 v232, v152, s20, v237
    v_fma_f32 v233, v153, s20, v237
    v_exp_f32 v232, v232
    v_mfma_f32_32x32x16_bf16 a[0:15], a[188:191], v[200:203], a[0:15]
    ds_read_b64_tr_b16 a[184:185], v218 offset:40960
    ds_read_b64_tr_b16 a[186:187], v218 offset:41472
    v_add_f32 v239, v239, v234
    v_exp_f32 v233, v233
    v_add_f32 v239, v239, v235
    v_cvt_pk_bf16_f32 v195, v234, v235
    v_fma_f32 v234, v154, s20, v237
    v_mfma_f32_32x32x16_bf16 v[64:79], a[192:195], v[204:207], v[64:79]
    buffer_load_dwordx4 v223, s[8:11], s24 offen offset:3072 lds
    s_add_u32 s24, s24, 0x10000
    ds_read_b64_tr_b16 a[188:189], v219 offset:40960
    ds_read_b64_tr_b16 a[190:191], v219 offset:41472
    v_fma_f32 v235, v155, s20, v237
    v_exp_f32 v234, v234
    v_add_f32 v239, v239, v232
    v_mfma_f32_32x32x16_bf16 v[80:95], a[196:199], v[204:207], v[80:95]
    ds_read_b64_tr_b16 a[192:193], v216 offset:45056
    ds_read_b64_tr_b16 a[194:195], v216 offset:45568
    v_exp_f32 v235, v235
    v_add_f32 v239, v239, v233
    v_cvt_pk_bf16_f32 v196, v232, v233
    v_fma_f32 v232, v156, s20, v237
    v_fma_f32 v233, v157, s20, v237
    v_mfma_f32_32x32x16_bf16 v[96:111], a[200:203], v[204:207], v[96:111]
    ds_read_b64_tr_b16 a[196:197], v217 offset:45056
    ds_read_b64_tr_b16 a[198:199], v217 offset:45568
    v_exp_f32 v232, v232
    v_add_f32 v239, v239, v234
    v_exp_f32 v233, v233
    v_add_f32 v239, v239, v235
    v_mfma_f32_32x32x16_bf16 a[0:15], a[204:207], v[204:207], a[0:15]
    v_cvt_pk_bf16_f32 v197, v234, v235
    v_fma_f32 v234, v158, s20, v237
    v_fma_f32 v235, v159, s20, v237
    v_exp_f32 v234, v234
    v_add_f32 v239, v239, v232
    v_exp_f32 v235, v235
    s_waitcnt lgkmcnt(14)
    v_mfma_f32_32x32x16_bf16 v[0:15], a[144:147], v[176:179], v[0:15]
    ds_read_b64_tr_b16 a[200:201], v218 offset:45056
    ds_read_b64_tr_b16 a[202:203], v218 offset:45568
    v_add_f32 v239, v239, v233
    v_cvt_pk_bf16_f32 v198, v232, v233
    v_cmp_gt_i32 vcc, 0, v243
    v_cmp_gt_i32 s[40:41], 1, v243
    v_cmp_gt_i32 s[42:43], 2, v243
    v_cndmask_b32 v160, v160, v242, vcc
    v_mfma_f32_32x32x16_bf16 v[16:31], a[148:151], v[176:179], v[16:31]
    ds_read_b64_tr_b16 a[204:205], v219 offset:45056
    ds_read_b64_tr_b16 a[206:207], v219 offset:45568
    v_cmp_gt_i32 vcc, 3, v243
    v_cndmask_b32 v161, v161, v242, s[40:41]
    v_cmp_gt_i32 s[40:41], 8, v243
    v_cndmask_b32 v162, v162, v242, s[42:43]
    v_cmp_gt_i32 s[42:43], 9, v243
    v_cndmask_b32 v163, v163, v242, vcc
    v_mfma_f32_32x32x16_bf16 v[32:47], a[152:155], v[176:179], v[32:47]
    v_cmp_gt_i32 vcc, 10, v243
    v_cndmask_b32 v164, v164, v242, s[40:41]
    v_cmp_gt_i32 s[40:41], 11, v243
    v_cndmask_b32 v165, v165, v242, s[42:43]
    v_cmp_gt_i32 s[42:43], 16, v243
    v_cndmask_b32 v166, v166, v242, vcc
    v_cmp_gt_i32 vcc, 17, v243
    v_cndmask_b32 v167, v167, v242, s[40:41]
    v_mfma_f32_32x32x16_bf16 v[48:63], a[156:159], v[176:179], v[48:63]
    v_cmp_gt_i32 s[40:41], 18, v243
    v_cndmask_b32 v168, v168, v242, s[42:43]
    v_cmp_gt_i32 s[42:43], 19, v243
    v_cndmask_b32 v169, v169, v242, vcc
    v_cmp_gt_i32 vcc, 24, v243
    v_cndmask_b32 v170, v170, v242, s[40:41]
    v_cmp_gt_i32 s[40:41], 25, v243
    v_cndmask_b32 v171, v171, v242, s[42:43]
    v_mfma_f32_32x32x16_bf16 v[0:15], a[160:163], v[180:183], v[0:15]
    v_cmp_gt_i32 s[42:43], 26, v243
    v_cndmask_b32 v172, v172, v242, vcc
    v_cmp_gt_i32 vcc, 27, v243
    v_cndmask_b32 v173, v173, v242, s[40:41]
    s_nop 0
    v_cndmask_b32 v174, v174, v242, s[42:43]
    s_nop 0
    v_cndmask_b32 v175, v175, v242, vcc
    v_mfma_f32_32x32x16_bf16 v[16:31], a[164:167], v[180:183], v[16:31]
    v_fma_f32 v232, v160, s20, v237
    v_fma_f32 v233, v161, s20, v237
    v_exp_f32 v232, v232
    v_add_f32 v239, v239, v234
    v_exp_f32 v233, v233
    v_add_f32 v239, v239, v235
    v_mfma_f32_32x32x16_bf16 v[32:47], a[168:171], v[180:183], v[32:47]
    v_cvt_pk_bf16_f32 v199, v234, v235
    v_fma_f32 v234, v162, s20, v237
    v_fma_f32 v235, v163, s20, v237
    v_exp_f32 v234, v234
    v_add_f32 v239, v239, v232
    v_exp_f32 v235, v235
    s_waitcnt lgkmcnt(14)
    v_mfma_f32_32x32x16_bf16 v[48:63], a[172:175], v[180:183], v[48:63]
    v_add_f32 v239, v239, v233
    v_cvt_pk_bf16_f32 v200, v232, v233
    v_fma_f32 v232, v164, s20, v237
    v_fma_f32 v233, v165, s20, v237
    v_exp_f32 v232, v232
    v_add_f32 v239, v239, v234
    s_waitcnt lgkmcnt(0)
    s_barrier
    s_mov_b32 m0, s64
    s_nop 0
    buffer_load_dwordx4 v224, s[12:15], s25 offen offset:0 lds
    v_exp_f32 v233, v233
    v_add_f32 v239, v239, v235
    v_cvt_pk_bf16_f32 v201, v234, v235
    buffer_load_dwordx4 v225, s[12:15], s25 offen offset:1024 lds
    v_fma_f32 v234, v166, s20, v237
    v_fma_f32 v235, v167, s20, v237
    v_exp_f32 v234, v234
    buffer_load_dwordx4 v226, s[12:15], s25 offen offset:2048 lds
    v_add_f32 v239, v239, v232
    v_exp_f32 v235, v235
    v_add_f32 v239, v239, v233
    buffer_load_dwordx4 v227, s[12:15], s25 offen offset:3072 lds
    s_add_u32 s25, s25, 0x10000
    v_cvt_pk_bf16_f32 v202, v232, v233
    v_fma_f32 v232, v168, s20, v237
    v_fma_f32 v233, v169, s20, v237
    v_exp_f32 v232, v232
    v_add_f32 v239, v239, v234
    v_exp_f32 v233, v233
    v_add_f32 v239, v239, v235
    v_cvt_pk_bf16_f32 v203, v234, v235
    v_fma_f32 v234, v170, s20, v237
    v_fma_f32 v235, v171, s20, v237
    v_exp_f32 v234, v234
    v_add_f32 v239, v239, v232
    v_exp_f32 v235, v235
    v_add_f32 v239, v239, v233
    v_cvt_pk_bf16_f32 v204, v232, v233
    v_fma_f32 v232, v172, s20, v237
    v_fma_f32 v233, v173, s20, v237
    v_exp_f32 v232, v232
    v_add_f32 v239, v239, v234
    v_exp_f32 v233, v233
    v_add_f32 v239, v239, v235
    v_cvt_pk_bf16_f32 v205, v234, v235
    v_fma_f32 v234, v174, s20, v237
    v_fma_f32 v235, v175, s20, v237
    v_exp_f32 v234, v234
    v_add_f32 v239, v239, v232
    v_exp_f32 v235, v235
    v_add_f32 v239, v239, v233
    v_cvt_pk_bf16_f32 v206, v232, v233
    v_add_f32 v239, v239, v234
    v_add_f32 v239, v239, v235
    v_cvt_pk_bf16_f32 v207, v234, v235
    s_nop 1
    s_waitcnt lgkmcnt(0)
    s_cmp_eq_u32 s29, 0
    s_cbranch_scc1 L_drain_0b
    s_branch L_ts_0
L_last_01:
    s_waitcnt lgkmcnt(8)
    v_mfma_f32_32x32x16_bf16 v[112:127], a[80:83], a[16:19], 0
    v_fma_f32 v234, v162, s20, v237
    v_fma_f32 v235, v163, s20, v237
    v_exp_f32 v234, v234
    v_add_f32 v239, v239, v232
    v_exp_f32 v235, v235
    v_add_f32 v239, v239, v233
    v_mfma_f32_32x32x16_bf16 v[112:127], a[84:87], a[20:23], v[112:127]
    s_waitcnt vmcnt(0) lgkmcnt(0)
    s_barrier
    s_mov_b32 s10, s52
    s_mov_b32 s14, s52
    s_mov_b32 s6, s50
    s_add_u32 s24, s49, s75
    s_mov_b32 s25, s24
    v_cvt_pk_bf16_f32 v200, v232, v233
    v_fma_f32 v232, v164, s20, v237
    v_mfma_f32_32x32x16_bf16 v[112:127], a[88:91], a[24:27], v[112:127]
    v_lshrrev_b32 v132, 12, v220
    v_mul_u32_u24 v132, 0x3000, v132
    v_add_u32 v128, v220, v132
    v_add_u32 v129, v221, v132
    v_add_u32 v129, 0xc00, v129
    v_add_u32 v130, v222, v132
    v_add_u32 v130, 0x1800, v130
    v_add_u32 v131, v223, v132
    v_add_u32 v131, 0x2400, v131
    v_mfma_f32_32x32x16_bf16 v[112:127], a[92:95], a[28:31], v[112:127]
    s_add_u32 s32, s48, s77
    s_mov_b32 s33, s61
    s_mov_b32 m0, s33
    s_add_u32 s33, s33, 0x1000
    buffer_load_dwordx4 v128, s[4:7], s32 offen offset:0 nt lds
    v_fma_f32 v233, v165, s20, v237
    v_exp_f32 v232, v232
    v_add_f32 v239, v239, v234
    v_mfma_f32_32x32x16_bf16 v[112:127], a[96:99], a[32:35], v[112:127]
    buffer_load_dwordx4 v129, s[4:7], s32 offen offset:1024 nt lds
    v_exp_f32 v233, v233
    v_add_f32 v239, v239, v235
    v_cvt_pk_bf16_f32 v201, v234, v235
    v_fma_f32 v234, v166, s20, v237
    v_fma_f32 v235, v167, s20, v237
    v_mfma_f32_32x32x16_bf16 v[112:127], a[100:103], a[36:39], v[112:127]
    v_exp_f32 v234, v234
    v_add_f32 v239, v239, v232
    v_exp_f32 v235, v235
    v_add_f32 v239, v239, v233
    v_cvt_pk_bf16_f32 v202, v232, v233
    v_fma_f32 v232, v168, s20, v237
    v_mfma_f32_32x32x16_bf16 v[112:127], a[104:107], a[40:43], v[112:127]
    buffer_load_dwordx4 v130, s[4:7], s32 offen offset:2048 nt lds
    v_fma_f32 v233, v169, s20, v237
    v_exp_f32 v232, v232
    v_add_f32 v239, v239, v234
    v_exp_f32 v233, v233
    v_add_f32 v239, v239, v235
    v_mfma_f32_32x32x16_bf16 v[112:127], a[108:111], a[44:47], v[112:127]
    buffer_load_dwordx4 v131, s[4:7], s32 offen offset:3072 nt lds
    v_cvt_pk_bf16_f32 v203, v234, v235
    v_fma_f32 v234, v170, s20, v237
    v_fma_f32 v235, v171, s20, v237
    v_exp_f32 v234, v234
    v_add_f32 v239, v239, v232
    v_mfma_f32_32x32x16_bf16 v[144:159], a[80:83], a[48:51], 0
    v_exp_f32 v235, v235
    v_add_f32 v239, v239, v233
    v_cvt_pk_bf16_f32 v204, v232, v233
    v_fma_f32 v232, v172, s20, v237
    v_fma_f32 v233, v173, s20, v237
    v_exp_f32 v232, v232
    v_mfma_f32_32x32x16_bf16 v[144:159], a[84:87], a[52:55], v[144:159]
    s_mov_b32 m0, s33
    s_add_u32 s32, s32, 0x10000
    buffer_load_dwordx4 v128, s[4:7], s32 offen offset:0 nt lds
    v_add_f32 v239, v239, v234
    v_exp_f32 v233, v233
    v_add_f32 v239, v239, v235
    v_cvt_pk_bf16_f32 v205, v234, v235
    v_mfma_f32_32x32x16_bf16 v[144:159], a[88:91], a[56:59], v[144:159]
    buffer_load_dwordx4 v129, s[4:7], s32 offen offset:1024 nt lds
    v_fma_f32 v234, v174, s20, v237
    v_fma_f32 v235, v175, s20, v237
    v_exp_f32 v234, v234
    v_add_f32 v239, v239, v232
    v_exp_f32 v235, v235
    v_mfma_f32_32x32x16_bf16 v[144:159], a[92:95], a[60:63], v[144:159]
    v_add_f32 v239, v239, v233
    v_cvt_pk_bf16_f32 v206, v232, v233
    v_add_f32 v239, v239, v234
    v_add_f32 v239, v239, v235
    v_cvt_pk_bf16_f32 v207, v234, v235
    v_cmp_gt_i32 vcc, 0, v243
    v_cmp_gt_i32 s[40:41], 1, v243
    v_cmp_gt_i32 s[42:43], 2, v243
    v_mfma_f32_32x32x16_bf16 v[144:159], a[96:99], a[64:67], v[144:159]
    buffer_load_dwordx4 v130, s[4:7], s32 offen offset:2048 nt lds
    v_cndmask_b32 v112, v112, v242, vcc
    v_cmp_gt_i32 vcc, 3, v243
    v_cndmask_b32 v113, v113, v242, s[40:41]
    v_cmp_gt_i32 s[40:41], 8, v243
    v_cndmask_b32 v114, v114, v242, s[42:43]
    v_cmp_gt_i32 s[42:43], 9, v243
    v_cndmask_b32 v115, v115, v242, vcc
    v_mfma_f32_32x32x16_bf16 v[144:159], a[100:103], a[68:71], v[144:159]
    buffer_load_dwordx4 v131, s[4:7], s32 offen offset:3072 nt lds
    v_cmp_gt_i32 vcc, 10, v243
    v_cndmask_b32 v116, v116, v242, s[40:41]
    v_cmp_gt_i32 s[40:41], 11, v243
    v_cndmask_b32 v117, v117, v242, s[42:43]
    v_cmp_gt_i32 s[42:43], 16, v243
    v_cndmask_b32 v118, v118, v242, vcc
    v_cmp_gt_i32 vcc, 17, v243
    v_mfma_f32_32x32x16_bf16 v[144:159], a[104:107], a[72:75], v[144:159]
    v_cndmask_b32 v119, v119, v242, s[40:41]
    v_cmp_gt_i32 s[40:41], 18, v243
    v_cndmask_b32 v120, v120, v242, s[42:43]
    v_cmp_gt_i32 s[42:43], 19, v243
    v_cndmask_b32 v121, v121, v242, vcc
    v_cmp_gt_i32 vcc, 24, v243
    v_cndmask_b32 v122, v122, v242, s[40:41]
    v_cmp_gt_i32 s[40:41], 25, v243
    v_mfma_f32_32x32x16_bf16 v[144:159], a[108:111], a[76:79], v[144:159]
    s_mov_b32 m0, s66
    s_add_u32 s26, s24, 0x4000
    buffer_load_dwordx4 v220, s[8:11], s24 offen offset:0 lds
    v_cndmask_b32 v123, v123, v242, s[42:43]
    v_cmp_gt_i32 s[42:43], 26, v243
    v_cndmask_b32 v124, v124, v242, vcc
    v_cmp_gt_i32 vcc, 27, v243
    v_cndmask_b32 v125, v125, v242, s[40:41]
    v_mfma_f32_32x32x16_bf16 v[64:79], a[144:147], v[192:195], v[64:79]
    s_nop 0
    v_cndmask_b32 v126, v126, v242, s[42:43]
    s_nop 0
    v_cndmask_b32 v127, v127, v242, vcc
    v_fma_f32 v232, v112, s20, v236
    v_fma_f32 v233, v113, s20, v236
    v_exp_f32 v232, v232
    v_mfma_f32_32x32x16_bf16 v[80:95], a[148:151], v[192:195], v[80:95]
    ds_read_b64_tr_b16 a[144:145], v216 offset:32768
    v_exp_f32 v233, v233
    v_fma_f32 v234, v114, s20, v236
    v_fma_f32 v235, v115, s20, v236
    v_exp_f32 v234, v234
    v_add_f32 v238, v238, v232
    v_mfma_f32_32x32x16_bf16 v[96:111], a[152:155], v[192:195], v[96:111]
    buffer_load_dwordx4 v221, s[8:11], s24 offen offset:1024 lds
    ds_read_b64_tr_b16 a[146:147], v216 offset:33280
    v_exp_f32 v235, v235
    v_add_f32 v238, v238, v233
    v_cvt_pk_bf16_f32 v176, v232, v233
    v_fma_f32 v232, v116, s20, v236
    v_fma_f32 v233, v117, s20, v236
    v_mfma_f32_32x32x16_bf16 a[0:15], a[156:159], v[192:195], a[0:15]
    ds_read_b64_tr_b16 a[148:149], v217 offset:32768
    v_exp_f32 v232, v232
    v_add_f32 v238, v238, v234
    v_exp_f32 v233, v233
    v_add_f32 v238, v238, v235
    v_cvt_pk_bf16_f32 v177, v234, v235
    v_mfma_f32_32x32x16_bf16 v[64:79], a[160:163], v[196:199], v[64:79]
    ds_read_b64_tr_b16 a[150:151], v217 offset:33280
    v_fma_f32 v234, v118, s20, v236
    v_fma_f32 v235, v119, s20, v236
    v_exp_f32 v234, v234
    v_add_f32 v238, v238, v232
    v_exp_f32 v235, v235
    v_mfma_f32_32x32x16_bf16 v[80:95], a[164:167], v[196:199], v[80:95]
    buffer_load_dwordx4 v222, s[8:11], s24 offen offset:2048 lds
    ds_read_b64_tr_b16 a[152:153], v218 offset:32768
    v_add_f32 v238, v238, v233
    v_cvt_pk_bf16_f32 v178, v232, v233
    v_fma_f32 v232, v120, s20, v236
    v_fma_f32 v233, v121, s20, v236
    v_exp_f32 v232, v232
    v_mfma_f32_32x32x16_bf16 v[96:111], a[168:171], v[196:199], v[96:111]
    ds_read_b64_tr_b16 a[154:155], v218 offset:33280
    v_add_f32 v238, v238, v234
    v_exp_f32 v233, v233
    v_add_f32 v238, v238, v235
    v_cvt_pk_bf16_f32 v179, v234, v235
    v_fma_f32 v234, v122, s20, v236
    v_fma_f32 v235, v123, s20, v236
    v_mfma_f32_32x32x16_bf16 a[0:15], a[172:175], v[196:199], a[0:15]
    ds_read_b64_tr_b16 a[156:157], v219 offset:32768
    v_exp_f32 v234, v234
    v_add_f32 v238, v238, v232
    v_exp_f32 v235, v235
    v_add_f32 v238, v238, v233
    v_cvt_pk_bf16_f32 v180, v232, v233
    v_mfma_f32_32x32x16_bf16 v[160:175], a[112:115], a[48:51], 0
    buffer_load_dwordx4 v223, s[8:11], s24 offen offset:3072 lds
    ds_read_b64_tr_b16 a[158:159], v219 offset:33280
    v_fma_f32 v232, v124, s20, v236
    v_fma_f32 v233, v125, s20, v236
    v_exp_f32 v232, v232
    v_add_f32 v238, v238, v234
    v_mfma_f32_32x32x16_bf16 v[160:175], a[116:119], a[52:55], v[160:175]
    ds_read_b64_tr_b16 a[160:161], v216 offset:36864
    v_exp_f32 v233, v233
    v_add_f32 v238, v238, v235
    v_cvt_pk_bf16_f32 v181, v234, v235
    v_fma_f32 v234, v126, s20, v236
    v_fma_f32 v235, v127, s20, v236
    v_mfma_f32_32x32x16_bf16 v[160:175], a[120:123], a[56:59], v[160:175]
    ds_read_b64_tr_b16 a[162:163], v216 offset:37376
    v_exp_f32 v234, v234
    v_add_f32 v238, v238, v232
    v_exp_f32 v235, v235
    v_add_f32 v238, v238, v233
    v_cvt_pk_bf16_f32 v182, v232, v233
    v_mfma_f32_32x32x16_bf16 v[160:175], a[124:127], a[60:63], v[160:175]
    s_mov_b32 m0, s70
    s_add_u32 s24, s24, 0x20000
    buffer_load_dwordx4 v220, s[8:11], s26 offen offset:0 lds
    ds_read_b64_tr_b16 a[164:165], v217 offset:36864
    v_add_f32 v238, v238, v234
    v_add_f32 v238, v238, v235
    v_cvt_pk_bf16_f32 v183, v234, v235
    v_fma_f32 v232, v144, s20, v237
    v_mfma_f32_32x32x16_bf16 v[160:175], a[128:131], a[64:67], v[160:175]
    ds_read_b64_tr_b16 a[166:167], v217 offset:37376
    v_fma_f32 v233, v145, s20, v237
    v_exp_f32 v232, v232
    v_exp_f32 v233, v233
    v_fma_f32 v234, v146, s20, v237
    v_fma_f32 v235, v147, s20, v237
    v_mfma_f32_32x32x16_bf16 v[160:175], a[132:135], a[68:71], v[160:175]
    ds_read_b64_tr_b16 a[168:169], v218 offset:36864
    v_exp_f32 v234, v234
    v_add_f32 v239, v239, v232
    v_exp_f32 v235, v235
    v_add_f32 v239, v239, v233
    v_cvt_pk_bf16_f32 v192, v232, v233
    v_mfma_f32_32x32x16_bf16 v[160:175], a[136:139], a[72:75], v[160:175]
    buffer_load_dwordx4 v221, s[8:11], s26 offen offset:1024 lds
    ds_read_b64_tr_b16 a[170:171], v218 offset:37376
    v_fma_f32 v232, v148, s20, v237
    v_fma_f32 v233, v149, s20, v237
    v_exp_f32 v232, v232
    v_add_f32 v239, v239, v234
    v_mfma_f32_32x32x16_bf16 v[160:175], a[140:143], a[76:79], v[160:175]
    ds_read_b64_tr_b16 a[172:173], v219 offset:36864
    v_exp_f32 v233, v233
    v_add_f32 v239, v239, v235
    v_cvt_pk_bf16_f32 v193, v234, v235
    v_fma_f32 v234, v150, s20, v237
    v_fma_f32 v235, v151, s20, v237
    v_mfma_f32_32x32x16_bf16 v[64:79], a[176:179], v[200:203], v[64:79]
    ds_read_b64_tr_b16 a[174:175], v219 offset:37376
    v_exp_f32 v234, v234
    v_add_f32 v239, v239, v232
    v_exp_f32 v235, v235
    v_add_f32 v239, v239, v233
    v_cvt_pk_bf16_f32 v194, v232, v233
    v_mfma_f32_32x32x16_bf16 v[80:95], a[180:183], v[200:203], v[80:95]
    buffer_load_dwordx4 v222, s[8:11], s26 offen offset:2048 lds
    ds_read_b64_tr_b16 a[176:177], v216 offset:40960
    ds_read_b64_tr_b16 a[178:179], v216 offset:41472
    v_fma_f32 v232, v152, s20, v237
    v_fma_f32 v233, v153, s20, v237
    v_exp_f32 v232, v232
    v_add_f32 v239, v239, v234
    v_mfma_f32_32x32x16_bf16 v[96:111], a[184:187], v[200:203], v[96:111]
    ds_read_b64_tr_b16 a[180:181], v217 offset:40960
    ds_read_b64_tr_b16 a[182:183], v217 offset:41472
    v_exp_f32 v233, v233
    v_add_f32 v239, v239, v235
    v_cvt_pk_bf16_f32 v195, v234, v235
    v_fma_f32 v234, v154, s20, v237
    v_fma_f32 v235, v155, s20, v237
    v_mfma_f32_32x32x16_bf16 a[0:15], a[188:191], v[200:203], a[0:15]
    ds_read_b64_tr_b16 a[184:185], v218 offset:40960
    ds_read_b64_tr_b16 a[186:187], v218 offset:41472
    v_exp_f32 v234, v234
    v_add_f32 v239, v239, v232
    v_exp_f32 v235, v235
    v_add_f32 v239, v239, v233
    v_mfma_f32_32x32x16_bf16 v[64:79], a[192:195], v[204:207], v[64:79]
    buffer_load_dwordx4 v223, s[8:11], s26 offen offset:3072 lds
    ds_read_b64_tr_b16 a[188:189], v219 offset:40960
    ds_read_b64_tr_b16 a[190:191], v219 offset:41472
    v_cvt_pk_bf16_f32 v196, v232, v233
    v_fma_f32 v232, v156, s20, v237
    v_fma_f32 v233, v157, s20, v237
    v_exp_f32 v232, v232
    v_mfma_f32_32x32x16_bf16 v[80:95], a[196:199], v[204:207], v[80:95]
    ds_read_b64_tr_b16 a[192:193], v216 offset:45056
    ds_read_b64_tr_b16 a[194:195], v216 offset:45568
    v_add_f32 v239, v239, v234
    v_exp_f32 v233, v233
    v_add_f32 v239, v239, v235
    v_cvt_pk_bf16_f32 v197, v234, v235
    v_fma_f32 v234, v158, s20, v237
    v_mfma_f32_32x32x16_bf16 v[96:111], a[200:203], v[204:207], v[96:111]
    ds_read_b64_tr_b16 a[196:197], v217 offset:45056
    ds_read_b64_tr_b16 a[198:199], v217 offset:45568
    v_fma_f32 v235, v159, s20, v237
    v_exp_f32 v234, v234
    v_add_f32 v239, v239, v232
    v_exp_f32 v235, v235
    v_mfma_f32_32x32x16_bf16 a[0:15], a[204:207], v[204:207], a[0:15]
    v_add_f32 v239, v239, v233
    v_cvt_pk_bf16_f32 v198, v232, v233
    v_cmp_gt_i32 vcc, 0, v243
    v_cmp_gt_i32 s[40:41], 1, v243
    v_cmp_gt_i32 s[42:43], 2, v243
    v_cndmask_b32 v160, v160, v242, vcc
    v_cmp_gt_i32 vcc, 3, v243
    v_cndmask_b32 v161, v161, v242, s[40:41]
    s_waitcnt lgkmcnt(14)
    v_mfma_f32_32x32x16_bf16 v[0:15], a[144:147], v[176:179], v[0:15]
    ds_read_b64_tr_b16 a[200:201], v218 offset:45056
    ds_read_b64_tr_b16 a[202:203], v218 offset:45568
    v_cmp_gt_i32 s[40:41], 8, v243
    v_cndmask_b32 v162, v162, v242, s[42:43]
    v_cmp_gt_i32 s[42:43], 9, v243
    v_cndmask_b32 v163, v163, v242, vcc
    v_cmp_gt_i32 vcc, 10, v243
    v_cndmask_b32 v164, v164, v242, s[40:41]
    v_mfma_f32_32x32x16_bf16 v[16:31], a[148:151], v[176:179], v[16:31]
    ds_read_b64_tr_b16 a[204:205], v219 offset:45056
    ds_read_b64_tr_b16 a[206:207], v219 offset:45568
    v_cmp_gt_i32 s[40:41], 11, v243
    v_cndmask_b32 v165, v165, v242, s[42:43]
    v_cmp_gt_i32 s[42:43], 16, v243
    v_cndmask_b32 v166, v166, v242, vcc
    v_cmp_gt_i32 vcc, 17, v243
    v_cndmask_b32 v167, v167, v242, s[40:41]
    v_mfma_f32_32x32x16_bf16 v[32:47], a[152:155], v[176:179], v[32:47]
    v_cmp_gt_i32 s[40:41], 18, v243
    v_cndmask_b32 v168, v168, v242, s[42:43]
    v_cmp_gt_i32 s[42:43], 19, v243
    v_cndmask_b32 v169, v169, v242, vcc
    v_cmp_gt_i32 vcc, 24, v243
    v_cndmask_b32 v170, v170, v242, s[40:41]
    v_cmp_gt_i32 s[40:41], 25, v243
    v_cndmask_b32 v171, v171, v242, s[42:43]
    v_mfma_f32_32x32x16_bf16 v[48:63], a[156:159], v[176:179], v[48:63]
    v_cmp_gt_i32 s[42:43], 26, v243
    v_cndmask_b32 v172, v172, v242, vcc
    v_cmp_gt_i32 vcc, 27, v243
    v_cndmask_b32 v173, v173, v242, s[40:41]
    s_nop 0
    v_cndmask_b32 v174, v174, v242, s[42:43]
    s_nop 0
    v_cndmask_b32 v175, v175, v242, vcc
    v_mfma_f32_32x32x16_bf16 v[0:15], a[160:163], v[180:183], v[0:15]
    v_fma_f32 v232, v160, s20, v237
    v_fma_f32 v233, v161, s20, v237
    v_exp_f32 v232, v232
    v_add_f32 v239, v239, v234
    v_exp_f32 v233, v233
    v_add_f32 v239, v239, v235
    v_mfma_f32_32x32x16_bf16 v[16:31], a[164:167], v[180:183], v[16:31]
    v_cvt_pk_bf16_f32 v199, v234, v235
    v_fma_f32 v234, v162, s20, v237
    v_fma_f32 v235, v163, s20, v237
    v_exp_f32 v234, v234
    v_add_f32 v239, v239, v232
    v_exp_f32 v235, v235
    v_mfma_f32_32x32x16_bf16 v[32:47], a[168:171], v[180:183], v[32:47]
    v_add_f32 v239, v239, v233
    v_cvt_pk_bf16_f32 v200, v232, v233
    v_fma_f32 v232, v164, s20, v237
    v_fma_f32 v233, v165, s20, v237
    v_exp_f32 v232, v232
    v_add_f32 v239, v239, v234
    s_waitcnt lgkmcnt(14)
    v_mfma_f32_32x32x16_bf16 v[48:63], a[172:175], v[180:183], v[48:63]
    v_exp_f32 v233, v233
    v_add_f32 v239, v239, v235
    v_cvt_pk_bf16_f32 v201, v234, v235
    v_fma_f32 v234, v166, s20, v237
    v_fma_f32 v235, v167, s20, v237
    v_exp_f32 v234, v234
    s_waitcnt lgkmcnt(0)
    s_barrier
    s_mov_b32 m0, s68
    s_add_u32 s27, s25, 0x4000
    buffer_load_dwordx4 v224, s[12:15], s25 offen offset:0 lds
    v_add_f32 v239, v239, v232
    v_exp_f32 v235, v235
    v_add_f32 v239, v239, v233
    buffer_load_dwordx4 v225, s[12:15], s25 offen offset:1024 lds
    v_cvt_pk_bf16_f32 v202, v232, v233
    v_fma_f32 v232, v168, s20, v237
    v_fma_f32 v233, v169, s20, v237
    buffer_load_dwordx4 v226, s[12:15], s25 offen offset:2048 lds
    v_exp_f32 v232, v232
    v_add_f32 v239, v239, v234
    v_exp_f32 v233, v233
    buffer_load_dwordx4 v227, s[12:15], s25 offen offset:3072 lds
    v_add_f32 v239, v239, v235
    v_cvt_pk_bf16_f32 v203, v234, v235
    v_fma_f32 v234, v170, s20, v237
    s_mov_b32 m0, s72
    s_add_u32 s25, s25, 0x20000
    buffer_load_dwordx4 v224, s[12:15], s27 offen offset:0 lds
    v_fma_f32 v235, v171, s20, v237
    v_exp_f32 v234, v234
    v_add_f32 v239, v239, v232
    buffer_load_dwordx4 v225, s[12:15], s27 offen offset:1024 lds
    v_exp_f32 v235, v235
    v_add_f32 v239, v239, v233
    v_cvt_pk_bf16_f32 v204, v232, v233
    buffer_load_dwordx4 v226, s[12:15], s27 offen offset:2048 lds
    v_fma_f32 v232, v172, s20, v237
    v_fma_f32 v233, v173, s20, v237
    v_exp_f32 v232, v232
    buffer_load_dwordx4 v227, s[12:15], s27 offen offset:3072 lds
    v_add_f32 v239, v239, v234
    v_exp_f32 v233, v233
    v_add_f32 v239, v239, v235
    v_cvt_pk_bf16_f32 v205, v234, v235
    v_fma_f32 v234, v174, s20, v237
    v_fma_f32 v235, v175, s20, v237
    v_exp_f32 v234, v234
    v_add_f32 v239, v239, v232
    v_exp_f32 v235, v235
    v_add_f32 v239, v239, v233
    v_cvt_pk_bf16_f32 v206, v232, v233
    v_add_f32 v239, v239, v234
    v_add_f32 v239, v239, v235
    v_cvt_pk_bf16_f32 v207, v234, v235
    s_xor_b32 s39, s37, s79
    s_mov_b32 s37, s79
    v_xor_b32 v208, s39, v208
    v_xor_b32 v209, s39, v209
    v_xor_b32 v210, s39, v210
    v_xor_b32 v211, s39, v211
    v_xor_b32 v212, s39, v212
    v_xor_b32 v213, s39, v213
    v_xor_b32 v214, s39, v214
    v_xor_b32 v215, s39, v215
    v_xor_b32 v216, s39, v216
    v_xor_b32 v217, s39, v217
    v_xor_b32 v218, s39, v218
    v_xor_b32 v219, s39, v219
    s_waitcnt lgkmcnt(0)
    s_branch L_ts_1
L_trig_1:
    s_cmp_lg_u32 s23, 1
    s_cbranch_scc1 L_event_1
L_lastsel_1:
    s_cmp_eq_u32 s29, 2
    s_cbranch_scc1 L_last_11
    s_waitcnt lgkmcnt(8)
    v_mfma_f32_32x32x16_bf16 v[112:127], a[80:83], a[16:19], 0
    v_fma_f32 v234, v162, s20, v237
    v_fma_f32 v235, v163, s20, v237
    v_exp_f32 v234, v234
    v_add_f32 v239, v239, v232
    v_exp_f32 v235, v235
    v_add_f32 v239, v239, v233
    v_mfma_f32_32x32x16_bf16 v[112:127], a[84:87], a[20:23], v[112:127]
    s_waitcnt vmcnt(0) lgkmcnt(0)
    s_barrier
    s_mov_b32 s10, s52
    s_mov_b32 s14, s52
    s_mov_b32 s6, s50
    s_add_u32 s24, s49, s74
    s_mov_b32 s25, s24
    v_cvt_pk_bf16_f32 v200, v232, v233
    v_fma_f32 v232, v164, s20, v237
    v_mfma_f32_32x32x16_bf16 v[112:127], a[88:91], a[24:27], v[112:127]
    v_lshrrev_b32 v132, 12, v220
    v_mul_u32_u24 v132, 0x3000, v132
    v_add_u32 v128, v220, v132
    v_add_u32 v129, v221, v132
    v_add_u32 v129, 0xc00, v129
    v_add_u32 v130, v222, v132
    v_add_u32 v130, 0x1800, v130
    v_add_u32 v131, v223, v132
    v_add_u32 v131, 0x2400, v131
    v_mfma_f32_32x32x16_bf16 v[112:127], a[92:95], a[28:31], v[112:127]
    s_add_u32 s32, s48, s76
    s_mov_b32 s33, s60
    s_mov_b32 m0, s33
    s_add_u32 s33, s33, 0x1000
    buffer_load_dwordx4 v128, s[4:7], s32 offen offset:0 nt lds
    v_fma_f32 v233, v165, s20, v237
    v_exp_f32 v232, v232
    v_add_f32 v239, v239, v234
    v_mfma_f32_32x32x16_bf16 v[112:127], a[96:99], a[32:35], v[112:127]
    buffer_load_dwordx4 v129, s[4:7], s32 offen offset:1024 nt lds
    v_exp_f32 v233, v233
    v_add_f32 v239, v239, v235
    v_cvt_pk_bf16_f32 v201, v234, v235
    v_fma_f32 v234, v166, s20, v237
    v_fma_f32 v235, v167, s20, v237
    v_mfma_f32_32x32x16_bf16 v[112:127], a[100:103], a[36:39], v[112:127]
    v_exp_f32 v234, v234
    v_add_f32 v239, v239, v232
    v_exp_f32 v235, v235
    v_add_f32 v239, v239, v233
    v_cvt_pk_bf16_f32 v202, v232, v233
    v_fma_f32 v232, v168, s20, v237
    v_mfma_f32_32x32x16_bf16 v[112:127], a[104:107], a[40:43], v[112:127]
    buffer_load_dwordx4 v130, s[4:7], s32 offen offset:2048 nt lds
    v_fma_f32 v233, v169, s20, v237
    v_exp_f32 v232, v232
    v_add_f32 v239, v239, v234
    v_exp_f32 v233, v233
    v_add_f32 v239, v239, v235
    v_mfma_f32_32x32x16_bf16 v[112:127], a[108:111], a[44:47], v[112:127]
    buffer_load_dwordx4 v131, s[4:7], s32 offen offset:3072 nt lds
    v_cvt_pk_bf16_f32 v203, v234, v235
    v_fma_f32 v234, v170, s20, v237
    v_fma_f32 v235, v171, s20, v237
    v_exp_f32 v234, v234
    v_add_f32 v239, v239, v232
    v_mfma_f32_32x32x16_bf16 v[144:159], a[80:83], a[48:51], 0
    v_exp_f32 v235, v235
    v_add_f32 v239, v239, v233
    v_cvt_pk_bf16_f32 v204, v232, v233
    v_fma_f32 v232, v172, s20, v237
    v_fma_f32 v233, v173, s20, v237
    v_exp_f32 v232, v232
    v_mfma_f32_32x32x16_bf16 v[144:159], a[84:87], a[52:55], v[144:159]
    s_mov_b32 m0, s33
    s_add_u32 s32, s32, 0x10000
    buffer_load_dwordx4 v128, s[4:7], s32 offen offset:0 nt lds
    v_add_f32 v239, v239, v234
    v_exp_f32 v233, v233
    v_add_f32 v239, v239, v235
    v_cvt_pk_bf16_f32 v205, v234, v235
    v_mfma_f32_32x32x16_bf16 v[144:159], a[88:91], a[56:59], v[144:159]
    buffer_load_dwordx4 v129, s[4:7], s32 offen offset:1024 nt lds
    v_fma_f32 v234, v174, s20, v237
    v_fma_f32 v235, v175, s20, v237
    v_exp_f32 v234, v234
    v_add_f32 v239, v239, v232
    v_exp_f32 v235, v235
    v_mfma_f32_32x32x16_bf16 v[144:159], a[92:95], a[60:63], v[144:159]
    v_add_f32 v239, v239, v233
    v_cvt_pk_bf16_f32 v206, v232, v233
    v_add_f32 v239, v239, v234
    v_add_f32 v239, v239, v235
    v_cvt_pk_bf16_f32 v207, v234, v235
    v_cmp_gt_i32 vcc, 0, v243
    v_cmp_gt_i32 s[40:41], 1, v243
    v_cmp_gt_i32 s[42:43], 2, v243
    v_mfma_f32_32x32x16_bf16 v[144:159], a[96:99], a[64:67], v[144:159]
    buffer_load_dwordx4 v130, s[4:7], s32 offen offset:2048 nt lds
    v_cndmask_b32 v112, v112, v242, vcc
    v_cmp_gt_i32 vcc, 3, v243
    v_cndmask_b32 v113, v113, v242, s[40:41]
    v_cmp_gt_i32 s[40:41], 8, v243
    v_cndmask_b32 v114, v114, v242, s[42:43]
    v_cmp_gt_i32 s[42:43], 9, v243
    v_cndmask_b32 v115, v115, v242, vcc
    v_mfma_f32_32x32x16_bf16 v[144:159], a[100:103], a[68:71], v[144:159]
    buffer_load_dwordx4 v131, s[4:7], s32 offen offset:3072 nt lds
    v_cmp_gt_i32 vcc, 10, v243
    v_cndmask_b32 v116, v116, v242, s[40:41]
    v_cmp_gt_i32 s[40:41], 11, v243
    v_cndmask_b32 v117, v117, v242, s[42:43]
    v_cmp_gt_i32 s[42:43], 16, v243
    v_cndmask_b32 v118, v118, v242, vcc
    v_cmp_gt_i32 vcc, 17, v243
    v_mfma_f32_32x32x16_bf16 v[144:159], a[104:107], a[72:75], v[144:159]
    v_cndmask_b32 v119, v119, v242, s[40:41]
    v_cmp_gt_i32 s[40:41], 18, v243
    v_cndmask_b32 v120, v120, v242, s[42:43]
    v_cmp_gt_i32 s[42:43], 19, v243
    v_cndmask_b32 v121, v121, v242, vcc
    v_cmp_gt_i32 vcc, 24, v243
    v_cndmask_b32 v122, v122, v242, s[40:41]
    v_cmp_gt_i32 s[40:41], 25, v243
    v_mfma_f32_32x32x16_bf16 v[144:159], a[108:111], a[76:79], v[144:159]
    s_add_u32 s32, s32, 0x10000
    s_sub_u32 s33, s59, 0x4000
    s_mov_b32 m0, s33
    s_add_u32 s33, s33, 0x1000
    buffer_load_dwordx4 v128, s[4:7], s32 offen offset:0 nt lds
    v_cndmask_b32 v123, v123, v242, s[42:43]
    v_cmp_gt_i32 s[42:43], 26, v243
    v_cndmask_b32 v124, v124, v242, vcc
    v_cmp_gt_i32 vcc, 27, v243
    v_mfma_f32_32x32x16_bf16 v[64:79], a[144:147], v[192:195], v[64:79]
    buffer_load_dwordx4 v129, s[4:7], s32 offen offset:1024 nt lds
    v_cndmask_b32 v125, v125, v242, s[40:41]
    s_nop 0
    v_cndmask_b32 v126, v126, v242, s[42:43]
    s_nop 0
    v_cndmask_b32 v127, v127, v242, vcc
    v_fma_f32 v232, v112, s20, v236
    v_fma_f32 v233, v113, s20, v236
    v_mfma_f32_32x32x16_bf16 v[80:95], a[148:151], v[192:195], v[80:95]
    ds_read_b64_tr_b16 a[144:145], v216 offset:49152
    v_exp_f32 v232, v232
    v_exp_f32 v233, v233
    v_fma_f32 v234, v114, s20, v236
    v_fma_f32 v235, v115, s20, v236
    v_mfma_f32_32x32x16_bf16 v[96:111], a[152:155], v[192:195], v[96:111]
    buffer_load_dwordx4 v130, s[4:7], s32 offen offset:2048 nt lds
    ds_read_b64_tr_b16 a[146:147], v216 offset:49664
    v_exp_f32 v234, v234
    v_add_f32 v238, v238, v232
    v_exp_f32 v235, v235
    v_add_f32 v238, v238, v233
    v_mfma_f32_32x32x16_bf16 a[0:15], a[156:159], v[192:195], a[0:15]
    buffer_load_dwordx4 v131, s[4:7], s32 offen offset:3072 nt lds
    ds_read_b64_tr_b16 a[148:149], v217 offset:49152
    v_cvt_pk_bf16_f32 v176, v232, v233
    v_fma_f32 v232, v116, s20, v236
    v_fma_f32 v233, v117, s20, v236
    v_exp_f32 v232, v232
    v_add_f32 v238, v238, v234
    v_mfma_f32_32x32x16_bf16 v[64:79], a[160:163], v[196:199], v[64:79]
    ds_read_b64_tr_b16 a[150:151], v217 offset:49664
    v_exp_f32 v233, v233
    v_add_f32 v238, v238, v235
    v_cvt_pk_bf16_f32 v177, v234, v235
    v_fma_f32 v234, v118, s20, v236
    v_fma_f32 v235, v119, s20, v236
    v_mfma_f32_32x32x16_bf16 v[80:95], a[164:167], v[196:199], v[80:95]
    s_mov_b32 m0, s33
    s_add_u32 s32, s32, 0x10000
    buffer_load_dwordx4 v128, s[4:7], s32 offen offset:0 nt lds
    ds_read_b64_tr_b16 a[152:153], v218 offset:49152
    v_exp_f32 v234, v234
    v_add_f32 v238, v238, v232
    v_mfma_f32_32x32x16_bf16 v[96:111], a[168:171], v[196:199], v[96:111]
    buffer_load_dwordx4 v129, s[4:7], s32 offen offset:1024 nt lds
    ds_read_b64_tr_b16 a[154:155], v218 offset:49664
    v_exp_f32 v235, v235
    v_add_f32 v238, v238, v233
    v_cvt_pk_bf16_f32 v178, v232, v233
    v_fma_f32 v232, v120, s20, v236
    v_fma_f32 v233, v121, s20, v236
    v_mfma_f32_32x32x16_bf16 a[0:15], a[172:175], v[196:199], a[0:15]
    ds_read_b64_tr_b16 a[156:157], v219 offset:49152
    v_exp_f32 v232, v232
    v_add_f32 v238, v238, v234
    v_exp_f32 v233, v233
    v_add_f32 v238, v238, v235
    v_cvt_pk_bf16_f32 v179, v234, v235
    v_mfma_f32_32x32x16_bf16 v[160:175], a[112:115], a[48:51], 0
    buffer_load_dwordx4 v130, s[4:7], s32 offen offset:2048 nt lds
    ds_read_b64_tr_b16 a[158:159], v219 offset:49664
    v_fma_f32 v234, v122, s20, v236
    v_fma_f32 v235, v123, s20, v236
    v_exp_f32 v234, v234
    v_add_f32 v238, v238, v232
    v_mfma_f32_32x32x16_bf16 v[160:175], a[116:119], a[52:55], v[160:175]
    buffer_load_dwordx4 v131, s[4:7], s32 offen offset:3072 nt lds
    ds_read_b64_tr_b16 a[160:161], v216 offset:53248
    v_exp_f32 v235, v235
    v_add_f32 v238, v238, v233
    v_cvt_pk_bf16_f32 v180, v232, v233
    v_fma_f32 v232, v124, s20, v236
    v_fma_f32 v233, v125, s20, v236
    v_mfma_f32_32x32x16_bf16 v[160:175], a[120:123], a[56:59], v[160:175]
    ds_read_b64_tr_b16 a[162:163], v216 offset:53760
    v_exp_f32 v232, v232
    v_add_f32 v238, v238, v234
    v_exp_f32 v233, v233
    v_add_f32 v238, v238, v235
    v_cvt_pk_bf16_f32 v181, v234, v235
    s_mov_b32 m0, s62
    v_mfma_f32_32x32x16_bf16 v[160:175], a[124:127], a[60:63], v[160:175]
    buffer_load_dwordx4 v220, s[8:11], s24 offen offset:0 lds
    ds_read_b64_tr_b16 a[164:165], v217 offset:53248
    v_fma_f32 v234, v126, s20, v236
    v_fma_f32 v235, v127, s20, v236
    v_exp_f32 v234, v234
    v_add_f32 v238, v238, v232
    v_mfma_f32_32x32x16_bf16 v[160:175], a[128:131], a[64:67], v[160:175]
    ds_read_b64_tr_b16 a[166:167], v217 offset:53760
    v_exp_f32 v235, v235
    v_add_f32 v238, v238, v233
    v_cvt_pk_bf16_f32 v182, v232, v233
    v_add_f32 v238, v238, v234
    v_add_f32 v238, v238, v235
    v_cvt_pk_bf16_f32 v183, v234, v235
    v_mfma_f32_32x32x16_bf16 v[160:175], a[132:135], a[68:71], v[160:175]
    buffer_load_dwordx4 v221, s[8:11], s24 offen offset:1024 lds
    ds_read_b64_tr_b16 a[168:169], v218 offset:53248
    v_fma_f32 v232, v144, s20, v237
    v_fma_f32 v233, v145, s20, v237
    v_exp_f32 v232, v232
    v_exp_f32 v233, v233
    v_mfma_f32_32x32x16_bf16 v[160:175], a[136:139], a[72:75], v[160:175]
    ds_read_b64_tr_b16 a[170:171], v218 offset:53760
    v_fma_f32 v234, v146, s20, v237
    v_fma_f32 v235, v147, s20, v237
    v_exp_f32 v234, v234
    v_add_f32 v239, v239, v232
    v_exp_f32 v235, v235
    v_mfma_f32_32x32x16_bf16 v[160:175], a[140:143], a[76:79], v[160:175]
    buffer_load_dwordx4 v222, s[8:11], s24 offen offset:2048 lds
    ds_read_b64_tr_b16 a[172:173], v219 offset:53248
    v_add_f32 v239, v239, v233
    v_cvt_pk_bf16_f32 v192, v232, v233
    v_fma_f32 v232, v148, s20, v237
    v_fma_f32 v233, v149, s20, v237
    v_exp_f32 v232, v232
    v_mfma_f32_32x32x16_bf16 v[64:79], a[176:179], v[200:203], v[64:79]
    ds_read_b64_tr_b16 a[174:175], v219 offset:53760
    v_add_f32 v239, v239, v234
    v_exp_f32 v233, v233
    v_add_f32 v239, v239, v235
    v_cvt_pk_bf16_f32 v193, v234, v235
    v_fma_f32 v234, v150, s20, v237
    v_fma_f32 v235, v151, s20, v237
    v_mfma_f32_32x32x16_bf16 v[80:95], a[180:183], v[200:203], v[80:95]
    ds_read_b64_tr_b16 a[176:177], v216 offset:57344
    ds_read_b64_tr_b16 a[178:179], v216 offset:57856
    v_exp_f32 v234, v234
    v_add_f32 v239, v239, v232
    v_exp_f32 v235, v235
    v_add_f32 v239, v239, v233
    v_mfma_f32_32x32x16_bf16 v[96:111], a[184:187], v[200:203], v[96:111]
    buffer_load_dwordx4 v223, s[8:11], s24 offen offset:3072 lds
    s_add_u32 s24, s24, 0x10000
    ds_read_b64_tr_b16 a[180:181], v217 offset:57344
    ds_read_b64_tr_b16 a[182:183], v217 offset:57856
    v_cvt_pk_bf16_f32 v194, v232, v233
    v_fma_f32 v232, v152, s20, v237
    v_fma_f32 v233, v153, s20, v237
    v_mfma_f32_32x32x16_bf16 a[0:15], a[188:191], v[200:203], a[0:15]
    ds_read_b64_tr_b16 a[184:185], v218 offset:57344
    ds_read_b64_tr_b16 a[186:187], v218 offset:57856
    v_exp_f32 v232, v232
    v_add_f32 v239, v239, v234
    v_exp_f32 v233, v233
    v_add_f32 v239, v239, v235
    s_mov_b32 m0, s64
    v_mfma_f32_32x32x16_bf16 v[64:79], a[192:195], v[204:207], v[64:79]
    buffer_load_dwordx4 v224, s[12:15], s25 offen offset:0 lds
    ds_read_b64_tr_b16 a[188:189], v219 offset:57344
    ds_read_b64_tr_b16 a[190:191], v219 offset:57856
    v_cvt_pk_bf16_f32 v195, v234, v235
    v_fma_f32 v234, v154, s20, v237
    v_fma_f32 v235, v155, s20, v237
    v_mfma_f32_32x32x16_bf16 v[80:95], a[196:199], v[204:207], v[80:95]
    ds_read_b64_tr_b16 a[192:193], v216 offset:61440
    ds_read_b64_tr_b16 a[194:195], v216 offset:61952
    v_exp_f32 v234, v234
    v_add_f32 v239, v239, v232
    v_exp_f32 v235, v235
    v_add_f32 v239, v239, v233
    v_mfma_f32_32x32x16_bf16 v[96:111], a[200:203], v[204:207], v[96:111]
    buffer_load_dwordx4 v225, s[12:15], s25 offen offset:1024 lds
    ds_read_b64_tr_b16 a[196:197], v217 offset:61440
    ds_read_b64_tr_b16 a[198:199], v217 offset:61952
    v_cvt_pk_bf16_f32 v196, v232, v233
    v_fma_f32 v232, v156, s20, v237
    v_fma_f32 v233, v157, s20, v237
    v_exp_f32 v232, v232
    v_mfma_f32_32x32x16_bf16 a[0:15], a[204:207], v[204:207], a[0:15]
    v_add_f32 v239, v239, v234
    v_exp_f32 v233, v233
    v_add_f32 v239, v239, v235
    v_cvt_pk_bf16_f32 v197, v234, v235
    v_fma_f32 v234, v158, s20, v237
    v_fma_f32 v235, v159, s20, v237
    s_waitcnt lgkmcnt(14)
    v_mfma_f32_32x32x16_bf16 v[0:15], a[144:147], v[176:179], v[0:15]
    ds_read_b64_tr_b16 a[200:201], v218 offset:61440
    ds_read_b64_tr_b16 a[202:203], v218 offset:61952
    v_exp_f32 v234, v234
    v_add_f32 v239, v239, v232
    v_exp_f32 v235, v235
    v_add_f32 v239, v239, v233
    v_mfma_f32_32x32x16_bf16 v[16:31], a[148:151], v[176:179], v[16:31]
    buffer_load_dwordx4 v226, s[12:15], s25 offen offset:2048 lds
    ds_read_b64_tr_b16 a[204:205], v219 offset:61440
    ds_read_b64_tr_b16 a[206:207], v219 offset:61952
    v_cvt_pk_bf16_f32 v198, v232, v233
    v_cmp_gt_i32 vcc, 0, v243
    v_cmp_gt_i32 s[40:41], 1, v243
    v_cmp_gt_i32 s[42:43], 2, v243
    v_cndmask_b32 v160, v160, v242, vcc
    v_mfma_f32_32x32x16_bf16 v[32:47], a[152:155], v[176:179], v[32:47]
    v_cmp_gt_i32 vcc, 3, v243
    v_cndmask_b32 v161, v161, v242, s[40:41]
    v_cmp_gt_i32 s[40:41], 8, v243
    v_cndmask_b32 v162, v162, v242, s[42:43]
    v_cmp_gt_i32 s[42:43], 9, v243
    v_cndmask_b32 v163, v163, v242, vcc
    v_cmp_gt_i32 vcc, 10, v243
    v_cndmask_b32 v164, v164, v242, s[40:41]
    v_mfma_f32_32x32x16_bf16 v[48:63], a[156:159], v[176:179], v[48:63]
    buffer_load_dwordx4 v227, s[12:15], s25 offen offset:3072 lds
    s_add_u32 s25, s25, 0x10000
    v_cmp_gt_i32 s[40:41], 11, v243
    v_cndmask_b32 v165, v165, v242, s[42:43]
    v_cmp_gt_i32 s[42:43], 16, v243
    v_cndmask_b32 v166, v166, v242, vcc
    v_cmp_gt_i32 vcc, 17, v243
    v_cndmask_b32 v167, v167, v242, s[40:41]
    v_mfma_f32_32x32x16_bf16 v[0:15], a[160:163], v[180:183], v[0:15]
    v_cmp_gt_i32 s[40:41], 18, v243
    v_cndmask_b32 v168, v168, v242, s[42:43]
    v_cmp_gt_i32 s[42:43], 19, v243
    v_cndmask_b32 v169, v169, v242, vcc
    v_cmp_gt_i32 vcc, 24, v243
    v_cndmask_b32 v170, v170, v242, s[40:41]
    v_cmp_gt_i32 s[40:41], 25, v243
    v_cndmask_b32 v171, v171, v242, s[42:43]
    v_mfma_f32_32x32x16_bf16 v[16:31], a[164:167], v[180:183], v[16:31]
    v_cmp_gt_i32 s[42:43], 26, v243
    v_cndmask_b32 v172, v172, v242, vcc
    v_cmp_gt_i32 vcc, 27, v243
    v_cndmask_b32 v173, v173, v242, s[40:41]
    s_nop 0
    v_cndmask_b32 v174, v174, v242, s[42:43]
    s_nop 0
    v_cndmask_b32 v175, v175, v242, vcc
    v_mfma_f32_32x32x16_bf16 v[32:47], a[168:171], v[180:183], v[32:47]
    v_fma_f32 v232, v160, s20, v237
    v_fma_f32 v233, v161, s20, v237
    v_exp_f32 v232, v232
    v_add_f32 v239, v239, v234
    v_exp_f32 v233, v233
    v_add_f32 v239, v239, v235
    s_waitcnt lgkmcnt(14)
    v_mfma_f32_32x32x16_bf16 v[48:63], a[172:175], v[180:183], v[48:63]
    v_cvt_pk_bf16_f32 v199, v234, v235
    v_fma_f32 v234, v162, s20, v237
    v_fma_f32 v235, v163, s20, v237
    v_exp_f32 v234, v234
    v_add_f32 v239, v239, v232
    v_exp_f32 v235, v235
    s_waitcnt lgkmcnt(0)
    s_barrier
    v_add_f32 v239, v239, v233
    v_cvt_pk_bf16_f32 v200, v232, v233
    v_fma_f32 v232, v164, s20, v237
    v_fma_f32 v233, v165, s20, v237
    v_exp_f32 v232, v232
    v_add_f32 v239, v239, v234
    v_exp_f32 v233, v233
    v_add_f32 v239, v239, v235
    v_cvt_pk_bf16_f32 v201, v234, v235
    v_fma_f32 v234, v166, s20, v237
    v_fma_f32 v235, v167, s20, v237
    v_exp_f32 v234, v234
    v_add_f32 v239, v239, v232
    v_exp_f32 v235, v235
    v_add_f32 v239, v239, v233
    v_cvt_pk_bf16_f32 v202, v232, v233
    v_fma_f32 v232, v168, s20, v237
    v_fma_f32 v233, v169, s20, v237
    v_exp_f32 v232, v232
    v_add_f32 v239, v239, v234
    v_exp_f32 v233, v233
    v_add_f32 v239, v239, v235
    v_cvt_pk_bf16_f32 v203, v234, v235
    v_fma_f32 v234, v170, s20, v237
    v_fma_f32 v235, v171, s20, v237
    v_exp_f32 v234, v234
    v_add_f32 v239, v239, v232
    v_exp_f32 v235, v235
    v_add_f32 v239, v239, v233
    v_cvt_pk_bf16_f32 v204, v232, v233
    v_fma_f32 v232, v172, s20, v237
    v_fma_f32 v233, v173, s20, v237
    v_exp_f32 v232, v232
    v_add_f32 v239, v239, v234
    v_exp_f32 v233, v233
    v_add_f32 v239, v239, v235
    v_cvt_pk_bf16_f32 v205, v234, v235
    v_fma_f32 v234, v174, s20, v237
    v_fma_f32 v235, v175, s20, v237
    v_exp_f32 v234, v234
    v_add_f32 v239, v239, v232
    v_exp_f32 v235, v235
    v_add_f32 v239, v239, v233
    v_cvt_pk_bf16_f32 v206, v232, v233
    v_add_f32 v239, v239, v234
    v_add_f32 v239, v239, v235
    v_cvt_pk_bf16_f32 v207, v234, v235
    s_nop 1
    s_waitcnt lgkmcnt(0)
    s_cmp_eq_u32 s29, 0
    s_cbranch_scc1 L_drain_0b
    s_branch L_ts_0
L_last_11:
    s_waitcnt lgkmcnt(8)
    v_mfma_f32_32x32x16_bf16 v[112:127], a[80:83], a[16:19], 0
    v_fma_f32 v234, v162, s20, v237
    v_fma_f32 v235, v163, s20, v237
    v_exp_f32 v234, v234
    v_add_f32 v239, v239, v232
    v_exp_f32 v235, v235
    v_add_f32 v239, v239, v233
    v_mfma_f32_32x32x16_bf16 v[112:127], a[84:87], a[20:23], v[112:127]
    s_waitcnt vmcnt(0) lgkmcnt(0)
    s_barrier
    s_mov_b32 s10, s52
    s_mov_b32 s14, s52
    s_mov_b32 s6, s50
    s_add_u32 s24, s49, s75
    s_mov_b32 s25, s24
    v_cvt_pk_bf16_f32 v200, v232, v233
    v_fma_f32 v232, v164, s20, v237
    v_mfma_f32_32x32x16_bf16 v[112:127], a[88:91], a[24:27], v[112:127]
    v_lshrrev_b32 v132, 12, v220
    v_mul_u32_u24 v132, 0x3000, v132
    v_add_u32 v128, v220, v132
    v_add_u32 v129, v221, v132
    v_add_u32 v129, 0xc00, v129
    v_add_u32 v130, v222, v132
    v_add_u32 v130, 0x1800, v130
    v_add_u32 v131, v223, v132
    v_add_u32 v131, 0x2400, v131
    v_mfma_f32_32x32x16_bf16 v[112:127], a[92:95], a[28:31], v[112:127]
    s_add_u32 s32, s48, s77
    s_mov_b32 s33, s61
    s_mov_b32 m0, s33
    s_add_u32 s33, s33, 0x1000
    buffer_load_dwordx4 v128, s[4:7], s32 offen offset:0 nt lds
    v_fma_f32 v233, v165, s20, v237
    v_exp_f32 v232, v232
    v_add_f32 v239, v239, v234
    v_mfma_f32_32x32x16_bf16 v[112:127], a[96:99], a[32:35], v[112:127]
    buffer_load_dwordx4 v129, s[4:7], s32 offen offset:1024 nt lds
    v_exp_f32 v233, v233
    v_add_f32 v239, v239, v235
    v_cvt_pk_bf16_f32 v201, v234, v235
    v_fma_f32 v234, v166, s20, v237
    v_fma_f32 v235, v167, s20, v237
    v_mfma_f32_32x32x16_bf16 v[112:127], a[100:103], a[36:39], v[112:127]
    v_exp_f32 v234, v234
    v_add_f32 v239, v239, v232
    v_exp_f32 v235, v235
    v_add_f32 v239, v239, v233
    v_cvt_pk_bf16_f32 v202, v232, v233
    v_fma_f32 v232, v168, s20, v237
    v_mfma_f32_32x32x16_bf16 v[112:127], a[104:107], a[40:43], v[112:127]
    buffer_load_dwordx4 v130, s[4:7], s32 offen offset:2048 nt lds
    v_fma_f32 v233, v169, s20, v237
    v_exp_f32 v232, v232
    v_add_f32 v239, v239, v234
    v_exp_f32 v233, v233
    v_add_f32 v239, v239, v235
    v_mfma_f32_32x32x16_bf16 v[112:127], a[108:111], a[44:47], v[112:127]
    buffer_load_dwordx4 v131, s[4:7], s32 offen offset:3072 nt lds
    v_cvt_pk_bf16_f32 v203, v234, v235
    v_fma_f32 v234, v170, s20, v237
    v_fma_f32 v235, v171, s20, v237
    v_exp_f32 v234, v234
    v_add_f32 v239, v239, v232
    v_mfma_f32_32x32x16_bf16 v[144:159], a[80:83], a[48:51], 0
    v_exp_f32 v235, v235
    v_add_f32 v239, v239, v233
    v_cvt_pk_bf16_f32 v204, v232, v233
    v_fma_f32 v232, v172, s20, v237
    v_fma_f32 v233, v173, s20, v237
    v_exp_f32 v232, v232
    v_mfma_f32_32x32x16_bf16 v[144:159], a[84:87], a[52:55], v[144:159]
    s_mov_b32 m0, s33
    s_add_u32 s32, s32, 0x10000
    buffer_load_dwordx4 v128, s[4:7], s32 offen offset:0 nt lds
    v_add_f32 v239, v239, v234
    v_exp_f32 v233, v233
    v_add_f32 v239, v239, v235
    v_cvt_pk_bf16_f32 v205, v234, v235
    v_mfma_f32_32x32x16_bf16 v[144:159], a[88:91], a[56:59], v[144:159]
    buffer_load_dwordx4 v129, s[4:7], s32 offen offset:1024 nt lds
    v_fma_f32 v234, v174, s20, v237
    v_fma_f32 v235, v175, s20, v237
    v_exp_f32 v234, v234
    v_add_f32 v239, v239, v232
    v_exp_f32 v235, v235
    v_mfma_f32_32x32x16_bf16 v[144:159], a[92:95], a[60:63], v[144:159]
    v_add_f32 v239, v239, v233
    v_cvt_pk_bf16_f32 v206, v232, v233
    v_add_f32 v239, v239, v234
    v_add_f32 v239, v239, v235
    v_cvt_pk_bf16_f32 v207, v234, v235
    v_cmp_gt_i32 vcc, 0, v243
    v_cmp_gt_i32 s[40:41], 1, v243
    v_cmp_gt_i32 s[42:43], 2, v243
    v_mfma_f32_32x32x16_bf16 v[144:159], a[96:99], a[64:67], v[144:159]
    buffer_load_dwordx4 v130, s[4:7], s32 offen offset:2048 nt lds
    v_cndmask_b32 v112, v112, v242, vcc
    v_cmp_gt_i32 vcc, 3, v243
    v_cndmask_b32 v113, v113, v242, s[40:41]
    v_cmp_gt_i32 s[40:41], 8, v243
    v_cndmask_b32 v114, v114, v242, s[42:43]
    v_cmp_gt_i32 s[42:43], 9, v243
    v_cndmask_b32 v115, v115, v242, vcc
    v_mfma_f32_32x32x16_bf16 v[144:159], a[100:103], a[68:71], v[144:159]
    buffer_load_dwordx4 v131, s[4:7], s32 offen offset:3072 nt lds
    v_cmp_gt_i32 vcc, 10, v243
    v_cndmask_b32 v116, v116, v242, s[40:41]
    v_cmp_gt_i32 s[40:41], 11, v243
    v_cndmask_b32 v117, v117, v242, s[42:43]
    v_cmp_gt_i32 s[42:43], 16, v243
    v_cndmask_b32 v118, v118, v242, vcc
    v_cmp_gt_i32 vcc, 17, v243
    v_mfma_f32_32x32x16_bf16 v[144:159], a[104:107], a[72:75], v[144:159]
    v_cndmask_b32 v119, v119, v242, s[40:41]
    v_cmp_gt_i32 s[40:41], 18, v243
    v_cndmask_b32 v120, v120, v242, s[42:43]
    v_cmp_gt_i32 s[42:43], 19, v243
    v_cndmask_b32 v121, v121, v242, vcc
    v_cmp_gt_i32 vcc, 24, v243
    v_cndmask_b32 v122, v122, v242, s[40:41]
    v_cmp_gt_i32 s[40:41], 25, v243
    v_mfma_f32_32x32x16_bf16 v[144:159], a[108:111], a[76:79], v[144:159]
    s_mov_b32 m0, s66
    s_add_u32 s26, s24, 0x4000
    buffer_load_dwordx4 v220, s[8:11], s24 offen offset:0 lds
    v_cndmask_b32 v123, v123, v242, s[42:43]
    v_cmp_gt_i32 s[42:43], 26, v243
    v_cndmask_b32 v124, v124, v242, vcc
    v_cmp_gt_i32 vcc, 27, v243
    v_cndmask_b32 v125, v125, v242, s[40:41]
    v_mfma_f32_32x32x16_bf16 v[64:79], a[144:147], v[192:195], v[64:79]
    buffer_load_dwordx4 v221, s[8:11], s24 offen offset:1024 lds
    s_nop 0
    v_cndmask_b32 v126, v126, v242, s[42:43]
    s_nop 0
    v_cndmask_b32 v127, v127, v242, vcc
    v_fma_f32 v232, v112, s20, v236
    v_fma_f32 v233, v113, s20, v236
    v_mfma_f32_32x32x16_bf16 v[80:95], a[148:151], v[192:195], v[80:95]
    ds_read_b64_tr_b16 a[144:145], v216 offset:49152
    v_exp_f32 v232, v232
    v_exp_f32 v233, v233
    v_fma_f32 v234, v114, s20, v236
    v_fma_f32 v235, v115, s20, v236
    v_mfma_f32_32x32x16_bf16 v[96:111], a[152:155], v[192:195], v[96:111]
    buffer_load_dwordx4 v222, s[8:11], s24 offen offset:2048 lds
    ds_read_b64_tr_b16 a[146:147], v216 offset:49664
    v_exp_f32 v234, v234
    v_add_f32 v238, v238, v232
    v_exp_f32 v235, v235
    v_add_f32 v238, v238, v233
    v_mfma_f32_32x32x16_bf16 a[0:15], a[156:159], v[192:195], a[0:15]
    ds_read_b64_tr_b16 a[148:149], v217 offset:49152
    v_cvt_pk_bf16_f32 v176, v232, v233
    v_fma_f32 v232, v116, s20, v236
    v_fma_f32 v233, v117, s20, v236
    v_exp_f32 v232, v232
    v_add_f32 v238, v238, v234
    v_mfma_f32_32x32x16_bf16 v[64:79], a[160:163], v[196:199], v[64:79]
    buffer_load_dwordx4 v223, s[8:11], s24 offen offset:3072 lds
    ds_read_b64_tr_b16 a[150:151], v217 offset:49664
    v_exp_f32 v233, v233
    v_add_f32 v238, v238, v235
    v_cvt_pk_bf16_f32 v177, v234, v235
    v_fma_f32 v234, v118, s20, v236
    v_fma_f32 v235, v119, s20, v236
    v_mfma_f32_32x32x16_bf16 v[80:95], a[164:167], v[196:199], v[80:95]
    ds_read_b64_tr_b16 a[152:153], v218 offset:49152
    v_exp_f32 v234, v234
    v_add_f32 v238, v238, v232
    v_exp_f32 v235, v235
    v_add_f32 v238, v238, v233
    v_cvt_pk_bf16_f32 v178, v232, v233
    v_mfma_f32_32x32x16_bf16 v[96:111], a[168:171], v[196:199], v[96:111]
    s_mov_b32 m0, s70
    s_add_u32 s24, s24, 0x20000
    buffer_load_dwordx4 v220, s[8:11], s26 offen offset:0 lds
    ds_read_b64_tr_b16 a[154:155], v218 offset:49664
    v_fma_f32 v232, v120, s20, v236
    v_fma_f32 v233, v121, s20, v236
    v_exp_f32 v232, v232
    v_mfma_f32_32x32x16_bf16 a[0:15], a[172:175], v[196:199], a[0:15]
    ds_read_b64_tr_b16 a[156:157], v219 offset:49152
    v_add_f32 v238, v238, v234
    v_exp_f32 v233, v233
    v_add_f32 v238, v238, v235
    v_cvt_pk_bf16_f32 v179, v234, v235
    v_fma_f32 v234, v122, s20, v236
    v_fma_f32 v235, v123, s20, v236
    v_mfma_f32_32x32x16_bf16 v[160:175], a[112:115], a[48:51], 0
    buffer_load_dwordx4 v221, s[8:11], s26 offen offset:1024 lds
    ds_read_b64_tr_b16 a[158:159], v219 offset:49664
    v_exp_f32 v234, v234
    v_add_f32 v238, v238, v232
    v_exp_f32 v235, v235
    v_add_f32 v238, v238, v233
    v_mfma_f32_32x32x16_bf16 v[160:175], a[116:119], a[52:55], v[160:175]
    ds_read_b64_tr_b16 a[160:161], v216 offset:53248
    v_cvt_pk_bf16_f32 v180, v232, v233
    v_fma_f32 v232, v124, s20, v236
    v_fma_f32 v233, v125, s20, v236
    v_exp_f32 v232, v232
    v_add_f32 v238, v238, v234
    v_mfma_f32_32x32x16_bf16 v[160:175], a[120:123], a[56:59], v[160:175]
    buffer_load_dwordx4 v222, s[8:11], s26 offen offset:2048 lds
    ds_read_b64_tr_b16 a[162:163], v216 offset:53760
    v_exp_f32 v233, v233
    v_add_f32 v238, v238, v235
    v_cvt_pk_bf16_f32 v181, v234, v235
    v_fma_f32 v234, v126, s20, v236
    v_fma_f32 v235, v127, s20, v236
    v_mfma_f32_32x32x16_bf16 v[160:175], a[124:127], a[60:63], v[160:175]
    ds_read_b64_tr_b16 a[164:165], v217 offset:53248
    v_exp_f32 v234, v234
    v_add_f32 v238, v238, v232
    v_exp_f32 v235, v235
    v_add_f32 v238, v238, v233
    v_cvt_pk_bf16_f32 v182, v232, v233
    v_mfma_f32_32x32x16_bf16 v[160:175], a[128:131], a[64:67], v[160:175]
    buffer_load_dwordx4 v223, s[8:11], s26 offen offset:3072 lds
    ds_read_b64_tr_b16 a[166:167], v217 offset:53760
    v_add_f32 v238, v238, v234
    v_add_f32 v238, v238, v235
    v_cvt_pk_bf16_f32 v183, v234, v235
    v_fma_f32 v232, v144, s20, v237
    v_fma_f32 v233, v145, s20, v237
    v_mfma_f32_32x32x16_bf16 v[160:175], a[132:135], a[68:71], v[160:175]
    ds_read_b64_tr_b16 a[168:169], v218 offset:53248
    v_exp_f32 v232, v232
    v_exp_f32 v233, v233
    v_fma_f32 v234, v146, s20, v237
    v_fma_f32 v235, v147, s20, v237
    v_mfma_f32_32x32x16_bf16 v[160:175], a[136:139], a[72:75], v[160:175]
    s_mov_b32 m0, s68
    s_add_u32 s27, s25, 0x4000
    buffer_load_dwordx4 v224, s[12:15], s25 offen offset:0 lds
    ds_read_b64_tr_b16 a[170:171], v218 offset:53760
    v_exp_f32 v234, v234
    v_add_f32 v239, v239, v232
    v_mfma_f32_32x32x16_bf16 v[160:175], a[140:143], a[76:79], v[160:175]
    ds_read_b64_tr_b16 a[172:173], v219 offset:53248
    v_exp_f32 v235, v235
    v_add_f32 v239, v239, v233
    v_cvt_pk_bf16_f32 v192, v232, v233
    v_fma_f32 v232, v148, s20, v237
    v_fma_f32 v233, v149, s20, v237
    v_mfma_f32_32x32x16_bf16 v[64:79], a[176:179], v[200:203], v[64:79]
    buffer_load_dwordx4 v225, s[12:15], s25 offen offset:1024 lds
    ds_read_b64_tr_b16 a[174:175], v219 offset:53760
    v_exp_f32 v232, v232
    v_add_f32 v239, v239, v234
    v_exp_f32 v233, v233
    v_add_f32 v239, v239, v235
    v_mfma_f32_32x32x16_bf16 v[80:95], a[180:183], v[200:203], v[80:95]
    ds_read_b64_tr_b16 a[176:177], v216 offset:57344
    ds_read_b64_tr_b16 a[178:179], v216 offset:57856
    v_cvt_pk_bf16_f32 v193, v234, v235
    v_fma_f32 v234, v150, s20, v237
    v_fma_f32 v235, v151, s20, v237
    v_exp_f32 v234, v234
    v_add_f32 v239, v239, v232
    v_mfma_f32_32x32x16_bf16 v[96:111], a[184:187], v[200:203], v[96:111]
    buffer_load_dwordx4 v226, s[12:15], s25 offen offset:2048 lds
    ds_read_b64_tr_b16 a[180:181], v217 offset:57344
    ds_read_b64_tr_b16 a[182:183], v217 offset:57856
    v_exp_f32 v235, v235
    v_add_f32 v239, v239, v233
    v_cvt_pk_bf16_f32 v194, v232, v233
    v_fma_f32 v232, v152, s20, v237
    v_mfma_f32_32x32x16_bf16 a[0:15], a[188:191], v[200:203], a[0:15]
    ds_read_b64_tr_b16 a[184:185], v218 offset:57344
    ds_read_b64_tr_b16 a[186:187], v218 offset:57856
    v_fma_f32 v233, v153, s20, v237
    v_exp_f32 v232, v232
    v_add_f32 v239, v239, v234
    v_exp_f32 v233, v233
    v_mfma_f32_32x32x16_bf16 v[64:79], a[192:195], v[204:207], v[64:79]
    buffer_load_dwordx4 v227, s[12:15], s25 offen offset:3072 lds
    ds_read_b64_tr_b16 a[188:189], v219 offset:57344
    ds_read_b64_tr_b16 a[190:191], v219 offset:57856
    v_add_f32 v239, v239, v235
    v_cvt_pk_bf16_f32 v195, v234, v235
    v_fma_f32 v234, v154, s20, v237
    v_fma_f32 v235, v155, s20, v237
    v_mfma_f32_32x32x16_bf16 v[80:95], a[196:199], v[204:207], v[80:95]
    ds_read_b64_tr_b16 a[192:193], v216 offset:61440
    ds_read_b64_tr_b16 a[194:195], v216 offset:61952
    v_exp_f32 v234, v234
    v_add_f32 v239, v239, v232
    v_exp_f32 v235, v235
    v_add_f32 v239, v239, v233
    v_mfma_f32_32x32x16_bf16 v[96:111], a[200:203], v[204:207], v[96:111]
    s_mov_b32 m0, s72
    s_add_u32 s25, s25, 0x20000
    buffer_load_dwordx4 v224, s[12:15], s27 offen offset:0 lds
    ds_read_b64_tr_b16 a[196:197], v217 offset:61440
    ds_read_b64_tr_b16 a[198:199], v217 offset:61952
    v_cvt_pk_bf16_f32 v196, v232, v233
    v_fma_f32 v232, v156, s20, v237
    v_fma_f32 v233, v157, s20, v237
    v_mfma_f32_32x32x16_bf16 a[0:15], a[204:207], v[204:207], a[0:15]
    v_exp_f32 v232, v232
    v_add_f32 v239, v239, v234
    v_exp_f32 v233, v233
    v_add_f32 v239, v239, v235
    v_cvt_pk_bf16_f32 v197, v234, v235
    v_fma_f32 v234, v158, s20, v237
    s_waitcnt lgkmcnt(14)
    v_mfma_f32_32x32x16_bf16 v[0:15], a[144:147], v[176:179], v[0:15]
    buffer_load_dwordx4 v225, s[12:15], s27 offen offset:1024 lds
    ds_read_b64_tr_b16 a[200:201], v218 offset:61440
    ds_read_b64_tr_b16 a[202:203], v218 offset:61952
    v_fma_f32 v235, v159, s20, v237
    v_exp_f32 v234, v234
    v_add_f32 v239, v239, v232
    v_mfma_f32_32x32x16_bf16 v[16:31], a[148:151], v[176:179], v[16:31]
    ds_read_b64_tr_b16 a[204:205], v219 offset:61440
    ds_read_b64_tr_b16 a[206:207], v219 offset:61952
    v_exp_f32 v235, v235
    v_add_f32 v239, v239, v233
    v_cvt_pk_bf16_f32 v198, v232, v233
    v_cmp_gt_i32 vcc, 0, v243
    v_cmp_gt_i32 s[40:41], 1, v243
    v_mfma_f32_32x32x16_bf16 v[32:47], a[152:155], v[176:179], v[32:47]
    buffer_load_dwordx4 v226, s[12:15], s27 offen offset:2048 lds
    v_cmp_gt_i32 s[42:43], 2, v243
    v_cndmask_b32 v160, v160, v242, vcc
    v_cmp_gt_i32 vcc, 3, v243
    v_cndmask_b32 v161, v161, v242, s[40:41]
    v_cmp_gt_i32 s[40:41], 8, v243
    v_cndmask_b32 v162, v162, v242, s[42:43]
    v_cmp_gt_i32 s[42:43], 9, v243
    v_mfma_f32_32x32x16_bf16 v[48:63], a[156:159], v[176:179], v[48:63]
    v_cndmask_b32 v163, v163, v242, vcc
    v_cmp_gt_i32 vcc, 10, v243
    v_cndmask_b32 v164, v164, v242, s[40:41]
    v_cmp_gt_i32 s[40:41], 11, v243
    v_cndmask_b32 v165, v165, v242, s[42:43]
    v_cmp_gt_i32 s[42:43], 16, v243
    v_cndmask_b32 v166, v166, v242, vcc
    v_cmp_gt_i32 vcc, 17, v243
    v_mfma_f32_32x32x16_bf16 v[0:15], a[160:163], v[180:183], v[0:15]
    buffer_load_dwordx4 v227, s[12:15], s27 offen offset:3072 lds
    v_cndmask_b32 v167, v167, v242, s[40:41]
    v_cmp_gt_i32 s[40:41], 18, v243
    v_cndmask_b32 v168, v168, v242, s[42:43]
    v_cmp_gt_i32 s[42:43], 19, v243
    v_cndmask_b32 v169, v169, v242, vcc
    v_cmp_gt_i32 vcc, 24, v243
    v_cndmask_b32 v170, v170, v242, s[40:41]
    v_mfma_f32_32x32x16_bf16 v[16:31], a[164:167], v[180:183], v[16:31]
    v_cmp_gt_i32 s[40:41], 25, v243
    v_cndmask_b32 v171, v171, v242, s[42:43]
    v_cmp_gt_i32 s[42:43], 26, v243
    v_cndmask_b32 v172, v172, v242, vcc
    v_cmp_gt_i32 vcc, 27, v243
    v_cndmask_b32 v173, v173, v242, s[40:41]
    s_nop 0
    v_cndmask_b32 v174, v174, v242, s[42:43]
    v_mfma_f32_32x32x16_bf16 v[32:47], a[168:171], v[180:183], v[32:47]
    s_nop 0
    v_cndmask_b32 v175, v175, v242, vcc
    v_fma_f32 v232, v160, s20, v237
    v_fma_f32 v233, v161, s20, v237
    v_exp_f32 v232, v232
    v_add_f32 v239, v239, v234
    s_waitcnt lgkmcnt(14)
    v_mfma_f32_32x32x16_bf16 v[48:63], a[172:175], v[180:183], v[48:63]
    v_exp_f32 v233, v233
    v_add_f32 v239, v239, v235
    v_cvt_pk_bf16_f32 v199, v234, v235
    v_fma_f32 v234, v162, s20, v237
    v_fma_f32 v235, v163, s20, v237
    v_exp_f32 v234, v234
    s_waitcnt lgkmcnt(0)
    s_barrier
    v_add_f32 v239, v239, v232
    v_exp_f32 v235, v235
    v_add_f32 v239, v239, v233
    v_cvt_pk_bf16_f32 v200, v232, v233
    v_fma_f32 v232, v164, s20, v237
    v_fma_f32 v233, v165, s20, v237
    v_exp_f32 v232, v232
    v_add_f32 v239, v239, v234
    v_exp_f32 v233, v233
    v_add_f32 v239, v239, v235
    v_cvt_pk_bf16_f32 v201, v234, v235
    v_fma_f32 v234, v166, s20, v237
    v_fma_f32 v235, v167, s20, v237
    v_exp_f32 v234, v234
    v_add_f32 v239, v239, v232
    v_exp_f32 v235, v235
    v_add_f32 v239, v239, v233
    v_cvt_pk_bf16_f32 v202, v232, v233
    v_fma_f32 v232, v168, s20, v237
    v_fma_f32 v233, v169, s20, v237
    v_exp_f32 v232, v232
    v_add_f32 v239, v239, v234
    v_exp_f32 v233, v233
    v_add_f32 v239, v239, v235
    v_cvt_pk_bf16_f32 v203, v234, v235
    v_fma_f32 v234, v170, s20, v237
    v_fma_f32 v235, v171, s20, v237
    v_exp_f32 v234, v234
    v_add_f32 v239, v239, v232
    v_exp_f32 v235, v235
    v_add_f32 v239, v239, v233
    v_cvt_pk_bf16_f32 v204, v232, v233
    v_fma_f32 v232, v172, s20, v237
    v_fma_f32 v233, v173, s20, v237
    v_exp_f32 v232, v232
    v_add_f32 v239, v239, v234
    v_exp_f32 v233, v233
    v_add_f32 v239, v239, v235
    v_cvt_pk_bf16_f32 v205, v234, v235
    v_fma_f32 v234, v174, s20, v237
    v_fma_f32 v235, v175, s20, v237
    v_exp_f32 v234, v234
    v_add_f32 v239, v239, v232
    v_exp_f32 v235, v235
    v_add_f32 v239, v239, v233
    v_cvt_pk_bf16_f32 v206, v232, v233
    v_add_f32 v239, v239, v234
    v_add_f32 v239, v239, v235
    v_cvt_pk_bf16_f32 v207, v234, v235
    s_xor_b32 s39, s37, s79
    s_mov_b32 s37, s79
    v_xor_b32 v208, s39, v208
    v_xor_b32 v209, s39, v209
    v_xor_b32 v210, s39, v210
    v_xor_b32 v211, s39, v211
    v_xor_b32 v212, s39, v212
    v_xor_b32 v213, s39, v213
    v_xor_b32 v214, s39, v214
    v_xor_b32 v215, s39, v215
    v_xor_b32 v216, s39, v216
    v_xor_b32 v217, s39, v217
    v_xor_b32 v218, s39, v218
    v_xor_b32 v219, s39, v219
    s_waitcnt lgkmcnt(0)
    s_branch L_ts_1
L_drain_0:
    s_waitcnt vmcnt(0) lgkmcnt(0)
    s_barrier
    s_cmp_eq_u32 s29, 0
    s_cbranch_scc1 L_dr0_nn_13
    s_cmp_eq_u32 s29, 2
    s_cbranch_scc1 L_dr0_ns_12
    s_mov_b32 s10, s52
    s_mov_b32 s14, s52
    s_mov_b32 s6, s50
    s_add_u32 s24, s49, s74
    s_mov_b32 s25, s24
    v_lshrrev_b32 v132, 12, v220
    v_mul_u32_u24 v132, 0x3000, v132
    v_add_u32 v128, v220, v132
    v_add_u32 v129, v221, v132
    v_add_u32 v129, 0xc00, v129
    v_add_u32 v130, v222, v132
    v_add_u32 v130, 0x1800, v130
    v_add_u32 v131, v223, v132
    s_mov_b32 m0, s62
    v_add_u32 v131, 0x2400, v131
    buffer_load_dwordx4 v220, s[8:11], s24 offen offset:0 lds
    v_fma_f32 v234, v162, s20, v237
    v_fma_f32 v235, v163, s20, v237
    v_exp_f32 v234, v234
    buffer_load_dwordx4 v221, s[8:11], s24 offen offset:1024 lds
    v_add_f32 v239, v239, v232
    v_exp_f32 v235, v235
    v_add_f32 v239, v239, v233
    buffer_load_dwordx4 v222, s[8:11], s24 offen offset:2048 lds
    v_cvt_pk_bf16_f32 v200, v232, v233
    v_fma_f32 v232, v164, s20, v237
    v_fma_f32 v233, v165, s20, v237
    buffer_load_dwordx4 v223, s[8:11], s24 offen offset:3072 lds
    s_add_u32 s24, s24, 0x10000
    v_exp_f32 v232, v232
    v_add_f32 v239, v239, v234
    v_exp_f32 v233, v233
    s_add_u32 s32, s48, s76
    s_mov_b32 s33, s60
    s_mov_b32 m0, s33
    s_add_u32 s33, s33, 0x1000
    buffer_load_dwordx4 v128, s[4:7], s32 offen offset:0 nt lds
    v_add_f32 v239, v239, v235
    v_cvt_pk_bf16_f32 v201, v234, v235
    v_fma_f32 v234, v166, s20, v237
    buffer_load_dwordx4 v129, s[4:7], s32 offen offset:1024 nt lds
    v_fma_f32 v235, v167, s20, v237
    v_exp_f32 v234, v234
    v_add_f32 v239, v239, v232
    buffer_load_dwordx4 v130, s[4:7], s32 offen offset:2048 nt lds
    v_exp_f32 v235, v235
    v_add_f32 v239, v239, v233
    v_cvt_pk_bf16_f32 v202, v232, v233
    buffer_load_dwordx4 v131, s[4:7], s32 offen offset:3072 nt lds
    v_fma_f32 v232, v168, s20, v237
    v_fma_f32 v233, v169, s20, v237
    v_exp_f32 v232, v232
    s_mov_b32 m0, s33
    s_add_u32 s32, s32, 0x10000
    buffer_load_dwordx4 v128, s[4:7], s32 offen offset:0 nt lds
    v_add_f32 v239, v239, v234
    v_exp_f32 v233, v233
    v_add_f32 v239, v239, v235
    buffer_load_dwordx4 v129, s[4:7], s32 offen offset:1024 nt lds
    v_cvt_pk_bf16_f32 v203, v234, v235
    v_fma_f32 v234, v170, s20, v237
    v_fma_f32 v235, v171, s20, v237
    buffer_load_dwordx4 v130, s[4:7], s32 offen offset:2048 nt lds
    v_exp_f32 v234, v234
    v_add_f32 v239, v239, v232
    v_exp_f32 v235, v235
    buffer_load_dwordx4 v131, s[4:7], s32 offen offset:3072 nt lds
    v_add_f32 v239, v239, v233
    v_cvt_pk_bf16_f32 v204, v232, v233
    v_fma_f32 v232, v172, s20, v237
    s_add_u32 s32, s32, 0x10000
    s_sub_u32 s33, s59, 0x4000
    s_mov_b32 m0, s33
    s_add_u32 s33, s33, 0x1000
    buffer_load_dwordx4 v128, s[4:7], s32 offen offset:0 nt lds
    v_fma_f32 v233, v173, s20, v237
    v_exp_f32 v232, v232
    v_add_f32 v239, v239, v234
    buffer_load_dwordx4 v129, s[4:7], s32 offen offset:1024 nt lds
    v_exp_f32 v233, v233
    v_add_f32 v239, v239, v235
    v_cvt_pk_bf16_f32 v205, v234, v235
    buffer_load_dwordx4 v130, s[4:7], s32 offen offset:2048 nt lds
    v_fma_f32 v234, v174, s20, v237
    v_fma_f32 v235, v175, s20, v237
    v_exp_f32 v234, v234
    buffer_load_dwordx4 v131, s[4:7], s32 offen offset:3072 nt lds
    v_add_f32 v239, v239, v232
    v_exp_f32 v235, v235
    v_add_f32 v239, v239, v233
    s_mov_b32 m0, s33
    s_add_u32 s32, s32, 0x10000
    buffer_load_dwordx4 v128, s[4:7], s32 offen offset:0 nt lds
    v_cvt_pk_bf16_f32 v206, v232, v233
    v_add_f32 v239, v239, v234
    v_add_f32 v239, v239, v235
    buffer_load_dwordx4 v129, s[4:7], s32 offen offset:1024 nt lds
    v_cvt_pk_bf16_f32 v207, v234, v235
    buffer_load_dwordx4 v130, s[4:7], s32 offen offset:2048 nt lds
    buffer_load_dwordx4 v131, s[4:7], s32 offen offset:3072 nt lds
    s_branch L_dr0_ne_14
L_dr0_ns_12:
    s_mov_b32 s10, s52
    s_mov_b32 s14, s52
    s_mov_b32 s6, s50
    s_add_u32 s24, s49, s75
    s_mov_b32 s25, s24
    v_lshrrev_b32 v132, 12, v220
    v_mul_u32_u24 v132, 0x3000, v132
    v_add_u32 v128, v220, v132
    v_add_u32 v129, v221, v132
    v_add_u32 v129, 0xc00, v129
    v_add_u32 v130, v222, v132
    v_add_u32 v130, 0x1800, v130
    v_add_u32 v131, v223, v132
    v_add_u32 v131, 0x2400, v131
    s_mov_b32 m0, s66
    s_add_u32 s26, s24, 0x4000
    buffer_load_dwordx4 v220, s[8:11], s24 offen offset:0 lds
    v_fma_f32 v234, v162, s20, v237
    v_fma_f32 v235, v163, s20, v237
    v_exp_f32 v234, v234
    buffer_load_dwordx4 v221, s[8:11], s24 offen offset:1024 lds
    v_add_f32 v239, v239, v232
    v_exp_f32 v235, v235
    v_add_f32 v239, v239, v233
    buffer_load_dwordx4 v222, s[8:11], s24 offen offset:2048 lds
    v_cvt_pk_bf16_f32 v200, v232, v233
    v_fma_f32 v232, v164, s20, v237
    v_fma_f32 v233, v165, s20, v237
    buffer_load_dwordx4 v223, s[8:11], s24 offen offset:3072 lds
    v_exp_f32 v232, v232
    v_add_f32 v239, v239, v234
    v_exp_f32 v233, v233
    s_mov_b32 m0, s70
    s_add_u32 s24, s24, 0x20000
    buffer_load_dwordx4 v220, s[8:11], s26 offen offset:0 lds
    v_add_f32 v239, v239, v235
    v_cvt_pk_bf16_f32 v201, v234, v235
    v_fma_f32 v234, v166, s20, v237
    buffer_load_dwordx4 v221, s[8:11], s26 offen offset:1024 lds
    v_fma_f32 v235, v167, s20, v237
    v_exp_f32 v234, v234
    v_add_f32 v239, v239, v232
    buffer_load_dwordx4 v222, s[8:11], s26 offen offset:2048 lds
    v_exp_f32 v235, v235
    v_add_f32 v239, v239, v233
    v_cvt_pk_bf16_f32 v202, v232, v233
    buffer_load_dwordx4 v223, s[8:11], s26 offen offset:3072 lds
    v_fma_f32 v232, v168, s20, v237
    v_fma_f32 v233, v169, s20, v237
    v_exp_f32 v232, v232
    s_add_u32 s32, s48, s77
    s_mov_b32 s33, s61
    s_mov_b32 m0, s33
    s_add_u32 s33, s33, 0x1000
    buffer_load_dwordx4 v128, s[4:7], s32 offen offset:0 nt lds
    v_add_f32 v239, v239, v234
    v_exp_f32 v233, v233
    v_add_f32 v239, v239, v235
    buffer_load_dwordx4 v129, s[4:7], s32 offen offset:1024 nt lds
    v_cvt_pk_bf16_f32 v203, v234, v235
    v_fma_f32 v234, v170, s20, v237
    v_fma_f32 v235, v171, s20, v237
    buffer_load_dwordx4 v130, s[4:7], s32 offen offset:2048 nt lds
    v_exp_f32 v234, v234
    v_add_f32 v239, v239, v232
    v_exp_f32 v235, v235
    buffer_load_dwordx4 v131, s[4:7], s32 offen offset:3072 nt lds
    v_add_f32 v239, v239, v233
    v_cvt_pk_bf16_f32 v204, v232, v233
    v_fma_f32 v232, v172, s20, v237
    s_mov_b32 m0, s33
    s_add_u32 s32, s32, 0x10000
    buffer_load_dwordx4 v128, s[4:7], s32 offen offset:0 nt lds
    v_fma_f32 v233, v173, s20, v237
    v_exp_f32 v232, v232
    v_add_f32 v239, v239, v234
    buffer_load_dwordx4 v129, s[4:7], s32 offen offset:1024 nt lds
    v_exp_f32 v233, v233
    v_add_f32 v239, v239, v235
    v_cvt_pk_bf16_f32 v205, v234, v235
    buffer_load_dwordx4 v130, s[4:7], s32 offen offset:2048 nt lds
    v_fma_f32 v234, v174, s20, v237
    v_fma_f32 v235, v175, s20, v237
    v_exp_f32 v234, v234
    buffer_load_dwordx4 v131, s[4:7], s32 offen offset:3072 nt lds
    v_add_f32 v239, v239, v232
    v_exp_f32 v235, v235
    v_add_f32 v239, v239, v233
    v_cvt_pk_bf16_f32 v206, v232, v233
    v_add_f32 v239, v239, v234
    v_add_f32 v239, v239, v235
    v_cvt_pk_bf16_f32 v207, v234, v235
    s_branch L_dr0_ne_14
L_dr0_nn_13:
    v_fma_f32 v234, v162, s20, v237
    v_fma_f32 v235, v163, s20, v237
    v_exp_f32 v234, v234
    v_add_f32 v239, v239, v232
    v_exp_f32 v235, v235
    v_add_f32 v239, v239, v233
    v_cvt_pk_bf16_f32 v200, v232, v233
    v_fma_f32 v232, v164, s20, v237
    v_fma_f32 v233, v165, s20, v237
    v_exp_f32 v232, v232
    v_add_f32 v239, v239, v234
    v_exp_f32 v233, v233
    v_add_f32 v239, v239, v235
    v_cvt_pk_bf16_f32 v201, v234, v235
    v_fma_f32 v234, v166, s20, v237
    v_fma_f32 v235, v167, s20, v237
    v_exp_f32 v234, v234
    v_add_f32 v239, v239, v232
    v_exp_f32 v235, v235
    v_add_f32 v239, v239, v233
    v_cvt_pk_bf16_f32 v202, v232, v233
    v_fma_f32 v232, v168, s20, v237
    v_fma_f32 v233, v169, s20, v237
    v_exp_f32 v232, v232
    v_add_f32 v239, v239, v234
    v_exp_f32 v233, v233
    v_add_f32 v239, v239, v235
    v_cvt_pk_bf16_f32 v203, v234, v235
    v_fma_f32 v234, v170, s20, v237
    v_fma_f32 v235, v171, s20, v237
    v_exp_f32 v234, v234
    v_add_f32 v239, v239, v232
    v_exp_f32 v235, v235
    v_add_f32 v239, v239, v233
    v_cvt_pk_bf16_f32 v204, v232, v233
    v_fma_f32 v232, v172, s20, v237
    v_fma_f32 v233, v173, s20, v237
    v_exp_f32 v232, v232
    v_add_f32 v239, v239, v234
    v_exp_f32 v233, v233
    v_add_f32 v239, v239, v235
    v_cvt_pk_bf16_f32 v205, v234, v235
    v_fma_f32 v234, v174, s20, v237
    v_fma_f32 v235, v175, s20, v237
    v_exp_f32 v234, v234
    v_add_f32 v239, v239, v232
    v_exp_f32 v235, v235
    v_add_f32 v239, v239, v233
    v_cvt_pk_bf16_f32 v206, v232, v233
    v_add_f32 v239, v239, v234
    v_add_f32 v239, v239, v235
    v_cvt_pk_bf16_f32 v207, v234, v235
L_dr0_ne_14:
    s_nop 1
L_drain_0b:
    v_mfma_f32_32x32x16_bf16 v[64:79], a[144:147], v[192:195], v[64:79]
    v_mov_b32 v247, v238
    v_mov_b32 v228, v238
    s_nop 1
    v_permlane32_swap_b32 v247, v228
    v_add_f32 v228, v228, v247
    v_cmp_nge_f32 vcc, s21, v228
    s_nop 3
    s_cmp_lg_u64 vcc, 0
    s_cselect_b32 s38, s31, 0
    s_or_b32 s30, s30, s38
    v_mfma_f32_32x32x16_bf16 v[96:111], a[152:155], v[192:195], v[96:111]
    v_rcp_f32 v228, v228
    s_nop 0
    v_add_u32 v249, s59, v253
    s_mov_b32 s18, s89
    v_mul_f32 v0, v0, v228
    v_mul_f32 v1, v1, v228
    v_mul_f32 v2, v2, v228
    v_mul_f32 v3, v3, v228
    v_cvt_pk_bf16_f32 v0, v0, v1
    v_cvt_pk_bf16_f32 v1, v2, v3
    v_mfma_f32_32x32x16_bf16 v[64:79], a[160:163], v[196:199], v[64:79]
    v_mul_f32 v32, v32, v228
    v_mul_f32 v33, v33, v228
    v_mul_f32 v34, v34, v228
    v_mul_f32 v35, v35, v228
    v_cvt_pk_bf16_f32 v32, v32, v33
    v_cvt_pk_bf16_f32 v33, v34, v35
    ds_write2_b64 v249, v[0:1], v[32:33] offset0:0 offset1:16
    v_mfma_f32_32x32x16_bf16 v[96:111], a[168:171], v[196:199], v[96:111]
    v_mul_f32 v4, v4, v228
    v_mul_f32 v5, v5, v228
    v_mul_f32 v6, v6, v228
    v_mul_f32 v7, v7, v228
    v_cvt_pk_bf16_f32 v4, v4, v5
    v_cvt_pk_bf16_f32 v5, v6, v7
    v_mul_f32 v36, v36, v228
    v_mul_f32 v37, v37, v228
    v_mul_f32 v38, v38, v228
    v_mul_f32 v39, v39, v228
    v_mfma_f32_32x32x16_bf16 v[64:79], a[176:179], v[200:203], v[64:79]
    v_cvt_pk_bf16_f32 v36, v36, v37
    v_cvt_pk_bf16_f32 v37, v38, v39
    v_xor_b32 v231, 16, v249
    ds_write2_b64 v231, v[4:5], v[36:37] offset0:0 offset1:16
    v_mul_f32 v8, v8, v228
    v_mul_f32 v9, v9, v228
    v_mfma_f32_32x32x16_bf16 v[96:111], a[184:187], v[200:203], v[96:111]
    v_mul_f32 v10, v10, v228
    v_mul_f32 v11, v11, v228
    v_cvt_pk_bf16_f32 v8, v8, v9
    v_cvt_pk_bf16_f32 v9, v10, v11
    v_mul_f32 v40, v40, v228
    v_mul_f32 v41, v41, v228
    v_mul_f32 v42, v42, v228
    v_mul_f32 v43, v43, v228
    v_cvt_pk_bf16_f32 v40, v40, v41
    v_cvt_pk_bf16_f32 v41, v42, v43
    v_xor_b32 v230, 32, v249
    v_mfma_f32_32x32x16_bf16 v[64:79], a[192:195], v[204:207], v[64:79]
    ds_write2_b64 v230, v[8:9], v[40:41] offset0:0 offset1:16
    v_mul_f32 v12, v12, v228
    v_mul_f32 v13, v13, v228
    v_mul_f32 v14, v14, v228
    v_mul_f32 v15, v15, v228
    v_cvt_pk_bf16_f32 v12, v12, v13
    v_cvt_pk_bf16_f32 v13, v14, v15
    v_mfma_f32_32x32x16_bf16 v[96:111], a[200:203], v[204:207], v[96:111]
    v_mul_f32 v44, v44, v228
    v_mul_f32 v45, v45, v228
    v_mul_f32 v46, v46, v228
    v_mul_f32 v47, v47, v228
    v_cvt_pk_bf16_f32 v44, v44, v45
    v_cvt_pk_bf16_f32 v45, v46, v47
    v_xor_b32 v231, 48, v249
    ds_write2_b64 v231, v[12:13], v[44:45] offset0:0 offset1:16
    v_mfma_f32_32x32x16_bf16 v[80:95], a[148:151], v[192:195], v[80:95]
    v_mul_f32 v16, v16, v228
    v_mul_f32 v17, v17, v228
    v_mul_f32 v18, v18, v228
    v_mul_f32 v19, v19, v228
    v_cvt_pk_bf16_f32 v16, v16, v17
    v_cvt_pk_bf16_f32 v17, v18, v19
    v_mul_f32 v48, v48, v228
    v_mul_f32 v49, v49, v228
    v_mul_f32 v50, v50, v228
    v_mul_f32 v51, v51, v228
    v_mfma_f32_32x32x16_bf16 a[0:15], a[156:159], v[192:195], a[0:15]
    v_cvt_pk_bf16_f32 v48, v48, v49
    v_cvt_pk_bf16_f32 v49, v50, v51
    v_xor_b32 v230, 64, v249
    ds_write2_b64 v230, v[16:17], v[48:49] offset0:0 offset1:16
    v_mul_f32 v20, v20, v228
    v_mul_f32 v21, v21, v228
    v_mfma_f32_32x32x16_bf16 v[80:95], a[164:167], v[196:199], v[80:95]
    v_mul_f32 v22, v22, v228
    v_mul_f32 v23, v23, v228
    v_cvt_pk_bf16_f32 v20, v20, v21
    v_cvt_pk_bf16_f32 v21, v22, v23
    v_mul_f32 v52, v52, v228
    v_mul_f32 v53, v53, v228
    v_mul_f32 v54, v54, v228
    v_mul_f32 v55, v55, v228
    v_cvt_pk_bf16_f32 v52, v52, v53
    v_cvt_pk_bf16_f32 v53, v54, v55
    v_xor_b32 v231, 0x50, v249
    v_mfma_f32_32x32x16_bf16 a[0:15], a[172:175], v[196:199], a[0:15]
    ds_write2_b64 v231, v[20:21], v[52:53] offset0:0 offset1:16
    v_mul_f32 v24, v24, v228
    v_mul_f32 v25, v25, v228
    v_mul_f32 v26, v26, v228
    v_mul_f32 v27, v27, v228
    v_cvt_pk_bf16_f32 v24, v24, v25
    v_mfma_f32_32x32x16_bf16 v[80:95], a[180:183], v[200:203], v[80:95]
    v_cvt_pk_bf16_f32 v25, v26, v27
    v_mul_f32 v56, v56, v228
    v_mul_f32 v57, v57, v228
    v_mul_f32 v58, v58, v228
    v_mul_f32 v59, v59, v228
    v_cvt_pk_bf16_f32 v56, v56, v57
    v_cvt_pk_bf16_f32 v57, v58, v59
    v_xor_b32 v230, 0x60, v249
    ds_write2_b64 v230, v[24:25], v[56:57] offset0:0 offset1:16
    v_mfma_f32_32x32x16_bf16 a[0:15], a[188:191], v[200:203], a[0:15]
    v_mul_f32 v28, v28, v228
    v_mul_f32 v29, v29, v228
    v_mul_f32 v30, v30, v228
    v_mul_f32 v31, v31, v228
    v_cvt_pk_bf16_f32 v28, v28, v29
    v_cvt_pk_bf16_f32 v29, v30, v31
    v_mul_f32 v60, v60, v228
    v_mul_f32 v61, v61, v228
    v_mul_f32 v62, v62, v228
    v_mfma_f32_32x32x16_bf16 v[80:95], a[196:199], v[204:207], v[80:95]
    v_mul_f32 v63, v63, v228
    v_cvt_pk_bf16_f32 v60, v60, v61
    v_cvt_pk_bf16_f32 v61, v62, v63
    v_xor_b32 v231, 0x70, v249
    ds_write2_b64 v231, v[28:29], v[60:61] offset0:0 offset1:16
    v_add_u32 v230, s59, v255
    v_mfma_f32_32x32x16_bf16 a[0:15], a[204:207], v[204:207], a[0:15]
    ds_read_b128 a[208:211], v230 offset:0
    ds_read_b128 a[212:215], v230 offset:1024
    ds_read_b128 a[216:219], v230 offset:2048
    ds_read_b128 a[220:223], v230 offset:3072
    ds_read_b128 a[224:227], v230 offset:4096
    ds_read_b128 a[228:231], v230 offset:5120
    ds_read_b128 a[232:235], v230 offset:6144
    ds_read_b128 a[236:239], v230 offset:7168
    s_add_u32 s58, s36, 0
    v_add_u32 v247, s58, v250
    v_xor_b32 v248, 64, v247
    v_add_u32 v248, 0x4000, v248
    v_mov_b32 v231, v239
    v_mov_b32 v229, v239
    s_nop 1
    v_permlane32_swap_b32 v231, v229
    v_add_f32 v229, v229, v231
    v_cmp_nge_f32 vcc, s21, v229
    s_nop 3
    s_cmp_lg_u64 vcc, 0
    s_cselect_b32 s38, s31, 0
    s_or_b32 s30, s30, s38
    v_rcp_f32 v229, v229
    s_nop 0
    s_nop 3
    s_waitcnt lgkmcnt(7)
    buffer_store_dwordx4 a[208:211], v247, s[16:19], 0 offen offset:0 sc0 sc1
    v_add_u32 v247, 0x8000, v247
    v_mul_f32 v64, v64, v229
    v_mul_f32 v65, v65, v229
    v_mul_f32 v66, v66, v229
    v_mul_f32 v67, v67, v229
    v_cvt_pk_bf16_f32 v64, v64, v65
    v_cvt_pk_bf16_f32 v65, v66, v67
    v_mul_f32 v96, v96, v229
    v_mul_f32 v97, v97, v229
    v_mul_f32 v98, v98, v229
    v_mul_f32 v99, v99, v229
    v_cvt_pk_bf16_f32 v96, v96, v97
    v_cvt_pk_bf16_f32 v97, v98, v99
    ds_write2_b64 v249, v[64:65], v[96:97] offset0:0 offset1:16
    v_mul_f32 v68, v68, v229
    v_mul_f32 v69, v69, v229
    v_mul_f32 v70, v70, v229
    v_mul_f32 v71, v71, v229
    s_waitcnt lgkmcnt(7)
    buffer_store_dwordx4 a[212:215], v248, s[16:19], 0 offen offset:0 sc0 sc1
    v_add_u32 v248, 0x8000, v248
    v_cvt_pk_bf16_f32 v68, v68, v69
    v_cvt_pk_bf16_f32 v69, v70, v71
    v_mul_f32 v100, v100, v229
    v_mul_f32 v101, v101, v229
    v_mul_f32 v102, v102, v229
    v_mul_f32 v103, v103, v229
    v_cvt_pk_bf16_f32 v100, v100, v101
    v_cvt_pk_bf16_f32 v101, v102, v103
    v_xor_b32 v231, 16, v249
    ds_write2_b64 v231, v[68:69], v[100:101] offset0:0 offset1:16
    v_mul_f32 v72, v72, v229
    v_mul_f32 v73, v73, v229
    v_mul_f32 v74, v74, v229
    v_mul_f32 v75, v75, v229
    v_cvt_pk_bf16_f32 v72, v72, v73
    v_cvt_pk_bf16_f32 v73, v74, v75
    v_mul_f32 v104, v104, v229
    s_waitcnt lgkmcnt(7)
    buffer_store_dwordx4 a[216:219], v247, s[16:19], 0 offen offset:0 sc0 sc1
    v_add_u32 v247, 0x8000, v247
    v_mul_f32 v105, v105, v229
    v_mul_f32 v106, v106, v229
    v_mul_f32 v107, v107, v229
    v_cvt_pk_bf16_f32 v104, v104, v105
    v_cvt_pk_bf16_f32 v105, v106, v107
    v_xor_b32 v230, 32, v249
    ds_write2_b64 v230, v[72:73], v[104:105] offset0:0 offset1:16
    v_mul_f32 v76, v76, v229
    v_mul_f32 v77, v77, v229
    v_mul_f32 v78, v78, v229
    v_mul_f32 v79, v79, v229
    v_cvt_pk_bf16_f32 v76, v76, v77
    v_cvt_pk_bf16_f32 v77, v78, v79
    v_mul_f32 v108, v108, v229
    v_mul_f32 v109, v109, v229
    v_mul_f32 v110, v110, v229
    v_mul_f32 v111, v111, v229
    s_waitcnt lgkmcnt(7)
    buffer_store_dwordx4 a[220:223], v248, s[16:19], 0 offen offset:0 sc0 sc1
    v_add_u32 v248, 0x8000, v248
    v_cvt_pk_bf16_f32 v108, v108, v109
    v_cvt_pk_bf16_f32 v109, v110, v111
    v_xor_b32 v231, 48, v249
    ds_write2_b64 v231, v[76:77], v[108:109] offset0:0 offset1:16
    v_mul_f32 v80, v80, v229
    v_mul_f32 v81, v81, v229
    v_mul_f32 v82, v82, v229
    v_mul_f32 v83, v83, v229
    v_cvt_pk_bf16_f32 v80, v80, v81
    v_cvt_pk_bf16_f32 v81, v82, v83
    v_accvgpr_read_b32 v66, a0
    v_accvgpr_read_b32 v67, a1
    v_accvgpr_read_b32 v98, a2
    v_accvgpr_read_b32 v99, a3
    v_mul_f32 v66, v66, v229
    v_mul_f32 v67, v67, v229
    v_mul_f32 v98, v98, v229
    s_waitcnt lgkmcnt(7)
    buffer_store_dwordx4 a[224:227], v247, s[16:19], 0 offen offset:0 sc0 sc1
    v_add_u32 v247, 0x8000, v247
    v_mul_f32 v99, v99, v229
    v_cvt_pk_bf16_f32 v66, v66, v67
    v_cvt_pk_bf16_f32 v67, v98, v99
    v_xor_b32 v230, 64, v249
    ds_write2_b64 v230, v[80:81], v[66:67] offset0:0 offset1:16
    v_mul_f32 v84, v84, v229
    v_mul_f32 v85, v85, v229
    v_mul_f32 v86, v86, v229
    v_mul_f32 v87, v87, v229
    v_cvt_pk_bf16_f32 v84, v84, v85
    v_cvt_pk_bf16_f32 v85, v86, v87
    v_accvgpr_read_b32 v70, a4
    v_accvgpr_read_b32 v71, a5
    v_accvgpr_read_b32 v102, a6
    v_accvgpr_read_b32 v103, a7
    v_mul_f32 v70, v70, v229
    v_mul_f32 v71, v71, v229
    s_waitcnt lgkmcnt(7)
    buffer_store_dwordx4 a[228:231], v248, s[16:19], 0 offen offset:0 sc0 sc1
    v_add_u32 v248, 0x8000, v248
    v_mul_f32 v102, v102, v229
    v_mul_f32 v103, v103, v229
    v_cvt_pk_bf16_f32 v70, v70, v71
    v_cvt_pk_bf16_f32 v71, v102, v103
    v_xor_b32 v231, 0x50, v249
    ds_write2_b64 v231, v[84:85], v[70:71] offset0:0 offset1:16
    v_mul_f32 v88, v88, v229
    v_mul_f32 v89, v89, v229
    v_mul_f32 v90, v90, v229
    v_mul_f32 v91, v91, v229
    v_cvt_pk_bf16_f32 v88, v88, v89
    v_cvt_pk_bf16_f32 v89, v90, v91
    v_accvgpr_read_b32 v74, a8
    v_accvgpr_read_b32 v75, a9
    v_accvgpr_read_b32 v106, a10
    v_accvgpr_read_b32 v107, a11
    v_mul_f32 v74, v74, v229
    s_waitcnt lgkmcnt(7)
    buffer_store_dwordx4 a[232:235], v247, s[16:19], 0 offen offset:0 sc0 sc1
    v_mul_f32 v75, v75, v229
    v_mul_f32 v106, v106, v229
    v_mul_f32 v107, v107, v229
    v_cvt_pk_bf16_f32 v74, v74, v75
    v_cvt_pk_bf16_f32 v75, v106, v107
    v_xor_b32 v230, 0x60, v249
    ds_write2_b64 v230, v[88:89], v[74:75] offset0:0 offset1:16
    v_mul_f32 v92, v92, v229
    v_mul_f32 v93, v93, v229
    v_mul_f32 v94, v94, v229
    v_mul_f32 v95, v95, v229
    v_cvt_pk_bf16_f32 v92, v92, v93
    v_cvt_pk_bf16_f32 v93, v94, v95
    v_accvgpr_read_b32 v78, a12
    v_accvgpr_read_b32 v79, a13
    v_accvgpr_read_b32 v110, a14
    v_accvgpr_read_b32 v111, a15
    s_waitcnt lgkmcnt(7)
    buffer_store_dwordx4 a[236:239], v248, s[16:19], 0 offen offset:0 sc0 sc1
    v_mul_f32 v78, v78, v229
    v_mul_f32 v79, v79, v229
    v_mul_f32 v110, v110, v229
    v_mul_f32 v111, v111, v229
    v_cvt_pk_bf16_f32 v78, v78, v79
    v_cvt_pk_bf16_f32 v79, v110, v111
    v_xor_b32 v231, 0x70, v249
    ds_write2_b64 v231, v[92:93], v[78:79] offset0:0 offset1:16
    v_add_u32 v230, s59, v255
    ds_read_b128 a[208:211], v230 offset:0
    ds_read_b128 a[212:215], v230 offset:1024
    ds_read_b128 a[216:219], v230 offset:2048
    ds_read_b128 a[220:223], v230 offset:3072
    ds_read_b128 a[224:227], v230 offset:4096
    ds_read_b128 a[228:231], v230 offset:5120
    ds_read_b128 a[232:235], v230 offset:6144
    ds_read_b128 a[236:239], v230 offset:7168
    s_add_u32 s58, s36, 0x20000
    v_add_u32 v247, s58, v250
    v_xor_b32 v248, 64, v247
    v_add_u32 v248, 0x4000, v248
    s_waitcnt lgkmcnt(7)
    buffer_store_dwordx4 a[208:211], v247, s[16:19], 0 offen offset:0
    v_add_u32 v247, 0x8000, v247
    s_waitcnt lgkmcnt(6)
    buffer_store_dwordx4 a[212:215], v248, s[16:19], 0 offen offset:0
    v_add_u32 v248, 0x8000, v248
    s_waitcnt lgkmcnt(5)
    buffer_store_dwordx4 a[216:219], v247, s[16:19], 0 offen offset:0
    v_add_u32 v247, 0x8000, v247
    s_waitcnt lgkmcnt(4)
    buffer_store_dwordx4 a[220:223], v248, s[16:19], 0 offen offset:0
    v_add_u32 v248, 0x8000, v248
    s_waitcnt lgkmcnt(3)
    buffer_store_dwordx4 a[224:227], v247, s[16:19], 0 offen offset:0
    v_add_u32 v247, 0x8000, v247
    s_waitcnt lgkmcnt(2)
    buffer_store_dwordx4 a[228:231], v248, s[16:19], 0 offen offset:0
    v_add_u32 v248, 0x8000, v248
    s_waitcnt lgkmcnt(1)
    buffer_store_dwordx4 a[232:235], v247, s[16:19], 0 offen offset:0
    s_waitcnt lgkmcnt(0)
    buffer_store_dwordx4 a[236:239], v248, s[16:19], 0 offen offset:0
    s_cmp_eq_u32 s29, 0
    s_cbranch_scc1 L_fin
    s_cmp_eq_u32 s29, 2
    s_cbranch_scc1 L_entry_1
    s_branch L_entry_0
L_entry_1:
L_entryp_1:
    s_xor_b32 s39, s37, s79
    s_mov_b32 s37, s79
    v_xor_b32 v208, s39, v208
    v_xor_b32 v209, s39, v209
    v_xor_b32 v210, s39, v210
    v_xor_b32 v211, s39, v211
    v_xor_b32 v212, s39, v212
    v_xor_b32 v213, s39, v213
    v_xor_b32 v214, s39, v214
    v_xor_b32 v215, s39, v215
    v_xor_b32 v216, s39, v216
    v_xor_b32 v217, s39, v217
    v_xor_b32 v218, s39, v218
    v_xor_b32 v219, s39, v219
    s_waitcnt vmcnt(0) lgkmcnt(0)
    s_barrier
    ds_read_b128 a[80:83], v208 offset:0
    v_add_u32 v132, s100, v208
    ds_read_b128 a[16:19], v132 offset:0
    ds_read_b128 a[84:87], v209 offset:0
    ds_read_b128 a[48:51], v132 offset:8192
    ds_read_b128 a[88:91], v210 offset:0
    v_add_u32 v133, s100, v209
    ds_read_b128 a[20:23], v133 offset:0
    ds_read_b128 a[92:95], v211 offset:0
    ds_read_b128 a[52:55], v133 offset:8192
    ds_read_b128 a[96:99], v212 offset:0
    v_add_u32 v134, s100, v210
    ds_read_b128 a[24:27], v134 offset:0
    ds_read_b128 a[100:103], v213 offset:0
    ds_read_b128 a[56:59], v134 offset:8192
    ds_read_b128 a[104:107], v214 offset:0
    v_add_u32 v135, s100, v211
    ds_read_b128 a[28:31], v135 offset:0
    ds_read_b128 a[108:111], v215 offset:0
    ds_read_b128 a[60:63], v135 offset:8192
    ds_read_b128 a[112:115], v208 offset:8192
    v_add_u32 v132, s100, v212
    ds_read_b128 a[32:35], v132 offset:0
    ds_read_b128 a[116:119], v209 offset:8192
    ds_read_b128 a[64:67], v132 offset:8192
    ds_read_b128 a[120:123], v210 offset:8192
    v_add_u32 v133, s100, v213
    ds_read_b128 a[36:39], v133 offset:0
    ds_read_b128 a[124:127], v211 offset:8192
    ds_read_b128 a[68:71], v133 offset:8192
    ds_read_b128 a[128:131], v212 offset:8192
    v_add_u32 v134, s100, v214
    ds_read_b128 a[40:43], v134 offset:0
    ds_read_b128 a[132:135], v213 offset:8192
    ds_read_b128 a[72:75], v134 offset:8192
    ds_read_b128 a[136:139], v214 offset:8192
    v_add_u32 v135, s100, v215
    ds_read_b128 a[44:47], v135 offset:0
    ds_read_b128 a[140:143], v215 offset:8192
    ds_read_b128 a[76:79], v135 offset:8192
    s_xor_b32 s38, s80, 0x383
    s_xor_b32 s39, s81, 0x507
    s_or_b32 s38, s38, s39
    s_xor_b32 s39, s82, 0xbf7
    s_or_b32 s38, s38, s39
    s_xor_b32 s39, s83, 0xd35
    s_or_b32 s38, s38, s39
    s_xor_b32 s39, s84, 0xf7a
    s_or_b32 s38, s38, s39
    s_xor_b32 s39, s85, 0x1281
    s_or_b32 s38, s38, s39
    s_xor_b32 s39, s86, 0x14e7
    s_or_b32 s38, s38, s39
    s_xor_b32 s39, s87, 0x1c0c
    s_or_b32 s38, s38, s39
    s_cmp_lg_u32 s38, 0
    s_cbranch_scc1 L_generic
    s_and_b32 s23, s51, 0xff
    s_bfe_u32 s29, s51, 0x20010
    s_sub_u32 s34, s53, s101
    s_mov_b32 s35, s34
    s_waitcnt lgkmcnt(14)
    v_mfma_f32_32x32x16_bf16 v[112:127], a[80:83], a[16:19], 0
    s_mov_b32 m0, s68
    s_add_u32 s27, s25, 0x4000
    buffer_load_dwordx4 v224, s[12:15], s25 offen offset:0 lds
    v_mfma_f32_32x32x16_bf16 v[112:127], a[84:87], a[20:23], v[112:127]
    buffer_load_dwordx4 v225, s[12:15], s25 offen offset:1024 lds
    v_mfma_f32_32x32x16_bf16 v[112:127], a[88:91], a[24:27], v[112:127]
    buffer_load_dwordx4 v226, s[12:15], s25 offen offset:2048 lds
    v_mfma_f32_32x32x16_bf16 v[112:127], a[92:95], a[28:31], v[112:127]
    buffer_load_dwordx4 v227, s[12:15], s25 offen offset:3072 lds
    v_mfma_f32_32x32x16_bf16 v[112:127], a[96:99], a[32:35], v[112:127]
    s_mov_b32 m0, s72
    s_add_u32 s25, s25, 0x20000
    buffer_load_dwordx4 v224, s[12:15], s27 offen offset:0 lds
    s_waitcnt lgkmcnt(10)
    v_mfma_f32_32x32x16_bf16 v[112:127], a[100:103], a[36:39], v[112:127]
    buffer_load_dwordx4 v225, s[12:15], s27 offen offset:1024 lds
    s_waitcnt lgkmcnt(6)
    v_mfma_f32_32x32x16_bf16 v[112:127], a[104:107], a[40:43], v[112:127]
    buffer_load_dwordx4 v226, s[12:15], s27 offen offset:2048 lds
    s_waitcnt lgkmcnt(2)
    v_mfma_f32_32x32x16_bf16 v[112:127], a[108:111], a[44:47], v[112:127]
    buffer_load_dwordx4 v227, s[12:15], s27 offen offset:3072 lds
    v_mfma_f32_32x32x16_bf16 v[128:143], a[112:115], a[16:19], 0
    s_mov_b32 m0, s67
    s_add_u32 s26, s24, 0x4000
    buffer_load_dwordx4 v220, s[8:11], s24 offen offset:0 lds
    v_mfma_f32_32x32x16_bf16 v[128:143], a[116:119], a[20:23], v[128:143]
    buffer_load_dwordx4 v221, s[8:11], s24 offen offset:1024 lds
    v_mfma_f32_32x32x16_bf16 v[128:143], a[120:123], a[24:27], v[128:143]
    buffer_load_dwordx4 v222, s[8:11], s24 offen offset:2048 lds
    v_mfma_f32_32x32x16_bf16 v[128:143], a[124:127], a[28:31], v[128:143]
    buffer_load_dwordx4 v223, s[8:11], s24 offen offset:3072 lds
    v_mfma_f32_32x32x16_bf16 v[128:143], a[128:131], a[32:35], v[128:143]
    s_mov_b32 m0, s71
    s_add_u32 s24, s24, 0x20000
    buffer_load_dwordx4 v220, s[8:11], s26 offen offset:0 lds
    v_mfma_f32_32x32x16_bf16 v[128:143], a[132:135], a[36:39], v[128:143]
    buffer_load_dwordx4 v221, s[8:11], s26 offen offset:1024 lds
    v_mfma_f32_32x32x16_bf16 v[128:143], a[136:139], a[40:43], v[128:143]
    buffer_load_dwordx4 v222, s[8:11], s26 offen offset:2048 lds
    s_waitcnt lgkmcnt(1)
    v_mfma_f32_32x32x16_bf16 v[128:143], a[140:143], a[44:47], v[128:143]
    buffer_load_dwordx4 v223, s[8:11], s26 offen offset:3072 lds
    v_mfma_f32_32x32x16_bf16 v[64:79], a[240:243], a[240:243], 0
    s_mov_b32 m0, s69
    s_add_u32 s27, s25, 0x4000
    buffer_load_dwordx4 v224, s[12:15], s25 offen offset:0 lds
    v_max3_f32 v244, v112, v113, v114
    v_max3_f32 v244, v244, v115, v116
    v_max3_f32 v244, v244, v117, v118
    v_max3_f32 v244, v244, v119, v120
    v_max3_f32 v244, v244, v121, v122
    v_max3_f32 v244, v244, v123, v124
    v_max3_f32 v244, v244, v125, v126
    v_max_f32 v244, v244, v127
    v_max3_f32 v245, v128, v129, v130
    v_max3_f32 v245, v245, v131, v132
    v_max3_f32 v245, v245, v133, v134
    v_max3_f32 v245, v245, v135, v136
    v_mfma_f32_32x32x16_bf16 v[80:95], a[240:243], a[240:243], 0
    buffer_load_dwordx4 v225, s[12:15], s25 offen offset:1024 lds
    v_max3_f32 v245, v245, v137, v138
    v_max3_f32 v245, v245, v139, v140
    v_max3_f32 v245, v245, v141, v142
    v_max3_f32 v244, v244, v245, v143
    v_mov_b32 v245, v244
    s_nop 1
    v_permlane32_swap_b32 v244, v245
    v_max_f32 v244, v244, v245
    v_mul_f32 v236, s28, v244
    v_fma_f32 v232, v112, s20, v236
    v_fma_f32 v233, v113, s20, v236
    v_exp_f32 v232, v232
    v_mfma_f32_32x32x16_bf16 v[96:111], a[240:243], a[240:243], 0
    buffer_load_dwordx4 v226, s[12:15], s25 offen offset:2048 lds
    v_exp_f32 v233, v233
    v_fma_f32 v234, v114, s20, v236
    v_fma_f32 v235, v115, s20, v236
    v_exp_f32 v234, v234
    v_add_f32 v238, v232, v233
    v_exp_f32 v235, v235
    s_nop 0
    v_cvt_pk_bf16_f32 v176, v232, v233
    v_fma_f32 v232, v116, s20, v236
    v_fma_f32 v233, v117, s20, v236
    v_mfma_f32_32x32x16_bf16 a[0:15], a[240:243], a[240:243], 0
    buffer_load_dwordx4 v227, s[12:15], s25 offen offset:3072 lds
    v_exp_f32 v232, v232
    v_add_f32 v238, v238, v234
    v_exp_f32 v233, v233
    v_add_f32 v238, v238, v235
    v_cvt_pk_bf16_f32 v177, v234, v235
    v_fma_f32 v234, v118, s20, v236
    v_fma_f32 v235, v119, s20, v236
    v_exp_f32 v234, v234
    v_add_f32 v238, v238, v232
    v_exp_f32 v235, v235
    v_mfma_f32_32x32x16_bf16 v[144:159], a[80:83], a[48:51], 0
    s_mov_b32 m0, s73
    s_add_u32 s25, s25, 0x20000
    buffer_load_dwordx4 v224, s[12:15], s27 offen offset:0 lds
    v_add_f32 v238, v238, v233
    v_cvt_pk_bf16_f32 v178, v232, v233
    v_fma_f32 v232, v120, s20, v236
    v_fma_f32 v233, v121, s20, v236
    v_exp_f32 v232, v232
    v_mfma_f32_32x32x16_bf16 v[144:159], a[84:87], a[52:55], v[144:159]
    buffer_load_dwordx4 v225, s[12:15], s27 offen offset:1024 lds
    v_add_f32 v238, v238, v234
    v_exp_f32 v233, v233
    v_add_f32 v238, v238, v235
    v_cvt_pk_bf16_f32 v179, v234, v235
    v_fma_f32 v234, v122, s20, v236
    v_mfma_f32_32x32x16_bf16 v[144:159], a[88:91], a[56:59], v[144:159]
    buffer_load_dwordx4 v226, s[12:15], s27 offen offset:2048 lds
    v_fma_f32 v235, v123, s20, v236
    v_exp_f32 v234, v234
    v_add_f32 v238, v238, v232
    v_exp_f32 v235, v235
    v_mfma_f32_32x32x16_bf16 v[144:159], a[92:95], a[60:63], v[144:159]
    buffer_load_dwordx4 v227, s[12:15], s27 offen offset:3072 lds
    v_add_f32 v238, v238, v233
    v_cvt_pk_bf16_f32 v180, v232, v233
    v_fma_f32 v232, v124, s20, v236
    v_fma_f32 v233, v125, s20, v236
    v_exp_f32 v232, v232
    v_add_f32 v238, v238, v234
    v_mfma_f32_32x32x16_bf16 v[144:159], a[96:99], a[64:67], v[144:159]
    s_waitcnt vmcnt(16) lgkmcnt(0)
    s_barrier
    ds_read_b64_tr_b16 a[144:145], v216 offset:32768
    ds_read_b64_tr_b16 a[146:147], v216 offset:33280
    ds_read_b64_tr_b16 a[148:149], v217 offset:32768
    v_exp_f32 v233, v233
    v_add_f32 v238, v238, v235
    v_mfma_f32_32x32x16_bf16 v[144:159], a[100:103], a[68:71], v[144:159]
    ds_read_b64_tr_b16 a[150:151], v217 offset:33280
    ds_read_b64_tr_b16 a[152:153], v218 offset:32768
    ds_read_b64_tr_b16 a[154:155], v218 offset:33280
    s_mov_b32 m0, s66
    s_add_u32 s26, s24, 0x4000
    buffer_load_dwordx4 v220, s[8:11], s24 offen offset:0 lds
    v_cvt_pk_bf16_f32 v181, v234, v235
    v_fma_f32 v234, v126, s20, v236
    v_mfma_f32_32x32x16_bf16 v[144:159], a[104:107], a[72:75], v[144:159]
    ds_read_b64_tr_b16 a[156:157], v219 offset:32768
    ds_read_b64_tr_b16 a[158:159], v219 offset:33280
    buffer_load_dwordx4 v221, s[8:11], s24 offen offset:1024 lds
    v_fma_f32 v235, v127, s20, v236
    v_exp_f32 v234, v234
    v_add_f32 v238, v238, v232
    v_mfma_f32_32x32x16_bf16 v[144:159], a[108:111], a[76:79], v[144:159]
    ds_read_b64_tr_b16 a[160:161], v216 offset:36864
    ds_read_b64_tr_b16 a[162:163], v216 offset:37376
    ds_read_b64_tr_b16 a[164:165], v217 offset:36864
    buffer_load_dwordx4 v222, s[8:11], s24 offen offset:2048 lds
    v_exp_f32 v235, v235
    v_add_f32 v238, v238, v233
    v_cvt_pk_bf16_f32 v182, v232, v233
    v_mfma_f32_32x32x16_bf16 v[160:175], a[112:115], a[48:51], 0
    ds_read_b64_tr_b16 a[166:167], v217 offset:37376
    ds_read_b64_tr_b16 a[168:169], v218 offset:36864
    ds_read_b64_tr_b16 a[170:171], v218 offset:37376
    v_fma_f32 v232, v128, s20, v236
    v_fma_f32 v233, v129, s20, v236
    v_exp_f32 v232, v232
    v_mfma_f32_32x32x16_bf16 v[160:175], a[116:119], a[52:55], v[160:175]
    ds_read_b64_tr_b16 a[172:173], v219 offset:36864
    ds_read_b64_tr_b16 a[174:175], v219 offset:37376
    buffer_load_dwordx4 v223, s[8:11], s24 offen offset:3072 lds
    v_add_f32 v238, v238, v234
    v_exp_f32 v233, v233
    v_add_f32 v238, v238, v235
    v_cvt_pk_bf16_f32 v183, v234, v235
    v_mfma_f32_32x32x16_bf16 v[160:175], a[120:123], a[56:59], v[160:175]
    ds_read_b64_tr_b16 a[176:177], v216 offset:40960
    ds_read_b64_tr_b16 a[178:179], v216 offset:41472
    ds_read_b64_tr_b16 a[180:181], v217 offset:40960
    s_mov_b32 m0, s70
    s_add_u32 s24, s24, 0x20000
    buffer_load_dwordx4 v220, s[8:11], s26 offen offset:0 lds
    v_fma_f32 v234, v130, s20, v236
    v_fma_f32 v235, v131, s20, v236
    v_mfma_f32_32x32x16_bf16 v[160:175], a[124:127], a[60:63], v[160:175]
    ds_read_b64_tr_b16 a[182:183], v217 offset:41472
    ds_read_b64_tr_b16 a[184:185], v218 offset:40960
    ds_read_b64_tr_b16 a[186:187], v218 offset:41472
    buffer_load_dwordx4 v221, s[8:11], s26 offen offset:1024 lds
    v_exp_f32 v234, v234
    v_add_f32 v238, v238, v232
    v_mfma_f32_32x32x16_bf16 v[160:175], a[128:131], a[64:67], v[160:175]
    ds_read_b64_tr_b16 a[188:189], v219 offset:40960
    ds_read_b64_tr_b16 a[190:191], v219 offset:41472
    v_exp_f32 v235, v235
    v_add_f32 v238, v238, v233
    v_cvt_pk_bf16_f32 v184, v232, v233
    v_fma_f32 v232, v132, s20, v236
    v_fma_f32 v233, v133, s20, v236
    v_mfma_f32_32x32x16_bf16 v[160:175], a[132:135], a[68:71], v[160:175]
    ds_read_b64_tr_b16 a[192:193], v216 offset:45056
    ds_read_b64_tr_b16 a[194:195], v216 offset:45568
    ds_read_b64_tr_b16 a[196:197], v217 offset:45056
    buffer_load_dwordx4 v222, s[8:11], s26 offen offset:2048 lds
    v_exp_f32 v232, v232
    v_add_f32 v238, v238, v234
    v_mfma_f32_32x32x16_bf16 v[160:175], a[136:139], a[72:75], v[160:175]
    ds_read_b64_tr_b16 a[198:199], v217 offset:45568
    ds_read_b64_tr_b16 a[200:201], v218 offset:45056
    ds_read_b64_tr_b16 a[202:203], v218 offset:45568
    buffer_load_dwordx4 v223, s[8:11], s26 offen offset:3072 lds
    v_exp_f32 v233, v233
    v_add_f32 v238, v238, v235
    v_cvt_pk_bf16_f32 v185, v234, v235
    v_mfma_f32_32x32x16_bf16 v[160:175], a[140:143], a[76:79], v[160:175]
    ds_read_b64_tr_b16 a[204:205], v219 offset:45056
    ds_read_b64_tr_b16 a[206:207], v219 offset:45568
    v_fma_f32 v234, v134, s20, v236
    v_fma_f32 v235, v135, s20, v236
    v_exp_f32 v234, v234
    v_add_f32 v238, v238, v232
    v_exp_f32 v235, v235
    v_add_f32 v238, v238, v233
    v_cvt_pk_bf16_f32 v186, v232, v233
    v_fma_f32 v232, v136, s20, v236
    s_waitcnt vmcnt(16) lgkmcnt(0)
    s_barrier
    v_mfma_f32_32x32x16_bf16 v[0:15], a[144:147], v[176:179], 0
    ds_read_b128 a[80:83], v208 offset:16384
    v_fma_f32 v233, v137, s20, v236
    v_exp_f32 v232, v232
    v_add_f32 v238, v238, v234
    v_exp_f32 v233, v233
    v_add_f32 v238, v238, v235
    v_cvt_pk_bf16_f32 v187, v234, v235
    v_fma_f32 v234, v138, s20, v236
    v_mfma_f32_32x32x16_bf16 v[16:31], a[148:151], v[176:179], 0
    ds_read_b128 a[84:87], v209 offset:16384
    v_fma_f32 v235, v139, s20, v236
    v_exp_f32 v234, v234
    v_add_f32 v238, v238, v232
    v_exp_f32 v235, v235
    v_add_f32 v238, v238, v233
    v_cvt_pk_bf16_f32 v188, v232, v233
    v_mfma_f32_32x32x16_bf16 v[32:47], a[152:155], v[176:179], 0
    ds_read_b128 a[88:91], v210 offset:16384
    v_fma_f32 v232, v140, s20, v236
    v_fma_f32 v233, v141, s20, v236
    v_exp_f32 v232, v232
    v_add_f32 v238, v238, v234
    v_exp_f32 v233, v233
    v_add_f32 v238, v238, v235
    v_cvt_pk_bf16_f32 v189, v234, v235
    v_mfma_f32_32x32x16_bf16 v[48:63], a[156:159], v[176:179], 0
    ds_read_b128 a[92:95], v211 offset:16384
    v_fma_f32 v234, v142, s20, v236
    v_fma_f32 v235, v143, s20, v236
    v_exp_f32 v234, v234
    v_add_f32 v238, v238, v232
    v_exp_f32 v235, v235
    v_add_f32 v238, v238, v233
    v_cvt_pk_bf16_f32 v190, v232, v233
    v_mfma_f32_32x32x16_bf16 v[0:15], a[160:163], v[180:183], v[0:15]
    ds_read_b128 a[96:99], v212 offset:16384
    v_add_f32 v238, v238, v234
    v_add_f32 v238, v238, v235
    v_cvt_pk_bf16_f32 v191, v234, v235
    v_max3_f32 v244, v144, v145, v146
    v_max3_f32 v244, v244, v147, v148
    v_max3_f32 v244, v244, v149, v150
    v_max3_f32 v244, v244, v151, v152
    v_max3_f32 v244, v244, v153, v154
    v_mfma_f32_32x32x16_bf16 v[16:31], a[164:167], v[180:183], v[16:31]
    ds_read_b128 a[100:103], v213 offset:16384
    v_max3_f32 v244, v244, v155, v156
    v_max3_f32 v244, v244, v157, v158
    v_max_f32 v244, v244, v159
    v_max3_f32 v245, v160, v161, v162
    v_max3_f32 v245, v245, v163, v164
    v_max3_f32 v245, v245, v165, v166
    v_max3_f32 v245, v245, v167, v168
    v_max3_f32 v245, v245, v169, v170
    v_max3_f32 v245, v245, v171, v172
    v_mfma_f32_32x32x16_bf16 v[32:47], a[168:171], v[180:183], v[32:47]
    ds_read_b128 a[104:107], v214 offset:16384
    v_max3_f32 v245, v245, v173, v174
    v_max3_f32 v244, v244, v245, v175
    v_mov_b32 v245, v244
    s_nop 1
    v_permlane32_swap_b32 v244, v245
    v_max_f32 v244, v244, v245
    v_mul_f32 v237, s28, v244
    v_mfma_f32_32x32x16_bf16 v[48:63], a[172:175], v[180:183], v[48:63]
    ds_read_b128 a[108:111], v215 offset:16384
    v_fma_f32 v232, v144, s20, v237
    v_fma_f32 v233, v145, s20, v237
    v_exp_f32 v232, v232
    v_exp_f32 v233, v233
    v_fma_f32 v234, v146, s20, v237
    v_fma_f32 v235, v147, s20, v237
    v_exp_f32 v234, v234
    v_mfma_f32_32x32x16_bf16 v[0:15], a[176:179], v[184:187], v[0:15]
    ds_read_b128 a[112:115], v208 offset:24576
    v_add_f32 v239, v232, v233
    v_exp_f32 v235, v235
    s_nop 0
    v_cvt_pk_bf16_f32 v192, v232, v233
    v_fma_f32 v232, v148, s20, v237
    v_fma_f32 v233, v149, s20, v237
    v_mfma_f32_32x32x16_bf16 v[16:31], a[180:183], v[184:187], v[16:31]
    ds_read_b128 a[116:119], v209 offset:24576
    v_exp_f32 v232, v232
    v_add_f32 v239, v239, v234
    v_exp_f32 v233, v233
    v_add_f32 v239, v239, v235
    v_cvt_pk_bf16_f32 v193, v234, v235
    v_fma_f32 v234, v150, s20, v237
    v_fma_f32 v235, v151, s20, v237
    v_mfma_f32_32x32x16_bf16 v[32:47], a[184:187], v[184:187], v[32:47]
    ds_read_b128 a[120:123], v210 offset:24576
    v_exp_f32 v234, v234
    v_add_f32 v239, v239, v232
    v_exp_f32 v235, v235
    v_add_f32 v239, v239, v233
    v_cvt_pk_bf16_f32 v194, v232, v233
    v_fma_f32 v232, v152, s20, v237
    v_fma_f32 v233, v153, s20, v237
    v_mfma_f32_32x32x16_bf16 v[48:63], a[188:191], v[184:187], v[48:63]
    ds_read_b128 a[124:127], v211 offset:24576
    v_exp_f32 v232, v232
    v_add_f32 v239, v239, v234
    v_exp_f32 v233, v233
    v_add_f32 v239, v239, v235
    v_cvt_pk_bf16_f32 v195, v234, v235
    v_fma_f32 v234, v154, s20, v237
    v_fma_f32 v235, v155, s20, v237
    v_mfma_f32_32x32x16_bf16 v[0:15], a[192:195], v[188:191], v[0:15]
    ds_read_b128 a[128:131], v212 offset:24576
    v_exp_f32 v234, v234
    v_add_f32 v239, v239, v232
    v_exp_f32 v235, v235
    v_add_f32 v239, v239, v233
    v_cvt_pk_bf16_f32 v196, v232, v233
    v_fma_f32 v232, v156, s20, v237
    v_mfma_f32_32x32x16_bf16 v[16:31], a[196:199], v[188:191], v[16:31]
    ds_read_b128 a[132:135], v213 offset:24576
    v_fma_f32 v233, v157, s20, v237
    v_exp_f32 v232, v232
    v_add_f32 v239, v239, v234
    v_exp_f32 v233, v233
    v_add_f32 v239, v239, v235
    v_cvt_pk_bf16_f32 v197, v234, v235
    v_fma_f32 v234, v158, s20, v237
    v_mfma_f32_32x32x16_bf16 v[32:47], a[200:203], v[188:191], v[32:47]
    ds_read_b128 a[136:139], v214 offset:24576
    v_fma_f32 v235, v159, s20, v237
    v_exp_f32 v234, v234
    v_add_f32 v239, v239, v232
    v_exp_f32 v235, v235
    v_add_f32 v239, v239, v233
    v_cvt_pk_bf16_f32 v198, v232, v233
    v_mfma_f32_32x32x16_bf16 v[48:63], a[204:207], v[188:191], v[48:63]
    ds_read_b128 a[140:143], v215 offset:24576
    v_fma_f32 v232, v160, s20, v237
    v_fma_f32 v233, v161, s20, v237
    v_exp_f32 v232, v232
    v_add_f32 v239, v239, v234
    v_exp_f32 v233, v233
    v_add_f32 v239, v239, v235
    v_cvt_pk_bf16_f32 v199, v234, v235
    s_mov_b32 s89, s50
    s_add_u32 s36, s48, s78
    s_lshl_b32 s31, s31, 1
    s_load_dwordx8 s[48:55], s[56:57], 32
    s_add_u32 s56, s56, 32
    s_addc_u32 s57, s57, 0
    s_sub_u32 s23, s23, 1
    s_cmp_eq_u32 s23, 1
    s_cbranch_scc1 L_lasts_1
    s_branch L_mid1_1
L_ts_1:
    s_and_b32 s23, s51, 0xff
    s_bfe_u32 s29, s51, 0x20010
    s_sub_u32 s34, s53, s101
    s_mov_b32 s35, s34
    v_mfma_f32_32x32x16_bf16 v[64:79], a[144:147], v[192:195], v[64:79]
    v_mov_b32 v247, v238
    v_mov_b32 v228, v238
    s_nop 1
    v_permlane32_swap_b32 v247, v228
    v_add_f32 v228, v228, v247
    v_cmp_nge_f32 vcc, s21, v228
    s_nop 3
    s_cmp_lg_u64 vcc, 0
    s_cselect_b32 s38, s31, 0
    s_or_b32 s30, s30, s38
    v_rcp_f32 v228, v228
    v_mfma_f32_32x32x16_bf16 v[80:95], a[148:151], v[192:195], v[80:95]
    s_mov_b32 m0, s67
    s_add_u32 s26, s24, 0x4000
    buffer_load_dwordx4 v220, s[8:11], s24 offen offset:0 lds
    s_nop 0
    v_mov_b32 v247, v239
    v_mov_b32 v229, v239
    s_nop 1
    v_permlane32_swap_b32 v247, v229
    v_add_f32 v229, v229, v247
    v_cmp_nge_f32 vcc, s21, v229
    s_nop 3
    s_cmp_lg_u64 vcc, 0
    s_cselect_b32 s38, s31, 0
    s_or_b32 s30, s30, s38
    v_mfma_f32_32x32x16_bf16 v[96:111], a[152:155], v[192:195], v[96:111]
    buffer_load_dwordx4 v221, s[8:11], s24 offen offset:1024 lds
    v_rcp_f32 v229, v229
    s_nop 0
    v_add_u32 v249, s3, v253
    s_mov_b32 s18, s89
    v_mul_f32 v0, v0, v228
    v_mul_f32 v1, v1, v228
    v_mul_f32 v2, v2, v228
    v_mul_f32 v3, v3, v228
    v_cvt_pk_bf16_f32 v0, v0, v1
    v_mfma_f32_32x32x16_bf16 a[0:15], a[156:159], v[192:195], a[0:15]
    v_cvt_pk_bf16_f32 v1, v2, v3
    v_mul_f32 v32, v32, v228
    v_mul_f32 v33, v33, v228
    v_mul_f32 v34, v34, v228
    v_mul_f32 v35, v35, v228
    v_cvt_pk_bf16_f32 v32, v32, v33
    v_cvt_pk_bf16_f32 v33, v34, v35
    ds_write2_b64 v249, v[0:1], v[32:33] offset0:0 offset1:16
    v_mul_f32 v4, v4, v228
    v_mfma_f32_32x32x16_bf16 v[64:79], a[160:163], v[196:199], v[64:79]
    buffer_load_dwordx4 v222, s[8:11], s24 offen offset:2048 lds
    v_mul_f32 v5, v5, v228
    v_mul_f32 v6, v6, v228
    v_mul_f32 v7, v7, v228
    v_cvt_pk_bf16_f32 v4, v4, v5
    v_cvt_pk_bf16_f32 v5, v6, v7
    v_mul_f32 v36, v36, v228
    v_mul_f32 v37, v37, v228
    v_mul_f32 v38, v38, v228
    v_mul_f32 v39, v39, v228
    v_cvt_pk_bf16_f32 v36, v36, v37
    v_cvt_pk_bf16_f32 v37, v38, v39
    v_xor_b32 v231, 16, v249
    v_mfma_f32_32x32x16_bf16 v[80:95], a[164:167], v[196:199], v[80:95]
    ds_write2_b64 v231, v[4:5], v[36:37] offset0:0 offset1:16
    v_mul_f32 v8, v8, v228
    v_mul_f32 v9, v9, v228
    v_mul_f32 v10, v10, v228
    v_mul_f32 v11, v11, v228
    v_cvt_pk_bf16_f32 v8, v8, v9
    v_cvt_pk_bf16_f32 v9, v10, v11
    v_mul_f32 v40, v40, v228
    v_mul_f32 v41, v41, v228
    v_mfma_f32_32x32x16_bf16 v[96:111], a[168:171], v[196:199], v[96:111]
    buffer_load_dwordx4 v223, s[8:11], s24 offen offset:3072 lds
    v_mul_f32 v42, v42, v228
    v_mul_f32 v43, v43, v228
    v_cvt_pk_bf16_f32 v40, v40, v41
    v_cvt_pk_bf16_f32 v41, v42, v43
    v_xor_b32 v230, 32, v249
    ds_write2_b64 v230, v[8:9], v[40:41] offset0:0 offset1:16
    v_mul_f32 v12, v12, v228
    v_mul_f32 v13, v13, v228
    v_mfma_f32_32x32x16_bf16 a[0:15], a[172:175], v[196:199], a[0:15]
    v_mul_f32 v14, v14, v228
    v_mul_f32 v15, v15, v228
    v_cvt_pk_bf16_f32 v12, v12, v13
    v_cvt_pk_bf16_f32 v13, v14, v15
    v_mul_f32 v44, v44, v228
    v_mul_f32 v45, v45, v228
    v_mul_f32 v46, v46, v228
    v_mul_f32 v47, v47, v228
    v_cvt_pk_bf16_f32 v44, v44, v45
    v_cvt_pk_bf16_f32 v45, v46, v47
    v_xor_b32 v231, 48, v249
    v_mfma_f32_32x32x16_bf16 v[64:79], a[176:179], v[200:203], v[64:79]
    s_waitcnt vmcnt(12) lgkmcnt(0)
    s_barrier
    ds_read_b128 a[80:83], v208 offset:0
    v_add_u32 v132, s100, v208
    ds_read_b128 a[16:19], v132 offset:0
    s_mov_b32 m0, s71
    s_add_u32 s24, s24, 0x20000
    buffer_load_dwordx4 v220, s[8:11], s26 offen offset:0 lds
    ds_write2_b64 v231, v[12:13], v[44:45] offset0:0 offset1:16
    v_mul_f32 v16, v16, v228
    v_mul_f32 v17, v17, v228
    v_mul_f32 v18, v18, v228
    v_mfma_f32_32x32x16_bf16 v[80:95], a[180:183], v[200:203], v[80:95]
    ds_read_b128 a[84:87], v209 offset:0
    v_add_u32 v133, s100, v209
    ds_read_b128 a[20:23], v133 offset:0
    buffer_load_dwordx4 v221, s[8:11], s26 offen offset:1024 lds
    v_mul_f32 v19, v19, v228
    v_cvt_pk_bf16_f32 v16, v16, v17
    v_cvt_pk_bf16_f32 v17, v18, v19
    v_mul_f32 v48, v48, v228
    v_mul_f32 v49, v49, v228
    v_mul_f32 v50, v50, v228
    v_mul_f32 v51, v51, v228
    v_cvt_pk_bf16_f32 v48, v48, v49
    v_cvt_pk_bf16_f32 v49, v50, v51
    v_xor_b32 v230, 64, v249
    v_mfma_f32_32x32x16_bf16 v[96:111], a[184:187], v[200:203], v[96:111]
    ds_read_b128 a[88:91], v210 offset:0
    v_add_u32 v134, s100, v210
    ds_read_b128 a[24:27], v134 offset:0
    ds_write2_b64 v230, v[16:17], v[48:49] offset0:0 offset1:16
    v_mul_f32 v20, v20, v228
    v_mul_f32 v21, v21, v228
    v_mul_f32 v22, v22, v228
    v_mul_f32 v23, v23, v228
    v_cvt_pk_bf16_f32 v20, v20, v21
    v_mfma_f32_32x32x16_bf16 a[0:15], a[188:191], v[200:203], a[0:15]
    ds_read_b128 a[92:95], v211 offset:0
    v_add_u32 v135, s100, v211
    ds_read_b128 a[28:31], v135 offset:0
    buffer_load_dwordx4 v222, s[8:11], s26 offen offset:2048 lds
    v_cvt_pk_bf16_f32 v21, v22, v23
    v_mul_f32 v52, v52, v228
    v_mul_f32 v53, v53, v228
    v_mul_f32 v54, v54, v228
    v_mul_f32 v55, v55, v228
    v_cvt_pk_bf16_f32 v52, v52, v53
    v_cvt_pk_bf16_f32 v53, v54, v55
    v_xor_b32 v231, 0x50, v249
    v_mfma_f32_32x32x16_bf16 v[64:79], a[192:195], v[204:207], v[64:79]
    ds_read_b128 a[96:99], v212 offset:0
    v_add_u32 v132, s100, v212
    ds_read_b128 a[32:35], v132 offset:0
    ds_write2_b64 v231, v[20:21], v[52:53] offset0:0 offset1:16
    v_mul_f32 v24, v24, v228
    v_mul_f32 v25, v25, v228
    v_mul_f32 v26, v26, v228
    v_mul_f32 v27, v27, v228
    v_cvt_pk_bf16_f32 v24, v24, v25
    v_cvt_pk_bf16_f32 v25, v26, v27
    v_mul_f32 v56, v56, v228
    v_mfma_f32_32x32x16_bf16 v[80:95], a[196:199], v[204:207], v[80:95]
    ds_read_b128 a[100:103], v213 offset:0
    v_add_u32 v133, s100, v213
    ds_read_b128 a[36:39], v133 offset:0
    buffer_load_dwordx4 v223, s[8:11], s26 offen offset:3072 lds
    v_mul_f32 v57, v57, v228
    v_mul_f32 v58, v58, v228
    v_mul_f32 v59, v59, v228
    v_cvt_pk_bf16_f32 v56, v56, v57
    v_cvt_pk_bf16_f32 v57, v58, v59
    v_xor_b32 v230, 0x60, v249
    ds_write2_b64 v230, v[24:25], v[56:57] offset0:0 offset1:16
    v_mfma_f32_32x32x16_bf16 v[96:111], a[200:203], v[204:207], v[96:111]
    ds_read_b128 a[104:107], v214 offset:0
    v_add_u32 v134, s100, v214
    ds_read_b128 a[40:43], v134 offset:0
    v_mul_f32 v28, v28, v228
    v_mul_f32 v29, v29, v228
    v_mul_f32 v30, v30, v228
    v_mul_f32 v31, v31, v228
    v_cvt_pk_bf16_f32 v28, v28, v29
    v_cvt_pk_bf16_f32 v29, v30, v31
    v_mul_f32 v60, v60, v228
    v_mul_f32 v61, v61, v228
    v_mul_f32 v62, v62, v228
    v_mfma_f32_32x32x16_bf16 a[0:15], a[204:207], v[204:207], a[0:15]
    ds_read_b128 a[108:111], v215 offset:0
    v_add_u32 v135, s100, v215
    ds_read_b128 a[44:47], v135 offset:0
    v_mul_f32 v63, v63, v228
    v_cvt_pk_bf16_f32 v60, v60, v61
    v_cvt_pk_bf16_f32 v61, v62, v63
    v_xor_b32 v231, 0x70, v249
    ds_write2_b64 v231, v[28:29], v[60:61] offset0:0 offset1:16
    s_waitcnt lgkmcnt(14)
    v_mfma_f32_32x32x16_bf16 v[112:127], a[80:83], a[16:19], 0
    ds_read_b128 a[112:115], v208 offset:8192
    ds_read_b128 a[116:119], v209 offset:8192
    v_add_u32 v230, s3, v255
    ds_read_b128 a[208:211], v230 offset:0
    ds_read_b128 a[212:215], v230 offset:1024
    ds_read_b128 a[216:219], v230 offset:2048
    ds_read_b128 a[220:223], v230 offset:3072
    ds_read_b128 a[224:227], v230 offset:4096
    ds_read_b128 a[228:231], v230 offset:5120
    ds_read_b128 a[232:235], v230 offset:6144
    ds_read_b128 a[236:239], v230 offset:7168
    s_add_u32 s58, s36, 0
    v_add_u32 v247, s58, v250
    v_xor_b32 v248, 64, v247
    v_add_u32 v248, 0x4000, v248
    v_mfma_f32_32x32x16_bf16 v[112:127], a[84:87], a[20:23], v[112:127]
    ds_read_b128 a[120:123], v210 offset:8192
    ds_read_b128 a[124:127], v211 offset:8192
    v_mul_f32 v64, v64, v229
    v_mul_f32 v65, v65, v229
    v_mul_f32 v66, v66, v229
    v_mul_f32 v67, v67, v229
    v_cvt_pk_bf16_f32 v64, v64, v65
    v_cvt_pk_bf16_f32 v65, v66, v67
    v_mul_f32 v96, v96, v229
    v_mul_f32 v97, v97, v229
    v_mul_f32 v98, v98, v229
    v_mul_f32 v99, v99, v229
    v_cvt_pk_bf16_f32 v96, v96, v97
    v_cvt_pk_bf16_f32 v97, v98, v99
    v_mfma_f32_32x32x16_bf16 v[112:127], a[88:91], a[24:27], v[112:127]
    ds_read_b128 a[128:131], v212 offset:8192
    ds_write2_b64 v249, v[64:65], v[96:97] offset0:0 offset1:16
    v_mul_f32 v68, v68, v229
    v_mul_f32 v69, v69, v229
    v_mul_f32 v70, v70, v229
    v_mul_f32 v71, v71, v229
    v_cvt_pk_bf16_f32 v68, v68, v69
    v_cvt_pk_bf16_f32 v69, v70, v71
    s_waitcnt lgkmcnt(14)
    v_mfma_f32_32x32x16_bf16 v[112:127], a[92:95], a[28:31], v[112:127]
    ds_read_b128 a[132:135], v213 offset:8192
    ds_read_b128 a[136:139], v214 offset:8192
    s_waitcnt lgkmcnt(13)
    buffer_store_dwordx4 a[208:211], v247, s[16:19], 0 offen offset:0 sc0 sc1
    v_add_u32 v247, 0x8000, v247
    v_mul_f32 v100, v100, v229
    v_mul_f32 v101, v101, v229
    v_mul_f32 v102, v102, v229
    v_mul_f32 v103, v103, v229
    v_cvt_pk_bf16_f32 v100, v100, v101
    v_cvt_pk_bf16_f32 v101, v102, v103
    v_mfma_f32_32x32x16_bf16 v[112:127], a[96:99], a[32:35], v[112:127]
    ds_read_b128 a[140:143], v215 offset:8192
    v_xor_b32 v231, 16, v249
    ds_write2_b64 v231, v[68:69], v[100:101] offset0:0 offset1:16
    v_mul_f32 v72, v72, v229
    v_mul_f32 v73, v73, v229
    v_mul_f32 v74, v74, v229
    v_mul_f32 v75, v75, v229
    v_cvt_pk_bf16_f32 v72, v72, v73
    v_cvt_pk_bf16_f32 v73, v74, v75
    v_mfma_f32_32x32x16_bf16 v[112:127], a[100:103], a[36:39], v[112:127]
    s_waitcnt lgkmcnt(14)
    buffer_store_dwordx4 a[212:215], v248, s[16:19], 0 offen offset:0 sc0 sc1
    v_add_u32 v248, 0x8000, v248
    v_mul_f32 v104, v104, v229
    v_mul_f32 v105, v105, v229
    v_mul_f32 v106, v106, v229
    v_mul_f32 v107, v107, v229
    v_cvt_pk_bf16_f32 v104, v104, v105
    v_cvt_pk_bf16_f32 v105, v106, v107
    v_xor_b32 v230, 32, v249
    v_mfma_f32_32x32x16_bf16 v[112:127], a[104:107], a[40:43], v[112:127]
    s_waitcnt vmcnt(10) lgkmcnt(0)
    s_barrier
    v_add_u32 v188, s100, v208
    ds_read_b128 a[48:51], v188 offset:8192
    ds_write2_b64 v230, v[72:73], v[104:105] offset0:0 offset1:16
    v_mul_f32 v76, v76, v229
    v_mul_f32 v77, v77, v229
    v_mul_f32 v78, v78, v229
    v_mul_f32 v79, v79, v229
    v_cvt_pk_bf16_f32 v76, v76, v77
    v_mfma_f32_32x32x16_bf16 v[112:127], a[108:111], a[44:47], v[112:127]
    v_add_u32 v189, s100, v209
    ds_read_b128 a[52:55], v189 offset:8192
    s_mov_b32 m0, s66
    s_add_u32 s26, s24, 0x4000
    buffer_load_dwordx4 v220, s[8:11], s24 offen offset:0 lds
    buffer_store_dwordx4 a[216:219], v247, s[16:19], 0 offen offset:0 sc0 sc1
    v_add_u32 v247, 0x8000, v247
    v_cvt_pk_bf16_f32 v77, v78, v79
    v_mul_f32 v108, v108, v229
    v_mul_f32 v109, v109, v229
    v_mul_f32 v110, v110, v229
    v_mfma_f32_32x32x16_bf16 v[128:143], a[112:115], a[16:19], 0
    v_add_u32 v190, s100, v210
    ds_read_b128 a[56:59], v190 offset:8192
    v_mul_f32 v111, v111, v229
    v_cvt_pk_bf16_f32 v108, v108, v109
    v_cvt_pk_bf16_f32 v109, v110, v111
    v_xor_b32 v231, 48, v249
    ds_write2_b64 v231, v[76:77], v[108:109] offset0:0 offset1:16
    v_mul_f32 v80, v80, v229
    v_mfma_f32_32x32x16_bf16 v[128:143], a[116:119], a[20:23], v[128:143]
    v_add_u32 v191, s100, v211
    ds_read_b128 a[60:63], v191 offset:8192
    buffer_load_dwordx4 v221, s[8:11], s24 offen offset:1024 lds
    v_mul_f32 v81, v81, v229
    v_mul_f32 v82, v82, v229
    v_mul_f32 v83, v83, v229
    v_cvt_pk_bf16_f32 v80, v80, v81
    v_cvt_pk_bf16_f32 v81, v82, v83
    v_accvgpr_read_b32 v66, a0
    v_accvgpr_read_b32 v67, a1
    v_accvgpr_read_b32 v98, a2
    v_accvgpr_read_b32 v99, a3
    v_mul_f32 v66, v66, v229
    v_mul_f32 v67, v67, v229
    v_mfma_f32_32x32x16_bf16 v[128:143], a[120:123], a[24:27], v[128:143]
    v_add_u32 v188, s100, v212
    ds_read_b128 a[64:67], v188 offset:8192
    buffer_store_dwordx4 a[220:223], v248, s[16:19], 0 offen offset:0 sc0 sc1
    v_add_u32 v248, 0x8000, v248
    v_mul_f32 v98, v98, v229
    v_mul_f32 v99, v99, v229
    v_cvt_pk_bf16_f32 v66, v66, v67
    v_cvt_pk_bf16_f32 v67, v98, v99
    v_xor_b32 v230, 64, v249
    v_mfma_f32_32x32x16_bf16 v[128:143], a[124:127], a[28:31], v[128:143]
    v_add_u32 v189, s100, v213
    ds_read_b128 a[68:71], v189 offset:8192
    ds_write2_b64 v230, v[80:81], v[66:67] offset0:0 offset1:16
    v_mul_f32 v84, v84, v229
    v_mul_f32 v85, v85, v229
    v_mul_f32 v86, v86, v229
    v_mul_f32 v87, v87, v229
    v_cvt_pk_bf16_f32 v84, v84, v85
    v_cvt_pk_bf16_f32 v85, v86, v87
    v_accvgpr_read_b32 v70, a4
    v_mfma_f32_32x32x16_bf16 v[128:143], a[128:131], a[32:35], v[128:143]
    v_add_u32 v190, s100, v214
    ds_read_b128 a[72:75], v190 offset:8192
    ds_read_b64_tr_b16 a[144:145], v216 offset:32768
    ds_read_b64_tr_b16 a[146:147], v216 offset:33280
    buffer_load_dwordx4 v222, s[8:11], s24 offen offset:2048 lds
    buffer_store_dwordx4 a[224:227], v247, s[16:19], 0 offen offset:0 sc0 sc1
    v_add_u32 v247, 0x8000, v247
    v_accvgpr_read_b32 v71, a5
    v_accvgpr_read_b32 v102, a6
    v_accvgpr_read_b32 v103, a7
    v_mfma_f32_32x32x16_bf16 v[128:143], a[132:135], a[36:39], v[128:143]
    v_add_u32 v191, s100, v215
    ds_read_b128 a[76:79], v191 offset:8192
    ds_read_b64_tr_b16 a[148:149], v217 offset:32768
    ds_read_b64_tr_b16 a[150:151], v217 offset:33280
    v_mul_f32 v70, v70, v229
    v_mul_f32 v71, v71, v229
    v_mul_f32 v102, v102, v229
    v_mul_f32 v103, v103, v229
    v_cvt_pk_bf16_f32 v70, v70, v71
    v_cvt_pk_bf16_f32 v71, v102, v103
    v_xor_b32 v231, 0x50, v249
    v_mfma_f32_32x32x16_bf16 v[128:143], a[136:139], a[40:43], v[128:143]
    ds_read_b64_tr_b16 a[152:153], v218 offset:32768
    ds_read_b64_tr_b16 a[154:155], v218 offset:33280
    buffer_store_dwordx4 a[228:231], v248, s[16:19], 0 offen offset:0 sc0 sc1
    v_add_u32 v248, 0x8000, v248
    ds_write2_b64 v231, v[84:85], v[70:71] offset0:0 offset1:16
    v_mul_f32 v88, v88, v229
    v_mul_f32 v89, v89, v229
    v_mul_f32 v90, v90, v229
    v_mfma_f32_32x32x16_bf16 v[128:143], a[140:143], a[44:47], v[128:143]
    ds_read_b64_tr_b16 a[156:157], v219 offset:32768
    ds_read_b64_tr_b16 a[158:159], v219 offset:33280
    buffer_load_dwordx4 v223, s[8:11], s24 offen offset:3072 lds
    v_mul_f32 v91, v91, v229
    v_cvt_pk_bf16_f32 v88, v88, v89
    v_cvt_pk_bf16_f32 v89, v90, v91
    v_accvgpr_read_b32 v74, a8
    v_accvgpr_read_b32 v75, a9
    v_accvgpr_read_b32 v106, a10
    v_accvgpr_read_b32 v107, a11
    v_mul_f32 v74, v74, v229
    v_mul_f32 v75, v75, v229
    v_mul_f32 v106, v106, v229
    v_mul_f32 v107, v107, v229
    s_waitcnt lgkmcnt(14)
    v_mfma_f32_32x32x16_bf16 v[144:159], a[80:83], a[48:51], 0
    ds_read_b64_tr_b16 a[160:161], v216 offset:36864
    v_max3_f32 v244, v112, v113, v114
    v_cvt_pk_bf16_f32 v74, v74, v75
    v_max3_f32 v244, v244, v115, v116
    v_cvt_pk_bf16_f32 v75, v106, v107
    v_max3_f32 v244, v244, v117, v118
    v_max3_f32 v244, v244, v119, v120
    v_xor_b32 v230, 0x60, v249
    v_max3_f32 v244, v244, v121, v122
    v_max3_f32 v244, v244, v123, v124
    ds_write2_b64 v230, v[88:89], v[74:75] offset0:0 offset1:16
    v_mfma_f32_32x32x16_bf16 v[144:159], a[84:87], a[52:55], v[144:159]
    ds_read_b64_tr_b16 a[162:163], v216 offset:37376
    ds_read_b64_tr_b16 a[164:165], v217 offset:36864
    buffer_store_dwordx4 a[232:235], v247, s[16:19], 0 offen offset:0 sc0 sc1
    v_max3_f32 v244, v244, v125, v126
    v_max_f32 v244, v244, v127
    v_max3_f32 v245, v128, v129, v130
    v_max3_f32 v245, v245, v131, v132
    v_mfma_f32_32x32x16_bf16 v[144:159], a[88:91], a[56:59], v[144:159]
    ds_read_b64_tr_b16 a[166:167], v217 offset:37376
    ds_read_b64_tr_b16 a[168:169], v218 offset:36864
    s_mov_b32 m0, s70
    s_add_u32 s24, s24, 0x20000
    buffer_load_dwordx4 v220, s[8:11], s26 offen offset:0 lds
    v_max3_f32 v245, v245, v133, v134
    v_max3_f32 v245, v245, v135, v136
    v_max3_f32 v245, v245, v137, v138
    v_max3_f32 v245, v245, v139, v140
    v_max3_f32 v245, v245, v141, v142
    v_max3_f32 v244, v244, v245, v143
    v_mov_b32 v245, v244
    s_nop 1
    v_mul_f32 v92, v92, v229
    v_mfma_f32_32x32x16_bf16 v[144:159], a[92:95], a[60:63], v[144:159]
    ds_read_b64_tr_b16 a[170:171], v218 offset:37376
    ds_read_b64_tr_b16 a[172:173], v219 offset:36864
    buffer_store_dwordx4 a[236:239], v248, s[16:19], 0 offen offset:0 sc0 sc1
    v_permlane32_swap_b32 v244, v245
    v_mul_f32 v93, v93, v229
    v_max_f32 v244, v244, v245
    v_mul_f32 v236, s28, v244
    v_mul_f32 v94, v94, v229
    v_fma_f32 v232, v112, s20, v236
    v_mul_f32 v95, v95, v229
    s_waitcnt lgkmcnt(14)
    v_mfma_f32_32x32x16_bf16 v[144:159], a[96:99], a[64:67], v[144:159]
    ds_read_b64_tr_b16 a[174:175], v219 offset:37376
    v_fma_f32 v233, v113, s20, v236
    v_exp_f32 v232, v232
    v_cvt_pk_bf16_f32 v92, v92, v93
    v_exp_f32 v233, v233
    v_cvt_pk_bf16_f32 v93, v94, v95
    v_fma_f32 v234, v114, s20, v236
    v_accvgpr_read_b32 v78, a12
    v_fma_f32 v235, v115, s20, v236
    v_exp_f32 v234, v234
    v_accvgpr_read_b32 v79, a13
    v_accvgpr_read_b32 v110, a14
    v_mfma_f32_32x32x16_bf16 v[144:159], a[100:103], a[68:71], v[144:159]
    ds_read_b64_tr_b16 a[176:177], v216 offset:40960
    ds_read_b64_tr_b16 a[178:179], v216 offset:41472
    buffer_load_dwordx4 v221, s[8:11], s26 offen offset:1024 lds
    v_add_f32 v238, v232, v233
    v_exp_f32 v235, v235
    v_accvgpr_read_b32 v111, a15
    s_nop 0
    v_mul_f32 v78, v78, v229
    v_cvt_pk_bf16_f32 v176, v232, v233
    v_fma_f32 v232, v116, s20, v236
    v_mul_f32 v79, v79, v229
    v_fma_f32 v233, v117, s20, v236
    v_mul_f32 v110, v110, v229
    v_mfma_f32_32x32x16_bf16 v[144:159], a[104:107], a[72:75], v[144:159]
    ds_read_b64_tr_b16 a[180:181], v217 offset:40960
    ds_read_b64_tr_b16 a[182:183], v217 offset:41472
    v_exp_f32 v232, v232
    v_mul_f32 v111, v111, v229
    v_add_f32 v238, v238, v234
    v_exp_f32 v233, v233
    v_cvt_pk_bf16_f32 v78, v78, v79
    v_add_f32 v238, v238, v235
    v_cvt_pk_bf16_f32 v79, v110, v111
    v_cvt_pk_bf16_f32 v177, v234, v235
    v_xor_b32 v231, 0x70, v249
    v_fma_f32 v234, v118, s20, v236
    v_mfma_f32_32x32x16_bf16 v[144:159], a[108:111], a[76:79], v[144:159]
    ds_read_b64_tr_b16 a[184:185], v218 offset:40960
    ds_read_b64_tr_b16 a[186:187], v218 offset:41472
    v_fma_f32 v235, v119, s20, v236
    ds_write2_b64 v231, v[92:93], v[78:79] offset0:0 offset1:16
    v_exp_f32 v234, v234
    v_add_f32 v238, v238, v232
    v_exp_f32 v235, v235
    v_mfma_f32_32x32x16_bf16 v[160:175], a[112:115], a[48:51], 0
    ds_read_b64_tr_b16 a[188:189], v219 offset:40960
    ds_read_b64_tr_b16 a[190:191], v219 offset:41472
    buffer_load_dwordx4 v222, s[8:11], s26 offen offset:2048 lds
    v_add_f32 v238, v238, v233
    v_cvt_pk_bf16_f32 v178, v232, v233
    v_fma_f32 v232, v120, s20, v236
    v_fma_f32 v233, v121, s20, v236
    v_exp_f32 v232, v232
    v_add_f32 v238, v238, v234
    v_exp_f32 v233, v233
    v_add_f32 v238, v238, v235
    v_cvt_pk_bf16_f32 v179, v234, v235
    v_mfma_f32_32x32x16_bf16 v[160:175], a[116:119], a[52:55], v[160:175]
    ds_read_b64_tr_b16 a[192:193], v216 offset:45056
    v_fma_f32 v234, v122, s20, v236
    v_fma_f32 v235, v123, s20, v236
    v_exp_f32 v234, v234
    v_add_f32 v238, v238, v232
    v_exp_f32 v235, v235
    v_add_f32 v238, v238, v233
    v_cvt_pk_bf16_f32 v180, v232, v233
    v_fma_f32 v232, v124, s20, v236
    v_fma_f32 v233, v125, s20, v236
    v_add_u32 v230, s3, v255
    ds_read_b128 a[208:211], v230 offset:0
    v_mfma_f32_32x32x16_bf16 v[160:175], a[120:123], a[56:59], v[160:175]
    ds_read_b64_tr_b16 a[194:195], v216 offset:45568
    ds_read_b64_tr_b16 a[196:197], v217 offset:45056
    ds_read_b128 a[212:215], v230 offset:1024
    ds_read_b128 a[216:219], v230 offset:2048
    ds_read_b128 a[220:223], v230 offset:3072
    ds_read_b128 a[224:227], v230 offset:4096
    ds_read_b128 a[228:231], v230 offset:5120
    ds_read_b128 a[232:235], v230 offset:6144
    ds_read_b128 a[236:239], v230 offset:7168
    s_add_u32 s58, s36, 0x20000
    v_add_u32 v247, s58, v250
    v_xor_b32 v248, 64, v247
    v_add_u32 v248, 0x4000, v248
    v_exp_f32 v232, v232
    v_mfma_f32_32x32x16_bf16 v[160:175], a[124:127], a[60:63], v[160:175]
    ds_read_b64_tr_b16 a[198:199], v217 offset:45568
    ds_read_b64_tr_b16 a[200:201], v218 offset:45056
    buffer_load_dwordx4 v223, s[8:11], s26 offen offset:3072 lds
    v_add_f32 v238, v238, v234
    v_exp_f32 v233, v233
    v_add_f32 v238, v238, v235
    v_cvt_pk_bf16_f32 v181, v234, v235
    v_fma_f32 v234, v126, s20, v236
    v_fma_f32 v235, v127, s20, v236
    v_exp_f32 v234, v234
    v_add_f32 v238, v238, v232
    v_mfma_f32_32x32x16_bf16 v[160:175], a[128:131], a[64:67], v[160:175]
    ds_read_b64_tr_b16 a[202:203], v218 offset:45568
    ds_read_b64_tr_b16 a[204:205], v219 offset:45056
    s_waitcnt lgkmcnt(13)
    buffer_store_dwordx4 a[208:211], v247, s[16:19], 0 offen offset:0 sc0 sc1
    v_add_u32 v247, 0x8000, v247
    v_exp_f32 v235, v235
    v_add_f32 v238, v238, v233
    v_cvt_pk_bf16_f32 v182, v232, v233
    v_fma_f32 v232, v128, s20, v236
    v_fma_f32 v233, v129, s20, v236
    v_mfma_f32_32x32x16_bf16 v[160:175], a[132:135], a[68:71], v[160:175]
    ds_read_b64_tr_b16 a[206:207], v219 offset:45568
    v_exp_f32 v232, v232
    v_add_f32 v238, v238, v234
    v_exp_f32 v233, v233
    v_add_f32 v238, v238, v235
    v_cvt_pk_bf16_f32 v183, v234, v235
    v_fma_f32 v234, v130, s20, v236
    v_fma_f32 v235, v131, s20, v236
    v_exp_f32 v234, v234
    v_add_f32 v238, v238, v232
    v_exp_f32 v235, v235
    v_mfma_f32_32x32x16_bf16 v[160:175], a[136:139], a[72:75], v[160:175]
    s_waitcnt lgkmcnt(11)
    buffer_store_dwordx4 a[212:215], v248, s[16:19], 0 offen offset:0 sc0 sc1
    v_add_u32 v248, 0x8000, v248
    v_add_f32 v238, v238, v233
    v_cvt_pk_bf16_f32 v184, v232, v233
    v_fma_f32 v232, v132, s20, v236
    v_fma_f32 v233, v133, s20, v236
    v_exp_f32 v232, v232
    v_add_f32 v238, v238, v234
    v_exp_f32 v233, v233
    v_mfma_f32_32x32x16_bf16 v[160:175], a[140:143], a[76:79], v[160:175]
    s_waitcnt vmcnt(18) lgkmcnt(0)
    s_barrier
    v_add_f32 v238, v238, v235
    v_cvt_pk_bf16_f32 v185, v234, v235
    v_fma_f32 v234, v134, s20, v236
    v_fma_f32 v235, v135, s20, v236
    v_exp_f32 v234, v234
    v_add_f32 v238, v238, v232
    v_exp_f32 v235, v235
    v_add_f32 v238, v238, v233
    v_cvt_pk_bf16_f32 v186, v232, v233
    v_fma_f32 v232, v136, s20, v236
    v_mfma_f32_32x32x16_bf16 v[0:15], a[144:147], v[176:179], 0
    ds_read_b128 a[80:83], v208 offset:16384
    s_mov_b32 m0, s69
    s_add_u32 s27, s25, 0x4000
    buffer_load_dwordx4 v224, s[12:15], s25 offen offset:0 lds
    v_fma_f32 v233, v137, s20, v236
    v_exp_f32 v232, v232
    v_add_f32 v238, v238, v234
    v_exp_f32 v233, v233
    v_mfma_f32_32x32x16_bf16 v[16:31], a[148:151], v[176:179], 0
    ds_read_b128 a[84:87], v209 offset:16384
    buffer_store_dwordx4 a[216:219], v247, s[16:19], 0 offen offset:0 sc0 sc1
    v_add_u32 v247, 0x8000, v247
    v_add_f32 v238, v238, v235
    v_cvt_pk_bf16_f32 v187, v234, v235
    v_fma_f32 v234, v138, s20, v236
    v_mfma_f32_32x32x16_bf16 v[32:47], a[152:155], v[176:179], 0
    ds_read_b128 a[88:91], v210 offset:16384
    buffer_load_dwordx4 v225, s[12:15], s25 offen offset:1024 lds
    v_fma_f32 v235, v139, s20, v236
    v_exp_f32 v234, v234
    v_add_f32 v238, v238, v232
    v_exp_f32 v235, v235
    v_add_f32 v238, v238, v233
    v_cvt_pk_bf16_f32 v188, v232, v233
    v_mfma_f32_32x32x16_bf16 v[48:63], a[156:159], v[176:179], 0
    ds_read_b128 a[92:95], v211 offset:16384
    v_fma_f32 v232, v140, s20, v236
    v_fma_f32 v233, v141, s20, v236
    v_exp_f32 v232, v232
    v_add_f32 v238, v238, v234
    v_exp_f32 v233, v233
    v_add_f32 v238, v238, v235
    v_cvt_pk_bf16_f32 v189, v234, v235
    v_mfma_f32_32x32x16_bf16 v[0:15], a[160:163], v[180:183], v[0:15]
    ds_read_b128 a[96:99], v212 offset:16384
    buffer_store_dwordx4 a[220:223], v248, s[16:19], 0 offen offset:0 sc0 sc1
    v_add_u32 v248, 0x8000, v248
    buffer_load_dwordx4 v226, s[12:15], s25 offen offset:2048 lds
    v_fma_f32 v234, v142, s20, v236
    v_fma_f32 v235, v143, s20, v236
    v_mfma_f32_32x32x16_bf16 v[16:31], a[164:167], v[180:183], v[16:31]
    ds_read_b128 a[100:103], v213 offset:16384
    v_exp_f32 v234, v234
    v_add_f32 v238, v238, v232
    v_exp_f32 v235, v235
    v_add_f32 v238, v238, v233
    v_cvt_pk_bf16_f32 v190, v232, v233
    v_add_f32 v238, v238, v234
    v_add_f32 v238, v238, v235
    v_mfma_f32_32x32x16_bf16 v[32:47], a[168:171], v[180:183], v[32:47]
    ds_read_b128 a[104:107], v214 offset:16384
    buffer_load_dwordx4 v227, s[12:15], s25 offen offset:3072 lds
    v_cvt_pk_bf16_f32 v191, v234, v235
    v_max3_f32 v244, v144, v145, v146
    v_max3_f32 v244, v244, v147, v148
    v_max3_f32 v244, v244, v149, v150
    v_max3_f32 v244, v244, v151, v152
    v_max3_f32 v244, v244, v153, v154
    v_max3_f32 v244, v244, v155, v156
    v_max3_f32 v244, v244, v157, v158
    v_mfma_f32_32x32x16_bf16 v[48:63], a[172:175], v[180:183], v[48:63]
    ds_read_b128 a[108:111], v215 offset:16384
    buffer_store_dwordx4 a[224:227], v247, s[16:19], 0 offen offset:0 sc0 sc1
    v_add_u32 v247, 0x8000, v247
    v_max_f32 v244, v244, v159
    v_max3_f32 v245, v160, v161, v162
    v_max3_f32 v245, v245, v163, v164
    v_mfma_f32_32x32x16_bf16 v[0:15], a[176:179], v[184:187], v[0:15]
    ds_read_b128 a[112:115], v208 offset:24576
    s_mov_b32 m0, s73
    s_add_u32 s25, s25, 0x20000
    buffer_load_dwordx4 v224, s[12:15], s27 offen offset:0 lds
    v_max3_f32 v245, v245, v165, v166
    v_max3_f32 v245, v245, v167, v168
    v_max3_f32 v245, v245, v169, v170
    v_max3_f32 v245, v245, v171, v172
    v_max3_f32 v245, v245, v173, v174
    v_max3_f32 v244, v244, v245, v175
    v_mov_b32 v245, v244
    v_mfma_f32_32x32x16_bf16 v[16:31], a[180:183], v[184:187], v[16:31]
    ds_read_b128 a[116:119], v209 offset:24576
    buffer_store_dwordx4 a[228:231], v248, s[16:19], 0 offen offset:0 sc0 sc1
    v_add_u32 v248, 0x8000, v248
    s_nop 1
    v_permlane32_swap_b32 v244, v245
    v_mfma_f32_32x32x16_bf16 v[32:47], a[184:187], v[184:187], v[32:47]
    ds_read_b128 a[120:123], v210 offset:24576
    buffer_load_dwordx4 v225, s[12:15], s27 offen offset:1024 lds
    v_max_f32 v244, v244, v245
    v_mul_f32 v237, s28, v244
    v_fma_f32 v232, v144, s20, v237
    v_fma_f32 v233, v145, s20, v237
    v_exp_f32 v232, v232
    v_exp_f32 v233, v233
    v_mfma_f32_32x32x16_bf16 v[48:63], a[188:191], v[184:187], v[48:63]
    ds_read_b128 a[124:127], v211 offset:24576
    v_fma_f32 v234, v146, s20, v237
    v_fma_f32 v235, v147, s20, v237
    v_exp_f32 v234, v234
    v_add_f32 v239, v232, v233
    v_exp_f32 v235, v235
    s_nop 0
    v_mfma_f32_32x32x16_bf16 v[0:15], a[192:195], v[188:191], v[0:15]
    ds_read_b128 a[128:131], v212 offset:24576
    buffer_store_dwordx4 a[232:235], v247, s[16:19], 0 offen offset:0 sc0 sc1
    buffer_load_dwordx4 v226, s[12:15], s27 offen offset:2048 lds
    v_cvt_pk_bf16_f32 v192, v232, v233
    v_fma_f32 v232, v148, s20, v237
    v_fma_f32 v233, v149, s20, v237
    v_mfma_f32_32x32x16_bf16 v[16:31], a[196:199], v[188:191], v[16:31]
    ds_read_b128 a[132:135], v213 offset:24576
    v_exp_f32 v232, v232
    v_add_f32 v239, v239, v234
    v_exp_f32 v233, v233
    v_add_f32 v239, v239, v235
    v_cvt_pk_bf16_f32 v193, v234, v235
    v_fma_f32 v234, v150, s20, v237
    v_fma_f32 v235, v151, s20, v237
    v_mfma_f32_32x32x16_bf16 v[32:47], a[200:203], v[188:191], v[32:47]
    ds_read_b128 a[136:139], v214 offset:24576
    buffer_load_dwordx4 v227, s[12:15], s27 offen offset:3072 lds
    v_exp_f32 v234, v234
    v_add_f32 v239, v239, v232
    v_exp_f32 v235, v235
    v_add_f32 v239, v239, v233
    v_cvt_pk_bf16_f32 v194, v232, v233
    v_fma_f32 v232, v152, s20, v237
    v_mfma_f32_32x32x16_bf16 v[48:63], a[204:207], v[188:191], v[48:63]
    ds_read_b128 a[140:143], v215 offset:24576
    buffer_store_dwordx4 a[236:239], v248, s[16:19], 0 offen offset:0 sc0 sc1
    v_fma_f32 v233, v153, s20, v237
    v_exp_f32 v232, v232
    v_add_f32 v239, v239, v234
    v_mfma_f32_32x32x16_bf16 v[64:79], a[240:243], a[240:243], 0
    v_exp_f32 v233, v233
    v_add_f32 v239, v239, v235
    v_cvt_pk_bf16_f32 v195, v234, v235
    v_fma_f32 v234, v154, s20, v237
    v_fma_f32 v235, v155, s20, v237
    v_exp_f32 v234, v234
    v_add_f32 v239, v239, v232
    v_exp_f32 v235, v235
    v_mfma_f32_32x32x16_bf16 v[80:95], a[240:243], a[240:243], 0
    v_add_f32 v239, v239, v233
    v_cvt_pk_bf16_f32 v196, v232, v233
    v_fma_f32 v232, v156, s20, v237
    v_fma_f32 v233, v157, s20, v237
    v_exp_f32 v232, v232
    v_add_f32 v239, v239, v234
    v_exp_f32 v233, v233
    v_mfma_f32_32x32x16_bf16 v[96:111], a[240:243], a[240:243], 0
    v_add_f32 v239, v239, v235
    v_cvt_pk_bf16_f32 v197, v234, v235
    v_fma_f32 v234, v158, s20, v237
    v_fma_f32 v235, v159, s20, v237
    v_exp_f32 v234, v234
    v_add_f32 v239, v239, v232
    v_exp_f32 v235, v235
    v_add_f32 v239, v239, v233
    v_mfma_f32_32x32x16_bf16 a[0:15], a[240:243], a[240:243], 0
    v_cvt_pk_bf16_f32 v198, v232, v233
    v_fma_f32 v232, v160, s20, v237
    v_fma_f32 v233, v161, s20, v237
    v_exp_f32 v232, v232
    v_add_f32 v239, v239, v234
    v_exp_f32 v233, v233
    v_add_f32 v239, v239, v235
    v_cvt_pk_bf16_f32 v199, v234, v235
    s_mov_b32 s89, s50
    s_add_u32 s36, s48, s78
    s_lshl_b32 s31, s31, 1
    s_load_dwordx8 s[48:55], s[56:57], 32
    s_add_u32 s56, s56, 32
    s_addc_u32 s57, s57, 0
    s_sub_u32 s23, s23, 1
    s_cmp_eq_u32 s23, 1
    s_cbranch_scc1 L_lasts_1
.p2align 6
L_mid1_1:
    s_waitcnt lgkmcnt(8)
    v_mfma_f32_32x32x16_bf16 v[112:127], a[80:83], a[16:19], 0
    v_fma_f32 v234, v162, s20, v237
    v_fma_f32 v235, v163, s20, v237
    v_exp_f32 v234, v234
    v_add_f32 v239, v239, v232
    v_mfma_f32_32x32x16_bf16 v[112:127], a[84:87], a[20:23], v[112:127]
    v_exp_f32 v235, v235
    v_add_f32 v239, v239, v233
    v_cvt_pk_bf16_f32 v200, v232, v233
    v_fma_f32 v232, v164, s20, v237
    v_mfma_f32_32x32x16_bf16 v[112:127], a[88:91], a[24:27], v[112:127]
    v_fma_f32 v233, v165, s20, v237
    v_exp_f32 v232, v232
    v_add_f32 v239, v239, v234
    v_add_f32 v239, v239, v235
    v_mfma_f32_32x32x16_bf16 v[112:127], a[92:95], a[28:31], v[112:127]
    s_mov_b32 m0, s68
    s_add_u32 s27, s25, 0x4000
    buffer_load_dwordx4 v224, s[12:15], s25 offen offset:0 lds
    v_exp_f32 v233, v233
    v_cvt_pk_bf16_f32 v201, v234, v235
    v_fma_f32 v234, v166, s20, v237
    v_mfma_f32_32x32x16_bf16 v[112:127], a[96:99], a[32:35], v[112:127]
    v_fma_f32 v235, v167, s20, v237
    v_exp_f32 v234, v234
    v_add_f32 v239, v239, v232
    v_add_f32 v239, v239, v233
    v_mfma_f32_32x32x16_bf16 v[112:127], a[100:103], a[36:39], v[112:127]
    v_exp_f32 v235, v235
    v_cvt_pk_bf16_f32 v202, v232, v233
    v_fma_f32 v232, v168, s20, v237
    v_fma_f32 v233, v169, s20, v237
    v_mfma_f32_32x32x16_bf16 v[112:127], a[104:107], a[40:43], v[112:127]
    buffer_load_dwordx4 v225, s[12:15], s25 offen offset:1024 lds
    v_exp_f32 v232, v232
    v_add_f32 v239, v239, v234
    v_exp_f32 v233, v233
    v_mfma_f32_32x32x16_bf16 v[112:127], a[108:111], a[44:47], v[112:127]
    v_add_f32 v239, v239, v235
    v_cvt_pk_bf16_f32 v203, v234, v235
    v_fma_f32 v234, v170, s20, v237
    v_fma_f32 v235, v171, s20, v237
    v_add_f32 v239, v239, v232
    s_waitcnt lgkmcnt(0)
    v_mfma_f32_32x32x16_bf16 v[128:143], a[112:115], a[16:19], 0
    v_exp_f32 v234, v234
    v_exp_f32 v235, v235
    v_add_f32 v239, v239, v233
    v_mfma_f32_32x32x16_bf16 v[128:143], a[116:119], a[20:23], v[128:143]
    v_cvt_pk_bf16_f32 v204, v232, v233
    v_fma_f32 v232, v172, s20, v237
    v_fma_f32 v233, v173, s20, v237
    v_add_f32 v239, v239, v234
    v_mfma_f32_32x32x16_bf16 v[128:143], a[120:123], a[24:27], v[128:143]
    buffer_load_dwordx4 v226, s[12:15], s25 offen offset:2048 lds
    v_exp_f32 v232, v232
    v_exp_f32 v233, v233
    v_add_f32 v239, v239, v235
    v_mfma_f32_32x32x16_bf16 v[128:143], a[124:127], a[28:31], v[128:143]
    v_cvt_pk_bf16_f32 v205, v234, v235
    v_fma_f32 v234, v174, s20, v237
    v_fma_f32 v235, v175, s20, v237
    v_exp_f32 v234, v234
    v_mfma_f32_32x32x16_bf16 v[128:143], a[128:131], a[32:35], v[128:143]
    v_add_f32 v239, v239, v232
    v_exp_f32 v235, v235
    v_add_f32 v239, v239, v233
    v_cvt_pk_bf16_f32 v206, v232, v233
    v_mfma_f32_32x32x16_bf16 v[128:143], a[132:135], a[36:39], v[128:143]
    v_add_f32 v239, v239, v234
    v_add_f32 v239, v239, v235
    v_cvt_pk_bf16_f32 v207, v234, v235
    v_fma_f32 v232, v112, s20, v236
    v_fma_f32 v233, v113, s20, v236
    v_mfma_f32_32x32x16_bf16 v[128:143], a[136:139], a[40:43], v[128:143]
    buffer_load_dwordx4 v227, s[12:15], s25 offen offset:3072 lds
    v_exp_f32 v232, v232
    v_exp_f32 v233, v233
    v_fma_f32 v234, v114, s20, v236
    v_mfma_f32_32x32x16_bf16 v[128:143], a[140:143], a[44:47], v[128:143]
    s_waitcnt vmcnt(5) lgkmcnt(0)
    s_barrier
    v_mfma_f32_32x32x16_bf16 v[64:79], a[144:147], v[192:195], v[64:79]
    v_fma_f32 v235, v115, s20, v236
    v_exp_f32 v234, v234
    v_add_f32 v238, v238, v232
    v_add_f32 v238, v238, v233
    v_mfma_f32_32x32x16_bf16 v[80:95], a[148:151], v[192:195], v[80:95]
    s_mov_b32 m0, s72
    s_add_u32 s25, s25, 0x20000
    buffer_load_dwordx4 v224, s[12:15], s27 offen offset:0 lds
    ds_read_b64_tr_b16 a[144:145], v216 offset:49152
    ds_read_b64_tr_b16 a[146:147], v216 offset:49664
    v_exp_f32 v235, v235
    v_cvt_pk_bf16_f32 v176, v232, v233
    v_fma_f32 v232, v116, s20, v236
    v_fma_f32 v233, v117, s20, v236
    v_mfma_f32_32x32x16_bf16 v[96:111], a[152:155], v[192:195], v[96:111]
    ds_read_b64_tr_b16 a[148:149], v217 offset:49152
    v_exp_f32 v232, v232
    v_add_f32 v238, v238, v234
    v_exp_f32 v233, v233
    v_mfma_f32_32x32x16_bf16 a[0:15], a[156:159], v[192:195], a[0:15]
    ds_read_b64_tr_b16 a[150:151], v217 offset:49664
    v_add_f32 v238, v238, v235
    v_cvt_pk_bf16_f32 v177, v234, v235
    v_fma_f32 v234, v118, s20, v236
    v_fma_f32 v235, v119, s20, v236
    v_add_f32 v238, v238, v232
    v_mfma_f32_32x32x16_bf16 v[64:79], a[160:163], v[196:199], v[64:79]
    ds_read_b64_tr_b16 a[152:153], v218 offset:49152
    v_exp_f32 v234, v234
    v_exp_f32 v235, v235
    v_add_f32 v238, v238, v233
    v_mfma_f32_32x32x16_bf16 v[80:95], a[164:167], v[196:199], v[80:95]
    buffer_load_dwordx4 v225, s[12:15], s27 offen offset:1024 lds
    ds_read_b64_tr_b16 a[154:155], v218 offset:49664
    v_cvt_pk_bf16_f32 v178, v232, v233
    v_fma_f32 v232, v120, s20, v236
    v_fma_f32 v233, v121, s20, v236
    v_add_f32 v238, v238, v234
    v_mfma_f32_32x32x16_bf16 v[96:111], a[168:171], v[196:199], v[96:111]
    ds_read_b64_tr_b16 a[156:157], v219 offset:49152
    v_exp_f32 v232, v232
    v_exp_f32 v233, v233
    v_add_f32 v238, v238, v235
    v_mfma_f32_32x32x16_bf16 a[0:15], a[172:175], v[196:199], a[0:15]
    ds_read_b64_tr_b16 a[158:159], v219 offset:49664
    v_cvt_pk_bf16_f32 v179, v234, v235
    v_fma_f32 v234, v122, s20, v236
    v_fma_f32 v235, v123, s20, v236
    v_exp_f32 v234, v234
    v_mfma_f32_32x32x16_bf16 v[64:79], a[176:179], v[200:203], v[64:79]
    ds_read_b64_tr_b16 a[160:161], v216 offset:53248
    ds_read_b64_tr_b16 a[162:163], v216 offset:53760
    v_add_f32 v238, v238, v232
    v_exp_f32 v235, v235
    v_add_f32 v238, v238, v233
    v_cvt_pk_bf16_f32 v180, v232, v233
    v_mfma_f32_32x32x16_bf16 v[80:95], a[180:183], v[200:203], v[80:95]
    buffer_load_dwordx4 v226, s[12:15], s27 offen offset:2048 lds
    ds_read_b64_tr_b16 a[164:165], v217 offset:53248
    v_fma_f32 v232, v124, s20, v236
    v_fma_f32 v233, v125, s20, v236
    v_exp_f32 v232, v232
    v_add_f32 v238, v238, v234
    v_mfma_f32_32x32x16_bf16 v[96:111], a[184:187], v[200:203], v[96:111]
    ds_read_b64_tr_b16 a[166:167], v217 offset:53760
    v_exp_f32 v233, v233
    v_add_f32 v238, v238, v235
    v_cvt_pk_bf16_f32 v181, v234, v235
    v_fma_f32 v234, v126, s20, v236
    v_mfma_f32_32x32x16_bf16 a[0:15], a[188:191], v[200:203], a[0:15]
    ds_read_b64_tr_b16 a[168:169], v218 offset:53248
    v_fma_f32 v235, v127, s20, v236
    v_exp_f32 v234, v234
    v_add_f32 v238, v238, v232
    v_mfma_f32_32x32x16_bf16 v[64:79], a[192:195], v[204:207], v[64:79]
    buffer_load_dwordx4 v227, s[12:15], s27 offen offset:3072 lds
    ds_read_b64_tr_b16 a[170:171], v218 offset:53760
    v_exp_f32 v235, v235
    v_add_f32 v238, v238, v233
    v_cvt_pk_bf16_f32 v182, v232, v233
    v_fma_f32 v232, v128, s20, v236
    v_mfma_f32_32x32x16_bf16 v[80:95], a[196:199], v[204:207], v[80:95]
    ds_read_b64_tr_b16 a[172:173], v219 offset:53248
    v_fma_f32 v233, v129, s20, v236
    v_exp_f32 v232, v232
    v_add_f32 v238, v238, v234
    v_add_f32 v238, v238, v235
    v_mfma_f32_32x32x16_bf16 v[96:111], a[200:203], v[204:207], v[96:111]
    ds_read_b64_tr_b16 a[174:175], v219 offset:53760
    v_exp_f32 v233, v233
    v_cvt_pk_bf16_f32 v183, v234, v235
    v_fma_f32 v234, v130, s20, v236
    v_fma_f32 v235, v131, s20, v236
    v_mfma_f32_32x32x16_bf16 a[0:15], a[204:207], v[204:207], a[0:15]
    ds_read_b64_tr_b16 a[176:177], v216 offset:57344
    ds_read_b64_tr_b16 a[178:179], v216 offset:57856
    v_exp_f32 v234, v234
    v_add_f32 v238, v238, v232
    v_exp_f32 v235, v235
    v_mfma_f32_32x32x16_bf16 v[144:159], a[80:83], a[48:51], 0
    ds_read_b64_tr_b16 a[180:181], v217 offset:57344
    v_add_f32 v238, v238, v233
    v_cvt_pk_bf16_f32 v184, v232, v233
    v_fma_f32 v232, v132, s20, v236
    v_fma_f32 v233, v133, s20, v236
    v_add_f32 v238, v238, v234
    v_mfma_f32_32x32x16_bf16 v[144:159], a[84:87], a[52:55], v[144:159]
    s_mov_b32 m0, s67
    s_add_u32 s26, s24, 0x4000
    buffer_load_dwordx4 v220, s[8:11], s24 offen offset:0 lds
    ds_read_b64_tr_b16 a[182:183], v217 offset:57856
    v_exp_f32 v232, v232
    v_exp_f32 v233, v233
    v_mfma_f32_32x32x16_bf16 v[144:159], a[88:91], a[56:59], v[144:159]
    ds_read_b64_tr_b16 a[184:185], v218 offset:57344
    v_add_f32 v238, v238, v235
    v_cvt_pk_bf16_f32 v185, v234, v235
    v_fma_f32 v234, v134, s20, v236
    v_fma_f32 v235, v135, s20, v236
    v_add_f32 v238, v238, v232
    v_mfma_f32_32x32x16_bf16 v[144:159], a[92:95], a[60:63], v[144:159]
    ds_read_b64_tr_b16 a[186:187], v218 offset:57856
    v_exp_f32 v234, v234
    v_exp_f32 v235, v235
    v_add_f32 v238, v238, v233
    v_mfma_f32_32x32x16_bf16 v[144:159], a[96:99], a[64:67], v[144:159]
    ds_read_b64_tr_b16 a[188:189], v219 offset:57344
    v_cvt_pk_bf16_f32 v186, v232, v233
    v_fma_f32 v232, v136, s20, v236
    v_fma_f32 v233, v137, s20, v236
    v_exp_f32 v232, v232
    v_mfma_f32_32x32x16_bf16 v[144:159], a[100:103], a[68:71], v[144:159]
    buffer_load_dwordx4 v221, s[8:11], s24 offen offset:1024 lds
    ds_read_b64_tr_b16 a[190:191], v219 offset:57856
    v_add_f32 v238, v238, v234
    v_exp_f32 v233, v233
    v_add_f32 v238, v238, v235
    v_cvt_pk_bf16_f32 v187, v234, v235
    v_mfma_f32_32x32x16_bf16 v[144:159], a[104:107], a[72:75], v[144:159]
    ds_read_b64_tr_b16 a[192:193], v216 offset:61440
    ds_read_b64_tr_b16 a[194:195], v216 offset:61952
    v_fma_f32 v234, v138, s20, v236
    v_fma_f32 v235, v139, s20, v236
    v_exp_f32 v234, v234
    v_add_f32 v238, v238, v232
    v_mfma_f32_32x32x16_bf16 v[144:159], a[108:111], a[76:79], v[144:159]
    ds_read_b64_tr_b16 a[196:197], v217 offset:61440
    v_exp_f32 v235, v235
    v_add_f32 v238, v238, v233
    v_cvt_pk_bf16_f32 v188, v232, v233
    v_mfma_f32_32x32x16_bf16 v[160:175], a[112:115], a[48:51], 0
    ds_read_b64_tr_b16 a[198:199], v217 offset:61952
    v_fma_f32 v232, v140, s20, v236
    v_fma_f32 v233, v141, s20, v236
    v_exp_f32 v232, v232
    v_add_f32 v238, v238, v234
    v_mfma_f32_32x32x16_bf16 v[160:175], a[116:119], a[52:55], v[160:175]
    buffer_load_dwordx4 v222, s[8:11], s24 offen offset:2048 lds
    ds_read_b64_tr_b16 a[200:201], v218 offset:61440
    v_exp_f32 v233, v233
    v_add_f32 v238, v238, v235
    v_cvt_pk_bf16_f32 v189, v234, v235
    v_fma_f32 v234, v142, s20, v236
    v_mfma_f32_32x32x16_bf16 v[160:175], a[120:123], a[56:59], v[160:175]
    ds_read_b64_tr_b16 a[202:203], v218 offset:61952
    v_fma_f32 v235, v143, s20, v236
    v_exp_f32 v234, v234
    v_add_f32 v238, v238, v232
    v_add_f32 v238, v238, v233
    v_mfma_f32_32x32x16_bf16 v[160:175], a[124:127], a[60:63], v[160:175]
    ds_read_b64_tr_b16 a[204:205], v219 offset:61440
    v_exp_f32 v235, v235
    v_cvt_pk_bf16_f32 v190, v232, v233
    v_add_f32 v238, v238, v234
    v_add_f32 v238, v238, v235
    v_mfma_f32_32x32x16_bf16 v[160:175], a[128:131], a[64:67], v[160:175]
    ds_read_b64_tr_b16 a[206:207], v219 offset:61952
    v_cvt_pk_bf16_f32 v191, v234, v235
    v_mfma_f32_32x32x16_bf16 v[160:175], a[132:135], a[68:71], v[160:175]
    buffer_load_dwordx4 v223, s[8:11], s24 offen offset:3072 lds
    v_fma_f32 v232, v144, s20, v237
    v_fma_f32 v233, v145, s20, v237
    v_exp_f32 v232, v232
    v_mfma_f32_32x32x16_bf16 v[160:175], a[136:139], a[72:75], v[160:175]
    v_exp_f32 v233, v233
    v_fma_f32 v234, v146, s20, v237
    v_fma_f32 v235, v147, s20, v237
    v_add_f32 v239, v239, v232
    v_mfma_f32_32x32x16_bf16 v[160:175], a[140:143], a[76:79], v[160:175]
    s_waitcnt vmcnt(12) lgkmcnt(0)
    s_barrier
    v_mfma_f32_32x32x16_bf16 v[0:15], a[144:147], v[176:179], v[0:15]
    ds_read_b128 a[80:83], v208 offset:0
    s_mov_b32 m0, s71
    s_add_u32 s24, s24, 0x20000
    buffer_load_dwordx4 v220, s[8:11], s26 offen offset:0 lds
    v_exp_f32 v234, v234
    v_exp_f32 v235, v235
    v_add_f32 v239, v239, v233
    v_mfma_f32_32x32x16_bf16 v[16:31], a[148:151], v[176:179], v[16:31]
    ds_read_b128 a[84:87], v209 offset:0
    v_cvt_pk_bf16_f32 v192, v232, v233
    v_fma_f32 v232, v148, s20, v237
    v_fma_f32 v233, v149, s20, v237
    v_exp_f32 v232, v232
    v_mfma_f32_32x32x16_bf16 v[32:47], a[152:155], v[176:179], v[32:47]
    ds_read_b128 a[88:91], v210 offset:0
    v_add_f32 v239, v239, v234
    v_exp_f32 v233, v233
    v_add_f32 v239, v239, v235
    v_cvt_pk_bf16_f32 v193, v234, v235
    v_mfma_f32_32x32x16_bf16 v[48:63], a[156:159], v[176:179], v[48:63]
    ds_read_b128 a[92:95], v211 offset:0
    v_fma_f32 v234, v150, s20, v237
    v_fma_f32 v235, v151, s20, v237
    v_exp_f32 v234, v234
    v_mfma_f32_32x32x16_bf16 v[0:15], a[160:163], v[180:183], v[0:15]
    ds_read_b128 a[96:99], v212 offset:0
    buffer_load_dwordx4 v221, s[8:11], s26 offen offset:1024 lds
    v_add_f32 v239, v239, v232
    v_exp_f32 v235, v235
    v_add_f32 v239, v239, v233
    v_cvt_pk_bf16_f32 v194, v232, v233
    v_mfma_f32_32x32x16_bf16 v[16:31], a[164:167], v[180:183], v[16:31]
    ds_read_b128 a[100:103], v213 offset:0
    v_fma_f32 v232, v152, s20, v237
    v_fma_f32 v233, v153, s20, v237
    v_exp_f32 v232, v232
    v_add_f32 v239, v239, v234
    v_mfma_f32_32x32x16_bf16 v[32:47], a[168:171], v[180:183], v[32:47]
    ds_read_b128 a[104:107], v214 offset:0
    v_exp_f32 v233, v233
    v_add_f32 v239, v239, v235
    v_cvt_pk_bf16_f32 v195, v234, v235
    v_fma_f32 v234, v154, s20, v237
    v_mfma_f32_32x32x16_bf16 v[48:63], a[172:175], v[180:183], v[48:63]
    ds_read_b128 a[108:111], v215 offset:0
    v_fma_f32 v235, v155, s20, v237
    v_exp_f32 v234, v234
    v_add_f32 v239, v239, v232
    v_add_f32 v239, v239, v233
    v_mfma_f32_32x32x16_bf16 v[0:15], a[176:179], v[184:187], v[0:15]
    ds_read_b128 a[112:115], v208 offset:8192
    v_exp_f32 v235, v235
    v_cvt_pk_bf16_f32 v196, v232, v233
    v_fma_f32 v232, v156, s20, v237
    v_fma_f32 v233, v157, s20, v237
    v_mfma_f32_32x32x16_bf16 v[16:31], a[180:183], v[184:187], v[16:31]
    ds_read_b128 a[116:119], v209 offset:8192
    buffer_load_dwordx4 v222, s[8:11], s26 offen offset:2048 lds
    v_exp_f32 v232, v232
    v_add_f32 v239, v239, v234
    v_add_f32 v239, v239, v235
    v_mfma_f32_32x32x16_bf16 v[32:47], a[184:187], v[184:187], v[32:47]
    ds_read_b128 a[120:123], v210 offset:8192
    v_exp_f32 v233, v233
    v_cvt_pk_bf16_f32 v197, v234, v235
    v_fma_f32 v234, v158, s20, v237
    v_fma_f32 v235, v159, s20, v237
    v_mfma_f32_32x32x16_bf16 v[48:63], a[188:191], v[184:187], v[48:63]
    ds_read_b128 a[124:127], v211 offset:8192
    v_exp_f32 v234, v234
    v_add_f32 v239, v239, v232
    v_exp_f32 v235, v235
    v_mfma_f32_32x32x16_bf16 v[0:15], a[192:195], v[188:191], v[0:15]
    ds_read_b128 a[128:131], v212 offset:8192
    buffer_load_dwordx4 v223, s[8:11], s26 offen offset:3072 lds
    v_add_f32 v239, v239, v233
    v_cvt_pk_bf16_f32 v198, v232, v233
    v_fma_f32 v232, v160, s20, v237
    v_fma_f32 v233, v161, s20, v237
    v_add_f32 v239, v239, v234
    v_mfma_f32_32x32x16_bf16 v[16:31], a[196:199], v[188:191], v[16:31]
    ds_read_b128 a[132:135], v213 offset:8192
    v_exp_f32 v232, v232
    v_exp_f32 v233, v233
    v_add_f32 v239, v239, v235
    v_mfma_f32_32x32x16_bf16 v[32:47], a[200:203], v[188:191], v[32:47]
    ds_read_b128 a[136:139], v214 offset:8192
    v_cvt_pk_bf16_f32 v199, v234, v235
    v_mfma_f32_32x32x16_bf16 v[48:63], a[204:207], v[188:191], v[48:63]
    ds_read_b128 a[140:143], v215 offset:8192
    s_sub_u32 s23, s23, 1
    s_cmp_eq_u32 s23, 1
    s_cbranch_scc1 L_lasts_0
L_mid0_1:
    s_waitcnt lgkmcnt(8)
    v_mfma_f32_32x32x16_bf16 v[112:127], a[80:83], a[16:19], 0
    v_fma_f32 v234, v162, s20, v237
    v_fma_f32 v235, v163, s20, v237
    v_exp_f32 v234, v234
    v_add_f32 v239, v239, v232
    v_mfma_f32_32x32x16_bf16 v[112:127], a[84:87], a[20:23], v[112:127]
    v_exp_f32 v235, v235
    v_add_f32 v239, v239, v233
    v_cvt_pk_bf16_f32 v200, v232, v233
    v_fma_f32 v232, v164, s20, v237
    v_mfma_f32_32x32x16_bf16 v[112:127], a[88:91], a[24:27], v[112:127]
    v_fma_f32 v233, v165, s20, v237
    v_exp_f32 v232, v232
    v_add_f32 v239, v239, v234
    v_add_f32 v239, v239, v235
    v_mfma_f32_32x32x16_bf16 v[112:127], a[92:95], a[28:31], v[112:127]
    s_mov_b32 m0, s69
    s_add_u32 s27, s25, 0x4000
    buffer_load_dwordx4 v224, s[12:15], s25 offen offset:0 lds
    v_exp_f32 v233, v233
    v_cvt_pk_bf16_f32 v201, v234, v235
    v_fma_f32 v234, v166, s20, v237
    v_mfma_f32_32x32x16_bf16 v[112:127], a[96:99], a[32:35], v[112:127]
    v_fma_f32 v235, v167, s20, v237
    v_exp_f32 v234, v234
    v_add_f32 v239, v239, v232
    v_add_f32 v239, v239, v233
    v_mfma_f32_32x32x16_bf16 v[112:127], a[100:103], a[36:39], v[112:127]
    v_exp_f32 v235, v235
    v_cvt_pk_bf16_f32 v202, v232, v233
    v_fma_f32 v232, v168, s20, v237
    v_fma_f32 v233, v169, s20, v237
    v_mfma_f32_32x32x16_bf16 v[112:127], a[104:107], a[40:43], v[112:127]
    buffer_load_dwordx4 v225, s[12:15], s25 offen offset:1024 lds
    v_exp_f32 v232, v232
    v_add_f32 v239, v239, v234
    v_exp_f32 v233, v233
    v_mfma_f32_32x32x16_bf16 v[112:127], a[108:111], a[44:47], v[112:127]
    v_add_f32 v239, v239, v235
    v_cvt_pk_bf16_f32 v203, v234, v235
    v_fma_f32 v234, v170, s20, v237
    v_fma_f32 v235, v171, s20, v237
    v_add_f32 v239, v239, v232
    s_waitcnt lgkmcnt(0)
    v_mfma_f32_32x32x16_bf16 v[128:143], a[112:115], a[16:19], 0
    v_exp_f32 v234, v234
    v_exp_f32 v235, v235
    v_add_f32 v239, v239, v233
    v_mfma_f32_32x32x16_bf16 v[128:143], a[116:119], a[20:23], v[128:143]
    v_cvt_pk_bf16_f32 v204, v232, v233
    v_fma_f32 v232, v172, s20, v237
    v_fma_f32 v233, v173, s20, v237
    v_add_f32 v239, v239, v234
    v_mfma_f32_32x32x16_bf16 v[128:143], a[120:123], a[24:27], v[128:143]
    buffer_load_dwordx4 v226, s[12:15], s25 offen offset:2048 lds
    v_exp_f32 v232, v232
    v_exp_f32 v233, v233
    v_add_f32 v239, v239, v235
    v_mfma_f32_32x32x16_bf16 v[128:143], a[124:127], a[28:31], v[128:143]
    v_cvt_pk_bf16_f32 v205, v234, v235
    v_fma_f32 v234, v174, s20, v237
    v_fma_f32 v235, v175, s20, v237
    v_exp_f32 v234, v234
    v_mfma_f32_32x32x16_bf16 v[128:143], a[128:131], a[32:35], v[128:143]
    v_add_f32 v239, v239, v232
    v_exp_f32 v235, v235
    v_add_f32 v239, v239, v233
    v_cvt_pk_bf16_f32 v206, v232, v233
    v_mfma_f32_32x32x16_bf16 v[128:143], a[132:135], a[36:39], v[128:143]
    v_add_f32 v239, v239, v234
    v_add_f32 v239, v239, v235
    v_cvt_pk_bf16_f32 v207, v234, v235
    v_fma_f32 v232, v112, s20, v236
    v_fma_f32 v233, v113, s20, v236
    v_mfma_f32_32x32x16_bf16 v[128:143], a[136:139], a[40:43], v[128:143]
    buffer_load_dwordx4 v227, s[12:15], s25 offen offset:3072 lds
    v_exp_f32 v232, v232
    v_exp_f32 v233, v233
    v_fma_f32 v234, v114, s20, v236
    v_mfma_f32_32x32x16_bf16 v[128:143], a[140:143], a[44:47], v[128:143]
    s_waitcnt vmcnt(12) lgkmcnt(0)
    s_barrier
    v_mfma_f32_32x32x16_bf16 v[64:79], a[144:147], v[192:195], v[64:79]
    v_fma_f32 v235, v115, s20, v236
    v_exp_f32 v234, v234
    v_add_f32 v238, v238, v232
    v_add_f32 v238, v238, v233
    v_mfma_f32_32x32x16_bf16 v[80:95], a[148:151], v[192:195], v[80:95]
    s_mov_b32 m0, s73
    s_add_u32 s25, s25, 0x20000
    buffer_load_dwordx4 v224, s[12:15], s27 offen offset:0 lds
    ds_read_b64_tr_b16 a[144:145], v216 offset:32768
    ds_read_b64_tr_b16 a[146:147], v216 offset:33280
    v_exp_f32 v235, v235
    v_cvt_pk_bf16_f32 v176, v232, v233
    v_fma_f32 v232, v116, s20, v236
    v_fma_f32 v233, v117, s20, v236
    v_mfma_f32_32x32x16_bf16 v[96:111], a[152:155], v[192:195], v[96:111]
    ds_read_b64_tr_b16 a[148:149], v217 offset:32768
    v_exp_f32 v232, v232
    v_add_f32 v238, v238, v234
    v_exp_f32 v233, v233
    v_mfma_f32_32x32x16_bf16 a[0:15], a[156:159], v[192:195], a[0:15]
    ds_read_b64_tr_b16 a[150:151], v217 offset:33280
    v_add_f32 v238, v238, v235
    v_cvt_pk_bf16_f32 v177, v234, v235
    v_fma_f32 v234, v118, s20, v236
    v_fma_f32 v235, v119, s20, v236
    v_add_f32 v238, v238, v232
    v_mfma_f32_32x32x16_bf16 v[64:79], a[160:163], v[196:199], v[64:79]
    ds_read_b64_tr_b16 a[152:153], v218 offset:32768
    v_exp_f32 v234, v234
    v_exp_f32 v235, v235
    v_add_f32 v238, v238, v233
    v_mfma_f32_32x32x16_bf16 v[80:95], a[164:167], v[196:199], v[80:95]
    buffer_load_dwordx4 v225, s[12:15], s27 offen offset:1024 lds
    ds_read_b64_tr_b16 a[154:155], v218 offset:33280
    v_cvt_pk_bf16_f32 v178, v232, v233
    v_fma_f32 v232, v120, s20, v236
    v_fma_f32 v233, v121, s20, v236
    v_add_f32 v238, v238, v234
    v_mfma_f32_32x32x16_bf16 v[96:111], a[168:171], v[196:199], v[96:111]
    ds_read_b64_tr_b16 a[156:157], v219 offset:32768
    v_exp_f32 v232, v232
    v_exp_f32 v233, v233
    v_add_f32 v238, v238, v235
    v_mfma_f32_32x32x16_bf16 a[0:15], a[172:175], v[196:199], a[0:15]
    ds_read_b64_tr_b16 a[158:159], v219 offset:33280
    v_cvt_pk_bf16_f32 v179, v234, v235
    v_fma_f32 v234, v122, s20, v236
    v_fma_f32 v235, v123, s20, v236
    v_exp_f32 v234, v234
    v_mfma_f32_32x32x16_bf16 v[64:79], a[176:179], v[200:203], v[64:79]
    ds_read_b64_tr_b16 a[160:161], v216 offset:36864
    ds_read_b64_tr_b16 a[162:163], v216 offset:37376
    v_add_f32 v238, v238, v232
    v_exp_f32 v235, v235
    v_add_f32 v238, v238, v233
    v_cvt_pk_bf16_f32 v180, v232, v233
    v_mfma_f32_32x32x16_bf16 v[80:95], a[180:183], v[200:203], v[80:95]
    buffer_load_dwordx4 v226, s[12:15], s27 offen offset:2048 lds
    ds_read_b64_tr_b16 a[164:165], v217 offset:36864
    v_fma_f32 v232, v124, s20, v236
    v_fma_f32 v233, v125, s20, v236
    v_exp_f32 v232, v232
    v_add_f32 v238, v238, v234
    v_mfma_f32_32x32x16_bf16 v[96:111], a[184:187], v[200:203], v[96:111]
    ds_read_b64_tr_b16 a[166:167], v217 offset:37376
    v_exp_f32 v233, v233
    v_add_f32 v238, v238, v235
    v_cvt_pk_bf16_f32 v181, v234, v235
    v_fma_f32 v234, v126, s20, v236
    v_mfma_f32_32x32x16_bf16 a[0:15], a[188:191], v[200:203], a[0:15]
    ds_read_b64_tr_b16 a[168:169], v218 offset:36864
    v_fma_f32 v235, v127, s20, v236
    v_exp_f32 v234, v234
    v_add_f32 v238, v238, v232
    v_mfma_f32_32x32x16_bf16 v[64:79], a[192:195], v[204:207], v[64:79]
    buffer_load_dwordx4 v227, s[12:15], s27 offen offset:3072 lds
    ds_read_b64_tr_b16 a[170:171], v218 offset:37376
    v_exp_f32 v235, v235
    v_add_f32 v238, v238, v233
    v_cvt_pk_bf16_f32 v182, v232, v233
    v_fma_f32 v232, v128, s20, v236
    v_mfma_f32_32x32x16_bf16 v[80:95], a[196:199], v[204:207], v[80:95]
    ds_read_b64_tr_b16 a[172:173], v219 offset:36864
    v_fma_f32 v233, v129, s20, v236
    v_exp_f32 v232, v232
    v_add_f32 v238, v238, v234
    v_add_f32 v238, v238, v235
    v_mfma_f32_32x32x16_bf16 v[96:111], a[200:203], v[204:207], v[96:111]
    ds_read_b64_tr_b16 a[174:175], v219 offset:37376
    v_exp_f32 v233, v233
    v_cvt_pk_bf16_f32 v183, v234, v235
    v_fma_f32 v234, v130, s20, v236
    v_fma_f32 v235, v131, s20, v236
    v_mfma_f32_32x32x16_bf16 a[0:15], a[204:207], v[204:207], a[0:15]
    ds_read_b64_tr_b16 a[176:177], v216 offset:40960
    ds_read_b64_tr_b16 a[178:179], v216 offset:41472
    v_exp_f32 v234, v234
    v_add_f32 v238, v238, v232
    v_exp_f32 v235, v235
    v_mfma_f32_32x32x16_bf16 v[144:159], a[80:83], a[48:51], 0
    ds_read_b64_tr_b16 a[180:181], v217 offset:40960
    v_add_f32 v238, v238, v233
    v_cvt_pk_bf16_f32 v184, v232, v233
    v_fma_f32 v232, v132, s20, v236
    v_fma_f32 v233, v133, s20, v236
    v_add_f32 v238, v238, v234
    v_mfma_f32_32x32x16_bf16 v[144:159], a[84:87], a[52:55], v[144:159]
    s_mov_b32 m0, s66
    s_add_u32 s26, s24, 0x4000
    buffer_load_dwordx4 v220, s[8:11], s24 offen offset:0 lds
    ds_read_b64_tr_b16 a[182:183], v217 offset:41472
    v_exp_f32 v232, v232
    v_exp_f32 v233, v233
    v_mfma_f32_32x32x16_bf16 v[144:159], a[88:91], a[56:59], v[144:159]
    ds_read_b64_tr_b16 a[184:185], v218 offset:40960
    v_add_f32 v238, v238, v235
    v_cvt_pk_bf16_f32 v185, v234, v235
    v_fma_f32 v234, v134, s20, v236
    v_fma_f32 v235, v135, s20, v236
    v_add_f32 v238, v238, v232
    v_mfma_f32_32x32x16_bf16 v[144:159], a[92:95], a[60:63], v[144:159]
    ds_read_b64_tr_b16 a[186:187], v218 offset:41472
    v_exp_f32 v234, v234
    v_exp_f32 v235, v235
    v_add_f32 v238, v238, v233
    v_mfma_f32_32x32x16_bf16 v[144:159], a[96:99], a[64:67], v[144:159]
    ds_read_b64_tr_b16 a[188:189], v219 offset:40960
    v_cvt_pk_bf16_f32 v186, v232, v233
    v_fma_f32 v232, v136, s20, v236
    v_fma_f32 v233, v137, s20, v236
    v_exp_f32 v232, v232
    v_mfma_f32_32x32x16_bf16 v[144:159], a[100:103], a[68:71], v[144:159]
    buffer_load_dwordx4 v221, s[8:11], s24 offen offset:1024 lds
    ds_read_b64_tr_b16 a[190:191], v219 offset:41472
    v_add_f32 v238, v238, v234
    v_exp_f32 v233, v233
    v_add_f32 v238, v238, v235
    v_cvt_pk_bf16_f32 v187, v234, v235
    v_mfma_f32_32x32x16_bf16 v[144:159], a[104:107], a[72:75], v[144:159]
    ds_read_b64_tr_b16 a[192:193], v216 offset:45056
    ds_read_b64_tr_b16 a[194:195], v216 offset:45568
    v_fma_f32 v234, v138, s20, v236
    v_fma_f32 v235, v139, s20, v236
    v_exp_f32 v234, v234
    v_add_f32 v238, v238, v232
    v_mfma_f32_32x32x16_bf16 v[144:159], a[108:111], a[76:79], v[144:159]
    ds_read_b64_tr_b16 a[196:197], v217 offset:45056
    v_exp_f32 v235, v235
    v_add_f32 v238, v238, v233
    v_cvt_pk_bf16_f32 v188, v232, v233
    v_mfma_f32_32x32x16_bf16 v[160:175], a[112:115], a[48:51], 0
    ds_read_b64_tr_b16 a[198:199], v217 offset:45568
    v_fma_f32 v232, v140, s20, v236
    v_fma_f32 v233, v141, s20, v236
    v_exp_f32 v232, v232
    v_add_f32 v238, v238, v234
    v_mfma_f32_32x32x16_bf16 v[160:175], a[116:119], a[52:55], v[160:175]
    buffer_load_dwordx4 v222, s[8:11], s24 offen offset:2048 lds
    ds_read_b64_tr_b16 a[200:201], v218 offset:45056
    v_exp_f32 v233, v233
    v_add_f32 v238, v238, v235
    v_cvt_pk_bf16_f32 v189, v234, v235
    v_fma_f32 v234, v142, s20, v236
    v_mfma_f32_32x32x16_bf16 v[160:175], a[120:123], a[56:59], v[160:175]
    ds_read_b64_tr_b16 a[202:203], v218 offset:45568
    v_fma_f32 v235, v143, s20, v236
    v_exp_f32 v234, v234
    v_add_f32 v238, v238, v232
    v_add_f32 v238, v238, v233
    v_mfma_f32_32x32x16_bf16 v[160:175], a[124:127], a[60:63], v[160:175]
    ds_read_b64_tr_b16 a[204:205], v219 offset:45056
    v_exp_f32 v235, v235
    v_cvt_pk_bf16_f32 v190, v232, v233
    v_add_f32 v238, v238, v234
    v_add_f32 v238, v238, v235
    v_mfma_f32_32x32x16_bf16 v[160:175], a[128:131], a[64:67], v[160:175]
    ds_read_b64_tr_b16 a[206:207], v219 offset:45568
    v_cvt_pk_bf16_f32 v191, v234, v235
    v_mfma_f32_32x32x16_bf16 v[160:175], a[132:135], a[68:71], v[160:175]
    buffer_load_dwordx4 v223, s[8:11], s24 offen offset:3072 lds
    v_fma_f32 v232, v144, s20, v237
    v_fma_f32 v233, v145, s20, v237
    v_exp_f32 v232, v232
    v_mfma_f32_32x32x16_bf16 v[160:175], a[136:139], a[72:75], v[160:175]
    v_exp_f32 v233, v233
    v_fma_f32 v234, v146, s20, v237
    v_fma_f32 v235, v147, s20, v237
    v_add_f32 v239, v239, v232
    v_mfma_f32_32x32x16_bf16 v[160:175], a[140:143], a[76:79], v[160:175]
    s_waitcnt vmcnt(12) lgkmcnt(0)
    s_barrier
    v_mfma_f32_32x32x16_bf16 v[0:15], a[144:147], v[176:179], v[0:15]
    ds_read_b128 a[80:83], v208 offset:16384
    s_mov_b32 m0, s70
    s_add_u32 s24, s24, 0x20000
    buffer_load_dwordx4 v220, s[8:11], s26 offen offset:0 lds
    v_exp_f32 v234, v234
    v_exp_f32 v235, v235
    v_add_f32 v239, v239, v233
    v_mfma_f32_32x32x16_bf16 v[16:31], a[148:151], v[176:179], v[16:31]
    ds_read_b128 a[84:87], v209 offset:16384
    v_cvt_pk_bf16_f32 v192, v232, v233
    v_fma_f32 v232, v148, s20, v237
    v_fma_f32 v233, v149, s20, v237
    v_exp_f32 v232, v232
    v_mfma_f32_32x32x16_bf16 v[32:47], a[152:155], v[176:179], v[32:47]
    ds_read_b128 a[88:91], v210 offset:16384
    v_add_f32 v239, v239, v234
    v_exp_f32 v233, v233
    v_add_f32 v239, v239, v235
    v_cvt_pk_bf16_f32 v193, v234, v235
    v_mfma_f32_32x32x16_bf16 v[48:63], a[156:159], v[176:179], v[48:63]
    ds_read_b128 a[92:95], v211 offset:16384
    v_fma_f32 v234, v150, s20, v237
    v_fma_f32 v235, v151, s20, v237
    v_exp_f32 v234, v234
    v_mfma_f32_32x32x16_bf16 v[0:15], a[160:163], v[180:183], v[0:15]
    ds_read_b128 a[96:99], v212 offset:16384
    buffer_load_dwordx4 v221, s[8:11], s26 offen offset:1024 lds
    v_add_f32 v239, v239, v232
    v_exp_f32 v235, v235
    v_add_f32 v239, v239, v233
    v_cvt_pk_bf16_f32 v194, v232, v233
    v_mfma_f32_32x32x16_bf16 v[16:31], a[164:167], v[180:183], v[16:31]
    ds_read_b128 a[100:103], v213 offset:16384
    v_fma_f32 v232, v152, s20, v237
    v_fma_f32 v233, v153, s20, v237
    v_exp_f32 v232, v232
    v_add_f32 v239, v239, v234
    v_mfma_f32_32x32x16_bf16 v[32:47], a[168:171], v[180:183], v[32:47]
    ds_read_b128 a[104:107], v214 offset:16384
    v_exp_f32 v233, v233
    v_add_f32 v239, v239, v235
    v_cvt_pk_bf16_f32 v195, v234, v235
    v_fma_f32 v234, v154, s20, v237
    v_mfma_f32_32x32x16_bf16 v[48:63], a[172:175], v[180:183], v[48:63]
    ds_read_b128 a[108:111], v215 offset:16384
    v_fma_f32 v235, v155, s20, v237
    v_exp_f32 v234, v234
    v_add_f32 v239, v239, v232
    v_add_f32 v239, v239, v233
    v_mfma_f32_32x32x16_bf16 v[0:15], a[176:179], v[184:187], v[0:15]
    ds_read_b128 a[112:115], v208 offset:24576
    v_exp_f32 v235, v235
    v_cvt_pk_bf16_f32 v196, v232, v233
    v_fma_f32 v232, v156, s20, v237
    v_fma_f32 v233, v157, s20, v237
    v_mfma_f32_32x32x16_bf16 v[16:31], a[180:183], v[184:187], v[16:31]
    ds_read_b128 a[116:119], v209 offset:24576
    buffer_load_dwordx4 v222, s[8:11], s26 offen offset:2048 lds
    v_exp_f32 v232, v232
    v_add_f32 v239, v239, v234
    v_add_f32 v239, v239, v235
    v_mfma_f32_32x32x16_bf16 v[32:47], a[184:187], v[184:187], v[32:47]
    ds_read_b128 a[120:123], v210 offset:24576
    v_exp_f32 v233, v233
    v_cvt_pk_bf16_f32 v197, v234, v235
    v_fma_f32 v234, v158, s20, v237
    v_fma_f32 v235, v159, s20, v237
    v_mfma_f32_32x32x16_bf16 v[48:63], a[188:191], v[184:187], v[48:63]
    ds_read_b128 a[124:127], v211 offset:24576
    v_exp_f32 v234, v234
    v_add_f32 v239, v239, v232
    v_exp_f32 v235, v235
    v_mfma_f32_32x32x16_bf16 v[0:15], a[192:195], v[188:191], v[0:15]
    ds_read_b128 a[128:131], v212 offset:24576
    buffer_load_dwordx4 v223, s[8:11], s26 offen offset:3072 lds
    v_add_f32 v239, v239, v233
    v_cvt_pk_bf16_f32 v198, v232, v233
    v_fma_f32 v232, v160, s20, v237
    v_fma_f32 v233, v161, s20, v237
    v_add_f32 v239, v239, v234
    v_mfma_f32_32x32x16_bf16 v[16:31], a[196:199], v[188:191], v[16:31]
    ds_read_b128 a[132:135], v213 offset:24576
    v_exp_f32 v232, v232
    v_exp_f32 v233, v233
    v_add_f32 v239, v239, v235
    v_mfma_f32_32x32x16_bf16 v[32:47], a[200:203], v[188:191], v[32:47]
    ds_read_b128 a[136:139], v214 offset:24576
    v_cvt_pk_bf16_f32 v199, v234, v235
    v_mfma_f32_32x32x16_bf16 v[48:63], a[204:207], v[188:191], v[48:63]
    ds_read_b128 a[140:143], v215 offset:24576
    s_sub_u32 s23, s23, 1
    s_cmp_eq_u32 s23, 1
    s_cbranch_scc1 L_lasts_1
    s_branch L_mid1_1
L_lasts_0:
    s_waitcnt lgkmcnt(8)
    v_mfma_f32_32x32x16_bf16 v[112:127], a[80:83], a[16:19], 0
    v_fma_f32 v234, v162, s20, v237
    v_fma_f32 v235, v163, s20, v237
    v_exp_f32 v234, v234
    v_add_f32 v239, v239, v232
    v_mfma_f32_32x32x16_bf16 v[112:127], a[84:87], a[20:23], v[112:127]
    v_exp_f32 v235, v235
    v_add_f32 v239, v239, v233
    v_cvt_pk_bf16_f32 v200, v232, v233
    v_fma_f32 v232, v164, s20, v237
    v_mfma_f32_32x32x16_bf16 v[112:127], a[88:91], a[24:27], v[112:127]
    v_fma_f32 v233, v165, s20, v237
    v_exp_f32 v232, v232
    v_add_f32 v239, v239, v234
    v_add_f32 v239, v239, v235
    v_mfma_f32_32x32x16_bf16 v[112:127], a[92:95], a[28:31], v[112:127]
    v_exp_f32 v233, v233
    v_cvt_pk_bf16_f32 v201, v234, v235
    v_fma_f32 v234, v166, s20, v237
    v_mfma_f32_32x32x16_bf16 v[112:127], a[96:99], a[32:35], v[112:127]
    v_fma_f32 v235, v167, s20, v237
    v_exp_f32 v234, v234
    v_add_f32 v239, v239, v232
    v_add_f32 v239, v239, v233
    v_mfma_f32_32x32x16_bf16 v[112:127], a[100:103], a[36:39], v[112:127]
    v_exp_f32 v235, v235
    v_cvt_pk_bf16_f32 v202, v232, v233
    v_fma_f32 v232, v168, s20, v237
    v_fma_f32 v233, v169, s20, v237
    v_mfma_f32_32x32x16_bf16 v[112:127], a[104:107], a[40:43], v[112:127]
    v_exp_f32 v232, v232
    v_add_f32 v239, v239, v234
    v_exp_f32 v233, v233
    v_mfma_f32_32x32x16_bf16 v[112:127], a[108:111], a[44:47], v[112:127]
    v_add_f32 v239, v239, v235
    v_cvt_pk_bf16_f32 v203, v234, v235
    v_fma_f32 v234, v170, s20, v237
    v_fma_f32 v235, v171, s20, v237
    v_add_f32 v239, v239, v232
    s_waitcnt lgkmcnt(0)
    v_mfma_f32_32x32x16_bf16 v[128:143], a[112:115], a[16:19], 0
    v_exp_f32 v234, v234
    v_exp_f32 v235, v235
    v_add_f32 v239, v239, v233
    v_mfma_f32_32x32x16_bf16 v[128:143], a[116:119], a[20:23], v[128:143]
    v_cvt_pk_bf16_f32 v204, v232, v233
    v_fma_f32 v232, v172, s20, v237
    v_fma_f32 v233, v173, s20, v237
    v_add_f32 v239, v239, v234
    v_mfma_f32_32x32x16_bf16 v[128:143], a[120:123], a[24:27], v[128:143]
    v_exp_f32 v232, v232
    v_exp_f32 v233, v233
    v_add_f32 v239, v239, v235
    v_mfma_f32_32x32x16_bf16 v[128:143], a[124:127], a[28:31], v[128:143]
    v_cvt_pk_bf16_f32 v205, v234, v235
    v_fma_f32 v234, v174, s20, v237
    v_fma_f32 v235, v175, s20, v237
    v_exp_f32 v234, v234
    v_mfma_f32_32x32x16_bf16 v[128:143], a[128:131], a[32:35], v[128:143]
    v_add_f32 v239, v239, v232
    v_exp_f32 v235, v235
    v_add_f32 v239, v239, v233
    v_cvt_pk_bf16_f32 v206, v232, v233
    v_add_u32 v246, s34, v243
    v_cmp_gt_i32 vcc, 0, v246
    v_cmp_gt_i32 s[40:41], 1, v246
    v_cmp_gt_i32 s[42:43], 2, v246
    v_cndmask_b32 v112, v112, v242, vcc
    v_cmp_gt_i32 vcc, 3, v246
    v_cndmask_b32 v113, v113, v242, s[40:41]
    v_cmp_gt_i32 s[40:41], 8, v246
    v_cndmask_b32 v114, v114, v242, s[42:43]
    v_cmp_gt_i32 s[42:43], 9, v246
    v_cndmask_b32 v115, v115, v242, vcc
    v_cmp_gt_i32 vcc, 10, v246
    v_cndmask_b32 v116, v116, v242, s[40:41]
    v_cmp_gt_i32 s[40:41], 11, v246
    v_cndmask_b32 v117, v117, v242, s[42:43]
    v_cmp_gt_i32 s[42:43], 16, v246
    v_cndmask_b32 v118, v118, v242, vcc
    v_cmp_gt_i32 vcc, 17, v246
    v_cndmask_b32 v119, v119, v242, s[40:41]
    v_cmp_gt_i32 s[40:41], 18, v246
    v_cndmask_b32 v120, v120, v242, s[42:43]
    v_cmp_gt_i32 s[42:43], 19, v246
    v_cndmask_b32 v121, v121, v242, vcc
    v_cmp_gt_i32 vcc, 24, v246
    v_cndmask_b32 v122, v122, v242, s[40:41]
    v_cmp_gt_i32 s[40:41], 25, v246
    v_cndmask_b32 v123, v123, v242, s[42:43]
    v_cmp_gt_i32 s[42:43], 26, v246
    v_cndmask_b32 v124, v124, v242, vcc
    v_cmp_gt_i32 vcc, 27, v246
    v_cndmask_b32 v125, v125, v242, s[40:41]
    s_nop 0
    v_cndmask_b32 v126, v126, v242, s[42:43]
    s_nop 0
    v_cndmask_b32 v127, v127, v242, vcc
    v_mfma_f32_32x32x16_bf16 v[128:143], a[132:135], a[36:39], v[128:143]
    v_add_f32 v239, v239, v234
    v_add_f32 v239, v239, v235
    v_cvt_pk_bf16_f32 v207, v234, v235
    v_fma_f32 v232, v112, s20, v236
    v_fma_f32 v233, v113, s20, v236
    v_mfma_f32_32x32x16_bf16 v[128:143], a[136:139], a[40:43], v[128:143]
    v_exp_f32 v232, v232
    v_exp_f32 v233, v233
    v_fma_f32 v234, v114, s20, v236
    v_mfma_f32_32x32x16_bf16 v[128:143], a[140:143], a[44:47], v[128:143]
    s_waitcnt vmcnt(8) lgkmcnt(0)
    s_barrier
    v_mfma_f32_32x32x16_bf16 v[64:79], a[144:147], v[192:195], v[64:79]
    v_fma_f32 v235, v115, s20, v236
    v_exp_f32 v234, v234
    v_add_f32 v238, v238, v232
    v_add_f32 v238, v238, v233
    v_mfma_f32_32x32x16_bf16 v[80:95], a[148:151], v[192:195], v[80:95]
    ds_read_b64_tr_b16 a[144:145], v216 offset:32768
    ds_read_b64_tr_b16 a[146:147], v216 offset:33280
    v_exp_f32 v235, v235
    v_cvt_pk_bf16_f32 v176, v232, v233
    v_fma_f32 v232, v116, s20, v236
    v_fma_f32 v233, v117, s20, v236
    v_mfma_f32_32x32x16_bf16 v[96:111], a[152:155], v[192:195], v[96:111]
    ds_read_b64_tr_b16 a[148:149], v217 offset:32768
    v_exp_f32 v232, v232
    v_add_f32 v238, v238, v234
    v_exp_f32 v233, v233
    v_mfma_f32_32x32x16_bf16 a[0:15], a[156:159], v[192:195], a[0:15]
    ds_read_b64_tr_b16 a[150:151], v217 offset:33280
    v_add_f32 v238, v238, v235
    v_cvt_pk_bf16_f32 v177, v234, v235
    v_fma_f32 v234, v118, s20, v236
    v_fma_f32 v235, v119, s20, v236
    v_add_f32 v238, v238, v232
    v_add_u32 v246, s34, v243
    v_cmp_gt_i32 vcc, 32, v246
    v_cmp_gt_i32 s[40:41], 33, v246
    v_cmp_gt_i32 s[42:43], 34, v246
    v_cndmask_b32 v128, v128, v242, vcc
    v_cmp_gt_i32 vcc, 35, v246
    v_cndmask_b32 v129, v129, v242, s[40:41]
    v_cmp_gt_i32 s[40:41], 40, v246
    v_cndmask_b32 v130, v130, v242, s[42:43]
    v_cmp_gt_i32 s[42:43], 41, v246
    v_cndmask_b32 v131, v131, v242, vcc
    v_cmp_gt_i32 vcc, 42, v246
    v_cndmask_b32 v132, v132, v242, s[40:41]
    v_cmp_gt_i32 s[40:41], 43, v246
    v_cndmask_b32 v133, v133, v242, s[42:43]
    v_cmp_gt_i32 s[42:43], 48, v246
    v_cndmask_b32 v134, v134, v242, vcc
    v_cmp_gt_i32 vcc, 49, v246
    v_cndmask_b32 v135, v135, v242, s[40:41]
    v_cmp_gt_i32 s[40:41], 50, v246
    v_cndmask_b32 v136, v136, v242, s[42:43]
    v_cmp_gt_i32 s[42:43], 51, v246
    v_cndmask_b32 v137, v137, v242, vcc
    v_cmp_gt_i32 vcc, 56, v246
    v_cndmask_b32 v138, v138, v242, s[40:41]
    v_cmp_gt_i32 s[40:41], 57, v246
    v_cndmask_b32 v139, v139, v242, s[42:43]
    v_cmp_gt_i32 s[42:43], 58, v246
    v_cndmask_b32 v140, v140, v242, vcc
    v_cmp_gt_i32 vcc, 59, v246
    v_cndmask_b32 v141, v141, v242, s[40:41]
    s_nop 0
    v_cndmask_b32 v142, v142, v242, s[42:43]
    s_nop 0
    v_cndmask_b32 v143, v143, v242, vcc
    v_mfma_f32_32x32x16_bf16 v[64:79], a[160:163], v[196:199], v[64:79]
    ds_read_b64_tr_b16 a[152:153], v218 offset:32768
    v_exp_f32 v234, v234
    v_exp_f32 v235, v235
    v_add_f32 v238, v238, v233
    v_mfma_f32_32x32x16_bf16 v[80:95], a[164:167], v[196:199], v[80:95]
    ds_read_b64_tr_b16 a[154:155], v218 offset:33280
    v_cvt_pk_bf16_f32 v178, v232, v233
    v_fma_f32 v232, v120, s20, v236
    v_fma_f32 v233, v121, s20, v236
    v_add_f32 v238, v238, v234
    v_mfma_f32_32x32x16_bf16 v[96:111], a[168:171], v[196:199], v[96:111]
    ds_read_b64_tr_b16 a[156:157], v219 offset:32768
    v_exp_f32 v232, v232
    v_exp_f32 v233, v233
    v_add_f32 v238, v238, v235
    v_mfma_f32_32x32x16_bf16 a[0:15], a[172:175], v[196:199], a[0:15]
    ds_read_b64_tr_b16 a[158:159], v219 offset:33280
    v_cvt_pk_bf16_f32 v179, v234, v235
    v_fma_f32 v234, v122, s20, v236
    v_fma_f32 v235, v123, s20, v236
    v_exp_f32 v234, v234
    v_mfma_f32_32x32x16_bf16 v[64:79], a[176:179], v[200:203], v[64:79]
    ds_read_b64_tr_b16 a[160:161], v216 offset:36864
    ds_read_b64_tr_b16 a[162:163], v216 offset:37376
    v_add_f32 v238, v238, v232
    v_exp_f32 v235, v235
    v_add_f32 v238, v238, v233
    v_cvt_pk_bf16_f32 v180, v232, v233
    v_mfma_f32_32x32x16_bf16 v[80:95], a[180:183], v[200:203], v[80:95]
    ds_read_b64_tr_b16 a[164:165], v217 offset:36864
    v_fma_f32 v232, v124, s20, v236
    v_fma_f32 v233, v125, s20, v236
    v_exp_f32 v232, v232
    v_add_f32 v238, v238, v234
    v_mfma_f32_32x32x16_bf16 v[96:111], a[184:187], v[200:203], v[96:111]
    ds_read_b64_tr_b16 a[166:167], v217 offset:37376
    v_exp_f32 v233, v233
    v_add_f32 v238, v238, v235
    v_cvt_pk_bf16_f32 v181, v234, v235
    v_fma_f32 v234, v126, s20, v236
    v_mfma_f32_32x32x16_bf16 a[0:15], a[188:191], v[200:203], a[0:15]
    ds_read_b64_tr_b16 a[168:169], v218 offset:36864
    v_fma_f32 v235, v127, s20, v236
    v_exp_f32 v234, v234
    v_add_f32 v238, v238, v232
    v_mfma_f32_32x32x16_bf16 v[64:79], a[192:195], v[204:207], v[64:79]
    ds_read_b64_tr_b16 a[170:171], v218 offset:37376
    v_exp_f32 v235, v235
    v_add_f32 v238, v238, v233
    v_cvt_pk_bf16_f32 v182, v232, v233
    v_fma_f32 v232, v128, s20, v236
    v_mfma_f32_32x32x16_bf16 v[80:95], a[196:199], v[204:207], v[80:95]
    ds_read_b64_tr_b16 a[172:173], v219 offset:36864
    v_fma_f32 v233, v129, s20, v236
    v_exp_f32 v232, v232
    v_add_f32 v238, v238, v234
    v_add_f32 v238, v238, v235
    v_mfma_f32_32x32x16_bf16 v[96:111], a[200:203], v[204:207], v[96:111]
    ds_read_b64_tr_b16 a[174:175], v219 offset:37376
    v_exp_f32 v233, v233
    v_cvt_pk_bf16_f32 v183, v234, v235
    v_fma_f32 v234, v130, s20, v236
    v_fma_f32 v235, v131, s20, v236
    v_mfma_f32_32x32x16_bf16 a[0:15], a[204:207], v[204:207], a[0:15]
    ds_read_b64_tr_b16 a[176:177], v216 offset:40960
    ds_read_b64_tr_b16 a[178:179], v216 offset:41472
    v_exp_f32 v234, v234
    v_add_f32 v238, v238, v232
    v_exp_f32 v235, v235
    v_mfma_f32_32x32x16_bf16 v[144:159], a[80:83], a[48:51], 0
    ds_read_b64_tr_b16 a[180:181], v217 offset:40960
    v_add_f32 v238, v238, v233
    v_cvt_pk_bf16_f32 v184, v232, v233
    v_fma_f32 v232, v132, s20, v236
    v_fma_f32 v233, v133, s20, v236
    v_add_f32 v238, v238, v234
    v_mfma_f32_32x32x16_bf16 v[144:159], a[84:87], a[52:55], v[144:159]
    ds_read_b64_tr_b16 a[182:183], v217 offset:41472
    v_exp_f32 v232, v232
    v_exp_f32 v233, v233
    v_mfma_f32_32x32x16_bf16 v[144:159], a[88:91], a[56:59], v[144:159]
    ds_read_b64_tr_b16 a[184:185], v218 offset:40960
    v_add_f32 v238, v238, v235
    v_cvt_pk_bf16_f32 v185, v234, v235
    v_fma_f32 v234, v134, s20, v236
    v_fma_f32 v235, v135, s20, v236
    v_add_f32 v238, v238, v232
    v_mfma_f32_32x32x16_bf16 v[144:159], a[92:95], a[60:63], v[144:159]
    ds_read_b64_tr_b16 a[186:187], v218 offset:41472
    v_exp_f32 v234, v234
    v_exp_f32 v235, v235
    v_add_f32 v238, v238, v233
    v_mfma_f32_32x32x16_bf16 v[144:159], a[96:99], a[64:67], v[144:159]
    ds_read_b64_tr_b16 a[188:189], v219 offset:40960
    v_cvt_pk_bf16_f32 v186, v232, v233
    v_fma_f32 v232, v136, s20, v236
    v_fma_f32 v233, v137, s20, v236
    v_exp_f32 v232, v232
    v_mfma_f32_32x32x16_bf16 v[144:159], a[100:103], a[68:71], v[144:159]
    ds_read_b64_tr_b16 a[190:191], v219 offset:41472
    v_add_f32 v238, v238, v234
    v_exp_f32 v233, v233
    v_add_f32 v238, v238, v235
    v_cvt_pk_bf16_f32 v187, v234, v235
    v_mfma_f32_32x32x16_bf16 v[144:159], a[104:107], a[72:75], v[144:159]
    ds_read_b64_tr_b16 a[192:193], v216 offset:45056
    ds_read_b64_tr_b16 a[194:195], v216 offset:45568
    v_fma_f32 v234, v138, s20, v236
    v_fma_f32 v235, v139, s20, v236
    v_exp_f32 v234, v234
    v_add_f32 v238, v238, v232
    v_mfma_f32_32x32x16_bf16 v[144:159], a[108:111], a[76:79], v[144:159]
    ds_read_b64_tr_b16 a[196:197], v217 offset:45056
    v_exp_f32 v235, v235
    v_add_f32 v238, v238, v233
    v_cvt_pk_bf16_f32 v188, v232, v233
    v_mfma_f32_32x32x16_bf16 v[160:175], a[112:115], a[48:51], 0
    ds_read_b64_tr_b16 a[198:199], v217 offset:45568
    v_fma_f32 v232, v140, s20, v236
    v_fma_f32 v233, v141, s20, v236
    v_exp_f32 v232, v232
    v_add_f32 v238, v238, v234
    v_mfma_f32_32x32x16_bf16 v[160:175], a[116:119], a[52:55], v[160:175]
    ds_read_b64_tr_b16 a[200:201], v218 offset:45056
    v_exp_f32 v233, v233
    v_add_f32 v238, v238, v235
    v_cvt_pk_bf16_f32 v189, v234, v235
    v_fma_f32 v234, v142, s20, v236
    v_mfma_f32_32x32x16_bf16 v[160:175], a[120:123], a[56:59], v[160:175]
    ds_read_b64_tr_b16 a[202:203], v218 offset:45568
    v_fma_f32 v235, v143, s20, v236
    v_exp_f32 v234, v234
    v_add_f32 v238, v238, v232
    v_add_f32 v238, v238, v233
    v_mfma_f32_32x32x16_bf16 v[160:175], a[124:127], a[60:63], v[160:175]
    ds_read_b64_tr_b16 a[204:205], v219 offset:45056
    v_exp_f32 v235, v235
    v_cvt_pk_bf16_f32 v190, v232, v233
    v_add_f32 v238, v238, v234
    v_add_f32 v238, v238, v235
    v_mfma_f32_32x32x16_bf16 v[160:175], a[128:131], a[64:67], v[160:175]
    ds_read_b64_tr_b16 a[206:207], v219 offset:45568
    v_cvt_pk_bf16_f32 v191, v234, v235
    v_add_u32 v246, s35, v243
    v_cmp_gt_i32 vcc, 0, v246
    v_cmp_gt_i32 s[40:41], 1, v246
    v_cmp_gt_i32 s[42:43], 2, v246
    v_cndmask_b32 v144, v144, v242, vcc
    v_cmp_gt_i32 vcc, 3, v246
    v_cndmask_b32 v145, v145, v242, s[40:41]
    v_cmp_gt_i32 s[40:41], 8, v246
    v_cndmask_b32 v146, v146, v242, s[42:43]
    v_cmp_gt_i32 s[42:43], 9, v246
    v_cndmask_b32 v147, v147, v242, vcc
    v_cmp_gt_i32 vcc, 10, v246
    v_cndmask_b32 v148, v148, v242, s[40:41]
    v_cmp_gt_i32 s[40:41], 11, v246
    v_cndmask_b32 v149, v149, v242, s[42:43]
    v_cmp_gt_i32 s[42:43], 16, v246
    v_cndmask_b32 v150, v150, v242, vcc
    v_cmp_gt_i32 vcc, 17, v246
    v_cndmask_b32 v151, v151, v242, s[40:41]
    v_cmp_gt_i32 s[40:41], 18, v246
    v_cndmask_b32 v152, v152, v242, s[42:43]
    v_cmp_gt_i32 s[42:43], 19, v246
    v_cndmask_b32 v153, v153, v242, vcc
    v_cmp_gt_i32 vcc, 24, v246
    v_cndmask_b32 v154, v154, v242, s[40:41]
    v_cmp_gt_i32 s[40:41], 25, v246
    v_cndmask_b32 v155, v155, v242, s[42:43]
    v_cmp_gt_i32 s[42:43], 26, v246
    v_cndmask_b32 v156, v156, v242, vcc
    v_cmp_gt_i32 vcc, 27, v246
    v_cndmask_b32 v157, v157, v242, s[40:41]
    s_nop 0
    v_cndmask_b32 v158, v158, v242, s[42:43]
    s_nop 0
    v_cndmask_b32 v159, v159, v242, vcc
    v_mfma_f32_32x32x16_bf16 v[160:175], a[132:135], a[68:71], v[160:175]
    v_fma_f32 v232, v144, s20, v237
    v_fma_f32 v233, v145, s20, v237
    v_exp_f32 v232, v232
    v_mfma_f32_32x32x16_bf16 v[160:175], a[136:139], a[72:75], v[160:175]
    v_exp_f32 v233, v233
    v_fma_f32 v234, v146, s20, v237
    v_fma_f32 v235, v147, s20, v237
    v_add_f32 v239, v239, v232
    v_mfma_f32_32x32x16_bf16 v[160:175], a[140:143], a[76:79], v[160:175]
    s_waitcnt lgkmcnt(0)
    v_mfma_f32_32x32x16_bf16 v[0:15], a[144:147], v[176:179], v[0:15]
    v_exp_f32 v234, v234
    v_exp_f32 v235, v235
    v_add_f32 v239, v239, v233
    v_mfma_f32_32x32x16_bf16 v[16:31], a[148:151], v[176:179], v[16:31]
    v_cvt_pk_bf16_f32 v192, v232, v233
    v_fma_f32 v232, v148, s20, v237
    v_fma_f32 v233, v149, s20, v237
    v_exp_f32 v232, v232
    v_mfma_f32_32x32x16_bf16 v[32:47], a[152:155], v[176:179], v[32:47]
    v_add_f32 v239, v239, v234
    v_exp_f32 v233, v233
    v_add_f32 v239, v239, v235
    v_cvt_pk_bf16_f32 v193, v234, v235
    v_mfma_f32_32x32x16_bf16 v[48:63], a[156:159], v[176:179], v[48:63]
    v_fma_f32 v234, v150, s20, v237
    v_fma_f32 v235, v151, s20, v237
    v_exp_f32 v234, v234
    v_add_u32 v246, s35, v243
    v_cmp_gt_i32 vcc, 32, v246
    v_cmp_gt_i32 s[40:41], 33, v246
    v_cmp_gt_i32 s[42:43], 34, v246
    v_cndmask_b32 v160, v160, v242, vcc
    v_cmp_gt_i32 vcc, 35, v246
    v_cndmask_b32 v161, v161, v242, s[40:41]
    v_cmp_gt_i32 s[40:41], 40, v246
    v_cndmask_b32 v162, v162, v242, s[42:43]
    v_cmp_gt_i32 s[42:43], 41, v246
    v_cndmask_b32 v163, v163, v242, vcc
    v_cmp_gt_i32 vcc, 42, v246
    v_cndmask_b32 v164, v164, v242, s[40:41]
    v_cmp_gt_i32 s[40:41], 43, v246
    v_cndmask_b32 v165, v165, v242, s[42:43]
    v_cmp_gt_i32 s[42:43], 48, v246
    v_cndmask_b32 v166, v166, v242, vcc
    v_cmp_gt_i32 vcc, 49, v246
    v_cndmask_b32 v167, v167, v242, s[40:41]
    v_cmp_gt_i32 s[40:41], 50, v246
    v_cndmask_b32 v168, v168, v242, s[42:43]
    v_cmp_gt_i32 s[42:43], 51, v246
    v_cndmask_b32 v169, v169, v242, vcc
    v_cmp_gt_i32 vcc, 56, v246
    v_cndmask_b32 v170, v170, v242, s[40:41]
    v_cmp_gt_i32 s[40:41], 57, v246
    v_cndmask_b32 v171, v171, v242, s[42:43]
    v_cmp_gt_i32 s[42:43], 58, v246
    v_cndmask_b32 v172, v172, v242, vcc
    v_cmp_gt_i32 vcc, 59, v246
    v_cndmask_b32 v173, v173, v242, s[40:41]
    s_nop 0
    v_cndmask_b32 v174, v174, v242, s[42:43]
    s_nop 0
    v_cndmask_b32 v175, v175, v242, vcc
    v_mfma_f32_32x32x16_bf16 v[0:15], a[160:163], v[180:183], v[0:15]
    v_add_f32 v239, v239, v232
    v_exp_f32 v235, v235
    v_add_f32 v239, v239, v233
    v_cvt_pk_bf16_f32 v194, v232, v233
    v_mfma_f32_32x32x16_bf16 v[16:31], a[164:167], v[180:183], v[16:31]
    v_fma_f32 v232, v152, s20, v237
    v_fma_f32 v233, v153, s20, v237
    v_exp_f32 v232, v232
    v_add_f32 v239, v239, v234
    v_mfma_f32_32x32x16_bf16 v[32:47], a[168:171], v[180:183], v[32:47]
    v_exp_f32 v233, v233
    v_add_f32 v239, v239, v235
    v_cvt_pk_bf16_f32 v195, v234, v235
    v_fma_f32 v234, v154, s20, v237
    v_mfma_f32_32x32x16_bf16 v[48:63], a[172:175], v[180:183], v[48:63]
    v_fma_f32 v235, v155, s20, v237
    v_exp_f32 v234, v234
    v_add_f32 v239, v239, v232
    v_add_f32 v239, v239, v233
    v_mfma_f32_32x32x16_bf16 v[0:15], a[176:179], v[184:187], v[0:15]
    v_exp_f32 v235, v235
    v_cvt_pk_bf16_f32 v196, v232, v233
    v_fma_f32 v232, v156, s20, v237
    v_fma_f32 v233, v157, s20, v237
    v_mfma_f32_32x32x16_bf16 v[16:31], a[180:183], v[184:187], v[16:31]
    v_exp_f32 v232, v232
    v_add_f32 v239, v239, v234
    v_add_f32 v239, v239, v235
    v_mfma_f32_32x32x16_bf16 v[32:47], a[184:187], v[184:187], v[32:47]
    v_exp_f32 v233, v233
    v_cvt_pk_bf16_f32 v197, v234, v235
    v_fma_f32 v234, v158, s20, v237
    v_fma_f32 v235, v159, s20, v237
    v_mfma_f32_32x32x16_bf16 v[48:63], a[188:191], v[184:187], v[48:63]
    v_exp_f32 v234, v234
    v_add_f32 v239, v239, v232
    v_exp_f32 v235, v235
    v_mfma_f32_32x32x16_bf16 v[0:15], a[192:195], v[188:191], v[0:15]
    v_add_f32 v239, v239, v233
    v_cvt_pk_bf16_f32 v198, v232, v233
    v_fma_f32 v232, v160, s20, v237
    v_fma_f32 v233, v161, s20, v237
    v_add_f32 v239, v239, v234
    v_mfma_f32_32x32x16_bf16 v[16:31], a[196:199], v[188:191], v[16:31]
    v_exp_f32 v232, v232
    v_exp_f32 v233, v233
    v_add_f32 v239, v239, v235
    v_mfma_f32_32x32x16_bf16 v[32:47], a[200:203], v[188:191], v[32:47]
    v_cvt_pk_bf16_f32 v199, v234, v235
    v_mfma_f32_32x32x16_bf16 v[48:63], a[204:207], v[188:191], v[48:63]
    s_branch L_drain_1
L_lasts_1:
    s_waitcnt lgkmcnt(8)
    v_mfma_f32_32x32x16_bf16 v[112:127], a[80:83], a[16:19], 0
    v_fma_f32 v234, v162, s20, v237
    v_fma_f32 v235, v163, s20, v237
    v_exp_f32 v234, v234
    v_add_f32 v239, v239, v232
    v_mfma_f32_32x32x16_bf16 v[112:127], a[84:87], a[20:23], v[112:127]
    v_exp_f32 v235, v235
    v_add_f32 v239, v239, v233
    v_cvt_pk_bf16_f32 v200, v232, v233
    v_fma_f32 v232, v164, s20, v237
    v_mfma_f32_32x32x16_bf16 v[112:127], a[88:91], a[24:27], v[112:127]
    v_fma_f32 v233, v165, s20, v237
    v_exp_f32 v232, v232
    v_add_f32 v239, v239, v234
    v_add_f32 v239, v239, v235
    v_mfma_f32_32x32x16_bf16 v[112:127], a[92:95], a[28:31], v[112:127]
    v_exp_f32 v233, v233
    v_cvt_pk_bf16_f32 v201, v234, v235
    v_fma_f32 v234, v166, s20, v237
    v_mfma_f32_32x32x16_bf16 v[112:127], a[96:99], a[32:35], v[112:127]
    v_fma_f32 v235, v167, s20, v237
    v_exp_f32 v234, v234
    v_add_f32 v239, v239, v232
    v_add_f32 v239, v239, v233
    v_mfma_f32_32x32x16_bf16 v[112:127], a[100:103], a[36:39], v[112:127]
    v_exp_f32 v235, v235
    v_cvt_pk_bf16_f32 v202, v232, v233
    v_fma_f32 v232, v168, s20, v237
    v_fma_f32 v233, v169, s20, v237
    v_mfma_f32_32x32x16_bf16 v[112:127], a[104:107], a[40:43], v[112:127]
    v_exp_f32 v232, v232
    v_add_f32 v239, v239, v234
    v_exp_f32 v233, v233
    v_mfma_f32_32x32x16_bf16 v[112:127], a[108:111], a[44:47], v[112:127]
    v_add_f32 v239, v239, v235
    v_cvt_pk_bf16_f32 v203, v234, v235
    v_fma_f32 v234, v170, s20, v237
    v_fma_f32 v235, v171, s20, v237
    v_add_f32 v239, v239, v232
    s_waitcnt lgkmcnt(0)
    v_mfma_f32_32x32x16_bf16 v[128:143], a[112:115], a[16:19], 0
    v_exp_f32 v234, v234
    v_exp_f32 v235, v235
    v_add_f32 v239, v239, v233
    v_mfma_f32_32x32x16_bf16 v[128:143], a[116:119], a[20:23], v[128:143]
    v_cvt_pk_bf16_f32 v204, v232, v233
    v_fma_f32 v232, v172, s20, v237
    v_fma_f32 v233, v173, s20, v237
    v_add_f32 v239, v239, v234
    v_mfma_f32_32x32x16_bf16 v[128:143], a[120:123], a[24:27], v[128:143]
    v_exp_f32 v232, v232
    v_exp_f32 v233, v233
    v_add_f32 v239, v239, v235
    v_mfma_f32_32x32x16_bf16 v[128:143], a[124:127], a[28:31], v[128:143]
    v_cvt_pk_bf16_f32 v205, v234, v235
    v_fma_f32 v234, v174, s20, v237
    v_fma_f32 v235, v175, s20, v237
    v_exp_f32 v234, v234
    v_mfma_f32_32x32x16_bf16 v[128:143], a[128:131], a[32:35], v[128:143]
    v_add_f32 v239, v239, v232
    v_exp_f32 v235, v235
    v_add_f32 v239, v239, v233
    v_cvt_pk_bf16_f32 v206, v232, v233
    v_add_u32 v246, s34, v243
    v_cmp_gt_i32 vcc, 0, v246
    v_cmp_gt_i32 s[40:41], 1, v246
    v_cmp_gt_i32 s[42:43], 2, v246
    v_cndmask_b32 v112, v112, v242, vcc
    v_cmp_gt_i32 vcc, 3, v246
    v_cndmask_b32 v113, v113, v242, s[40:41]
    v_cmp_gt_i32 s[40:41], 8, v246
    v_cndmask_b32 v114, v114, v242, s[42:43]
    v_cmp_gt_i32 s[42:43], 9, v246
    v_cndmask_b32 v115, v115, v242, vcc
    v_cmp_gt_i32 vcc, 10, v246
    v_cndmask_b32 v116, v116, v242, s[40:41]
    v_cmp_gt_i32 s[40:41], 11, v246
    v_cndmask_b32 v117, v117, v242, s[42:43]
    v_cmp_gt_i32 s[42:43], 16, v246
    v_cndmask_b32 v118, v118, v242, vcc
    v_cmp_gt_i32 vcc, 17, v246
    v_cndmask_b32 v119, v119, v242, s[40:41]
    v_cmp_gt_i32 s[40:41], 18, v246
    v_cndmask_b32 v120, v120, v242, s[42:43]
    v_cmp_gt_i32 s[42:43], 19, v246
    v_cndmask_b32 v121, v121, v242, vcc
    v_cmp_gt_i32 vcc, 24, v246
    v_cndmask_b32 v122, v122, v242, s[40:41]
    v_cmp_gt_i32 s[40:41], 25, v246
    v_cndmask_b32 v123, v123, v242, s[42:43]
    v_cmp_gt_i32 s[42:43], 26, v246
    v_cndmask_b32 v124, v124, v242, vcc
    v_cmp_gt_i32 vcc, 27, v246
    v_cndmask_b32 v125, v125, v242, s[40:41]
    s_nop 0
    v_cndmask_b32 v126, v126, v242, s[42:43]
    s_nop 0
    v_cndmask_b32 v127, v127, v242, vcc
    v_mfma_f32_32x32x16_bf16 v[128:143], a[132:135], a[36:39], v[128:143]
    v_add_f32 v239, v239, v234
    v_add_f32 v239, v239, v235
    v_cvt_pk_bf16_f32 v207, v234, v235
    v_fma_f32 v232, v112, s20, v236
    v_fma_f32 v233, v113, s20, v236
    v_mfma_f32_32x32x16_bf16 v[128:143], a[136:139], a[40:43], v[128:143]
    v_exp_f32 v232, v232
    v_exp_f32 v233, v233
    v_fma_f32 v234, v114, s20, v236
    v_mfma_f32_32x32x16_bf16 v[128:143], a[140:143], a[44:47], v[128:143]
    s_waitcnt vmcnt(1) lgkmcnt(0)
    s_barrier
    v_mfma_f32_32x32x16_bf16 v[64:79], a[144:147], v[192:195], v[64:79]
    v_fma_f32 v235, v115, s20, v236
    v_exp_f32 v234, v234
    v_add_f32 v238, v238, v232
    v_add_f32 v238, v238, v233
    v_mfma_f32_32x32x16_bf16 v[80:95], a[148:151], v[192:195], v[80:95]
    ds_read_b64_tr_b16 a[144:145], v216 offset:49152
    ds_read_b64_tr_b16 a[146:147], v216 offset:49664
    v_exp_f32 v235, v235
    v_cvt_pk_bf16_f32 v176, v232, v233
    v_fma_f32 v232, v116, s20, v236
    v_fma_f32 v233, v117, s20, v236
    v_mfma_f32_32x32x16_bf16 v[96:111], a[152:155], v[192:195], v[96:111]
    ds_read_b64_tr_b16 a[148:149], v217 offset:49152
    v_exp_f32 v232, v232
    v_add_f32 v238, v238, v234
    v_exp_f32 v233, v233
    v_mfma_f32_32x32x16_bf16 a[0:15], a[156:159], v[192:195], a[0:15]
    ds_read_b64_tr_b16 a[150:151], v217 offset:49664
    v_add_f32 v238, v238, v235
    v_cvt_pk_bf16_f32 v177, v234, v235
    v_fma_f32 v234, v118, s20, v236
    v_fma_f32 v235, v119, s20, v236
    v_add_f32 v238, v238, v232
    v_add_u32 v246, s34, v243
    v_cmp_gt_i32 vcc, 32, v246
    v_cmp_gt_i32 s[40:41], 33, v246
    v_cmp_gt_i32 s[42:43], 34, v246
    v_cndmask_b32 v128, v128, v242, vcc
    v_cmp_gt_i32 vcc, 35, v246
    v_cndmask_b32 v129, v129, v242, s[40:41]
    v_cmp_gt_i32 s[40:41], 40, v246
    v_cndmask_b32 v130, v130, v242, s[42:43]
    v_cmp_gt_i32 s[42:43], 41, v246
    v_cndmask_b32 v131, v131, v242, vcc
    v_cmp_gt_i32 vcc, 42, v246
    v_cndmask_b32 v132, v132, v242, s[40:41]
    v_cmp_gt_i32 s[40:41], 43, v246
    v_cndmask_b32 v133, v133, v242, s[42:43]
    v_cmp_gt_i32 s[42:43], 48, v246
    v_cndmask_b32 v134, v134, v242, vcc
    v_cmp_gt_i32 vcc, 49, v246
    v_cndmask_b32 v135, v135, v242, s[40:41]
    v_cmp_gt_i32 s[40:41], 50, v246
    v_cndmask_b32 v136, v136, v242, s[42:43]
    v_cmp_gt_i32 s[42:43], 51, v246
    v_cndmask_b32 v137, v137, v242, vcc
    v_cmp_gt_i32 vcc, 56, v246
    v_cndmask_b32 v138, v138, v242, s[40:41]
    v_cmp_gt_i32 s[40:41], 57, v246
    v_cndmask_b32 v139, v139, v242, s[42:43]
    v_cmp_gt_i32 s[42:43], 58, v246
    v_cndmask_b32 v140, v140, v242, vcc
    v_cmp_gt_i32 vcc, 59, v246
    v_cndmask_b32 v141, v141, v242, s[40:41]
    s_nop 0
    v_cndmask_b32 v142, v142, v242, s[42:43]
    s_nop 0
    v_cndmask_b32 v143, v143, v242, vcc
    v_mfma_f32_32x32x16_bf16 v[64:79], a[160:163], v[196:199], v[64:79]
    ds_read_b64_tr_b16 a[152:153], v218 offset:49152
    v_exp_f32 v234, v234
    v_exp_f32 v235, v235
    v_add_f32 v238, v238, v233
    v_mfma_f32_32x32x16_bf16 v[80:95], a[164:167], v[196:199], v[80:95]
    ds_read_b64_tr_b16 a[154:155], v218 offset:49664
    v_cvt_pk_bf16_f32 v178, v232, v233
    v_fma_f32 v232, v120, s20, v236
    v_fma_f32 v233, v121, s20, v236
    v_add_f32 v238, v238, v234
    v_mfma_f32_32x32x16_bf16 v[96:111], a[168:171], v[196:199], v[96:111]
    ds_read_b64_tr_b16 a[156:157], v219 offset:49152
    v_exp_f32 v232, v232
    v_exp_f32 v233, v233
    v_add_f32 v238, v238, v235
    v_mfma_f32_32x32x16_bf16 a[0:15], a[172:175], v[196:199], a[0:15]
    ds_read_b64_tr_b16 a[158:159], v219 offset:49664
    v_cvt_pk_bf16_f32 v179, v234, v235
    v_fma_f32 v234, v122, s20, v236
    v_fma_f32 v235, v123, s20, v236
    v_exp_f32 v234, v234
    v_mfma_f32_32x32x16_bf16 v[64:79], a[176:179], v[200:203], v[64:79]
    ds_read_b64_tr_b16 a[160:161], v216 offset:53248
    ds_read_b64_tr_b16 a[162:163], v216 offset:53760
    v_add_f32 v238, v238, v232
    v_exp_f32 v235, v235
    v_add_f32 v238, v238, v233
    v_cvt_pk_bf16_f32 v180, v232, v233
    v_mfma_f32_32x32x16_bf16 v[80:95], a[180:183], v[200:203], v[80:95]
    ds_read_b64_tr_b16 a[164:165], v217 offset:53248
    v_fma_f32 v232, v124, s20, v236
    v_fma_f32 v233, v125, s20, v236
    v_exp_f32 v232, v232
    v_add_f32 v238, v238, v234
    v_mfma_f32_32x32x16_bf16 v[96:111], a[184:187], v[200:203], v[96:111]
    ds_read_b64_tr_b16 a[166:167], v217 offset:53760
    v_exp_f32 v233, v233
    v_add_f32 v238, v238, v235
    v_cvt_pk_bf16_f32 v181, v234, v235
    v_fma_f32 v234, v126, s20, v236
    v_mfma_f32_32x32x16_bf16 a[0:15], a[188:191], v[200:203], a[0:15]
    ds_read_b64_tr_b16 a[168:169], v218 offset:53248
    v_fma_f32 v235, v127, s20, v236
    v_exp_f32 v234, v234
    v_add_f32 v238, v238, v232
    v_mfma_f32_32x32x16_bf16 v[64:79], a[192:195], v[204:207], v[64:79]
    ds_read_b64_tr_b16 a[170:171], v218 offset:53760
    v_exp_f32 v235, v235
    v_add_f32 v238, v238, v233
    v_cvt_pk_bf16_f32 v182, v232, v233
    v_fma_f32 v232, v128, s20, v236
    v_mfma_f32_32x32x16_bf16 v[80:95], a[196:199], v[204:207], v[80:95]
    ds_read_b64_tr_b16 a[172:173], v219 offset:53248
    v_fma_f32 v233, v129, s20, v236
    v_exp_f32 v232, v232
    v_add_f32 v238, v238, v234
    v_add_f32 v238, v238, v235
    v_mfma_f32_32x32x16_bf16 v[96:111], a[200:203], v[204:207], v[96:111]
    ds_read_b64_tr_b16 a[174:175], v219 offset:53760
    v_exp_f32 v233, v233
    v_cvt_pk_bf16_f32 v183, v234, v235
    v_fma_f32 v234, v130, s20, v236
    v_fma_f32 v235, v131, s20, v236
    v_mfma_f32_32x32x16_bf16 a[0:15], a[204:207], v[204:207], a[0:15]
    ds_read_b64_tr_b16 a[176:177], v216 offset:57344
    ds_read_b64_tr_b16 a[178:179], v216 offset:57856
    v_exp_f32 v234, v234
    v_add_f32 v238, v238, v232
    v_exp_f32 v235, v235
    v_mfma_f32_32x32x16_bf16 v[144:159], a[80:83], a[48:51], 0
    ds_read_b64_tr_b16 a[180:181], v217 offset:57344
    v_add_f32 v238, v238, v233
    v_cvt_pk_bf16_f32 v184, v232, v233
    v_fma_f32 v232, v132, s20, v236
    v_fma_f32 v233, v133, s20, v236
    v_add_f32 v238, v238, v234
    v_mfma_f32_32x32x16_bf16 v[144:159], a[84:87], a[52:55], v[144:159]
    ds_read_b64_tr_b16 a[182:183], v217 offset:57856
    v_exp_f32 v232, v232
    v_exp_f32 v233, v233
    v_mfma_f32_32x32x16_bf16 v[144:159], a[88:91], a[56:59], v[144:159]
    ds_read_b64_tr_b16 a[184:185], v218 offset:57344
    v_add_f32 v238, v238, v235
    v_cvt_pk_bf16_f32 v185, v234, v235
    v_fma_f32 v234, v134, s20, v236
    v_fma_f32 v235, v135, s20, v236
    v_add_f32 v238, v238, v232
    v_mfma_f32_32x32x16_bf16 v[144:159], a[92:95], a[60:63], v[144:159]
    ds_read_b64_tr_b16 a[186:187], v218 offset:57856
    v_exp_f32 v234, v234
    v_exp_f32 v235, v235
    v_add_f32 v238, v238, v233
    v_mfma_f32_32x32x16_bf16 v[144:159], a[96:99], a[64:67], v[144:159]
    ds_read_b64_tr_b16 a[188:189], v219 offset:57344
    v_cvt_pk_bf16_f32 v186, v232, v233
    v_fma_f32 v232, v136, s20, v236
    v_fma_f32 v233, v137, s20, v236
    v_exp_f32 v232, v232
    v_mfma_f32_32x32x16_bf16 v[144:159], a[100:103], a[68:71], v[144:159]
    ds_read_b64_tr_b16 a[190:191], v219 offset:57856
    v_add_f32 v238, v238, v234
    v_exp_f32 v233, v233
    v_add_f32 v238, v238, v235
    v_cvt_pk_bf16_f32 v187, v234, v235
    v_mfma_f32_32x32x16_bf16 v[144:159], a[104:107], a[72:75], v[144:159]
    ds_read_b64_tr_b16 a[192:193], v216 offset:61440
    ds_read_b64_tr_b16 a[194:195], v216 offset:61952
    v_fma_f32 v234, v138, s20, v236
    v_fma_f32 v235, v139, s20, v236
    v_exp_f32 v234, v234
    v_add_f32 v238, v238, v232
    v_mfma_f32_32x32x16_bf16 v[144:159], a[108:111], a[76:79], v[144:159]
    ds_read_b64_tr_b16 a[196:197], v217 offset:61440
    v_exp_f32 v235, v235
    v_add_f32 v238, v238, v233
    v_cvt_pk_bf16_f32 v188, v232, v233
    v_mfma_f32_32x32x16_bf16 v[160:175], a[112:115], a[48:51], 0
    ds_read_b64_tr_b16 a[198:199], v217 offset:61952
    v_fma_f32 v232, v140, s20, v236
    v_fma_f32 v233, v141, s20, v236
    v_exp_f32 v232, v232
    v_add_f32 v238, v238, v234
    v_mfma_f32_32x32x16_bf16 v[160:175], a[116:119], a[52:55], v[160:175]
    ds_read_b64_tr_b16 a[200:201], v218 offset:61440
    v_exp_f32 v233, v233
    v_add_f32 v238, v238, v235
    v_cvt_pk_bf16_f32 v189, v234, v235
    v_fma_f32 v234, v142, s20, v236
    v_mfma_f32_32x32x16_bf16 v[160:175], a[120:123], a[56:59], v[160:175]
    ds_read_b64_tr_b16 a[202:203], v218 offset:61952
    v_fma_f32 v235, v143, s20, v236
    v_exp_f32 v234, v234
    v_add_f32 v238, v238, v232
    v_add_f32 v238, v238, v233
    v_mfma_f32_32x32x16_bf16 v[160:175], a[124:127], a[60:63], v[160:175]
    ds_read_b64_tr_b16 a[204:205], v219 offset:61440
    v_exp_f32 v235, v235
    v_cvt_pk_bf16_f32 v190, v232, v233
    v_add_f32 v238, v238, v234
    v_add_f32 v238, v238, v235
    v_mfma_f32_32x32x16_bf16 v[160:175], a[128:131], a[64:67], v[160:175]
    ds_read_b64_tr_b16 a[206:207], v219 offset:61952
    v_cvt_pk_bf16_f32 v191, v234, v235
    v_add_u32 v246, s35, v243
    v_cmp_gt_i32 vcc, 0, v246
    v_cmp_gt_i32 s[40:41], 1, v246
    v_cmp_gt_i32 s[42:43], 2, v246
    v_cndmask_b32 v144, v144, v242, vcc
    v_cmp_gt_i32 vcc, 3, v246
    v_cndmask_b32 v145, v145, v242, s[40:41]
    v_cmp_gt_i32 s[40:41], 8, v246
    v_cndmask_b32 v146, v146, v242, s[42:43]
    v_cmp_gt_i32 s[42:43], 9, v246
    v_cndmask_b32 v147, v147, v242, vcc
    v_cmp_gt_i32 vcc, 10, v246
    v_cndmask_b32 v148, v148, v242, s[40:41]
    v_cmp_gt_i32 s[40:41], 11, v246
    v_cndmask_b32 v149, v149, v242, s[42:43]
    v_cmp_gt_i32 s[42:43], 16, v246
    v_cndmask_b32 v150, v150, v242, vcc
    v_cmp_gt_i32 vcc, 17, v246
    v_cndmask_b32 v151, v151, v242, s[40:41]
    v_cmp_gt_i32 s[40:41], 18, v246
    v_cndmask_b32 v152, v152, v242, s[42:43]
    v_cmp_gt_i32 s[42:43], 19, v246
    v_cndmask_b32 v153, v153, v242, vcc
    v_cmp_gt_i32 vcc, 24, v246
    v_cndmask_b32 v154, v154, v242, s[40:41]
    v_cmp_gt_i32 s[40:41], 25, v246
    v_cndmask_b32 v155, v155, v242, s[42:43]
    v_cmp_gt_i32 s[42:43], 26, v246
    v_cndmask_b32 v156, v156, v242, vcc
    v_cmp_gt_i32 vcc, 27, v246
    v_cndmask_b32 v157, v157, v242, s[40:41]
    s_nop 0
    v_cndmask_b32 v158, v158, v242, s[42:43]
    s_nop 0
    v_cndmask_b32 v159, v159, v242, vcc
    v_mfma_f32_32x32x16_bf16 v[160:175], a[132:135], a[68:71], v[160:175]
    v_fma_f32 v232, v144, s20, v237
    v_fma_f32 v233, v145, s20, v237
    v_exp_f32 v232, v232
    v_mfma_f32_32x32x16_bf16 v[160:175], a[136:139], a[72:75], v[160:175]
    v_exp_f32 v233, v233
    v_fma_f32 v234, v146, s20, v237
    v_fma_f32 v235, v147, s20, v237
    v_add_f32 v239, v239, v232
    v_mfma_f32_32x32x16_bf16 v[160:175], a[140:143], a[76:79], v[160:175]
    s_waitcnt lgkmcnt(0)
    v_mfma_f32_32x32x16_bf16 v[0:15], a[144:147], v[176:179], v[0:15]
    v_exp_f32 v234, v234
    v_exp_f32 v235, v235
    v_add_f32 v239, v239, v233
    v_mfma_f32_32x32x16_bf16 v[16:31], a[148:151], v[176:179], v[16:31]
    v_cvt_pk_bf16_f32 v192, v232, v233
    v_fma_f32 v232, v148, s20, v237
    v_fma_f32 v233, v149, s20, v237
    v_exp_f32 v232, v232
    v_mfma_f32_32x32x16_bf16 v[32:47], a[152:155], v[176:179], v[32:47]
    v_add_f32 v239, v239, v234
    v_exp_f32 v233, v233
    v_add_f32 v239, v239, v235
    v_cvt_pk_bf16_f32 v193, v234, v235
    v_mfma_f32_32x32x16_bf16 v[48:63], a[156:159], v[176:179], v[48:63]
    v_fma_f32 v234, v150, s20, v237
    v_fma_f32 v235, v151, s20, v237
    v_exp_f32 v234, v234
    v_add_u32 v246, s35, v243
    v_cmp_gt_i32 vcc, 32, v246
    v_cmp_gt_i32 s[40:41], 33, v246
    v_cmp_gt_i32 s[42:43], 34, v246
    v_cndmask_b32 v160, v160, v242, vcc
    v_cmp_gt_i32 vcc, 35, v246
    v_cndmask_b32 v161, v161, v242, s[40:41]
    v_cmp_gt_i32 s[40:41], 40, v246
    v_cndmask_b32 v162, v162, v242, s[42:43]
    v_cmp_gt_i32 s[42:43], 41, v246
    v_cndmask_b32 v163, v163, v242, vcc
    v_cmp_gt_i32 vcc, 42, v246
    v_cndmask_b32 v164, v164, v242, s[40:41]
    v_cmp_gt_i32 s[40:41], 43, v246
    v_cndmask_b32 v165, v165, v242, s[42:43]
    v_cmp_gt_i32 s[42:43], 48, v246
    v_cndmask_b32 v166, v166, v242, vcc
    v_cmp_gt_i32 vcc, 49, v246
    v_cndmask_b32 v167, v167, v242, s[40:41]
    v_cmp_gt_i32 s[40:41], 50, v246
    v_cndmask_b32 v168, v168, v242, s[42:43]
    v_cmp_gt_i32 s[42:43], 51, v246
    v_cndmask_b32 v169, v169, v242, vcc
    v_cmp_gt_i32 vcc, 56, v246
    v_cndmask_b32 v170, v170, v242, s[40:41]
    v_cmp_gt_i32 s[40:41], 57, v246
    v_cndmask_b32 v171, v171, v242, s[42:43]
    v_cmp_gt_i32 s[42:43], 58, v246
    v_cndmask_b32 v172, v172, v242, vcc
    v_cmp_gt_i32 vcc, 59, v246
    v_cndmask_b32 v173, v173, v242, s[40:41]
    s_nop 0
    v_cndmask_b32 v174, v174, v242, s[42:43]
    s_nop 0
    v_cndmask_b32 v175, v175, v242, vcc
    v_mfma_f32_32x32x16_bf16 v[0:15], a[160:163], v[180:183], v[0:15]
    v_add_f32 v239, v239, v232
    v_exp_f32 v235, v235
    v_add_f32 v239, v239, v233
    v_cvt_pk_bf16_f32 v194, v232, v233
    v_mfma_f32_32x32x16_bf16 v[16:31], a[164:167], v[180:183], v[16:31]
    v_fma_f32 v232, v152, s20, v237
    v_fma_f32 v233, v153, s20, v237
    v_exp_f32 v232, v232
    v_add_f32 v239, v239, v234
    v_mfma_f32_32x32x16_bf16 v[32:47], a[168:171], v[180:183], v[32:47]
    v_exp_f32 v233, v233
    v_add_f32 v239, v239, v235
    v_cvt_pk_bf16_f32 v195, v234, v235
    v_fma_f32 v234, v154, s20, v237
    v_mfma_f32_32x32x16_bf16 v[48:63], a[172:175], v[180:183], v[48:63]
    v_fma_f32 v235, v155, s20, v237
    v_exp_f32 v234, v234
    v_add_f32 v239, v239, v232
    v_add_f32 v239, v239, v233
    v_mfma_f32_32x32x16_bf16 v[0:15], a[176:179], v[184:187], v[0:15]
    v_exp_f32 v235, v235
    v_cvt_pk_bf16_f32 v196, v232, v233
    v_fma_f32 v232, v156, s20, v237
    v_fma_f32 v233, v157, s20, v237
    v_mfma_f32_32x32x16_bf16 v[16:31], a[180:183], v[184:187], v[16:31]
    v_exp_f32 v232, v232
    v_add_f32 v239, v239, v234
    v_add_f32 v239, v239, v235
    v_mfma_f32_32x32x16_bf16 v[32:47], a[184:187], v[184:187], v[32:47]
    v_exp_f32 v233, v233
    v_cvt_pk_bf16_f32 v197, v234, v235
    v_fma_f32 v234, v158, s20, v237
    v_fma_f32 v235, v159, s20, v237
    v_mfma_f32_32x32x16_bf16 v[48:63], a[188:191], v[184:187], v[48:63]
    v_exp_f32 v234, v234
    v_add_f32 v239, v239, v232
    v_exp_f32 v235, v235
    v_mfma_f32_32x32x16_bf16 v[0:15], a[192:195], v[188:191], v[0:15]
    v_add_f32 v239, v239, v233
    v_cvt_pk_bf16_f32 v198, v232, v233
    v_fma_f32 v232, v160, s20, v237
    v_fma_f32 v233, v161, s20, v237
    v_add_f32 v239, v239, v234
    v_mfma_f32_32x32x16_bf16 v[16:31], a[196:199], v[188:191], v[16:31]
    v_exp_f32 v232, v232
    v_exp_f32 v233, v233
    v_add_f32 v239, v239, v235
    v_mfma_f32_32x32x16_bf16 v[32:47], a[200:203], v[188:191], v[32:47]
    v_cvt_pk_bf16_f32 v199, v234, v235
    v_mfma_f32_32x32x16_bf16 v[48:63], a[204:207], v[188:191], v[48:63]
L_drain_1:
    s_waitcnt vmcnt(0) lgkmcnt(0)
    s_barrier
    s_cmp_eq_u32 s29, 0
    s_cbranch_scc1 L_dr1_nn_16
    s_cmp_eq_u32 s29, 2
    s_cbranch_scc1 L_dr1_ns_15
    s_mov_b32 s10, s52
    s_mov_b32 s14, s52
    s_mov_b32 s6, s50
    s_add_u32 s24, s49, s74
    s_mov_b32 s25, s24
    v_lshrrev_b32 v132, 12, v220
    v_mul_u32_u24 v132, 0x3000, v132
    v_add_u32 v128, v220, v132
    v_add_u32 v129, v221, v132
    v_add_u32 v129, 0xc00, v129
    v_add_u32 v130, v222, v132
    v_add_u32 v130, 0x1800, v130
    v_add_u32 v131, v223, v132
    s_mov_b32 m0, s62
    v_add_u32 v131, 0x2400, v131
    buffer_load_dwordx4 v220, s[8:11], s24 offen offset:0 lds
    v_fma_f32 v234, v162, s20, v237
    v_fma_f32 v235, v163, s20, v237
    v_exp_f32 v234, v234
    buffer_load_dwordx4 v221, s[8:11], s24 offen offset:1024 lds
    v_add_f32 v239, v239, v232
    v_exp_f32 v235, v235
    v_add_f32 v239, v239, v233
    buffer_load_dwordx4 v222, s[8:11], s24 offen offset:2048 lds
    v_cvt_pk_bf16_f32 v200, v232, v233
    v_fma_f32 v232, v164, s20, v237
    v_fma_f32 v233, v165, s20, v237
    buffer_load_dwordx4 v223, s[8:11], s24 offen offset:3072 lds
    s_add_u32 s24, s24, 0x10000
    v_exp_f32 v232, v232
    v_add_f32 v239, v239, v234
    v_exp_f32 v233, v233
    s_add_u32 s32, s48, s76
    s_mov_b32 s33, s60
    s_mov_b32 m0, s33
    s_add_u32 s33, s33, 0x1000
    buffer_load_dwordx4 v128, s[4:7], s32 offen offset:0 nt lds
    v_add_f32 v239, v239, v235
    v_cvt_pk_bf16_f32 v201, v234, v235
    v_fma_f32 v234, v166, s20, v237
    buffer_load_dwordx4 v129, s[4:7], s32 offen offset:1024 nt lds
    v_fma_f32 v235, v167, s20, v237
    v_exp_f32 v234, v234
    v_add_f32 v239, v239, v232
    buffer_load_dwordx4 v130, s[4:7], s32 offen offset:2048 nt lds
    v_exp_f32 v235, v235
    v_add_f32 v239, v239, v233
    v_cvt_pk_bf16_f32 v202, v232, v233
    buffer_load_dwordx4 v131, s[4:7], s32 offen offset:3072 nt lds
    v_fma_f32 v232, v168, s20, v237
    v_fma_f32 v233, v169, s20, v237
    v_exp_f32 v232, v232
    s_mov_b32 m0, s33
    s_add_u32 s32, s32, 0x10000
    buffer_load_dwordx4 v128, s[4:7], s32 offen offset:0 nt lds
    v_add_f32 v239, v239, v234
    v_exp_f32 v233, v233
    v_add_f32 v239, v239, v235
    buffer_load_dwordx4 v129, s[4:7], s32 offen offset:1024 nt lds
    v_cvt_pk_bf16_f32 v203, v234, v235
    v_fma_f32 v234, v170, s20, v237
    v_fma_f32 v235, v171, s20, v237
    buffer_load_dwordx4 v130, s[4:7], s32 offen offset:2048 nt lds
    v_exp_f32 v234, v234
    v_add_f32 v239, v239, v232
    v_exp_f32 v235, v235
    buffer_load_dwordx4 v131, s[4:7], s32 offen offset:3072 nt lds
    v_add_f32 v239, v239, v233
    v_cvt_pk_bf16_f32 v204, v232, v233
    v_fma_f32 v232, v172, s20, v237
    s_add_u32 s32, s32, 0x10000
    s_sub_u32 s33, s59, 0x4000
    s_mov_b32 m0, s33
    s_add_u32 s33, s33, 0x1000
    buffer_load_dwordx4 v128, s[4:7], s32 offen offset:0 nt lds
    v_fma_f32 v233, v173, s20, v237
    v_exp_f32 v232, v232
    v_add_f32 v239, v239, v234
    buffer_load_dwordx4 v129, s[4:7], s32 offen offset:1024 nt lds
    v_exp_f32 v233, v233
    v_add_f32 v239, v239, v235
    v_cvt_pk_bf16_f32 v205, v234, v235
    buffer_load_dwordx4 v130, s[4:7], s32 offen offset:2048 nt lds
    v_fma_f32 v234, v174, s20, v237
    v_fma_f32 v235, v175, s20, v237
    v_exp_f32 v234, v234
    buffer_load_dwordx4 v131, s[4:7], s32 offen offset:3072 nt lds
    v_add_f32 v239, v239, v232
    v_exp_f32 v235, v235
    v_add_f32 v239, v239, v233
    s_mov_b32 m0, s33
    s_add_u32 s32, s32, 0x10000
    buffer_load_dwordx4 v128, s[4:7], s32 offen offset:0 nt lds
    v_cvt_pk_bf16_f32 v206, v232, v233
    v_add_f32 v239, v239, v234
    v_add_f32 v239, v239, v235
    buffer_load_dwordx4 v129, s[4:7], s32 offen offset:1024 nt lds
    v_cvt_pk_bf16_f32 v207, v234, v235
    buffer_load_dwordx4 v130, s[4:7], s32 offen offset:2048 nt lds
    buffer_load_dwordx4 v131, s[4:7], s32 offen offset:3072 nt lds
    s_branch L_dr1_ne_17
L_dr1_ns_15:
    s_mov_b32 s10, s52
    s_mov_b32 s14, s52
    s_mov_b32 s6, s50
    s_add_u32 s24, s49, s75
    s_mov_b32 s25, s24
    v_lshrrev_b32 v132, 12, v220
    v_mul_u32_u24 v132, 0x3000, v132
    v_add_u32 v128, v220, v132
    v_add_u32 v129, v221, v132
    v_add_u32 v129, 0xc00, v129
    v_add_u32 v130, v222, v132
    v_add_u32 v130, 0x1800, v130
    v_add_u32 v131, v223, v132
    v_add_u32 v131, 0x2400, v131
    s_mov_b32 m0, s66
    s_add_u32 s26, s24, 0x4000
    buffer_load_dwordx4 v220, s[8:11], s24 offen offset:0 lds
    v_fma_f32 v234, v162, s20, v237
    v_fma_f32 v235, v163, s20, v237
    v_exp_f32 v234, v234
    buffer_load_dwordx4 v221, s[8:11], s24 offen offset:1024 lds
    v_add_f32 v239, v239, v232
    v_exp_f32 v235, v235
    v_add_f32 v239, v239, v233
    buffer_load_dwordx4 v222, s[8:11], s24 offen offset:2048 lds
    v_cvt_pk_bf16_f32 v200, v232, v233
    v_fma_f32 v232, v164, s20, v237
    v_fma_f32 v233, v165, s20, v237
    buffer_load_dwordx4 v223, s[8:11], s24 offen offset:3072 lds
    v_exp_f32 v232, v232
    v_add_f32 v239, v239, v234
    v_exp_f32 v233, v233
    s_mov_b32 m0, s70
    s_add_u32 s24, s24, 0x20000
    buffer_load_dwordx4 v220, s[8:11], s26 offen offset:0 lds
    v_add_f32 v239, v239, v235
    v_cvt_pk_bf16_f32 v201, v234, v235
    v_fma_f32 v234, v166, s20, v237
    buffer_load_dwordx4 v221, s[8:11], s26 offen offset:1024 lds
    v_fma_f32 v235, v167, s20, v237
    v_exp_f32 v234, v234
    v_add_f32 v239, v239, v232
    buffer_load_dwordx4 v222, s[8:11], s26 offen offset:2048 lds
    v_exp_f32 v235, v235
    v_add_f32 v239, v239, v233
    v_cvt_pk_bf16_f32 v202, v232, v233
    buffer_load_dwordx4 v223, s[8:11], s26 offen offset:3072 lds
    v_fma_f32 v232, v168, s20, v237
    v_fma_f32 v233, v169, s20, v237
    v_exp_f32 v232, v232
    s_add_u32 s32, s48, s77
    s_mov_b32 s33, s61
    s_mov_b32 m0, s33
    s_add_u32 s33, s33, 0x1000
    buffer_load_dwordx4 v128, s[4:7], s32 offen offset:0 nt lds
    v_add_f32 v239, v239, v234
    v_exp_f32 v233, v233
    v_add_f32 v239, v239, v235
    buffer_load_dwordx4 v129, s[4:7], s32 offen offset:1024 nt lds
    v_cvt_pk_bf16_f32 v203, v234, v235
    v_fma_f32 v234, v170, s20, v237
    v_fma_f32 v235, v171, s20, v237
    buffer_load_dwordx4 v130, s[4:7], s32 offen offset:2048 nt lds
    v_exp_f32 v234, v234
    v_add_f32 v239, v239, v232
    v_exp_f32 v235, v235
    buffer_load_dwordx4 v131, s[4:7], s32 offen offset:3072 nt lds
    v_add_f32 v239, v239, v233
    v_cvt_pk_bf16_f32 v204, v232, v233
    v_fma_f32 v232, v172, s20, v237
    s_mov_b32 m0, s33
    s_add_u32 s32, s32, 0x10000
    buffer_load_dwordx4 v128, s[4:7], s32 offen offset:0 nt lds
    v_fma_f32 v233, v173, s20, v237
    v_exp_f32 v232, v232
    v_add_f32 v239, v239, v234
    buffer_load_dwordx4 v129, s[4:7], s32 offen offset:1024 nt lds
    v_exp_f32 v233, v233
    v_add_f32 v239, v239, v235
    v_cvt_pk_bf16_f32 v205, v234, v235
    buffer_load_dwordx4 v130, s[4:7], s32 offen offset:2048 nt lds
    v_fma_f32 v234, v174, s20, v237
    v_fma_f32 v235, v175, s20, v237
    v_exp_f32 v234, v234
    buffer_load_dwordx4 v131, s[4:7], s32 offen offset:3072 nt lds
    v_add_f32 v239, v239, v232
    v_exp_f32 v235, v235
    v_add_f32 v239, v239, v233
    v_cvt_pk_bf16_f32 v206, v232, v233
    v_add_f32 v239, v239, v234
    v_add_f32 v239, v239, v235
    v_cvt_pk_bf16_f32 v207, v234, v235
    s_branch L_dr1_ne_17
L_dr1_nn_16:
    v_fma_f32 v234, v162, s20, v237
    v_fma_f32 v235, v163, s20, v237
    v_exp_f32 v234, v234
    v_add_f32 v239, v239, v232
    v_exp_f32 v235, v235
    v_add_f32 v239, v239, v233
    v_cvt_pk_bf16_f32 v200, v232, v233
    v_fma_f32 v232, v164, s20, v237
    v_fma_f32 v233, v165, s20, v237
    v_exp_f32 v232, v232
    v_add_f32 v239, v239, v234
    v_exp_f32 v233, v233
    v_add_f32 v239, v239, v235
    v_cvt_pk_bf16_f32 v201, v234, v235
    v_fma_f32 v234, v166, s20, v237
    v_fma_f32 v235, v167, s20, v237
    v_exp_f32 v234, v234
    v_add_f32 v239, v239, v232
    v_exp_f32 v235, v235
    v_add_f32 v239, v239, v233
    v_cvt_pk_bf16_f32 v202, v232, v233
    v_fma_f32 v232, v168, s20, v237
    v_fma_f32 v233, v169, s20, v237
    v_exp_f32 v232, v232
    v_add_f32 v239, v239, v234
    v_exp_f32 v233, v233
    v_add_f32 v239, v239, v235
    v_cvt_pk_bf16_f32 v203, v234, v235
    v_fma_f32 v234, v170, s20, v237
    v_fma_f32 v235, v171, s20, v237
    v_exp_f32 v234, v234
    v_add_f32 v239, v239, v232
    v_exp_f32 v235, v235
    v_add_f32 v239, v239, v233
    v_cvt_pk_bf16_f32 v204, v232, v233
    v_fma_f32 v232, v172, s20, v237
    v_fma_f32 v233, v173, s20, v237
    v_exp_f32 v232, v232
    v_add_f32 v239, v239, v234
    v_exp_f32 v233, v233
    v_add_f32 v239, v239, v235
    v_cvt_pk_bf16_f32 v205, v234, v235
    v_fma_f32 v234, v174, s20, v237
    v_fma_f32 v235, v175, s20, v237
    v_exp_f32 v234, v234
    v_add_f32 v239, v239, v232
    v_exp_f32 v235, v235
    v_add_f32 v239, v239, v233
    v_cvt_pk_bf16_f32 v206, v232, v233
    v_add_f32 v239, v239, v234
    v_add_f32 v239, v239, v235
    v_cvt_pk_bf16_f32 v207, v234, v235
L_dr1_ne_17:
    s_nop 1
    s_mov_b32 s18, s89
    s_lshl_b32 s47, s44, 16
    s_lshl_b32 s58, s45, 15
    s_add_u32 s47, s47, s58
    s_add_u32 s47, s47, 0x4000
    s_xor_b32 s58, s47, 0x10000
    v_add_u32 v248, s47, v255
    v_add_u32 v249, s58, v255
    ds_write_b128 v249, v[236:239] offset:0
    v_max_f32 v244, v238, v239
    v_add_f32 v245, v238, v239
    v_cmp_nge_f32 vcc, s21, v245
    s_nop 3
    s_cmp_lg_u64 vcc, 0
    s_cselect_b32 s38, s31, 0
    s_or_b32 s30, s30, s38
    s_cmp_eq_u32 s44, 1
    s_cbranch_scc1 L_cmb_p1_18
    v_mfma_f32_32x32x16_bf16 v[64:79], a[144:147], v[192:195], v[64:79]
    v_mfma_f32_32x32x16_bf16 v[80:95], a[148:151], v[192:195], v[80:95]
    s_waitcnt lgkmcnt(0)
    s_barrier
    v_mfma_f32_32x32x16_bf16 v[96:111], a[152:155], v[192:195], v[96:111]
    ds_read_b128 v[232:235], v248 offset:0
    s_waitcnt lgkmcnt(0)
    v_min_f32 v244, v236, v232
    v_sub_f32 v245, v244, v236
    v_sub_f32 v246, v244, v232
    v_exp_f32 v245, v245
    v_exp_f32 v246, v246
    s_nop 0
    v_mfma_f32_32x32x16_bf16 a[0:15], a[156:159], v[192:195], a[0:15]
    v_mul_f32 v247, v238, v245
    v_fma_f32 v247, v234, v246, v247
    v_mov_b32 v244, v247
    s_nop 1
    v_permlane32_swap_b32 v247, v244
    v_add_f32 v247, v247, v244
    v_rcp_f32 v247, v247
    v_mfma_f32_32x32x16_bf16 v[64:79], a[160:163], v[196:199], v[64:79]
    s_nop 0
    v_mul_f32 v240, v245, v247
    v_min_f32 v244, v237, v233
    v_sub_f32 v245, v244, v237
    v_sub_f32 v246, v244, v233
    v_exp_f32 v245, v245
    v_exp_f32 v246, v246
    v_mfma_f32_32x32x16_bf16 v[80:95], a[164:167], v[196:199], v[80:95]
    s_nop 0
    v_mul_f32 v247, v239, v245
    v_fma_f32 v247, v235, v246, v247
    v_mov_b32 v244, v247
    s_nop 1
    v_permlane32_swap_b32 v247, v244
    v_add_f32 v247, v247, v244
    v_rcp_f32 v247, v247
    v_mfma_f32_32x32x16_bf16 v[96:111], a[168:171], v[196:199], v[96:111]
    s_nop 0
    v_mul_f32 v241, v245, v247
    v_mul_f32 v32, v32, v240
    v_mul_f32 v33, v33, v240
    v_mul_f32 v34, v34, v240
    v_mul_f32 v35, v35, v240
    v_mfma_f32_32x32x16_bf16 a[0:15], a[172:175], v[196:199], a[0:15]
    ds_write_b128 v248, v[32:35] offset:0
    v_mul_f32 v36, v36, v240
    v_mul_f32 v37, v37, v240
    v_mul_f32 v38, v38, v240
    v_mul_f32 v39, v39, v240
    v_mfma_f32_32x32x16_bf16 v[64:79], a[176:179], v[200:203], v[64:79]
    ds_write_b128 v248, v[36:39] offset:1024
    v_mul_f32 v40, v40, v240
    v_mul_f32 v41, v41, v240
    v_mul_f32 v42, v42, v240
    v_mfma_f32_32x32x16_bf16 v[80:95], a[180:183], v[200:203], v[80:95]
    v_mul_f32 v43, v43, v240
    ds_write_b128 v248, v[40:43] offset:2048
    v_mul_f32 v44, v44, v240
    v_mfma_f32_32x32x16_bf16 v[96:111], a[184:187], v[200:203], v[96:111]
    v_mul_f32 v45, v45, v240
    v_mul_f32 v46, v46, v240
    v_mul_f32 v47, v47, v240
    ds_write_b128 v248, v[44:47] offset:3072
    v_mfma_f32_32x32x16_bf16 a[0:15], a[188:191], v[200:203], a[0:15]
    v_mul_f32 v48, v48, v240
    v_mul_f32 v49, v49, v240
    v_mul_f32 v50, v50, v240
    v_mul_f32 v51, v51, v240
    ds_write_b128 v248, v[48:51] offset:4096
    v_mfma_f32_32x32x16_bf16 v[64:79], a[192:195], v[204:207], v[64:79]
    v_mul_f32 v52, v52, v240
    v_mul_f32 v53, v53, v240
    v_mul_f32 v54, v54, v240
    v_mul_f32 v55, v55, v240
    v_mfma_f32_32x32x16_bf16 v[80:95], a[196:199], v[204:207], v[80:95]
    ds_write_b128 v248, v[52:55] offset:5120
    v_mul_f32 v56, v56, v240
    v_mul_f32 v57, v57, v240
    v_mul_f32 v58, v58, v240
    v_mul_f32 v59, v59, v240
    v_mfma_f32_32x32x16_bf16 v[96:111], a[200:203], v[204:207], v[96:111]
    ds_write_b128 v248, v[56:59] offset:6144
    v_mul_f32 v60, v60, v240
    v_mul_f32 v61, v61, v240
    v_mfma_f32_32x32x16_bf16 a[0:15], a[204:207], v[204:207], a[0:15]
    v_mul_f32 v62, v62, v240
    v_mul_f32 v63, v63, v240
    ds_write_b128 v248, v[60:63] offset:7168
    s_nop 7
    s_nop 3
    v_mul_f32 v96, v96, v241
    v_mul_f32 v97, v97, v241
    v_mul_f32 v98, v98, v241
    v_mul_f32 v99, v99, v241
    ds_write_b128 v248, v[96:99] offset:8192
    v_mul_f32 v100, v100, v241
    v_mul_f32 v101, v101, v241
    v_mul_f32 v102, v102, v241
    v_mul_f32 v103, v103, v241
    ds_write_b128 v248, v[100:103] offset:9216
    v_mul_f32 v104, v104, v241
    v_mul_f32 v105, v105, v241
    v_mul_f32 v106, v106, v241
    v_mul_f32 v107, v107, v241
    ds_write_b128 v248, v[104:107] offset:10240
    v_mul_f32 v108, v108, v241
    v_mul_f32 v109, v109, v241
    v_mul_f32 v110, v110, v241
    v_mul_f32 v111, v111, v241
    ds_write_b128 v248, v[108:111] offset:11264
    v_accvgpr_read_b32 v176, a0
    v_mul_f32 v176, v176, v241
    v_accvgpr_read_b32 v177, a1
    v_mul_f32 v177, v177, v241
    v_accvgpr_read_b32 v178, a2
    v_mul_f32 v178, v178, v241
    v_accvgpr_read_b32 v179, a3
    v_mul_f32 v179, v179, v241
    ds_write_b128 v248, v[176:179] offset:12288
    v_accvgpr_read_b32 v180, a4
    v_mul_f32 v180, v180, v241
    v_accvgpr_read_b32 v181, a5
    v_mul_f32 v181, v181, v241
    v_accvgpr_read_b32 v182, a6
    v_mul_f32 v182, v182, v241
    v_accvgpr_read_b32 v183, a7
    v_mul_f32 v183, v183, v241
    ds_write_b128 v248, v[180:183] offset:13312
    v_accvgpr_read_b32 v184, a8
    v_mul_f32 v184, v184, v241
    v_accvgpr_read_b32 v185, a9
    v_mul_f32 v185, v185, v241
    v_accvgpr_read_b32 v186, a10
    v_mul_f32 v186, v186, v241
    v_accvgpr_read_b32 v187, a11
    v_mul_f32 v187, v187, v241
    ds_write_b128 v248, v[184:187] offset:14336
    v_accvgpr_read_b32 v188, a12
    v_mul_f32 v188, v188, v241
    v_accvgpr_read_b32 v189, a13
    v_mul_f32 v189, v189, v241
    v_accvgpr_read_b32 v190, a14
    v_mul_f32 v190, v190, v241
    v_accvgpr_read_b32 v191, a15
    v_mul_f32 v191, v191, v241
    ds_write_b128 v248, v[188:191] offset:15360
    s_waitcnt lgkmcnt(0)
    s_barrier
    ds_read_b128 v[112:115], v249 offset:0
    ds_read_b128 v[116:119], v249 offset:1024
    ds_read_b128 v[120:123], v249 offset:2048
    ds_read_b128 v[124:127], v249 offset:3072
    ds_read_b128 v[128:131], v249 offset:4096
    ds_read_b128 v[132:135], v249 offset:5120
    ds_read_b128 v[136:139], v249 offset:6144
    ds_read_b128 v[140:143], v249 offset:7168
    ds_read_b128 v[144:147], v249 offset:8192
    ds_read_b128 v[148:151], v249 offset:9216
    ds_read_b128 v[152:155], v249 offset:10240
    ds_read_b128 v[156:159], v249 offset:11264
    ds_read_b128 v[160:163], v249 offset:12288
    ds_read_b128 v[164:167], v249 offset:13312
    ds_read_b128 v[168:171], v249 offset:14336
    ds_read_b128 v[172:175], v249 offset:15360
    v_bfe_u32 v244, v255, 4, 5
    v_lshrrev_b32 v245, 9, v255
    v_lshlrev_b32 v246, 7, v244
    v_lshl_add_u32 v246, v245, 3, v246
    v_and_b32 v244, 7, v244
    v_lshl_add_u32 v246, v244, 4, v246
    v_add_u32 v192, s58, v246
    v_xor_b32 v193, 16, v192
    v_xor_b32 v194, 32, v192
    v_xor_b32 v195, 48, v192
    v_xor_b32 v196, 64, v192
    v_xor_b32 v197, 0x50, v192
    v_xor_b32 v198, 0x60, v192
    v_xor_b32 v199, 0x70, v192
    s_waitcnt lgkmcnt(0)
    v_fma_f32 v112, v0, v240, v112
    v_fma_f32 v113, v1, v240, v113
    v_fma_f32 v114, v2, v240, v114
    v_fma_f32 v115, v3, v240, v115
    v_cvt_pk_bf16_f32 v200, v112, v113
    v_cvt_pk_bf16_f32 v201, v114, v115
    ds_write_b64 v192, v[200:201] offset:0
    v_fma_f32 v116, v4, v240, v116
    v_fma_f32 v117, v5, v240, v117
    v_fma_f32 v118, v6, v240, v118
    v_fma_f32 v119, v7, v240, v119
    v_cvt_pk_bf16_f32 v202, v116, v117
    v_cvt_pk_bf16_f32 v203, v118, v119
    ds_write_b64 v193, v[202:203] offset:0
    v_fma_f32 v120, v8, v240, v120
    v_fma_f32 v121, v9, v240, v121
    v_fma_f32 v122, v10, v240, v122
    v_fma_f32 v123, v11, v240, v123
    v_cvt_pk_bf16_f32 v204, v120, v121
    v_cvt_pk_bf16_f32 v205, v122, v123
    ds_write_b64 v194, v[204:205] offset:0
    v_fma_f32 v124, v12, v240, v124
    v_fma_f32 v125, v13, v240, v125
    v_fma_f32 v126, v14, v240, v126
    v_fma_f32 v127, v15, v240, v127
    v_cvt_pk_bf16_f32 v206, v124, v125
    v_cvt_pk_bf16_f32 v207, v126, v127
    ds_write_b64 v195, v[206:207] offset:0
    v_fma_f32 v128, v16, v240, v128
    v_fma_f32 v129, v17, v240, v129
    v_fma_f32 v130, v18, v240, v130
    v_fma_f32 v131, v19, v240, v131
    v_cvt_pk_bf16_f32 v200, v128, v129
    v_cvt_pk_bf16_f32 v201, v130, v131
    ds_write_b64 v196, v[200:201] offset:0
    v_fma_f32 v132, v20, v240, v132
    v_fma_f32 v133, v21, v240, v133
    v_fma_f32 v134, v22, v240, v134
    v_fma_f32 v135, v23, v240, v135
    v_cvt_pk_bf16_f32 v202, v132, v133
    v_cvt_pk_bf16_f32 v203, v134, v135
    ds_write_b64 v197, v[202:203] offset:0
    v_fma_f32 v136, v24, v240, v136
    v_fma_f32 v137, v25, v240, v137
    v_fma_f32 v138, v26, v240, v138
    v_fma_f32 v139, v27, v240, v139
    v_cvt_pk_bf16_f32 v204, v136, v137
    v_cvt_pk_bf16_f32 v205, v138, v139
    ds_write_b64 v198, v[204:205] offset:0
    v_fma_f32 v140, v28, v240, v140
    v_fma_f32 v141, v29, v240, v141
    v_fma_f32 v142, v30, v240, v142
    v_fma_f32 v143, v31, v240, v143
    v_cvt_pk_bf16_f32 v206, v140, v141
    v_cvt_pk_bf16_f32 v207, v142, v143
    ds_write_b64 v199, v[206:207] offset:0
    v_fma_f32 v144, v64, v241, v144
    v_fma_f32 v145, v65, v241, v145
    v_fma_f32 v146, v66, v241, v146
    v_fma_f32 v147, v67, v241, v147
    v_cvt_pk_bf16_f32 v200, v144, v145
    v_cvt_pk_bf16_f32 v201, v146, v147
    ds_write_b64 v192, v[200:201] offset:4096
    v_fma_f32 v148, v68, v241, v148
    v_fma_f32 v149, v69, v241, v149
    v_fma_f32 v150, v70, v241, v150
    v_fma_f32 v151, v71, v241, v151
    v_cvt_pk_bf16_f32 v202, v148, v149
    v_cvt_pk_bf16_f32 v203, v150, v151
    ds_write_b64 v193, v[202:203] offset:4096
    v_fma_f32 v152, v72, v241, v152
    v_fma_f32 v153, v73, v241, v153
    v_fma_f32 v154, v74, v241, v154
    v_fma_f32 v155, v75, v241, v155
    v_cvt_pk_bf16_f32 v204, v152, v153
    v_cvt_pk_bf16_f32 v205, v154, v155
    ds_write_b64 v194, v[204:205] offset:4096
    v_fma_f32 v156, v76, v241, v156
    v_fma_f32 v157, v77, v241, v157
    v_fma_f32 v158, v78, v241, v158
    v_fma_f32 v159, v79, v241, v159
    v_cvt_pk_bf16_f32 v206, v156, v157
    v_cvt_pk_bf16_f32 v207, v158, v159
    ds_write_b64 v195, v[206:207] offset:4096
    v_fma_f32 v160, v80, v241, v160
    v_fma_f32 v161, v81, v241, v161
    v_fma_f32 v162, v82, v241, v162
    v_fma_f32 v163, v83, v241, v163
    v_cvt_pk_bf16_f32 v200, v160, v161
    v_cvt_pk_bf16_f32 v201, v162, v163
    ds_write_b64 v196, v[200:201] offset:4096
    v_fma_f32 v164, v84, v241, v164
    v_fma_f32 v165, v85, v241, v165
    v_fma_f32 v166, v86, v241, v166
    v_fma_f32 v167, v87, v241, v167
    v_cvt_pk_bf16_f32 v202, v164, v165
    v_cvt_pk_bf16_f32 v203, v166, v167
    ds_write_b64 v197, v[202:203] offset:4096
    v_fma_f32 v168, v88, v241, v168
    v_fma_f32 v169, v89, v241, v169
    v_fma_f32 v170, v90, v241, v170
    v_fma_f32 v171, v91, v241, v171
    v_cvt_pk_bf16_f32 v204, v168, v169
    v_cvt_pk_bf16_f32 v205, v170, v171
    ds_write_b64 v198, v[204:205] offset:4096
    v_fma_f32 v172, v92, v241, v172
    v_fma_f32 v173, v93, v241, v173
    v_fma_f32 v174, v94, v241, v174
    v_fma_f32 v175, v95, v241, v175
    v_cvt_pk_bf16_f32 v206, v172, v173
    v_cvt_pk_bf16_f32 v207, v174, v175
    ds_write_b64 v199, v[206:207] offset:4096
    ds_read_b128 a[208:211], v249 offset:0
    ds_read_b128 a[212:215], v249 offset:1024
    ds_read_b128 a[216:219], v249 offset:2048
    ds_read_b128 a[220:223], v249 offset:3072
    ds_read_b128 a[224:227], v249 offset:4096
    ds_read_b128 a[228:231], v249 offset:5120
    ds_read_b128 a[232:235], v249 offset:6144
    ds_read_b128 a[236:239], v249 offset:7168
    v_add_u32 v244, s36, v251
    s_waitcnt lgkmcnt(7)
    buffer_store_dwordx4 a[208:211], v244, s[16:19], 0 offen offset:0
    v_add_u32 v244, 0x8000, v244
    s_waitcnt lgkmcnt(6)
    buffer_store_dwordx4 a[212:215], v244, s[16:19], 0 offen offset:0
    v_add_u32 v244, 0x8000, v244
    s_waitcnt lgkmcnt(5)
    buffer_store_dwordx4 a[216:219], v244, s[16:19], 0 offen offset:0
    v_add_u32 v244, 0x8000, v244
    s_waitcnt lgkmcnt(4)
    buffer_store_dwordx4 a[220:223], v244, s[16:19], 0 offen offset:0
    v_add_u32 v244, s36, v251
    s_waitcnt lgkmcnt(3)
    buffer_store_dwordx4 a[224:227], v244, s[16:19], 0 offen offset:256
    v_add_u32 v244, 0x8000, v244
    s_waitcnt lgkmcnt(2)
    buffer_store_dwordx4 a[228:231], v244, s[16:19], 0 offen offset:256
    v_add_u32 v244, 0x8000, v244
    s_waitcnt lgkmcnt(1)
    buffer_store_dwordx4 a[232:235], v244, s[16:19], 0 offen offset:256
    v_add_u32 v244, 0x8000, v244
    s_waitcnt lgkmcnt(0)
    buffer_store_dwordx4 a[236:239], v244, s[16:19], 0 offen offset:256
    s_branch L_cmb_end_19
L_cmb_p1_18:
    v_mfma_f32_32x32x16_bf16 v[64:79], a[144:147], v[192:195], v[64:79]
    v_mfma_f32_32x32x16_bf16 v[80:95], a[148:151], v[192:195], v[80:95]
    s_waitcnt lgkmcnt(0)
    s_barrier
    v_mfma_f32_32x32x16_bf16 v[96:111], a[152:155], v[192:195], v[96:111]
    ds_read_b128 v[232:235], v248 offset:0
    s_waitcnt lgkmcnt(0)
    v_min_f32 v244, v236, v232
    v_sub_f32 v245, v244, v236
    v_sub_f32 v246, v244, v232
    v_exp_f32 v245, v245
    v_exp_f32 v246, v246
    s_nop 0
    v_mfma_f32_32x32x16_bf16 a[0:15], a[156:159], v[192:195], a[0:15]
    v_mul_f32 v247, v238, v245
    v_fma_f32 v247, v234, v246, v247
    v_mov_b32 v244, v247
    s_nop 1
    v_permlane32_swap_b32 v247, v244
    v_add_f32 v247, v247, v244
    v_rcp_f32 v247, v247
    v_mfma_f32_32x32x16_bf16 v[64:79], a[160:163], v[196:199], v[64:79]
    s_nop 0
    v_mul_f32 v240, v245, v247
    v_min_f32 v244, v237, v233
    v_sub_f32 v245, v244, v237
    v_sub_f32 v246, v244, v233
    v_exp_f32 v245, v245
    v_exp_f32 v246, v246
    v_mfma_f32_32x32x16_bf16 v[80:95], a[164:167], v[196:199], v[80:95]
    s_nop 0
    v_mul_f32 v247, v239, v245
    v_fma_f32 v247, v235, v246, v247
    v_mov_b32 v244, v247
    s_nop 1
    v_permlane32_swap_b32 v247, v244
    v_add_f32 v247, v247, v244
    v_rcp_f32 v247, v247
    v_mfma_f32_32x32x16_bf16 v[96:111], a[168:171], v[196:199], v[96:111]
    s_nop 0
    v_mul_f32 v241, v245, v247
    v_mul_f32 v0, v0, v240
    v_mul_f32 v1, v1, v240
    v_mul_f32 v2, v2, v240
    v_mul_f32 v3, v3, v240
    v_mfma_f32_32x32x16_bf16 a[0:15], a[172:175], v[196:199], a[0:15]
    ds_write_b128 v248, v[0:3] offset:0
    v_mul_f32 v4, v4, v240
    v_mul_f32 v5, v5, v240
    v_mul_f32 v6, v6, v240
    v_mul_f32 v7, v7, v240
    v_mfma_f32_32x32x16_bf16 v[64:79], a[176:179], v[200:203], v[64:79]
    ds_write_b128 v248, v[4:7] offset:1024
    v_mul_f32 v8, v8, v240
    v_mul_f32 v9, v9, v240
    v_mul_f32 v10, v10, v240
    v_mfma_f32_32x32x16_bf16 v[80:95], a[180:183], v[200:203], v[80:95]
    v_mul_f32 v11, v11, v240
    ds_write_b128 v248, v[8:11] offset:2048
    v_mul_f32 v12, v12, v240
    v_mfma_f32_32x32x16_bf16 v[96:111], a[184:187], v[200:203], v[96:111]
    v_mul_f32 v13, v13, v240
    v_mul_f32 v14, v14, v240
    v_mul_f32 v15, v15, v240
    ds_write_b128 v248, v[12:15] offset:3072
    v_mfma_f32_32x32x16_bf16 a[0:15], a[188:191], v[200:203], a[0:15]
    v_mul_f32 v16, v16, v240
    v_mul_f32 v17, v17, v240
    v_mul_f32 v18, v18, v240
    v_mul_f32 v19, v19, v240
    ds_write_b128 v248, v[16:19] offset:4096
    v_mfma_f32_32x32x16_bf16 v[64:79], a[192:195], v[204:207], v[64:79]
    v_mul_f32 v20, v20, v240
    v_mul_f32 v21, v21, v240
    v_mul_f32 v22, v22, v240
    v_mul_f32 v23, v23, v240
    v_mfma_f32_32x32x16_bf16 v[80:95], a[196:199], v[204:207], v[80:95]
    ds_write_b128 v248, v[20:23] offset:5120
    v_mul_f32 v24, v24, v240
    v_mul_f32 v25, v25, v240
    v_mul_f32 v26, v26, v240
    v_mul_f32 v27, v27, v240
    v_mfma_f32_32x32x16_bf16 v[96:111], a[200:203], v[204:207], v[96:111]
    ds_write_b128 v248, v[24:27] offset:6144
    v_mul_f32 v28, v28, v240
    v_mul_f32 v29, v29, v240
    v_mfma_f32_32x32x16_bf16 a[0:15], a[204:207], v[204:207], a[0:15]
    v_mul_f32 v30, v30, v240
    v_mul_f32 v31, v31, v240
    ds_write_b128 v248, v[28:31] offset:7168
    s_nop 7
    s_nop 3
    v_mul_f32 v64, v64, v241
    v_mul_f32 v65, v65, v241
    v_mul_f32 v66, v66, v241
    v_mul_f32 v67, v67, v241
    ds_write_b128 v248, v[64:67] offset:8192
    v_mul_f32 v68, v68, v241
    v_mul_f32 v69, v69, v241
    v_mul_f32 v70, v70, v241
    v_mul_f32 v71, v71, v241
    ds_write_b128 v248, v[68:71] offset:9216
    v_mul_f32 v72, v72, v241
    v_mul_f32 v73, v73, v241
    v_mul_f32 v74, v74, v241
    v_mul_f32 v75, v75, v241
    ds_write_b128 v248, v[72:75] offset:10240
    v_mul_f32 v76, v76, v241
    v_mul_f32 v77, v77, v241
    v_mul_f32 v78, v78, v241
    v_mul_f32 v79, v79, v241
    ds_write_b128 v248, v[76:79] offset:11264
    v_mul_f32 v80, v80, v241
    v_mul_f32 v81, v81, v241
    v_mul_f32 v82, v82, v241
    v_mul_f32 v83, v83, v241
    ds_write_b128 v248, v[80:83] offset:12288
    v_mul_f32 v84, v84, v241
    v_mul_f32 v85, v85, v241
    v_mul_f32 v86, v86, v241
    v_mul_f32 v87, v87, v241
    ds_write_b128 v248, v[84:87] offset:13312
    v_mul_f32 v88, v88, v241
    v_mul_f32 v89, v89, v241
    v_mul_f32 v90, v90, v241
    v_mul_f32 v91, v91, v241
    ds_write_b128 v248, v[88:91] offset:14336
    v_mul_f32 v92, v92, v241
    v_mul_f32 v93, v93, v241
    v_mul_f32 v94, v94, v241
    v_mul_f32 v95, v95, v241
    ds_write_b128 v248, v[92:95] offset:15360
    s_waitcnt lgkmcnt(0)
    s_barrier
    ds_read_b128 v[112:115], v249 offset:0
    ds_read_b128 v[116:119], v249 offset:1024
    ds_read_b128 v[120:123], v249 offset:2048
    ds_read_b128 v[124:127], v249 offset:3072
    ds_read_b128 v[128:131], v249 offset:4096
    ds_read_b128 v[132:135], v249 offset:5120
    ds_read_b128 v[136:139], v249 offset:6144
    ds_read_b128 v[140:143], v249 offset:7168
    ds_read_b128 v[144:147], v249 offset:8192
    ds_read_b128 v[148:151], v249 offset:9216
    ds_read_b128 v[152:155], v249 offset:10240
    ds_read_b128 v[156:159], v249 offset:11264
    ds_read_b128 v[160:163], v249 offset:12288
    ds_read_b128 v[164:167], v249 offset:13312
    ds_read_b128 v[168:171], v249 offset:14336
    ds_read_b128 v[172:175], v249 offset:15360
    v_bfe_u32 v244, v255, 4, 5
    v_lshrrev_b32 v245, 9, v255
    v_lshlrev_b32 v246, 7, v244
    v_lshl_add_u32 v246, v245, 3, v246
    v_and_b32 v244, 7, v244
    v_lshl_add_u32 v246, v244, 4, v246
    v_add_u32 v192, s58, v246
    v_xor_b32 v193, 16, v192
    v_xor_b32 v194, 32, v192
    v_xor_b32 v195, 48, v192
    v_xor_b32 v196, 64, v192
    v_xor_b32 v197, 0x50, v192
    v_xor_b32 v198, 0x60, v192
    v_xor_b32 v199, 0x70, v192
    s_waitcnt lgkmcnt(0)
    v_fma_f32 v112, v32, v240, v112
    v_fma_f32 v113, v33, v240, v113
    v_fma_f32 v114, v34, v240, v114
    v_fma_f32 v115, v35, v240, v115
    v_cvt_pk_bf16_f32 v200, v112, v113
    v_cvt_pk_bf16_f32 v201, v114, v115
    ds_write_b64 v192, v[200:201] offset:0
    v_fma_f32 v116, v36, v240, v116
    v_fma_f32 v117, v37, v240, v117
    v_fma_f32 v118, v38, v240, v118
    v_fma_f32 v119, v39, v240, v119
    v_cvt_pk_bf16_f32 v202, v116, v117
    v_cvt_pk_bf16_f32 v203, v118, v119
    ds_write_b64 v193, v[202:203] offset:0
    v_fma_f32 v120, v40, v240, v120
    v_fma_f32 v121, v41, v240, v121
    v_fma_f32 v122, v42, v240, v122
    v_fma_f32 v123, v43, v240, v123
    v_cvt_pk_bf16_f32 v204, v120, v121
    v_cvt_pk_bf16_f32 v205, v122, v123
    ds_write_b64 v194, v[204:205] offset:0
    v_fma_f32 v124, v44, v240, v124
    v_fma_f32 v125, v45, v240, v125
    v_fma_f32 v126, v46, v240, v126
    v_fma_f32 v127, v47, v240, v127
    v_cvt_pk_bf16_f32 v206, v124, v125
    v_cvt_pk_bf16_f32 v207, v126, v127
    ds_write_b64 v195, v[206:207] offset:0
    v_fma_f32 v128, v48, v240, v128
    v_fma_f32 v129, v49, v240, v129
    v_fma_f32 v130, v50, v240, v130
    v_fma_f32 v131, v51, v240, v131
    v_cvt_pk_bf16_f32 v200, v128, v129
    v_cvt_pk_bf16_f32 v201, v130, v131
    ds_write_b64 v196, v[200:201] offset:0
    v_fma_f32 v132, v52, v240, v132
    v_fma_f32 v133, v53, v240, v133
    v_fma_f32 v134, v54, v240, v134
    v_fma_f32 v135, v55, v240, v135
    v_cvt_pk_bf16_f32 v202, v132, v133
    v_cvt_pk_bf16_f32 v203, v134, v135
    ds_write_b64 v197, v[202:203] offset:0
    v_fma_f32 v136, v56, v240, v136
    v_fma_f32 v137, v57, v240, v137
    v_fma_f32 v138, v58, v240, v138
    v_fma_f32 v139, v59, v240, v139
    v_cvt_pk_bf16_f32 v204, v136, v137
    v_cvt_pk_bf16_f32 v205, v138, v139
    ds_write_b64 v198, v[204:205] offset:0
    v_fma_f32 v140, v60, v240, v140
    v_fma_f32 v141, v61, v240, v141
    v_fma_f32 v142, v62, v240, v142
    v_fma_f32 v143, v63, v240, v143
    v_cvt_pk_bf16_f32 v206, v140, v141
    v_cvt_pk_bf16_f32 v207, v142, v143
    ds_write_b64 v199, v[206:207] offset:0
    v_fma_f32 v144, v96, v241, v144
    v_fma_f32 v145, v97, v241, v145
    v_fma_f32 v146, v98, v241, v146
    v_fma_f32 v147, v99, v241, v147
    v_cvt_pk_bf16_f32 v200, v144, v145
    v_cvt_pk_bf16_f32 v201, v146, v147
    ds_write_b64 v192, v[200:201] offset:4096
    v_fma_f32 v148, v100, v241, v148
    v_fma_f32 v149, v101, v241, v149
    v_fma_f32 v150, v102, v241, v150
    v_fma_f32 v151, v103, v241, v151
    v_cvt_pk_bf16_f32 v202, v148, v149
    v_cvt_pk_bf16_f32 v203, v150, v151
    ds_write_b64 v193, v[202:203] offset:4096
    v_fma_f32 v152, v104, v241, v152
    v_fma_f32 v153, v105, v241, v153
    v_fma_f32 v154, v106, v241, v154
    v_fma_f32 v155, v107, v241, v155
    v_cvt_pk_bf16_f32 v204, v152, v153
    v_cvt_pk_bf16_f32 v205, v154, v155
    ds_write_b64 v194, v[204:205] offset:4096
    v_fma_f32 v156, v108, v241, v156
    v_fma_f32 v157, v109, v241, v157
    v_fma_f32 v158, v110, v241, v158
    v_fma_f32 v159, v111, v241, v159
    v_cvt_pk_bf16_f32 v206, v156, v157
    v_cvt_pk_bf16_f32 v207, v158, v159
    ds_write_b64 v195, v[206:207] offset:4096
    v_accvgpr_read_b32 v176, a0
    v_fma_f32 v160, v176, v241, v160
    v_accvgpr_read_b32 v177, a1
    v_fma_f32 v161, v177, v241, v161
    v_accvgpr_read_b32 v178, a2
    v_fma_f32 v162, v178, v241, v162
    v_accvgpr_read_b32 v179, a3
    v_fma_f32 v163, v179, v241, v163
    v_cvt_pk_bf16_f32 v200, v160, v161
    v_cvt_pk_bf16_f32 v201, v162, v163
    ds_write_b64 v196, v[200:201] offset:4096
    v_accvgpr_read_b32 v176, a4
    v_fma_f32 v164, v176, v241, v164
    v_accvgpr_read_b32 v177, a5
    v_fma_f32 v165, v177, v241, v165
    v_accvgpr_read_b32 v178, a6
    v_fma_f32 v166, v178, v241, v166
    v_accvgpr_read_b32 v179, a7
    v_fma_f32 v167, v179, v241, v167
    v_cvt_pk_bf16_f32 v202, v164, v165
    v_cvt_pk_bf16_f32 v203, v166, v167
    ds_write_b64 v197, v[202:203] offset:4096
    v_accvgpr_read_b32 v176, a8
    v_fma_f32 v168, v176, v241, v168
    v_accvgpr_read_b32 v177, a9
    v_fma_f32 v169, v177, v241, v169
    v_accvgpr_read_b32 v178, a10
    v_fma_f32 v170, v178, v241, v170
    v_accvgpr_read_b32 v179, a11
    v_fma_f32 v171, v179, v241, v171
    v_cvt_pk_bf16_f32 v204, v168, v169
    v_cvt_pk_bf16_f32 v205, v170, v171
    ds_write_b64 v198, v[204:205] offset:4096
    v_accvgpr_read_b32 v176, a12
    v_fma_f32 v172, v176, v241, v172
    v_accvgpr_read_b32 v177, a13
    v_fma_f32 v173, v177, v241, v173
    v_accvgpr_read_b32 v178, a14
    v_fma_f32 v174, v178, v241, v174
    v_accvgpr_read_b32 v179, a15
    v_fma_f32 v175, v179, v241, v175
    v_cvt_pk_bf16_f32 v206, v172, v173
    v_cvt_pk_bf16_f32 v207, v174, v175
    ds_write_b64 v199, v[206:207] offset:4096
    ds_read_b128 a[208:211], v249 offset:0
    ds_read_b128 a[212:215], v249 offset:1024
    ds_read_b128 a[216:219], v249 offset:2048
    ds_read_b128 a[220:223], v249 offset:3072
    ds_read_b128 a[224:227], v249 offset:4096
    ds_read_b128 a[228:231], v249 offset:5120
    ds_read_b128 a[232:235], v249 offset:6144
    ds_read_b128 a[236:239], v249 offset:7168
    v_add_u32 v244, s36, v251
    s_waitcnt lgkmcnt(7)
    buffer_store_dwordx4 a[208:211], v244, s[16:19], 0 offen offset:0
    v_add_u32 v244, 0x8000, v244
    s_waitcnt lgkmcnt(6)
    buffer_store_dwordx4 a[212:215], v244, s[16:19], 0 offen offset:0
    v_add_u32 v244, 0x8000, v244
    s_waitcnt lgkmcnt(5)
    buffer_store_dwordx4 a[216:219], v244, s[16:19], 0 offen offset:0
    v_add_u32 v244, 0x8000, v244
    s_waitcnt lgkmcnt(4)
    buffer_store_dwordx4 a[220:223], v244, s[16:19], 0 offen offset:0
    v_add_u32 v244, s36, v251
    s_waitcnt lgkmcnt(3)
    buffer_store_dwordx4 a[224:227], v244, s[16:19], 0 offen offset:256
    v_add_u32 v244, 0x8000, v244
    s_waitcnt lgkmcnt(2)
    buffer_store_dwordx4 a[228:231], v244, s[16:19], 0 offen offset:256
    v_add_u32 v244, 0x8000, v244
    s_waitcnt lgkmcnt(1)
    buffer_store_dwordx4 a[232:235], v244, s[16:19], 0 offen offset:256
    v_add_u32 v244, 0x8000, v244
    s_waitcnt lgkmcnt(0)
    buffer_store_dwordx4 a[236:239], v244, s[16:19], 0 offen offset:256
L_cmb_end_19:
    s_cmp_eq_u32 s29, 0
    s_cbranch_scc1 L_fin
    s_cmp_eq_u32 s29, 2
    s_cbranch_scc1 L_entry_1
    s_branch L_entry_0
L_fin:
    v_mov_b32 v244, s30
    s_lshl_b32 s38, s22, 2
    v_mov_b32 v245, s38
    v_mov_b32 v246, 0
    s_waitcnt vmcnt(8)
    s_barrier
    ds_write_b32 v245, v244 offset:0
    s_waitcnt lgkmcnt(0)
    s_barrier
    ds_read_b128 v[232:235], v246 offset:0
    s_waitcnt lgkmcnt(0)
    v_or_b32 v244, v232, v233
    v_or3_b32 v244, v244, v234, v235
    s_nop 1
    v_readfirstlane_b32 s30, v244
    s_nop 3
    s_lshr_b32 s30, s30, 1
    s_cmp_eq_u32 s30, 0
    s_cbranch_scc1 L_done
L_redo:
    s_load_dwordx8 s[48:55], s[94:95], 0
    s_waitcnt vmcnt(0) lgkmcnt(0)
    s_bitcmp0_b32 s30, 0
    s_cbranch_scc1 L_redo_next
L_safe:
    s_barrier
    s_mov_b32 s39, s37
    s_mov_b32 s37, 0
    v_xor_b32 v208, s39, v208
    v_xor_b32 v209, s39, v209
    v_xor_b32 v210, s39, v210
    v_xor_b32 v211, s39, v211
    v_xor_b32 v212, s39, v212
    v_xor_b32 v213, s39, v213
    v_xor_b32 v214, s39, v214
    v_xor_b32 v215, s39, v215
    v_xor_b32 v216, s39, v216
    v_xor_b32 v217, s39, v217
    v_xor_b32 v218, s39, v218
    v_xor_b32 v219, s39, v219
    s_mov_b32 s10, s52
    s_mov_b32 s14, s52
    s_mov_b32 s6, s50
    s_add_u32 s24, s49, s74
    s_mov_b32 s25, s24
    v_lshrrev_b32 v132, 12, v220
    v_mul_u32_u24 v132, 0x3000, v132
    v_add_u32 v128, v220, v132
    v_add_u32 v129, v221, v132
    v_add_u32 v129, 0xc00, v129
    v_add_u32 v130, v222, v132
    v_add_u32 v130, 0x1800, v130
    v_add_u32 v131, v223, v132
    v_add_u32 v131, 0x2400, v131
    s_lshr_b32 s34, s51, 18
    s_add_u32 s35, s34, 32
    s_and_b32 s38, s49, 0xfffffc00
    s_sub_u32 s23, s52, s38
    s_add_u32 s23, s23, 0xffff
    s_lshr_b32 s23, s23, 16
    s_max_u32 s23, s23, 1
    s_min_u32 s23, s23, 0x71
    s_and_b32 s38, s48, 0xfffff000
    s_add_u32 s38, s38, 0x20000
    s_min_u32 s38, s38, s50
    s_bitcmp1_b32 s51, 9
    s_cselect_b32 s89, s38, s50
    s_add_u32 s36, s48, s76
    s_add_u32 s32, s48, s76
    s_mov_b32 s33, s60
    s_mov_b32 m0, s33
    s_add_u32 s33, s33, 0x1000
    buffer_load_dwordx4 v128, s[4:7], s32 offen offset:0 nt lds
    buffer_load_dwordx4 v129, s[4:7], s32 offen offset:1024 nt lds
    buffer_load_dwordx4 v130, s[4:7], s32 offen offset:2048 nt lds
    buffer_load_dwordx4 v131, s[4:7], s32 offen offset:3072 nt lds
    s_mov_b32 m0, s33
    s_add_u32 s32, s32, 0x10000
    buffer_load_dwordx4 v128, s[4:7], s32 offen offset:0 nt lds
    buffer_load_dwordx4 v129, s[4:7], s32 offen offset:1024 nt lds
    buffer_load_dwordx4 v130, s[4:7], s32 offen offset:2048 nt lds
    buffer_load_dwordx4 v131, s[4:7], s32 offen offset:3072 nt lds
    s_add_u32 s32, s32, 0x10000
    s_sub_u32 s33, s59, 0x4000
    s_mov_b32 m0, s33
    s_add_u32 s33, s33, 0x1000
    buffer_load_dwordx4 v128, s[4:7], s32 offen offset:0 nt lds
    buffer_load_dwordx4 v129, s[4:7], s32 offen offset:1024 nt lds
    buffer_load_dwordx4 v130, s[4:7], s32 offen offset:2048 nt lds
    buffer_load_dwordx4 v131, s[4:7], s32 offen offset:3072 nt lds
    s_mov_b32 m0, s33
    s_add_u32 s32, s32, 0x10000
    buffer_load_dwordx4 v128, s[4:7], s32 offen offset:0 nt lds
    buffer_load_dwordx4 v129, s[4:7], s32 offen offset:1024 nt lds
    buffer_load_dwordx4 v130, s[4:7], s32 offen offset:2048 nt lds
    buffer_load_dwordx4 v131, s[4:7], s32 offen offset:3072 nt lds
    s_waitcnt vmcnt(0)
    v_add_u32 v132, s60, v208
    ds_read_b128 a[16:19], v132 offset:0
    v_add_u32 v133, s60, v209
    ds_read_b128 a[20:23], v133 offset:0
    v_add_u32 v134, s60, v210
    ds_read_b128 a[24:27], v134 offset:0
    v_add_u32 v135, s60, v211
    ds_read_b128 a[28:31], v135 offset:0
    v_add_u32 v132, s60, v212
    ds_read_b128 a[32:35], v132 offset:0
    v_add_u32 v133, s60, v213
    ds_read_b128 a[36:39], v133 offset:0
    v_add_u32 v134, s60, v214
    ds_read_b128 a[40:43], v134 offset:0
    v_add_u32 v135, s60, v215
    ds_read_b128 a[44:47], v135 offset:0
    s_sub_u32 s47, s59, 0x4000
    v_add_u32 v132, s47, v208
    ds_read_b128 a[48:51], v132 offset:0
    v_add_u32 v133, s47, v209
    ds_read_b128 a[52:55], v133 offset:0
    v_add_u32 v134, s47, v210
    ds_read_b128 a[56:59], v134 offset:0
    v_add_u32 v135, s47, v211
    ds_read_b128 a[60:63], v135 offset:0
    v_add_u32 v132, s47, v212
    ds_read_b128 a[64:67], v132 offset:0
    v_add_u32 v133, s47, v213
    ds_read_b128 a[68:71], v133 offset:0
    v_add_u32 v134, s47, v214
    ds_read_b128 a[72:75], v134 offset:0
    v_add_u32 v135, s47, v215
    ds_read_b128 a[76:79], v135 offset:0
    v_mfma_f32_32x32x16_bf16 v[0:15], a[240:243], a[240:243], 0
    v_mfma_f32_32x32x16_bf16 v[16:31], a[240:243], a[240:243], 0
    v_mfma_f32_32x32x16_bf16 v[32:47], a[240:243], a[240:243], 0
    v_mfma_f32_32x32x16_bf16 v[48:63], a[240:243], a[240:243], 0
    v_mfma_f32_32x32x16_bf16 v[64:79], a[240:243], a[240:243], 0
    v_mfma_f32_32x32x16_bf16 v[80:95], a[240:243], a[240:243], 0
    v_mfma_f32_32x32x16_bf16 v[96:111], a[240:243], a[240:243], 0
    v_mfma_f32_32x32x16_bf16 a[0:15], a[240:243], a[240:243], 0
    v_mov_b32 v236, 0x7f800000
    v_mov_b32 v238, 0
    v_mov_b32 v237, 0x7f800000
    v_mov_b32 v239, 0
L_safe_loop:
    s_waitcnt lgkmcnt(0)
    s_barrier
    s_mov_b32 m0, s62
    s_nop 0
    buffer_load_dwordx4 v220, s[8:11], s24 offen offset:0 lds
    buffer_load_dwordx4 v221, s[8:11], s24 offen offset:1024 lds
    buffer_load_dwordx4 v222, s[8:11], s24 offen offset:2048 lds
    buffer_load_dwordx4 v223, s[8:11], s24 offen offset:3072 lds
    s_add_u32 s24, s24, 0x10000
    s_mov_b32 m0, s64
    s_nop 0
    buffer_load_dwordx4 v224, s[12:15], s25 offen offset:0 lds
    buffer_load_dwordx4 v225, s[12:15], s25 offen offset:1024 lds
    buffer_load_dwordx4 v226, s[12:15], s25 offen offset:2048 lds
    buffer_load_dwordx4 v227, s[12:15], s25 offen offset:3072 lds
    s_add_u32 s25, s25, 0x10000
    s_waitcnt vmcnt(0)
    s_barrier
    ds_read_b128 a[80:83], v208 offset:0
    ds_read_b128 a[84:87], v209 offset:0
    ds_read_b128 a[88:91], v210 offset:0
    ds_read_b128 a[92:95], v211 offset:0
    ds_read_b128 a[96:99], v212 offset:0
    ds_read_b128 a[100:103], v213 offset:0
    ds_read_b128 a[104:107], v214 offset:0
    ds_read_b128 a[108:111], v215 offset:0
    ds_read_b128 a[112:115], v208 offset:8192
    ds_read_b128 a[116:119], v209 offset:8192
    ds_read_b128 a[120:123], v210 offset:8192
    ds_read_b128 a[124:127], v211 offset:8192
    ds_read_b128 a[128:131], v212 offset:8192
    ds_read_b128 a[132:135], v213 offset:8192
    ds_read_b128 a[136:139], v214 offset:8192
    ds_read_b128 a[140:143], v215 offset:8192
    s_waitcnt lgkmcnt(14)
    v_mfma_f32_32x32x16_bf16 v[112:127], a[80:83], a[16:19], 0
    v_mfma_f32_32x32x16_bf16 v[112:127], a[84:87], a[20:23], v[112:127]
    s_waitcnt lgkmcnt(13)
    v_mfma_f32_32x32x16_bf16 v[112:127], a[88:91], a[24:27], v[112:127]
    s_waitcnt lgkmcnt(12)
    v_mfma_f32_32x32x16_bf16 v[112:127], a[92:95], a[28:31], v[112:127]
    s_waitcnt lgkmcnt(11)
    v_mfma_f32_32x32x16_bf16 v[112:127], a[96:99], a[32:35], v[112:127]
    s_waitcnt lgkmcnt(10)
    v_mfma_f32_32x32x16_bf16 v[112:127], a[100:103], a[36:39], v[112:127]
    s_waitcnt lgkmcnt(9)
    v_mfma_f32_32x32x16_bf16 v[112:127], a[104:107], a[40:43], v[112:127]
    s_waitcnt lgkmcnt(8)
    v_mfma_f32_32x32x16_bf16 v[112:127], a[108:111], a[44:47], v[112:127]
    s_waitcnt lgkmcnt(7)
    v_mfma_f32_32x32x16_bf16 v[128:143], a[112:115], a[16:19], 0
    s_waitcnt lgkmcnt(6)
    v_mfma_f32_32x32x16_bf16 v[128:143], a[116:119], a[20:23], v[128:143]
    s_waitcnt lgkmcnt(5)
    v_mfma_f32_32x32x16_bf16 v[128:143], a[120:123], a[24:27], v[128:143]
    s_waitcnt lgkmcnt(4)
    v_mfma_f32_32x32x16_bf16 v[128:143], a[124:127], a[28:31], v[128:143]
    s_waitcnt lgkmcnt(3)
    v_mfma_f32_32x32x16_bf16 v[128:143], a[128:131], a[32:35], v[128:143]
    s_waitcnt lgkmcnt(2)
    v_mfma_f32_32x32x16_bf16 v[128:143], a[132:135], a[36:39], v[128:143]
    s_waitcnt lgkmcnt(1)
    v_mfma_f32_32x32x16_bf16 v[128:143], a[136:139], a[40:43], v[128:143]
    s_waitcnt lgkmcnt(0)
    v_mfma_f32_32x32x16_bf16 v[128:143], a[140:143], a[44:47], v[128:143]
    v_mfma_f32_32x32x16_bf16 v[144:159], a[80:83], a[48:51], 0
    v_mfma_f32_32x32x16_bf16 v[144:159], a[84:87], a[52:55], v[144:159]
    v_mfma_f32_32x32x16_bf16 v[144:159], a[88:91], a[56:59], v[144:159]
    v_mfma_f32_32x32x16_bf16 v[144:159], a[92:95], a[60:63], v[144:159]
    v_mfma_f32_32x32x16_bf16 v[144:159], a[96:99], a[64:67], v[144:159]
    v_mfma_f32_32x32x16_bf16 v[144:159], a[100:103], a[68:71], v[144:159]
    v_mfma_f32_32x32x16_bf16 v[144:159], a[104:107], a[72:75], v[144:159]
    v_mfma_f32_32x32x16_bf16 v[144:159], a[108:111], a[76:79], v[144:159]
    v_mfma_f32_32x32x16_bf16 v[160:175], a[112:115], a[48:51], 0
    v_mfma_f32_32x32x16_bf16 v[160:175], a[116:119], a[52:55], v[160:175]
    v_mfma_f32_32x32x16_bf16 v[160:175], a[120:123], a[56:59], v[160:175]
    v_mfma_f32_32x32x16_bf16 v[160:175], a[124:127], a[60:63], v[160:175]
    v_mfma_f32_32x32x16_bf16 v[160:175], a[128:131], a[64:67], v[160:175]
    v_mfma_f32_32x32x16_bf16 v[160:175], a[132:135], a[68:71], v[160:175]
    v_mfma_f32_32x32x16_bf16 v[160:175], a[136:139], a[72:75], v[160:175]
    v_mfma_f32_32x32x16_bf16 v[160:175], a[140:143], a[76:79], v[160:175]
    ds_read_b64_tr_b16 a[144:145], v216 offset:32768
    ds_read_b64_tr_b16 a[146:147], v216 offset:33280
    ds_read_b64_tr_b16 a[148:149], v217 offset:32768
    ds_read_b64_tr_b16 a[150:151], v217 offset:33280
    ds_read_b64_tr_b16 a[152:153], v218 offset:32768
    ds_read_b64_tr_b16 a[154:155], v218 offset:33280
    ds_read_b64_tr_b16 a[156:157], v219 offset:32768
    ds_read_b64_tr_b16 a[158:159], v219 offset:33280
    ds_read_b64_tr_b16 a[160:161], v216 offset:36864
    ds_read_b64_tr_b16 a[162:163], v216 offset:37376
    ds_read_b64_tr_b16 a[164:165], v217 offset:36864
    ds_read_b64_tr_b16 a[166:167], v217 offset:37376
    ds_read_b64_tr_b16 a[168:169], v218 offset:36864
    ds_read_b64_tr_b16 a[170:171], v218 offset:37376
    ds_read_b64_tr_b16 a[172:173], v219 offset:36864
    ds_read_b64_tr_b16 a[174:175], v219 offset:37376
    ds_read_b64_tr_b16 a[176:177], v216 offset:40960
    ds_read_b64_tr_b16 a[178:179], v216 offset:41472
    ds_read_b64_tr_b16 a[180:181], v217 offset:40960
    ds_read_b64_tr_b16 a[182:183], v217 offset:41472
    ds_read_b64_tr_b16 a[184:185], v218 offset:40960
    ds_read_b64_tr_b16 a[186:187], v218 offset:41472
    ds_read_b64_tr_b16 a[188:189], v219 offset:40960
    ds_read_b64_tr_b16 a[190:191], v219 offset:41472
    ds_read_b64_tr_b16 a[192:193], v216 offset:45056
    ds_read_b64_tr_b16 a[194:195], v216 offset:45568
    ds_read_b64_tr_b16 a[196:197], v217 offset:45056
    ds_read_b64_tr_b16 a[198:199], v217 offset:45568
    ds_read_b64_tr_b16 a[200:201], v218 offset:45056
    ds_read_b64_tr_b16 a[202:203], v218 offset:45568
    ds_read_b64_tr_b16 a[204:205], v219 offset:45056
    ds_read_b64_tr_b16 a[206:207], v219 offset:45568
    s_nop 7
    s_nop 7
    v_add_u32 v246, s34, v243
    v_cmp_gt_i32 vcc, 0, v246
    v_cmp_gt_i32 s[40:41], 1, v246
    v_cmp_gt_i32 s[42:43], 2, v246
    v_cndmask_b32 v112, v112, v242, vcc
    v_cmp_gt_i32 vcc, 3, v246
    v_cndmask_b32 v113, v113, v242, s[40:41]
    v_cmp_gt_i32 s[40:41], 8, v246
    v_cndmask_b32 v114, v114, v242, s[42:43]
    v_cmp_gt_i32 s[42:43], 9, v246
    v_cndmask_b32 v115, v115, v242, vcc
    v_cmp_gt_i32 vcc, 10, v246
    v_cndmask_b32 v116, v116, v242, s[40:41]
    v_cmp_gt_i32 s[40:41], 11, v246
    v_cndmask_b32 v117, v117, v242, s[42:43]
    v_cmp_gt_i32 s[42:43], 16, v246
    v_cndmask_b32 v118, v118, v242, vcc
    v_cmp_gt_i32 vcc, 17, v246
    v_cndmask_b32 v119, v119, v242, s[40:41]
    v_cmp_gt_i32 s[40:41], 18, v246
    v_cndmask_b32 v120, v120, v242, s[42:43]
    v_cmp_gt_i32 s[42:43], 19, v246
    v_cndmask_b32 v121, v121, v242, vcc
    v_cmp_gt_i32 vcc, 24, v246
    v_cndmask_b32 v122, v122, v242, s[40:41]
    v_cmp_gt_i32 s[40:41], 25, v246
    v_cndmask_b32 v123, v123, v242, s[42:43]
    v_cmp_gt_i32 s[42:43], 26, v246
    v_cndmask_b32 v124, v124, v242, vcc
    v_cmp_gt_i32 vcc, 27, v246
    v_cndmask_b32 v125, v125, v242, s[40:41]
    v_cmp_gt_i32 s[40:41], 32, v246
    v_cndmask_b32 v126, v126, v242, s[42:43]
    v_cmp_gt_i32 s[42:43], 33, v246
    v_cndmask_b32 v127, v127, v242, vcc
    v_cmp_gt_i32 vcc, 34, v246
    v_cndmask_b32 v128, v128, v242, s[40:41]
    v_cmp_gt_i32 s[40:41], 35, v246
    v_cndmask_b32 v129, v129, v242, s[42:43]
    v_cmp_gt_i32 s[42:43], 40, v246
    v_cndmask_b32 v130, v130, v242, vcc
    v_cmp_gt_i32 vcc, 41, v246
    v_cndmask_b32 v131, v131, v242, s[40:41]
    v_cmp_gt_i32 s[40:41], 42, v246
    v_cndmask_b32 v132, v132, v242, s[42:43]
    v_cmp_gt_i32 s[42:43], 43, v246
    v_cndmask_b32 v133, v133, v242, vcc
    v_cmp_gt_i32 vcc, 48, v246
    v_cndmask_b32 v134, v134, v242, s[40:41]
    v_cmp_gt_i32 s[40:41], 49, v246
    v_cndmask_b32 v135, v135, v242, s[42:43]
    v_cmp_gt_i32 s[42:43], 50, v246
    v_cndmask_b32 v136, v136, v242, vcc
    v_cmp_gt_i32 vcc, 51, v246
    v_cndmask_b32 v137, v137, v242, s[40:41]
    v_cmp_gt_i32 s[40:41], 56, v246
    v_cndmask_b32 v138, v138, v242, s[42:43]
    v_cmp_gt_i32 s[42:43], 57, v246
    v_cndmask_b32 v139, v139, v242, vcc
    v_cmp_gt_i32 vcc, 58, v246
    v_cndmask_b32 v140, v140, v242, s[40:41]
    v_cmp_gt_i32 s[40:41], 59, v246
    v_cndmask_b32 v141, v141, v242, s[42:43]
    s_nop 0
    v_cndmask_b32 v142, v142, v242, vcc
    s_nop 0
    v_cndmask_b32 v143, v143, v242, s[40:41]
    v_max3_f32 v244, v112, v113, v114
    v_max3_f32 v244, v244, v115, v116
    v_max3_f32 v244, v244, v117, v118
    v_max3_f32 v244, v244, v119, v120
    v_max3_f32 v244, v244, v121, v122
    v_max3_f32 v244, v244, v123, v124
    v_max3_f32 v244, v244, v125, v126
    v_max_f32 v244, v244, v127
    v_max3_f32 v245, v128, v129, v130
    v_max3_f32 v245, v245, v131, v132
    v_max3_f32 v245, v245, v133, v134
    v_max3_f32 v245, v245, v135, v136
    v_max3_f32 v245, v245, v137, v138
    v_max3_f32 v245, v245, v139, v140
    v_max3_f32 v245, v245, v141, v142
    v_max3_f32 v244, v244, v245, v143
    v_mov_b32 v245, v244
    s_nop 1
    v_permlane32_swap_b32 v244, v245
    v_max_f32 v244, v244, v245
    v_mul_f32 v244, s28, v244
    v_min_f32 v244, v244, v236
    v_sub_f32 v245, v244, v236
    v_exp_f32 v245, v245
    v_mov_b32 v236, v244
    v_mul_f32 v238, v238, v245
    v_mul_f32 v0, v0, v245
    v_mul_f32 v1, v1, v245
    v_mul_f32 v2, v2, v245
    v_mul_f32 v3, v3, v245
    v_mul_f32 v4, v4, v245
    v_mul_f32 v5, v5, v245
    v_mul_f32 v6, v6, v245
    v_mul_f32 v7, v7, v245
    v_mul_f32 v8, v8, v245
    v_mul_f32 v9, v9, v245
    v_mul_f32 v10, v10, v245
    v_mul_f32 v11, v11, v245
    v_mul_f32 v12, v12, v245
    v_mul_f32 v13, v13, v245
    v_mul_f32 v14, v14, v245
    v_mul_f32 v15, v15, v245
    v_mul_f32 v16, v16, v245
    v_mul_f32 v17, v17, v245
    v_mul_f32 v18, v18, v245
    v_mul_f32 v19, v19, v245
    v_mul_f32 v20, v20, v245
    v_mul_f32 v21, v21, v245
    v_mul_f32 v22, v22, v245
    v_mul_f32 v23, v23, v245
    v_mul_f32 v24, v24, v245
    v_mul_f32 v25, v25, v245
    v_mul_f32 v26, v26, v245
    v_mul_f32 v27, v27, v245
    v_mul_f32 v28, v28, v245
    v_mul_f32 v29, v29, v245
    v_mul_f32 v30, v30, v245
    v_mul_f32 v31, v31, v245
    v_mul_f32 v32, v32, v245
    v_mul_f32 v33, v33, v245
    v_mul_f32 v34, v34, v245
    v_mul_f32 v35, v35, v245
    v_mul_f32 v36, v36, v245
    v_mul_f32 v37, v37, v245
    v_mul_f32 v38, v38, v245
    v_mul_f32 v39, v39, v245
    v_mul_f32 v40, v40, v245
    v_mul_f32 v41, v41, v245
    v_mul_f32 v42, v42, v245
    v_mul_f32 v43, v43, v245
    v_mul_f32 v44, v44, v245
    v_mul_f32 v45, v45, v245
    v_mul_f32 v46, v46, v245
    v_mul_f32 v47, v47, v245
    v_mul_f32 v48, v48, v245
    v_mul_f32 v49, v49, v245
    v_mul_f32 v50, v50, v245
    v_mul_f32 v51, v51, v245
    v_mul_f32 v52, v52, v245
    v_mul_f32 v53, v53, v245
    v_mul_f32 v54, v54, v245
    v_mul_f32 v55, v55, v245
    v_mul_f32 v56, v56, v245
    v_mul_f32 v57, v57, v245
    v_mul_f32 v58, v58, v245
    v_mul_f32 v59, v59, v245
    v_mul_f32 v60, v60, v245
    v_mul_f32 v61, v61, v245
    v_mul_f32 v62, v62, v245
    v_mul_f32 v63, v63, v245
    v_fma_f32 v232, v112, s20, v236
    v_fma_f32 v233, v113, s20, v236
    v_exp_f32 v232, v232
    v_exp_f32 v233, v233
    v_fma_f32 v234, v114, s20, v236
    v_fma_f32 v235, v115, s20, v236
    v_exp_f32 v234, v234
    v_add_f32 v238, v238, v232
    v_exp_f32 v235, v235
    v_add_f32 v238, v238, v233
    v_cvt_pk_bf16_f32 v176, v232, v233
    v_fma_f32 v232, v116, s20, v236
    v_fma_f32 v233, v117, s20, v236
    v_exp_f32 v232, v232
    v_add_f32 v238, v238, v234
    v_exp_f32 v233, v233
    v_add_f32 v238, v238, v235
    v_cvt_pk_bf16_f32 v177, v234, v235
    v_fma_f32 v234, v118, s20, v236
    v_fma_f32 v235, v119, s20, v236
    v_exp_f32 v234, v234
    v_add_f32 v238, v238, v232
    v_exp_f32 v235, v235
    v_add_f32 v238, v238, v233
    v_cvt_pk_bf16_f32 v178, v232, v233
    v_fma_f32 v232, v120, s20, v236
    v_fma_f32 v233, v121, s20, v236
    v_exp_f32 v232, v232
    v_add_f32 v238, v238, v234
    v_exp_f32 v233, v233
    v_add_f32 v238, v238, v235
    v_cvt_pk_bf16_f32 v179, v234, v235
    v_fma_f32 v234, v122, s20, v236
    v_fma_f32 v235, v123, s20, v236
    v_exp_f32 v234, v234
    v_add_f32 v238, v238, v232
    v_exp_f32 v235, v235
    v_add_f32 v238, v238, v233
    v_cvt_pk_bf16_f32 v180, v232, v233
    v_fma_f32 v232, v124, s20, v236
    v_fma_f32 v233, v125, s20, v236
    v_exp_f32 v232, v232
    v_add_f32 v238, v238, v234
    v_exp_f32 v233, v233
    v_add_f32 v238, v238, v235
    v_cvt_pk_bf16_f32 v181, v234, v235
    v_fma_f32 v234, v126, s20, v236
    v_fma_f32 v235, v127, s20, v236
    v_exp_f32 v234, v234
    v_add_f32 v238, v238, v232
    v_exp_f32 v235, v235
    v_add_f32 v238, v238, v233
    v_cvt_pk_bf16_f32 v182, v232, v233
    v_fma_f32 v232, v128, s20, v236
    v_fma_f32 v233, v129, s20, v236
    v_exp_f32 v232, v232
    v_add_f32 v238, v238, v234
    v_exp_f32 v233, v233
    v_add_f32 v238, v238, v235
    v_cvt_pk_bf16_f32 v183, v234, v235
    v_fma_f32 v234, v130, s20, v236
    v_fma_f32 v235, v131, s20, v236
    v_exp_f32 v234, v234
    v_add_f32 v238, v238, v232
    v_exp_f32 v235, v235
    v_add_f32 v238, v238, v233
    v_cvt_pk_bf16_f32 v184, v232, v233
    v_fma_f32 v232, v132, s20, v236
    v_fma_f32 v233, v133, s20, v236
    v_exp_f32 v232, v232
    v_add_f32 v238, v238, v234
    v_exp_f32 v233, v233
    v_add_f32 v238, v238, v235
    v_cvt_pk_bf16_f32 v185, v234, v235
    v_fma_f32 v234, v134, s20, v236
    v_fma_f32 v235, v135, s20, v236
    v_exp_f32 v234, v234
    v_add_f32 v238, v238, v232
    v_exp_f32 v235, v235
    v_add_f32 v238, v238, v233
    v_cvt_pk_bf16_f32 v186, v232, v233
    v_fma_f32 v232, v136, s20, v236
    v_fma_f32 v233, v137, s20, v236
    v_exp_f32 v232, v232
    v_add_f32 v238, v238, v234
    v_exp_f32 v233, v233
    v_add_f32 v238, v238, v235
    v_cvt_pk_bf16_f32 v187, v234, v235
    v_fma_f32 v234, v138, s20, v236
    v_fma_f32 v235, v139, s20, v236
    v_exp_f32 v234, v234
    v_add_f32 v238, v238, v232
    v_exp_f32 v235, v235
    v_add_f32 v238, v238, v233
    v_cvt_pk_bf16_f32 v188, v232, v233
    v_fma_f32 v232, v140, s20, v236
    v_fma_f32 v233, v141, s20, v236
    v_exp_f32 v232, v232
    v_add_f32 v238, v238, v234
    v_exp_f32 v233, v233
    v_add_f32 v238, v238, v235
    v_cvt_pk_bf16_f32 v189, v234, v235
    v_fma_f32 v234, v142, s20, v236
    v_fma_f32 v235, v143, s20, v236
    v_exp_f32 v234, v234
    v_add_f32 v238, v238, v232
    v_exp_f32 v235, v235
    v_add_f32 v238, v238, v233
    v_cvt_pk_bf16_f32 v190, v232, v233
    v_add_f32 v238, v238, v234
    v_add_f32 v238, v238, v235
    v_cvt_pk_bf16_f32 v191, v234, v235
    s_nop 1
    s_waitcnt lgkmcnt(14)
    v_mfma_f32_32x32x16_bf16 v[0:15], a[144:147], v[176:179], v[0:15]
    v_mfma_f32_32x32x16_bf16 v[16:31], a[148:151], v[176:179], v[16:31]
    v_mfma_f32_32x32x16_bf16 v[32:47], a[152:155], v[176:179], v[32:47]
    v_mfma_f32_32x32x16_bf16 v[48:63], a[156:159], v[176:179], v[48:63]
    v_mfma_f32_32x32x16_bf16 v[0:15], a[160:163], v[180:183], v[0:15]
    v_mfma_f32_32x32x16_bf16 v[16:31], a[164:167], v[180:183], v[16:31]
    v_mfma_f32_32x32x16_bf16 v[32:47], a[168:171], v[180:183], v[32:47]
    v_mfma_f32_32x32x16_bf16 v[48:63], a[172:175], v[180:183], v[48:63]
    v_mfma_f32_32x32x16_bf16 v[0:15], a[176:179], v[184:187], v[0:15]
    s_waitcnt lgkmcnt(12)
    v_mfma_f32_32x32x16_bf16 v[16:31], a[180:183], v[184:187], v[16:31]
    s_waitcnt lgkmcnt(10)
    v_mfma_f32_32x32x16_bf16 v[32:47], a[184:187], v[184:187], v[32:47]
    s_waitcnt lgkmcnt(8)
    v_mfma_f32_32x32x16_bf16 v[48:63], a[188:191], v[184:187], v[48:63]
    s_waitcnt lgkmcnt(6)
    v_mfma_f32_32x32x16_bf16 v[0:15], a[192:195], v[188:191], v[0:15]
    s_waitcnt lgkmcnt(4)
    v_mfma_f32_32x32x16_bf16 v[16:31], a[196:199], v[188:191], v[16:31]
    s_waitcnt lgkmcnt(2)
    v_mfma_f32_32x32x16_bf16 v[32:47], a[200:203], v[188:191], v[32:47]
    s_waitcnt lgkmcnt(0)
    v_mfma_f32_32x32x16_bf16 v[48:63], a[204:207], v[188:191], v[48:63]
    v_add_u32 v246, s35, v243
    v_cmp_gt_i32 vcc, 0, v246
    v_cmp_gt_i32 s[40:41], 1, v246
    v_cmp_gt_i32 s[42:43], 2, v246
    v_cndmask_b32 v144, v144, v242, vcc
    v_cmp_gt_i32 vcc, 3, v246
    v_cndmask_b32 v145, v145, v242, s[40:41]
    v_cmp_gt_i32 s[40:41], 8, v246
    v_cndmask_b32 v146, v146, v242, s[42:43]
    v_cmp_gt_i32 s[42:43], 9, v246
    v_cndmask_b32 v147, v147, v242, vcc
    v_cmp_gt_i32 vcc, 10, v246
    v_cndmask_b32 v148, v148, v242, s[40:41]
    v_cmp_gt_i32 s[40:41], 11, v246
    v_cndmask_b32 v149, v149, v242, s[42:43]
    v_cmp_gt_i32 s[42:43], 16, v246
    v_cndmask_b32 v150, v150, v242, vcc
    v_cmp_gt_i32 vcc, 17, v246
    v_cndmask_b32 v151, v151, v242, s[40:41]
    v_cmp_gt_i32 s[40:41], 18, v246
    v_cndmask_b32 v152, v152, v242, s[42:43]
    v_cmp_gt_i32 s[42:43], 19, v246
    v_cndmask_b32 v153, v153, v242, vcc
    v_cmp_gt_i32 vcc, 24, v246
    v_cndmask_b32 v154, v154, v242, s[40:41]
    v_cmp_gt_i32 s[40:41], 25, v246
    v_cndmask_b32 v155, v155, v242, s[42:43]
    v_cmp_gt_i32 s[42:43], 26, v246
    v_cndmask_b32 v156, v156, v242, vcc
    v_cmp_gt_i32 vcc, 27, v246
    v_cndmask_b32 v157, v157, v242, s[40:41]
    v_cmp_gt_i32 s[40:41], 32, v246
    v_cndmask_b32 v158, v158, v242, s[42:43]
    v_cmp_gt_i32 s[42:43], 33, v246
    v_cndmask_b32 v159, v159, v242, vcc
    v_cmp_gt_i32 vcc, 34, v246
    v_cndmask_b32 v160, v160, v242, s[40:41]
    v_cmp_gt_i32 s[40:41], 35, v246
    v_cndmask_b32 v161, v161, v242, s[42:43]
    v_cmp_gt_i32 s[42:43], 40, v246
    v_cndmask_b32 v162, v162, v242, vcc
    v_cmp_gt_i32 vcc, 41, v246
    v_cndmask_b32 v163, v163, v242, s[40:41]
    v_cmp_gt_i32 s[40:41], 42, v246
    v_cndmask_b32 v164, v164, v242, s[42:43]
    v_cmp_gt_i32 s[42:43], 43, v246
    v_cndmask_b32 v165, v165, v242, vcc
    v_cmp_gt_i32 vcc, 48, v246
    v_cndmask_b32 v166, v166, v242, s[40:41]
    v_cmp_gt_i32 s[40:41], 49, v246
    v_cndmask_b32 v167, v167, v242, s[42:43]
    v_cmp_gt_i32 s[42:43], 50, v246
    v_cndmask_b32 v168, v168, v242, vcc
    v_cmp_gt_i32 vcc, 51, v246
    v_cndmask_b32 v169, v169, v242, s[40:41]
    v_cmp_gt_i32 s[40:41], 56, v246
    v_cndmask_b32 v170, v170, v242, s[42:43]
    v_cmp_gt_i32 s[42:43], 57, v246
    v_cndmask_b32 v171, v171, v242, vcc
    v_cmp_gt_i32 vcc, 58, v246
    v_cndmask_b32 v172, v172, v242, s[40:41]
    v_cmp_gt_i32 s[40:41], 59, v246
    v_cndmask_b32 v173, v173, v242, s[42:43]
    s_nop 0
    v_cndmask_b32 v174, v174, v242, vcc
    s_nop 0
    v_cndmask_b32 v175, v175, v242, s[40:41]
    v_max3_f32 v244, v144, v145, v146
    v_max3_f32 v244, v244, v147, v148
    v_max3_f32 v244, v244, v149, v150
    v_max3_f32 v244, v244, v151, v152
    v_max3_f32 v244, v244, v153, v154
    v_max3_f32 v244, v244, v155, v156
    v_max3_f32 v244, v244, v157, v158
    v_max_f32 v244, v244, v159
    v_max3_f32 v245, v160, v161, v162
    v_max3_f32 v245, v245, v163, v164
    v_max3_f32 v245, v245, v165, v166
    v_max3_f32 v245, v245, v167, v168
    v_max3_f32 v245, v245, v169, v170
    v_max3_f32 v245, v245, v171, v172
    v_max3_f32 v245, v245, v173, v174
    v_max3_f32 v244, v244, v245, v175
    v_mov_b32 v245, v244
    s_nop 1
    v_permlane32_swap_b32 v244, v245
    v_max_f32 v244, v244, v245
    v_mul_f32 v244, s28, v244
    v_min_f32 v244, v244, v237
    v_sub_f32 v245, v244, v237
    v_exp_f32 v245, v245
    v_mov_b32 v237, v244
    v_mul_f32 v239, v239, v245
    v_mul_f32 v64, v64, v245
    v_mul_f32 v65, v65, v245
    v_mul_f32 v66, v66, v245
    v_mul_f32 v67, v67, v245
    v_mul_f32 v68, v68, v245
    v_mul_f32 v69, v69, v245
    v_mul_f32 v70, v70, v245
    v_mul_f32 v71, v71, v245
    v_mul_f32 v72, v72, v245
    v_mul_f32 v73, v73, v245
    v_mul_f32 v74, v74, v245
    v_mul_f32 v75, v75, v245
    v_mul_f32 v76, v76, v245
    v_mul_f32 v77, v77, v245
    v_mul_f32 v78, v78, v245
    v_mul_f32 v79, v79, v245
    v_mul_f32 v80, v80, v245
    v_mul_f32 v81, v81, v245
    v_mul_f32 v82, v82, v245
    v_mul_f32 v83, v83, v245
    v_mul_f32 v84, v84, v245
    v_mul_f32 v85, v85, v245
    v_mul_f32 v86, v86, v245
    v_mul_f32 v87, v87, v245
    v_mul_f32 v88, v88, v245
    v_mul_f32 v89, v89, v245
    v_mul_f32 v90, v90, v245
    v_mul_f32 v91, v91, v245
    v_mul_f32 v92, v92, v245
    v_mul_f32 v93, v93, v245
    v_mul_f32 v94, v94, v245
    v_mul_f32 v95, v95, v245
    v_mul_f32 v96, v96, v245
    v_mul_f32 v97, v97, v245
    v_mul_f32 v98, v98, v245
    v_mul_f32 v99, v99, v245
    v_mul_f32 v100, v100, v245
    v_mul_f32 v101, v101, v245
    v_mul_f32 v102, v102, v245
    v_mul_f32 v103, v103, v245
    v_mul_f32 v104, v104, v245
    v_mul_f32 v105, v105, v245
    v_mul_f32 v106, v106, v245
    v_mul_f32 v107, v107, v245
    v_mul_f32 v108, v108, v245
    v_mul_f32 v109, v109, v245
    v_mul_f32 v110, v110, v245
    v_mul_f32 v111, v111, v245
    v_accvgpr_read_b32 v246, a0
    v_mul_f32 v246, v246, v245
    v_accvgpr_write_b32 a0, v246
    v_accvgpr_read_b32 v246, a1
    v_mul_f32 v246, v246, v245
    v_accvgpr_write_b32 a1, v246
    v_accvgpr_read_b32 v246, a2
    v_mul_f32 v246, v246, v245
    v_accvgpr_write_b32 a2, v246
    v_accvgpr_read_b32 v246, a3
    v_mul_f32 v246, v246, v245
    v_accvgpr_write_b32 a3, v246
    v_accvgpr_read_b32 v246, a4
    v_mul_f32 v246, v246, v245
    v_accvgpr_write_b32 a4, v246
    v_accvgpr_read_b32 v246, a5
    v_mul_f32 v246, v246, v245
    v_accvgpr_write_b32 a5, v246
    v_accvgpr_read_b32 v246, a6
    v_mul_f32 v246, v246, v245
    v_accvgpr_write_b32 a6, v246
    v_accvgpr_read_b32 v246, a7
    v_mul_f32 v246, v246, v245
    v_accvgpr_write_b32 a7, v246
    v_accvgpr_read_b32 v246, a8
    v_mul_f32 v246, v246, v245
    v_accvgpr_write_b32 a8, v246
    v_accvgpr_read_b32 v246, a9
    v_mul_f32 v246, v246, v245
    v_accvgpr_write_b32 a9, v246
    v_accvgpr_read_b32 v246, a10
    v_mul_f32 v246, v246, v245
    v_accvgpr_write_b32 a10, v246
    v_accvgpr_read_b32 v246, a11
    v_mul_f32 v246, v246, v245
    v_accvgpr_write_b32 a11, v246
    v_accvgpr_read_b32 v246, a12
    v_mul_f32 v246, v246, v245
    v_accvgpr_write_b32 a12, v246
    v_accvgpr_read_b32 v246, a13
    v_mul_f32 v246, v246, v245
    v_accvgpr_write_b32 a13, v246
    v_accvgpr_read_b32 v246, a14
    v_mul_f32 v246, v246, v245
    v_accvgpr_write_b32 a14, v246
    v_accvgpr_read_b32 v246, a15
    v_mul_f32 v246, v246, v245
    v_accvgpr_write_b32 a15, v246
    v_fma_f32 v232, v144, s20, v237
    v_fma_f32 v233, v145, s20, v237
    v_exp_f32 v232, v232
    v_exp_f32 v233, v233
    v_fma_f32 v234, v146, s20, v237
    v_fma_f32 v235, v147, s20, v237
    v_exp_f32 v234, v234
    v_add_f32 v239, v239, v232
    v_exp_f32 v235, v235
    v_add_f32 v239, v239, v233
    v_cvt_pk_bf16_f32 v192, v232, v233
    v_fma_f32 v232, v148, s20, v237
    v_fma_f32 v233, v149, s20, v237
    v_exp_f32 v232, v232
    v_add_f32 v239, v239, v234
    v_exp_f32 v233, v233
    v_add_f32 v239, v239, v235
    v_cvt_pk_bf16_f32 v193, v234, v235
    v_fma_f32 v234, v150, s20, v237
    v_fma_f32 v235, v151, s20, v237
    v_exp_f32 v234, v234
    v_add_f32 v239, v239, v232
    v_exp_f32 v235, v235
    v_add_f32 v239, v239, v233
    v_cvt_pk_bf16_f32 v194, v232, v233
    v_fma_f32 v232, v152, s20, v237
    v_fma_f32 v233, v153, s20, v237
    v_exp_f32 v232, v232
    v_add_f32 v239, v239, v234
    v_exp_f32 v233, v233
    v_add_f32 v239, v239, v235
    v_cvt_pk_bf16_f32 v195, v234, v235
    v_fma_f32 v234, v154, s20, v237
    v_fma_f32 v235, v155, s20, v237
    v_exp_f32 v234, v234
    v_add_f32 v239, v239, v232
    v_exp_f32 v235, v235
    v_add_f32 v239, v239, v233
    v_cvt_pk_bf16_f32 v196, v232, v233
    v_fma_f32 v232, v156, s20, v237
    v_fma_f32 v233, v157, s20, v237
    v_exp_f32 v232, v232
    v_add_f32 v239, v239, v234
    v_exp_f32 v233, v233
    v_add_f32 v239, v239, v235
    v_cvt_pk_bf16_f32 v197, v234, v235
    v_fma_f32 v234, v158, s20, v237
    v_fma_f32 v235, v159, s20, v237
    v_exp_f32 v234, v234
    v_add_f32 v239, v239, v232
    v_exp_f32 v235, v235
    v_add_f32 v239, v239, v233
    v_cvt_pk_bf16_f32 v198, v232, v233
    v_fma_f32 v232, v160, s20, v237
    v_fma_f32 v233, v161, s20, v237
    v_exp_f32 v232, v232
    v_add_f32 v239, v239, v234
    v_exp_f32 v233, v233
    v_add_f32 v239, v239, v235
    v_cvt_pk_bf16_f32 v199, v234, v235
    v_fma_f32 v234, v162, s20, v237
    v_fma_f32 v235, v163, s20, v237
    v_exp_f32 v234, v234
    v_add_f32 v239, v239, v232
    v_exp_f32 v235, v235
    v_add_f32 v239, v239, v233
    v_cvt_pk_bf16_f32 v200, v232, v233
    v_fma_f32 v232, v164, s20, v237
    v_fma_f32 v233, v165, s20, v237
    v_exp_f32 v232, v232
    v_add_f32 v239, v239, v234
    v_exp_f32 v233, v233
    v_add_f32 v239, v239, v235
    v_cvt_pk_bf16_f32 v201, v234, v235
    v_fma_f32 v234, v166, s20, v237
    v_fma_f32 v235, v167, s20, v237
    v_exp_f32 v234, v234
    v_add_f32 v239, v239, v232
    v_exp_f32 v235, v235
    v_add_f32 v239, v239, v233
    v_cvt_pk_bf16_f32 v202, v232, v233
    v_fma_f32 v232, v168, s20, v237
    v_fma_f32 v233, v169, s20, v237
    v_exp_f32 v232, v232
    v_add_f32 v239, v239, v234
    v_exp_f32 v233, v233
    v_add_f32 v239, v239, v235
    v_cvt_pk_bf16_f32 v203, v234, v235
    v_fma_f32 v234, v170, s20, v237
    v_fma_f32 v235, v171, s20, v237
    v_exp_f32 v234, v234
    v_add_f32 v239, v239, v232
    v_exp_f32 v235, v235
    v_add_f32 v239, v239, v233
    v_cvt_pk_bf16_f32 v204, v232, v233
    v_fma_f32 v232, v172, s20, v237
    v_fma_f32 v233, v173, s20, v237
    v_exp_f32 v232, v232
    v_add_f32 v239, v239, v234
    v_exp_f32 v233, v233
    v_add_f32 v239, v239, v235
    v_cvt_pk_bf16_f32 v205, v234, v235
    v_fma_f32 v234, v174, s20, v237
    v_fma_f32 v235, v175, s20, v237
    v_exp_f32 v234, v234
    v_add_f32 v239, v239, v232
    v_exp_f32 v235, v235
    v_add_f32 v239, v239, v233
    v_cvt_pk_bf16_f32 v206, v232, v233
    v_add_f32 v239, v239, v234
    v_add_f32 v239, v239, v235
    v_cvt_pk_bf16_f32 v207, v234, v235
    s_nop 1
    v_mfma_f32_32x32x16_bf16 v[64:79], a[144:147], v[192:195], v[64:79]
    v_mfma_f32_32x32x16_bf16 v[80:95], a[148:151], v[192:195], v[80:95]
    v_mfma_f32_32x32x16_bf16 v[96:111], a[152:155], v[192:195], v[96:111]
    v_mfma_f32_32x32x16_bf16 a[0:15], a[156:159], v[192:195], a[0:15]
    v_mfma_f32_32x32x16_bf16 v[64:79], a[160:163], v[196:199], v[64:79]
    v_mfma_f32_32x32x16_bf16 v[80:95], a[164:167], v[196:199], v[80:95]
    v_mfma_f32_32x32x16_bf16 v[96:111], a[168:171], v[196:199], v[96:111]
    v_mfma_f32_32x32x16_bf16 a[0:15], a[172:175], v[196:199], a[0:15]
    v_mfma_f32_32x32x16_bf16 v[64:79], a[176:179], v[200:203], v[64:79]
    v_mfma_f32_32x32x16_bf16 v[80:95], a[180:183], v[200:203], v[80:95]
    v_mfma_f32_32x32x16_bf16 v[96:111], a[184:187], v[200:203], v[96:111]
    v_mfma_f32_32x32x16_bf16 a[0:15], a[188:191], v[200:203], a[0:15]
    v_mfma_f32_32x32x16_bf16 v[64:79], a[192:195], v[204:207], v[64:79]
    v_mfma_f32_32x32x16_bf16 v[80:95], a[196:199], v[204:207], v[80:95]
    v_mfma_f32_32x32x16_bf16 v[96:111], a[200:203], v[204:207], v[96:111]
    v_mfma_f32_32x32x16_bf16 a[0:15], a[204:207], v[204:207], a[0:15]
    s_nop 7
    s_nop 7
    s_sub_u32 s34, s34, 64
    s_sub_u32 s35, s35, 64
    s_sub_u32 s23, s23, 1
    s_cmp_lg_u32 s23, 0
    s_cbranch_scc1 L_safe_loop
    s_mov_b32 s31, 0
    v_mov_b32 v247, v238
    v_mov_b32 v228, v238
    s_nop 1
    v_permlane32_swap_b32 v247, v228
    v_add_f32 v228, v228, v247
    v_cmp_nge_f32 vcc, s21, v228
    s_nop 3
    s_cmp_lg_u64 vcc, 0
    s_cselect_b32 s38, s31, 0
    s_or_b32 s30, s30, s38
    v_rcp_f32 v228, v228
    s_nop 0
    v_mov_b32 v247, v239
    v_mov_b32 v229, v239
    s_nop 1
    v_permlane32_swap_b32 v247, v229
    v_add_f32 v229, v229, v247
    v_cmp_nge_f32 vcc, s21, v229
    s_nop 3
    s_cmp_lg_u64 vcc, 0
    s_cselect_b32 s38, s31, 0
    s_or_b32 s30, s30, s38
    v_rcp_f32 v229, v229
    s_nop 0
    v_add_u32 v249, s59, v253
    s_mov_b32 s18, s89
    v_mul_f32 v0, v0, v228
    v_mul_f32 v1, v1, v228
    v_mul_f32 v2, v2, v228
    v_mul_f32 v3, v3, v228
    v_cvt_pk_bf16_f32 v0, v0, v1
    v_cvt_pk_bf16_f32 v1, v2, v3
    v_mul_f32 v32, v32, v228
    v_mul_f32 v33, v33, v228
    v_mul_f32 v34, v34, v228
    v_mul_f32 v35, v35, v228
    v_cvt_pk_bf16_f32 v32, v32, v33
    v_cvt_pk_bf16_f32 v33, v34, v35
    ds_write2_b64 v249, v[0:1], v[32:33] offset0:0 offset1:16
    v_mul_f32 v4, v4, v228
    v_mul_f32 v5, v5, v228
    v_mul_f32 v6, v6, v228
    v_mul_f32 v7, v7, v228
    v_cvt_pk_bf16_f32 v4, v4, v5
    v_cvt_pk_bf16_f32 v5, v6, v7
    v_mul_f32 v36, v36, v228
    v_mul_f32 v37, v37, v228
    v_mul_f32 v38, v38, v228
    v_mul_f32 v39, v39, v228
    v_cvt_pk_bf16_f32 v36, v36, v37
    v_cvt_pk_bf16_f32 v37, v38, v39
    v_xor_b32 v231, 16, v249
    ds_write2_b64 v231, v[4:5], v[36:37] offset0:0 offset1:16
    v_mul_f32 v8, v8, v228
    v_mul_f32 v9, v9, v228
    v_mul_f32 v10, v10, v228
    v_mul_f32 v11, v11, v228
    v_cvt_pk_bf16_f32 v8, v8, v9
    v_cvt_pk_bf16_f32 v9, v10, v11
    v_mul_f32 v40, v40, v228
    v_mul_f32 v41, v41, v228
    v_mul_f32 v42, v42, v228
    v_mul_f32 v43, v43, v228
    v_cvt_pk_bf16_f32 v40, v40, v41
    v_cvt_pk_bf16_f32 v41, v42, v43
    v_xor_b32 v230, 32, v249
    ds_write2_b64 v230, v[8:9], v[40:41] offset0:0 offset1:16
    v_mul_f32 v12, v12, v228
    v_mul_f32 v13, v13, v228
    v_mul_f32 v14, v14, v228
    v_mul_f32 v15, v15, v228
    v_cvt_pk_bf16_f32 v12, v12, v13
    v_cvt_pk_bf16_f32 v13, v14, v15
    v_mul_f32 v44, v44, v228
    v_mul_f32 v45, v45, v228
    v_mul_f32 v46, v46, v228
    v_mul_f32 v47, v47, v228
    v_cvt_pk_bf16_f32 v44, v44, v45
    v_cvt_pk_bf16_f32 v45, v46, v47
    v_xor_b32 v231, 48, v249
    ds_write2_b64 v231, v[12:13], v[44:45] offset0:0 offset1:16
    v_mul_f32 v16, v16, v228
    v_mul_f32 v17, v17, v228
    v_mul_f32 v18, v18, v228
    v_mul_f32 v19, v19, v228
    v_cvt_pk_bf16_f32 v16, v16, v17
    v_cvt_pk_bf16_f32 v17, v18, v19
    v_mul_f32 v48, v48, v228
    v_mul_f32 v49, v49, v228
    v_mul_f32 v50, v50, v228
    v_mul_f32 v51, v51, v228
    v_cvt_pk_bf16_f32 v48, v48, v49
    v_cvt_pk_bf16_f32 v49, v50, v51
    v_xor_b32 v230, 64, v249
    ds_write2_b64 v230, v[16:17], v[48:49] offset0:0 offset1:16
    v_mul_f32 v20, v20, v228
    v_mul_f32 v21, v21, v228
    v_mul_f32 v22, v22, v228
    v_mul_f32 v23, v23, v228
    v_cvt_pk_bf16_f32 v20, v20, v21
    v_cvt_pk_bf16_f32 v21, v22, v23
    v_mul_f32 v52, v52, v228
    v_mul_f32 v53, v53, v228
    v_mul_f32 v54, v54, v228
    v_mul_f32 v55, v55, v228
    v_cvt_pk_bf16_f32 v52, v52, v53
    v_cvt_pk_bf16_f32 v53, v54, v55
    v_xor_b32 v231, 0x50, v249
    ds_write2_b64 v231, v[20:21], v[52:53] offset0:0 offset1:16
    v_mul_f32 v24, v24, v228
    v_mul_f32 v25, v25, v228
    v_mul_f32 v26, v26, v228
    v_mul_f32 v27, v27, v228
    v_cvt_pk_bf16_f32 v24, v24, v25
    v_cvt_pk_bf16_f32 v25, v26, v27
    v_mul_f32 v56, v56, v228
    v_mul_f32 v57, v57, v228
    v_mul_f32 v58, v58, v228
    v_mul_f32 v59, v59, v228
    v_cvt_pk_bf16_f32 v56, v56, v57
    v_cvt_pk_bf16_f32 v57, v58, v59
    v_xor_b32 v230, 0x60, v249
    ds_write2_b64 v230, v[24:25], v[56:57] offset0:0 offset1:16
    v_mul_f32 v28, v28, v228
    v_mul_f32 v29, v29, v228
    v_mul_f32 v30, v30, v228
    v_mul_f32 v31, v31, v228
    v_cvt_pk_bf16_f32 v28, v28, v29
    v_cvt_pk_bf16_f32 v29, v30, v31
    v_mul_f32 v60, v60, v228
    v_mul_f32 v61, v61, v228
    v_mul_f32 v62, v62, v228
    v_mul_f32 v63, v63, v228
    v_cvt_pk_bf16_f32 v60, v60, v61
    v_cvt_pk_bf16_f32 v61, v62, v63
    v_xor_b32 v231, 0x70, v249
    ds_write2_b64 v231, v[28:29], v[60:61] offset0:0 offset1:16
    v_add_u32 v230, s59, v255
    ds_read_b128 a[208:211], v230 offset:0
    ds_read_b128 a[212:215], v230 offset:1024
    ds_read_b128 a[216:219], v230 offset:2048
    ds_read_b128 a[220:223], v230 offset:3072
    ds_read_b128 a[224:227], v230 offset:4096
    ds_read_b128 a[228:231], v230 offset:5120
    ds_read_b128 a[232:235], v230 offset:6144
    ds_read_b128 a[236:239], v230 offset:7168
    s_add_u32 s58, s36, 0
    v_add_u32 v247, s58, v250
    v_xor_b32 v248, 64, v247
    v_add_u32 v248, 0x4000, v248
    s_waitcnt lgkmcnt(7)
    buffer_store_dwordx4 a[208:211], v247, s[16:19], 0 offen offset:0 sc0 sc1
    v_add_u32 v247, 0x8000, v247
    s_waitcnt lgkmcnt(6)
    buffer_store_dwordx4 a[212:215], v248, s[16:19], 0 offen offset:0 sc0 sc1
    v_add_u32 v248, 0x8000, v248
    s_waitcnt lgkmcnt(5)
    buffer_store_dwordx4 a[216:219], v247, s[16:19], 0 offen offset:0 sc0 sc1
    v_add_u32 v247, 0x8000, v247
    s_waitcnt lgkmcnt(4)
    buffer_store_dwordx4 a[220:223], v248, s[16:19], 0 offen offset:0 sc0 sc1
    v_add_u32 v248, 0x8000, v248
    s_waitcnt lgkmcnt(3)
    buffer_store_dwordx4 a[224:227], v247, s[16:19], 0 offen offset:0 sc0 sc1
    v_add_u32 v247, 0x8000, v247
    s_waitcnt lgkmcnt(2)
    buffer_store_dwordx4 a[228:231], v248, s[16:19], 0 offen offset:0 sc0 sc1
    v_add_u32 v248, 0x8000, v248
    s_waitcnt lgkmcnt(1)
    buffer_store_dwordx4 a[232:235], v247, s[16:19], 0 offen offset:0 sc0 sc1
    s_waitcnt lgkmcnt(0)
    buffer_store_dwordx4 a[236:239], v248, s[16:19], 0 offen offset:0 sc0 sc1
    s_nop 1
    v_mul_f32 v64, v64, v229
    v_mul_f32 v65, v65, v229
    v_mul_f32 v66, v66, v229
    v_mul_f32 v67, v67, v229
    v_cvt_pk_bf16_f32 v64, v64, v65
    v_cvt_pk_bf16_f32 v65, v66, v67
    v_mul_f32 v96, v96, v229
    v_mul_f32 v97, v97, v229
    v_mul_f32 v98, v98, v229
    v_mul_f32 v99, v99, v229
    v_cvt_pk_bf16_f32 v96, v96, v97
    v_cvt_pk_bf16_f32 v97, v98, v99
    ds_write2_b64 v249, v[64:65], v[96:97] offset0:0 offset1:16
    v_mul_f32 v68, v68, v229
    v_mul_f32 v69, v69, v229
    v_mul_f32 v70, v70, v229
    v_mul_f32 v71, v71, v229
    v_cvt_pk_bf16_f32 v68, v68, v69
    v_cvt_pk_bf16_f32 v69, v70, v71
    v_mul_f32 v100, v100, v229
    v_mul_f32 v101, v101, v229
    v_mul_f32 v102, v102, v229
    v_mul_f32 v103, v103, v229
    v_cvt_pk_bf16_f32 v100, v100, v101
    v_cvt_pk_bf16_f32 v101, v102, v103
    v_xor_b32 v231, 16, v249
    ds_write2_b64 v231, v[68:69], v[100:101] offset0:0 offset1:16
    v_mul_f32 v72, v72, v229
    v_mul_f32 v73, v73, v229
    v_mul_f32 v74, v74, v229
    v_mul_f32 v75, v75, v229
    v_cvt_pk_bf16_f32 v72, v72, v73
    v_cvt_pk_bf16_f32 v73, v74, v75
    v_mul_f32 v104, v104, v229
    v_mul_f32 v105, v105, v229
    v_mul_f32 v106, v106, v229
    v_mul_f32 v107, v107, v229
    v_cvt_pk_bf16_f32 v104, v104, v105
    v_cvt_pk_bf16_f32 v105, v106, v107
    v_xor_b32 v230, 32, v249
    ds_write2_b64 v230, v[72:73], v[104:105] offset0:0 offset1:16
    v_mul_f32 v76, v76, v229
    v_mul_f32 v77, v77, v229
    v_mul_f32 v78, v78, v229
    v_mul_f32 v79, v79, v229
    v_cvt_pk_bf16_f32 v76, v76, v77
    v_cvt_pk_bf16_f32 v77, v78, v79
    v_mul_f32 v108, v108, v229
    v_mul_f32 v109, v109, v229
    v_mul_f32 v110, v110, v229
    v_mul_f32 v111, v111, v229
    v_cvt_pk_bf16_f32 v108, v108, v109
    v_cvt_pk_bf16_f32 v109, v110, v111
    v_xor_b32 v231, 48, v249
    ds_write2_b64 v231, v[76:77], v[108:109] offset0:0 offset1:16
    v_mul_f32 v80, v80, v229
    v_mul_f32 v81, v81, v229
    v_mul_f32 v82, v82, v229
    v_mul_f32 v83, v83, v229
    v_cvt_pk_bf16_f32 v80, v80, v81
    v_cvt_pk_bf16_f32 v81, v82, v83
    v_accvgpr_read_b32 v66, a0
    v_accvgpr_read_b32 v67, a1
    v_accvgpr_read_b32 v98, a2
    v_accvgpr_read_b32 v99, a3
    v_mul_f32 v66, v66, v229
    v_mul_f32 v67, v67, v229
    v_mul_f32 v98, v98, v229
    v_mul_f32 v99, v99, v229
    v_cvt_pk_bf16_f32 v66, v66, v67
    v_cvt_pk_bf16_f32 v67, v98, v99
    v_xor_b32 v230, 64, v249
    ds_write2_b64 v230, v[80:81], v[66:67] offset0:0 offset1:16
    v_mul_f32 v84, v84, v229
    v_mul_f32 v85, v85, v229
    v_mul_f32 v86, v86, v229
    v_mul_f32 v87, v87, v229
    v_cvt_pk_bf16_f32 v84, v84, v85
    v_cvt_pk_bf16_f32 v85, v86, v87
    v_accvgpr_read_b32 v70, a4
    v_accvgpr_read_b32 v71, a5
    v_accvgpr_read_b32 v102, a6
    v_accvgpr_read_b32 v103, a7
    v_mul_f32 v70, v70, v229
    v_mul_f32 v71, v71, v229
    v_mul_f32 v102, v102, v229
    v_mul_f32 v103, v103, v229
    v_cvt_pk_bf16_f32 v70, v70, v71
    v_cvt_pk_bf16_f32 v71, v102, v103
    v_xor_b32 v231, 0x50, v249
    ds_write2_b64 v231, v[84:85], v[70:71] offset0:0 offset1:16
    v_mul_f32 v88, v88, v229
    v_mul_f32 v89, v89, v229
    v_mul_f32 v90, v90, v229
    v_mul_f32 v91, v91, v229
    v_cvt_pk_bf16_f32 v88, v88, v89
    v_cvt_pk_bf16_f32 v89, v90, v91
    v_accvgpr_read_b32 v74, a8
    v_accvgpr_read_b32 v75, a9
    v_accvgpr_read_b32 v106, a10
    v_accvgpr_read_b32 v107, a11
    v_mul_f32 v74, v74, v229
    v_mul_f32 v75, v75, v229
    v_mul_f32 v106, v106, v229
    v_mul_f32 v107, v107, v229
    v_cvt_pk_bf16_f32 v74, v74, v75
    v_cvt_pk_bf16_f32 v75, v106, v107
    v_xor_b32 v230, 0x60, v249
    ds_write2_b64 v230, v[88:89], v[74:75] offset0:0 offset1:16
    v_mul_f32 v92, v92, v229
    v_mul_f32 v93, v93, v229
    v_mul_f32 v94, v94, v229
    v_mul_f32 v95, v95, v229
    v_cvt_pk_bf16_f32 v92, v92, v93
    v_cvt_pk_bf16_f32 v93, v94, v95
    v_accvgpr_read_b32 v78, a12
    v_accvgpr_read_b32 v79, a13
    v_accvgpr_read_b32 v110, a14
    v_accvgpr_read_b32 v111, a15
    v_mul_f32 v78, v78, v229
    v_mul_f32 v79, v79, v229
    v_mul_f32 v110, v110, v229
    v_mul_f32 v111, v111, v229
    v_cvt_pk_bf16_f32 v78, v78, v79
    v_cvt_pk_bf16_f32 v79, v110, v111
    v_xor_b32 v231, 0x70, v249
    ds_write2_b64 v231, v[92:93], v[78:79] offset0:0 offset1:16
    v_add_u32 v230, s59, v255
    ds_read_b128 a[208:211], v230 offset:0
    ds_read_b128 a[212:215], v230 offset:1024
    ds_read_b128 a[216:219], v230 offset:2048
    ds_read_b128 a[220:223], v230 offset:3072
    ds_read_b128 a[224:227], v230 offset:4096
    ds_read_b128 a[228:231], v230 offset:5120
    ds_read_b128 a[232:235], v230 offset:6144
    ds_read_b128 a[236:239], v230 offset:7168
    s_add_u32 s58, s36, 0x20000
    v_add_u32 v247, s58, v250
    v_xor_b32 v248, 64, v247
    v_add_u32 v248, 0x4000, v248
    s_waitcnt lgkmcnt(7)
    buffer_store_dwordx4 a[208:211], v247, s[16:19], 0 offen offset:0
    v_add_u32 v247, 0x8000, v247
    s_waitcnt lgkmcnt(6)
    buffer_store_dwordx4 a[212:215], v248, s[16:19], 0 offen offset:0
    v_add_u32 v248, 0x8000, v248
    s_waitcnt lgkmcnt(5)
    buffer_store_dwordx4 a[216:219], v247, s[16:19], 0 offen offset:0
    v_add_u32 v247, 0x8000, v247
    s_waitcnt lgkmcnt(4)
    buffer_store_dwordx4 a[220:223], v248, s[16:19], 0 offen offset:0
    v_add_u32 v248, 0x8000, v248
    s_waitcnt lgkmcnt(3)
    buffer_store_dwordx4 a[224:227], v247, s[16:19], 0 offen offset:0
    v_add_u32 v247, 0x8000, v247
    s_waitcnt lgkmcnt(2)
    buffer_store_dwordx4 a[228:231], v248, s[16:19], 0 offen offset:0
    v_add_u32 v248, 0x8000, v248
    s_waitcnt lgkmcnt(1)
    buffer_store_dwordx4 a[232:235], v247, s[16:19], 0 offen offset:0
    s_waitcnt lgkmcnt(0)
    buffer_store_dwordx4 a[236:239], v248, s[16:19], 0 offen offset:0
    s_cmp_lg_u32 s88, 0
    s_cbranch_scc1 L_gen_next
L_redo_next:
    s_add_u32 s94, s94, 32
    s_addc_u32 s95, s95, 0
    s_lshr_b32 s30, s30, 1
    s_cmp_lg_u32 s30, 0
    s_cbranch_scc1 L_redo
    s_branch L_done
L_generic:
    s_mov_b32 s88, 1
    s_sub_u32 s96, s2, 0x100
L_gen_next:
    s_add_u32 s96, s96, 0x100
    s_mov_b32 s46, s96
    s_waitcnt vmcnt(0) lgkmcnt(0)
    s_cmp_ge_u32 s96, 0x200
    s_cbranch_scc1 L_done
    s_mov_b32 s47, 0
    s_mov_b32 s58, s80
    s_sub_u32 s38, s58, s47
    s_add_u32 s38, s38, 63
    s_lshr_b32 s38, s38, 6
    s_lshl_b32 s38, s38, 2
    s_cmp_lt_u32 s46, s38
    s_cbranch_scc1 L_gen_found
    s_sub_u32 s46, s46, s38
    s_mov_b32 s47, s80
    s_mov_b32 s58, s81
    s_sub_u32 s38, s58, s47
    s_add_u32 s38, s38, 63
    s_lshr_b32 s38, s38, 6
    s_lshl_b32 s38, s38, 2
    s_cmp_lt_u32 s46, s38
    s_cbranch_scc1 L_gen_found
    s_sub_u32 s46, s46, s38
    s_mov_b32 s47, s81
    s_mov_b32 s58, s82
    s_sub_u32 s38, s58, s47
    s_add_u32 s38, s38, 63
    s_lshr_b32 s38, s38, 6
    s_lshl_b32 s38, s38, 2
    s_cmp_lt_u32 s46, s38
    s_cbranch_scc1 L_gen_found
    s_sub_u32 s46, s46, s38
    s_mov_b32 s47, s82
    s_mov_b32 s58, s83
    s_sub_u32 s38, s58, s47
    s_add_u32 s38, s38, 63
    s_lshr_b32 s38, s38, 6
    s_lshl_b32 s38, s38, 2
    s_cmp_lt_u32 s46, s38
    s_cbranch_scc1 L_gen_found
    s_sub_u32 s46, s46, s38
    s_mov_b32 s47, s83
    s_mov_b32 s58, s84
    s_sub_u32 s38, s58, s47
    s_add_u32 s38, s38, 63
    s_lshr_b32 s38, s38, 6
    s_lshl_b32 s38, s38, 2
    s_cmp_lt_u32 s46, s38
    s_cbranch_scc1 L_gen_found
    s_sub_u32 s46, s46, s38
    s_mov_b32 s47, s84
    s_mov_b32 s58, s85
    s_sub_u32 s38, s58, s47
    s_add_u32 s38, s38, 63
    s_lshr_b32 s38, s38, 6
    s_lshl_b32 s38, s38, 2
    s_cmp_lt_u32 s46, s38
    s_cbranch_scc1 L_gen_found
    s_sub_u32 s46, s46, s38
    s_mov_b32 s47, s85
    s_mov_b32 s58, s86
    s_sub_u32 s38, s58, s47
    s_add_u32 s38, s38, 63
    s_lshr_b32 s38, s38, 6
    s_lshl_b32 s38, s38, 2
    s_cmp_lt_u32 s46, s38
    s_cbranch_scc1 L_gen_found
    s_sub_u32 s46, s46, s38
    s_mov_b32 s47, s86
    s_mov_b32 s58, s87
    s_sub_u32 s38, s58, s47
    s_add_u32 s38, s38, 63
    s_lshr_b32 s38, s38, 6
    s_lshl_b32 s38, s38, 2
    s_cmp_lt_u32 s46, s38
    s_cbranch_scc1 L_gen_found
    s_sub_u32 s46, s46, s38
    s_branch L_done
L_gen_found:
    s_min_u32 s58, s58, 0x1c0c
    s_and_b32 s38, s46, 3
    s_lshr_b32 s39, s46, 2
    s_lshl_b32 s39, s39, 6
    s_add_u32 s48, s47, s39
    s_add_u32 s52, s48, 64
    s_min_u32 s52, s52, s58
    s_lshl_b32 s52, s52, 10
    s_lshl_b32 s48, s48, 12
    s_lshl_b32 s49, s38, 10
    s_add_u32 s48, s48, s49
    s_lshl_b32 s49, s47, 10
    s_lshl_b32 s38, s38, 8
    s_add_u32 s49, s49, s38
    s_lshl_b32 s50, s58, 12
    s_lshl_b32 s51, s39, 18
    s_or_b32 s51, s51, 0x100
    s_branch L_safe
L_done:
L_end:
    s_endpgm
L_mask_4:
    s_nop 7
    s_nop 3
    v_add_u32 v246, s34, v243
    v_cmp_gt_i32 vcc, 0, v246
    v_cmp_gt_i32 s[40:41], 1, v246
    v_cmp_gt_i32 s[42:43], 2, v246
    v_cndmask_b32 v112, v112, v242, vcc
    v_cmp_gt_i32 vcc, 3, v246
    v_cndmask_b32 v113, v113, v242, s[40:41]
    v_cmp_gt_i32 s[40:41], 8, v246
    v_cndmask_b32 v114, v114, v242, s[42:43]
    v_cmp_gt_i32 s[42:43], 9, v246
    v_cndmask_b32 v115, v115, v242, vcc
    v_cmp_gt_i32 vcc, 10, v246
    v_cndmask_b32 v116, v116, v242, s[40:41]
    v_cmp_gt_i32 s[40:41], 11, v246
    v_cndmask_b32 v117, v117, v242, s[42:43]
    v_cmp_gt_i32 s[42:43], 16, v246
    v_cndmask_b32 v118, v118, v242, vcc
    v_cmp_gt_i32 vcc, 17, v246
    v_cndmask_b32 v119, v119, v242, s[40:41]
    v_cmp_gt_i32 s[40:41], 18, v246
    v_cndmask_b32 v120, v120, v242, s[42:43]
    v_cmp_gt_i32 s[42:43], 19, v246
    v_cndmask_b32 v121, v121, v242, vcc
    v_cmp_gt_i32 vcc, 24, v246
    v_cndmask_b32 v122, v122, v242, s[40:41]
    v_cmp_gt_i32 s[40:41], 25, v246
    v_cndmask_b32 v123, v123, v242, s[42:43]
    v_cmp_gt_i32 s[42:43], 26, v246
    v_cndmask_b32 v124, v124, v242, vcc
    v_cmp_gt_i32 vcc, 27, v246
    v_cndmask_b32 v125, v125, v242, s[40:41]
    v_cmp_gt_i32 s[40:41], 32, v246
    v_cndmask_b32 v126, v126, v242, s[42:43]
    v_cmp_gt_i32 s[42:43], 33, v246
    v_cndmask_b32 v127, v127, v242, vcc
    v_cmp_gt_i32 vcc, 34, v246
    v_cndmask_b32 v128, v128, v242, s[40:41]
    v_cmp_gt_i32 s[40:41], 35, v246
    v_cndmask_b32 v129, v129, v242, s[42:43]
    v_cmp_gt_i32 s[42:43], 40, v246
    v_cndmask_b32 v130, v130, v242, vcc
    v_cmp_gt_i32 vcc, 41, v246
    v_cndmask_b32 v131, v131, v242, s[40:41]
    v_cmp_gt_i32 s[40:41], 42, v246
    v_cndmask_b32 v132, v132, v242, s[42:43]
    v_cmp_gt_i32 s[42:43], 43, v246
    v_cndmask_b32 v133, v133, v242, vcc
    v_cmp_gt_i32 vcc, 48, v246
    v_cndmask_b32 v134, v134, v242, s[40:41]
    v_cmp_gt_i32 s[40:41], 49, v246
    v_cndmask_b32 v135, v135, v242, s[42:43]
    v_cmp_gt_i32 s[42:43], 50, v246
    v_cndmask_b32 v136, v136, v242, vcc
    v_cmp_gt_i32 vcc, 51, v246
    v_cndmask_b32 v137, v137, v242, s[40:41]
    v_cmp_gt_i32 s[40:41], 56, v246
    v_cndmask_b32 v138, v138, v242, s[42:43]
    v_cmp_gt_i32 s[42:43], 57, v246
    v_cndmask_b32 v139, v139, v242, vcc
    v_cmp_gt_i32 vcc, 58, v246
    v_cndmask_b32 v140, v140, v242, s[40:41]
    v_cmp_gt_i32 s[40:41], 59, v246
    v_cndmask_b32 v141, v141, v242, s[42:43]
    s_nop 0
    v_cndmask_b32 v142, v142, v242, vcc
    s_nop 0
    v_cndmask_b32 v143, v143, v242, s[40:41]
    s_nop 1
    s_branch L_maskb_5
L_mask_6:
    s_nop 7
    s_nop 3
    v_add_u32 v246, s35, v243
    v_cmp_gt_i32 vcc, 0, v246
    v_cmp_gt_i32 s[40:41], 1, v246
    v_cmp_gt_i32 s[42:43], 2, v246
    v_cndmask_b32 v144, v144, v242, vcc
    v_cmp_gt_i32 vcc, 3, v246
    v_cndmask_b32 v145, v145, v242, s[40:41]
    v_cmp_gt_i32 s[40:41], 8, v246
    v_cndmask_b32 v146, v146, v242, s[42:43]
    v_cmp_gt_i32 s[42:43], 9, v246
    v_cndmask_b32 v147, v147, v242, vcc
    v_cmp_gt_i32 vcc, 10, v246
    v_cndmask_b32 v148, v148, v242, s[40:41]
    v_cmp_gt_i32 s[40:41], 11, v246
    v_cndmask_b32 v149, v149, v242, s[42:43]
    v_cmp_gt_i32 s[42:43], 16, v246
    v_cndmask_b32 v150, v150, v242, vcc
    v_cmp_gt_i32 vcc, 17, v246
    v_cndmask_b32 v151, v151, v242, s[40:41]
    v_cmp_gt_i32 s[40:41], 18, v246
    v_cndmask_b32 v152, v152, v242, s[42:43]
    v_cmp_gt_i32 s[42:43], 19, v246
    v_cndmask_b32 v153, v153, v242, vcc
    v_cmp_gt_i32 vcc, 24, v246
    v_cndmask_b32 v154, v154, v242, s[40:41]
    v_cmp_gt_i32 s[40:41], 25, v246
    v_cndmask_b32 v155, v155, v242, s[42:43]
    v_cmp_gt_i32 s[42:43], 26, v246
    v_cndmask_b32 v156, v156, v242, vcc
    v_cmp_gt_i32 vcc, 27, v246
    v_cndmask_b32 v157, v157, v242, s[40:41]
    v_cmp_gt_i32 s[40:41], 32, v246
    v_cndmask_b32 v158, v158, v242, s[42:43]
    v_cmp_gt_i32 s[42:43], 33, v246
    v_cndmask_b32 v159, v159, v242, vcc
    v_cmp_gt_i32 vcc, 34, v246
    v_cndmask_b32 v160, v160, v242, s[40:41]
    v_cmp_gt_i32 s[40:41], 35, v246
    v_cndmask_b32 v161, v161, v242, s[42:43]
    v_cmp_gt_i32 s[42:43], 40, v246
    v_cndmask_b32 v162, v162, v242, vcc
    v_cmp_gt_i32 vcc, 41, v246
    v_cndmask_b32 v163, v163, v242, s[40:41]
    v_cmp_gt_i32 s[40:41], 42, v246
    v_cndmask_b32 v164, v164, v242, s[42:43]
    v_cmp_gt_i32 s[42:43], 43, v246
    v_cndmask_b32 v165, v165, v242, vcc
    v_cmp_gt_i32 vcc, 48, v246
    v_cndmask_b32 v166, v166, v242, s[40:41]
    v_cmp_gt_i32 s[40:41], 49, v246
    v_cndmask_b32 v167, v167, v242, s[42:43]
    v_cmp_gt_i32 s[42:43], 50, v246
    v_cndmask_b32 v168, v168, v242, vcc
    v_cmp_gt_i32 vcc, 51, v246
    v_cndmask_b32 v169, v169, v242, s[40:41]
    v_cmp_gt_i32 s[40:41], 56, v246
    v_cndmask_b32 v170, v170, v242, s[42:43]
    v_cmp_gt_i32 s[42:43], 57, v246
    v_cndmask_b32 v171, v171, v242, vcc
    v_cmp_gt_i32 vcc, 58, v246
    v_cndmask_b32 v172, v172, v242, s[40:41]
    v_cmp_gt_i32 s[40:41], 59, v246
    v_cndmask_b32 v173, v173, v242, s[42:43]
    s_nop 0
    v_cndmask_b32 v174, v174, v242, vcc
    s_nop 0
    v_cndmask_b32 v175, v175, v242, s[40:41]
    s_nop 1
    s_branch L_maskb_7
L_mask_8:
    s_nop 7
    s_nop 3
    v_add_u32 v246, s34, v243
    v_cmp_gt_i32 vcc, 0, v246
    v_cmp_gt_i32 s[40:41], 1, v246
    v_cmp_gt_i32 s[42:43], 2, v246
    v_cndmask_b32 v112, v112, v242, vcc
    v_cmp_gt_i32 vcc, 3, v246
    v_cndmask_b32 v113, v113, v242, s[40:41]
    v_cmp_gt_i32 s[40:41], 8, v246
    v_cndmask_b32 v114, v114, v242, s[42:43]
    v_cmp_gt_i32 s[42:43], 9, v246
    v_cndmask_b32 v115, v115, v242, vcc
    v_cmp_gt_i32 vcc, 10, v246
    v_cndmask_b32 v116, v116, v242, s[40:41]
    v_cmp_gt_i32 s[40:41], 11, v246
    v_cndmask_b32 v117, v117, v242, s[42:43]
    v_cmp_gt_i32 s[42:43], 16, v246
    v_cndmask_b32 v118, v118, v242, vcc
    v_cmp_gt_i32 vcc, 17, v246
    v_cndmask_b32 v119, v119, v242, s[40:41]
    v_cmp_gt_i32 s[40:41], 18, v246
    v_cndmask_b32 v120, v120, v242, s[42:43]
    v_cmp_gt_i32 s[42:43], 19, v246
    v_cndmask_b32 v121, v121, v242, vcc
    v_cmp_gt_i32 vcc, 24, v246
    v_cndmask_b32 v122, v122, v242, s[40:41]
    v_cmp_gt_i32 s[40:41], 25, v246
    v_cndmask_b32 v123, v123, v242, s[42:43]
    v_cmp_gt_i32 s[42:43], 26, v246
    v_cndmask_b32 v124, v124, v242, vcc
    v_cmp_gt_i32 vcc, 27, v246
    v_cndmask_b32 v125, v125, v242, s[40:41]
    v_cmp_gt_i32 s[40:41], 32, v246
    v_cndmask_b32 v126, v126, v242, s[42:43]
    v_cmp_gt_i32 s[42:43], 33, v246
    v_cndmask_b32 v127, v127, v242, vcc
    v_cmp_gt_i32 vcc, 34, v246
    v_cndmask_b32 v128, v128, v242, s[40:41]
    v_cmp_gt_i32 s[40:41], 35, v246
    v_cndmask_b32 v129, v129, v242, s[42:43]
    v_cmp_gt_i32 s[42:43], 40, v246
    v_cndmask_b32 v130, v130, v242, vcc
    v_cmp_gt_i32 vcc, 41, v246
    v_cndmask_b32 v131, v131, v242, s[40:41]
    v_cmp_gt_i32 s[40:41], 42, v246
    v_cndmask_b32 v132, v132, v242, s[42:43]
    v_cmp_gt_i32 s[42:43], 43, v246
    v_cndmask_b32 v133, v133, v242, vcc
    v_cmp_gt_i32 vcc, 48, v246
    v_cndmask_b32 v134, v134, v242, s[40:41]
    v_cmp_gt_i32 s[40:41], 49, v246
    v_cndmask_b32 v135, v135, v242, s[42:43]
    v_cmp_gt_i32 s[42:43], 50, v246
    v_cndmask_b32 v136, v136, v242, vcc
    v_cmp_gt_i32 vcc, 51, v246
    v_cndmask_b32 v137, v137, v242, s[40:41]
    v_cmp_gt_i32 s[40:41], 56, v246
    v_cndmask_b32 v138, v138, v242, s[42:43]
    v_cmp_gt_i32 s[42:43], 57, v246
    v_cndmask_b32 v139, v139, v242, vcc
    v_cmp_gt_i32 vcc, 58, v246
    v_cndmask_b32 v140, v140, v242, s[40:41]
    v_cmp_gt_i32 s[40:41], 59, v246
    v_cndmask_b32 v141, v141, v242, s[42:43]
    s_nop 0
    v_cndmask_b32 v142, v142, v242, vcc
    s_nop 0
    v_cndmask_b32 v143, v143, v242, s[40:41]
    s_nop 1
    s_branch L_maskb_9
L_mask_10:
    s_nop 7
    s_nop 3
    v_add_u32 v246, s35, v243
    v_cmp_gt_i32 vcc, 0, v246
    v_cmp_gt_i32 s[40:41], 1, v246
    v_cmp_gt_i32 s[42:43], 2, v246
    v_cndmask_b32 v144, v144, v242, vcc
    v_cmp_gt_i32 vcc, 3, v246
    v_cndmask_b32 v145, v145, v242, s[40:41]
    v_cmp_gt_i32 s[40:41], 8, v246
    v_cndmask_b32 v146, v146, v242, s[42:43]
    v_cmp_gt_i32 s[42:43], 9, v246
    v_cndmask_b32 v147, v147, v242, vcc
    v_cmp_gt_i32 vcc, 10, v246
    v_cndmask_b32 v148, v148, v242, s[40:41]
    v_cmp_gt_i32 s[40:41], 11, v246
    v_cndmask_b32 v149, v149, v242, s[42:43]
    v_cmp_gt_i32 s[42:43], 16, v246
    v_cndmask_b32 v150, v150, v242, vcc
    v_cmp_gt_i32 vcc, 17, v246
    v_cndmask_b32 v151, v151, v242, s[40:41]
    v_cmp_gt_i32 s[40:41], 18, v246
    v_cndmask_b32 v152, v152, v242, s[42:43]
    v_cmp_gt_i32 s[42:43], 19, v246
    v_cndmask_b32 v153, v153, v242, vcc
    v_cmp_gt_i32 vcc, 24, v246
    v_cndmask_b32 v154, v154, v242, s[40:41]
    v_cmp_gt_i32 s[40:41], 25, v246
    v_cndmask_b32 v155, v155, v242, s[42:43]
    v_cmp_gt_i32 s[42:43], 26, v246
    v_cndmask_b32 v156, v156, v242, vcc
    v_cmp_gt_i32 vcc, 27, v246
    v_cndmask_b32 v157, v157, v242, s[40:41]
    v_cmp_gt_i32 s[40:41], 32, v246
    v_cndmask_b32 v158, v158, v242, s[42:43]
    v_cmp_gt_i32 s[42:43], 33, v246
    v_cndmask_b32 v159, v159, v242, vcc
    v_cmp_gt_i32 vcc, 34, v246
    v_cndmask_b32 v160, v160, v242, s[40:41]
    v_cmp_gt_i32 s[40:41], 35, v246
    v_cndmask_b32 v161, v161, v242, s[42:43]
    v_cmp_gt_i32 s[42:43], 40, v246
    v_cndmask_b32 v162, v162, v242, vcc
    v_cmp_gt_i32 vcc, 41, v246
    v_cndmask_b32 v163, v163, v242, s[40:41]
    v_cmp_gt_i32 s[40:41], 42, v246
    v_cndmask_b32 v164, v164, v242, s[42:43]
    v_cmp_gt_i32 s[42:43], 43, v246
    v_cndmask_b32 v165, v165, v242, vcc
    v_cmp_gt_i32 vcc, 48, v246
    v_cndmask_b32 v166, v166, v242, s[40:41]
    v_cmp_gt_i32 s[40:41], 49, v246
    v_cndmask_b32 v167, v167, v242, s[42:43]
    v_cmp_gt_i32 s[42:43], 50, v246
    v_cndmask_b32 v168, v168, v242, vcc
    v_cmp_gt_i32 vcc, 51, v246
    v_cndmask_b32 v169, v169, v242, s[40:41]
    v_cmp_gt_i32 s[40:41], 56, v246
    v_cndmask_b32 v170, v170, v242, s[42:43]
    v_cmp_gt_i32 s[42:43], 57, v246
    v_cndmask_b32 v171, v171, v242, vcc
    v_cmp_gt_i32 vcc, 58, v246
    v_cndmask_b32 v172, v172, v242, s[40:41]
    v_cmp_gt_i32 s[40:41], 59, v246
    v_cndmask_b32 v173, v173, v242, s[42:43]
    s_nop 0
    v_cndmask_b32 v174, v174, v242, vcc
    s_nop 0
    v_cndmask_b32 v175, v175, v242, s[40:41]
    s_nop 1
    s_branch L_maskb_11
L_event_0:
    s_mov_b32 s38, s10
    s_mov_b32 s10, 0x703000
    s_mov_b32 s14, 0x703000
    s_add_u32 s39, s90, s93
    buffer_load_dword a244, v252, s[8:11], s39 offen offset:0
    buffer_load_dword a244, v252, s[12:15], s39 offen offset:0
    s_mov_b32 s10, s38
    s_mov_b32 s14, s38
    s_and_b32 s38, s91, 0xffffff00
    s_add_u32 s90, s90, s38
    s_sub_u32 s91, s91, 1
    s_sub_u32 s92, s23, 1
    s_and_b32 s38, s91, 0xff
    s_cmp_eq_u32 s38, 0
    s_cselect_b32 s92, 1, s92
    s_branch L_mid0_0
L_event_1:
    s_mov_b32 s38, s10
    s_mov_b32 s10, 0x703000
    s_mov_b32 s14, 0x703000
    s_add_u32 s39, s90, s93
    buffer_load_dword a244, v252, s[8:11], s39 offen offset:0
    buffer_load_dword a244, v252, s[12:15], s39 offen offset:0
    s_mov_b32 s10, s38
    s_mov_b32 s14, s38
    s_and_b32 s38, s91, 0xffffff00
    s_add_u32 s90, s90, s38
    s_sub_u32 s91, s91, 1
    s_sub_u32 s92, s23, 1
    s_and_b32 s38, s91, 0xff
    s_cmp_eq_u32 s38, 0
    s_cselect_b32 s92, 1, s92
    s_branch L_mid1_0
.p2align 7
.type sched_table,@object
sched_table:
    .long 0x987000, 0x141c00, 0xbf7000, 0x12000113, 0x271c00, 0xfffffb80, 0x0, 0x0, 0x0, 0x0, 0x0, 0x0, 0x0, 0x0, 0x0, 0x0, 0x0, 0x0, 0x0, 0x0, 0x0, 0x0, 0x0, 0x0, 0x0, 0x0, 0x0, 0x0, 0x0, 0x0, 0x0, 0x0, 0x0, 0x0, 0x0, 0x0, 0x0, 0x0, 0x0, 0x0
    .long 0x987400, 0x141d00, 0xbf7000, 0x12000113, 0x271c00, 0xfffffb80, 0x0, 0x0, 0x0, 0x0, 0x0, 0x0, 0x0, 0x0, 0x0, 0x0, 0x0, 0x0, 0x0, 0x0, 0x0, 0x0, 0x0, 0x0, 0x0, 0x0, 0x0, 0x0, 0x0, 0x0, 0x0, 0x0, 0x0, 0x0, 0x0, 0x0, 0x0, 0x0, 0x0, 0x0
    .long 0x987800, 0x141e00, 0xbf7000, 0x12000113, 0x271c00, 0xfffffb80, 0x0, 0x0, 0x0, 0x0, 0x0, 0x0, 0x0, 0x0, 0x0, 0x0, 0x0, 0x0, 0x0, 0x0, 0x0, 0x0, 0x0, 0x0, 0x0, 0x0, 0x0, 0x0, 0x0, 0x0, 0x0, 0x0, 0x0, 0x0, 0x0, 0x0, 0x0, 0x0, 0x0, 0x0
    .long 0x987c00, 0x141f00, 0xbf7000, 0x12000113, 0x271c00, 0xfffffb80, 0x0, 0x0, 0x0, 0x0, 0x0, 0x0, 0x0, 0x0, 0x0, 0x0, 0x0, 0x0, 0x0, 0x0, 0x0, 0x0, 0x0, 0x0, 0x0, 0x0, 0x0, 0x0, 0x0, 0x0, 0x0, 0x0, 0x0, 0x0, 0x0, 0x0, 0x0, 0x0, 0x0, 0x0
    .long 0x1967000, 0x539c00, 0x1c0c000, 0x12000113, 0x669c00, 0xfffffb80, 0x0, 0x0, 0x0, 0x0, 0x0, 0x0, 0x0, 0x0, 0x0, 0x0, 0x0, 0x0, 0x0, 0x0, 0x0, 0x0, 0x0, 0x0, 0x0, 0x0, 0x0, 0x0, 0x0, 0x0, 0x0, 0x0, 0x0, 0x0, 0x0, 0x0, 0x0, 0x0, 0x0, 0x0
    .long 0x1967400, 0x539d00, 0x1c0c000, 0x12000113, 0x669c00, 0xfffffb80, 0x0, 0x0, 0x0, 0x0, 0x0, 0x0, 0x0, 0x0, 0x0, 0x0, 0x0, 0x0, 0x0, 0x0, 0x0, 0x0, 0x0, 0x0, 0x0, 0x0, 0x0, 0x0, 0x0, 0x0, 0x0, 0x0, 0x0, 0x0, 0x0, 0x0, 0x0, 0x0, 0x0, 0x0
    .long 0x1967800, 0x539e00, 0x1c0c000, 0x12000113, 0x669c00, 0xfffffb80, 0x0, 0x0, 0x0, 0x0, 0x0, 0x0, 0x0, 0x0, 0x0, 0x0, 0x0, 0x0, 0x0, 0x0, 0x0, 0x0, 0x0, 0x0, 0x0, 0x0, 0x0, 0x0, 0x0, 0x0, 0x0, 0x0, 0x0, 0x0, 0x0, 0x0, 0x0, 0x0, 0x0, 0x0
    .long 0x1967c00, 0x539f00, 0x1c0c000, 0x12000113, 0x669c00, 0xfffffb80, 0x0, 0x0, 0x0, 0x0, 0x0, 0x0, 0x0, 0x0, 0x0, 0x0, 0x0, 0x0, 0x0, 0x0, 0x0, 0x0, 0x0, 0x0, 0x0, 0x0, 0x0, 0x0, 0x0, 0x0, 0x0, 0x0, 0x0, 0x0, 0x0, 0x0, 0x0, 0x0, 0x0, 0x0
    .long 0x9c7000, 0x141c00, 0xbf7000, 0x13000114, 0x281c00, 0xfffffb40, 0x0, 0x0, 0x0, 0x0, 0x0, 0x0, 0x0, 0x0, 0x0, 0x0, 0x0, 0x0, 0x0, 0x0, 0x0, 0x0, 0x0, 0x0, 0x0, 0x0, 0x0, 0x0, 0x0, 0x0, 0x0, 0x0, 0x0, 0x0, 0x0, 0x0, 0x0, 0x0, 0x0, 0x0
    .long 0x9c7400, 0x141d00, 0xbf7000, 0x13000114, 0x281c00, 0xfffffb40, 0x0, 0x0, 0x0, 0x0, 0x0, 0x0, 0x0, 0x0, 0x0, 0x0, 0x0, 0x0, 0x0, 0x0, 0x0, 0x0, 0x0, 0x0, 0x0, 0x0, 0x0, 0x0, 0x0, 0x0, 0x0, 0x0, 0x0, 0x0, 0x0, 0x0, 0x0, 0x0, 0x0, 0x0
    .long 0x9c7800, 0x141e00, 0xbf7000, 0x13000114, 0x281c00, 0xfffffb40, 0x0, 0x0, 0x0, 0x0, 0x0, 0x0, 0x0, 0x0, 0x0, 0x0, 0x0, 0x0, 0x0, 0x0, 0x0, 0x0, 0x0, 0x0, 0x0, 0x0, 0x0, 0x0, 0x0, 0x0, 0x0, 0x0, 0x0, 0x0, 0x0, 0x0, 0x0, 0x0, 0x0, 0x0
    .long 0x9c7c00, 0x141f00, 0xbf7000, 0x13000114, 0x281c00, 0xfffffb40, 0x0, 0x0, 0x0, 0x0, 0x0, 0x0, 0x0, 0x0, 0x0, 0x0, 0x0, 0x0, 0x0, 0x0, 0x0, 0x0, 0x0, 0x0, 0x0, 0x0, 0x0, 0x0, 0x0, 0x0, 0x0, 0x0, 0x0, 0x0, 0x0, 0x0, 0x0, 0x0, 0x0, 0x0
    .long 0x19a7000, 0x539c00, 0x1c0c000, 0x13000114, 0x679c00, 0xfffffb40, 0x0, 0x0, 0x0, 0x0, 0x0, 0x0, 0x0, 0x0, 0x0, 0x0, 0x0, 0x0, 0x0, 0x0, 0x0, 0x0, 0x0, 0x0, 0x0, 0x0, 0x0, 0x0, 0x0, 0x0, 0x0, 0x0, 0x0, 0x0, 0x0, 0x0, 0x0, 0x0, 0x0, 0x0
    .long 0x19a7400, 0x539d00, 0x1c0c000, 0x13000114, 0x679c00, 0xfffffb40, 0x0, 0x0, 0x0, 0x0, 0x0, 0x0, 0x0, 0x0, 0x0, 0x0, 0x0, 0x0, 0x0, 0x0, 0x0, 0x0, 0x0, 0x0, 0x0, 0x0, 0x0, 0x0, 0x0, 0x0, 0x0, 0x0, 0x0, 0x0, 0x0, 0x0, 0x0, 0x0, 0x0, 0x0
    .long 0x19a7800, 0x539e00, 0x1c0c000, 0x13000114, 0x679c00, 0xfffffb40, 0x0, 0x0, 0x0, 0x0, 0x0, 0x0, 0x0, 0x0, 0x0, 0x0, 0x0, 0x0, 0x0, 0x0, 0x0, 0x0, 0x0, 0x0, 0x0, 0x0, 0x0, 0x0, 0x0, 0x0, 0x0, 0x0, 0x0, 0x0, 0x0, 0x0, 0x0, 0x0, 0x0, 0x0
    .long 0x19a7c00, 0x539f00, 0x1c0c000, 0x13000114, 0x679c00, 0xfffffb40, 0x0, 0x0, 0x0, 0x0, 0x0, 0x0, 0x0, 0x0, 0x0, 0x0, 0x0, 0x0, 0x0, 0x0, 0x0, 0x0, 0x0, 0x0, 0x0, 0x0, 0x0, 0x0, 0x0, 0x0, 0x0, 0x0, 0x0, 0x0, 0x0, 0x0, 0x0, 0x0, 0x0, 0x0
    .long 0xa07000, 0x141c00, 0xbf7000, 0x14000115, 0x291c00, 0xfffffb00, 0x0, 0x0, 0x0, 0x0, 0x0, 0x0, 0x0, 0x0, 0x0, 0x0, 0x0, 0x0, 0x0, 0x0, 0x0, 0x0, 0x0, 0x0, 0x0, 0x0, 0x0, 0x0, 0x0, 0x0, 0x0, 0x0, 0x0, 0x0, 0x0, 0x0, 0x0, 0x0, 0x0, 0x0
    .long 0xa07400, 0x141d00, 0xbf7000, 0x14000115, 0x291c00, 0xfffffb00, 0x0, 0x0, 0x0, 0x0, 0x0, 0x0, 0x0, 0x0, 0x0, 0x0, 0x0, 0x0, 0x0, 0x0, 0x0, 0x0, 0x0, 0x0, 0x0, 0x0, 0x0, 0x0, 0x0, 0x0, 0x0, 0x0, 0x0, 0x0, 0x0, 0x0, 0x0, 0x0, 0x0, 0x0
    .long 0xa07800, 0x141e00, 0xbf7000, 0x14000115, 0x291c00, 0xfffffb00, 0x0, 0x0, 0x0, 0x0, 0x0, 0x0, 0x0, 0x0, 0x0, 0x0, 0x0, 0x0, 0x0, 0x0, 0x0, 0x0, 0x0, 0x0, 0x0, 0x0, 0x0, 0x0, 0x0, 0x0, 0x0, 0x0, 0x0, 0x0, 0x0, 0x0, 0x0, 0x0, 0x0, 0x0
    .long 0xa07c00, 0x141f00, 0xbf7000, 0x14000115, 0x291c00, 0xfffffb00, 0x0, 0x0, 0x0, 0x0, 0x0, 0x0, 0x0, 0x0, 0x0, 0x0, 0x0, 0x0, 0x0, 0x0, 0x0, 0x0, 0x0, 0x0, 0x0, 0x0, 0x0, 0x0, 0x0, 0x0, 0x0, 0x0, 0x0, 0x0, 0x0, 0x0, 0x0, 0x0, 0x0, 0x0
    .long 0x19e7000, 0x539c00, 0x1c0c000, 0x14000115, 0x689c00, 0xfffffb00, 0x0, 0x0, 0x0, 0x0, 0x0, 0x0, 0x0, 0x0, 0x0, 0x0, 0x0, 0x0, 0x0, 0x0, 0x0, 0x0, 0x0, 0x0, 0x0, 0x0, 0x0, 0x0, 0x0, 0x0, 0x0, 0x0, 0x0, 0x0, 0x0, 0x0, 0x0, 0x0, 0x0, 0x0
    .long 0x19e7400, 0x539d00, 0x1c0c000, 0x14000115, 0x689c00, 0xfffffb00, 0x0, 0x0, 0x0, 0x0, 0x0, 0x0, 0x0, 0x0, 0x0, 0x0, 0x0, 0x0, 0x0, 0x0, 0x0, 0x0, 0x0, 0x0, 0x0, 0x0, 0x0, 0x0, 0x0, 0x0, 0x0, 0x0, 0x0, 0x0, 0x0, 0x0, 0x0, 0x0, 0x0, 0x0
    .long 0x19e7800, 0x539e00, 0x1c0c000, 0x14000115, 0x689c00, 0xfffffb00, 0x0, 0x0, 0x0, 0x0, 0x0, 0x0, 0x0, 0x0, 0x0, 0x0, 0x0, 0x0, 0x0, 0x0, 0x0, 0x0, 0x0, 0x0, 0x0, 0x0, 0x0, 0x0, 0x0, 0x0, 0x0, 0x0, 0x0, 0x0, 0x0, 0x0, 0x0, 0x0, 0x0, 0x0
    .long 0x19e7c00, 0x539f00, 0x1c0c000, 0x14000115, 0x689c00, 0xfffffb00, 0x0, 0x0, 0x0, 0x0, 0x0, 0x0, 0x0, 0x0, 0x0, 0x0, 0x0, 0x0, 0x0, 0x0, 0x0, 0x0, 0x0, 0x0, 0x0, 0x0, 0x0, 0x0, 0x0, 0x0, 0x0, 0x0, 0x0, 0x0, 0x0, 0x0, 0x0, 0x0, 0x0, 0x0
    .long 0xa47000, 0x141c00, 0xbf7000, 0x15000116, 0x2a1c00, 0xfffffac0, 0x0, 0x0, 0x0, 0x0, 0x0, 0x0, 0x0, 0x0, 0x0, 0x0, 0x0, 0x0, 0x0, 0x0, 0x0, 0x0, 0x0, 0x0, 0x0, 0x0, 0x0, 0x0, 0x0, 0x0, 0x0, 0x0, 0x0, 0x0, 0x0, 0x0, 0x0, 0x0, 0x0, 0x0
    .long 0xa47400, 0x141d00, 0xbf7000, 0x15000116, 0x2a1c00, 0xfffffac0, 0x0, 0x0, 0x0, 0x0, 0x0, 0x0, 0x0, 0x0, 0x0, 0x0, 0x0, 0x0, 0x0, 0x0, 0x0, 0x0, 0x0, 0x0, 0x0, 0x0, 0x0, 0x0, 0x0, 0x0, 0x0, 0x0, 0x0, 0x0, 0x0, 0x0, 0x0, 0x0, 0x0, 0x0
    .long 0xa47800, 0x141e00, 0xbf7000, 0x15000116, 0x2a1c00, 0xfffffac0, 0x0, 0x0, 0x0, 0x0, 0x0, 0x0, 0x0, 0x0, 0x0, 0x0, 0x0, 0x0, 0x0, 0x0, 0x0, 0x0, 0x0, 0x0, 0x0, 0x0, 0x0, 0x0, 0x0, 0x0, 0x0, 0x0, 0x0, 0x0, 0x0, 0x0, 0x0, 0x0, 0x0, 0x0
    .long 0xa47c00, 0x141f00, 0xbf7000, 0x15000116, 0x2a1c00, 0xfffffac0, 0x0, 0x0, 0x0, 0x0, 0x0, 0x0, 0x0, 0x0, 0x0, 0x0, 0x0, 0x0, 0x0, 0x0, 0x0, 0x0, 0x0, 0x0, 0x0, 0x0, 0x0, 0x0, 0x0, 0x0, 0x0, 0x0, 0x0, 0x0, 0x0, 0x0, 0x0, 0x0, 0x0, 0x0
    .long 0x18e7000, 0x539c00, 0x1c0c000, 0x10010111, 0x649c00, 0xfffffc00, 0x0, 0x0, 0x14e7000, 0x539c00, 0x1c0c000, 0x101, 0x549c00, 0x0, 0x0, 0x0, 0x0, 0x0, 0x0, 0x0, 0x0, 0x0, 0x0, 0x0, 0x0, 0x0, 0x0, 0x0, 0x0, 0x0, 0x0, 0x0, 0x0, 0x0, 0x0, 0x0, 0x0, 0x0, 0x0, 0x0
    .long 0x18e7400, 0x539d00, 0x1c0c000, 0x10010111, 0x649c00, 0xfffffc00, 0x0, 0x0, 0x14e7400, 0x539d00, 0x1c0c000, 0x101, 0x549c00, 0x0, 0x0, 0x0, 0x0, 0x0, 0x0, 0x0, 0x0, 0x0, 0x0, 0x0, 0x0, 0x0, 0x0, 0x0, 0x0, 0x0, 0x0, 0x0, 0x0, 0x0, 0x0, 0x0, 0x0, 0x0, 0x0, 0x0
    .long 0x18e7800, 0x539e00, 0x1c0c000, 0x10010111, 0x649c00, 0xfffffc00, 0x0, 0x0, 0x14e7800, 0x539e00, 0x1c0c000, 0x101, 0x549c00, 0x0, 0x0, 0x0, 0x0, 0x0, 0x0, 0x0, 0x0, 0x0, 0x0, 0x0, 0x0, 0x0, 0x0, 0x0, 0x0, 0x0, 0x0, 0x0, 0x0, 0x0, 0x0, 0x0, 0x0, 0x0, 0x0, 0x0
    .long 0x18e7c00, 0x539f00, 0x1c0c000, 0x10010111, 0x649c00, 0xfffffc00, 0x0, 0x0, 0x14e7c00, 0x539f00, 0x1c0c000, 0x101, 0x549c00, 0x0, 0x0, 0x0, 0x0, 0x0, 0x0, 0x0, 0x0, 0x0, 0x0, 0x0, 0x0, 0x0, 0x0, 0x0, 0x0, 0x0, 0x0, 0x0, 0x0, 0x0, 0x0, 0x0, 0x0, 0x0, 0x0, 0x0
    .long 0x947000, 0x141c00, 0xbf7000, 0x11010112, 0x261c00, 0xfffffbc0, 0x0, 0x0, 0x12c1000, 0x4a0400, 0x14e7000, 0x1000102, 0x4c0400, 0xffffffc0, 0x0, 0x0, 0x0, 0x0, 0x0, 0x0, 0x0, 0x0, 0x0, 0x0, 0x0, 0x0, 0x0, 0x0, 0x0, 0x0, 0x0, 0x0, 0x0, 0x0, 0x0, 0x0, 0x0, 0x0, 0x0, 0x0
    .long 0x947400, 0x141d00, 0xbf7000, 0x11010112, 0x261c00, 0xfffffbc0, 0x0, 0x0, 0x12c1400, 0x4a0500, 0x14e7000, 0x1000102, 0x4c0400, 0xffffffc0, 0x0, 0x0, 0x0, 0x0, 0x0, 0x0, 0x0, 0x0, 0x0, 0x0, 0x0, 0x0, 0x0, 0x0, 0x0, 0x0, 0x0, 0x0, 0x0, 0x0, 0x0, 0x0, 0x0, 0x0, 0x0, 0x0
    .long 0x947800, 0x141e00, 0xbf7000, 0x11010112, 0x261c00, 0xfffffbc0, 0x0, 0x0, 0x12c1800, 0x4a0600, 0x14e7000, 0x1000102, 0x4c0400, 0xffffffc0, 0x0, 0x0, 0x0, 0x0, 0x0, 0x0, 0x0, 0x0, 0x0, 0x0, 0x0, 0x0, 0x0, 0x0, 0x0, 0x0, 0x0, 0x0, 0x0, 0x0, 0x0, 0x0, 0x0, 0x0, 0x0, 0x0
    .long 0x947c00, 0x141f00, 0xbf7000, 0x11010112, 0x261c00, 0xfffffbc0, 0x0, 0x0, 0x12c1c00, 0x4a0700, 0x14e7000, 0x1000102, 0x4c0400, 0xffffffc0, 0x0, 0x0, 0x0, 0x0, 0x0, 0x0, 0x0, 0x0, 0x0, 0x0, 0x0, 0x0, 0x0, 0x0, 0x0, 0x0, 0x0, 0x0, 0x0, 0x0, 0x0, 0x0, 0x0, 0x0, 0x0, 0x0
    .long 0x1927000, 0x539c00, 0x1c0c000, 0x11010112, 0x659c00, 0xfffffbc0, 0x0, 0x0, 0xbf7000, 0x2fdc00, 0xd35000, 0x101, 0x30dc00, 0x0, 0x0, 0x0, 0x0, 0x0, 0x0, 0x0, 0x0, 0x0, 0x0, 0x0, 0x0, 0x0, 0x0, 0x0, 0x0, 0x0, 0x0, 0x0, 0x0, 0x0, 0x0, 0x0, 0x0, 0x0, 0x0, 0x0
    .long 0x1927400, 0x539d00, 0x1c0c000, 0x11010112, 0x659c00, 0xfffffbc0, 0x0, 0x0, 0xbf7400, 0x2fdd00, 0xd35000, 0x101, 0x30dc00, 0x0, 0x0, 0x0, 0x0, 0x0, 0x0, 0x0, 0x0, 0x0, 0x0, 0x0, 0x0, 0x0, 0x0, 0x0, 0x0, 0x0, 0x0, 0x0, 0x0, 0x0, 0x0, 0x0, 0x0, 0x0, 0x0, 0x0
    .long 0x1927800, 0x539e00, 0x1c0c000, 0x11010112, 0x659c00, 0xfffffbc0, 0x0, 0x0, 0xbf7800, 0x2fde00, 0xd35000, 0x101, 0x30dc00, 0x0, 0x0, 0x0, 0x0, 0x0, 0x0, 0x0, 0x0, 0x0, 0x0, 0x0, 0x0, 0x0, 0x0, 0x0, 0x0, 0x0, 0x0, 0x0, 0x0, 0x0, 0x0, 0x0, 0x0, 0x0, 0x0, 0x0
    .long 0x1927c00, 0x539f00, 0x1c0c000, 0x11010112, 0x659c00, 0xfffffbc0, 0x0, 0x0, 0xbf7c00, 0x2fdf00, 0xd35000, 0x101, 0x30dc00, 0x0, 0x0, 0x0, 0x0, 0x0, 0x0, 0x0, 0x0, 0x0, 0x0, 0x0, 0x0, 0x0, 0x0, 0x0, 0x0, 0x0, 0x0, 0x0, 0x0, 0x0, 0x0, 0x0, 0x0, 0x0, 0x0, 0x0
    .long 0x907000, 0x141c00, 0xbf7000, 0x10010111, 0x251c00, 0xfffffc00, 0x0, 0x0, 0x1301000, 0x4a0400, 0x14e7000, 0x2000103, 0x4d0400, 0xffffff80, 0x0, 0x0, 0x0, 0x0, 0x0, 0x0, 0x0, 0x0, 0x0, 0x0, 0x0, 0x0, 0x0, 0x0, 0x0, 0x0, 0x0, 0x0, 0x0, 0x0, 0x0, 0x0, 0x0, 0x0, 0x0, 0x0
    .long 0x907400, 0x141d00, 0xbf7000, 0x10010111, 0x251c00, 0xfffffc00, 0x0, 0x0, 0x1301400, 0x4a0500, 0x14e7000, 0x2000103, 0x4d0400, 0xffffff80, 0x0, 0x0, 0x0, 0x0, 0x0, 0x0, 0x0, 0x0, 0x0, 0x0, 0x0, 0x0, 0x0, 0x0, 0x0, 0x0, 0x0, 0x0, 0x0, 0x0, 0x0, 0x0, 0x0, 0x0, 0x0, 0x0
    .long 0x907800, 0x141e00, 0xbf7000, 0x10010111, 0x251c00, 0xfffffc00, 0x0, 0x0, 0x1301800, 0x4a0600, 0x14e7000, 0x2000103, 0x4d0400, 0xffffff80, 0x0, 0x0, 0x0, 0x0, 0x0, 0x0, 0x0, 0x0, 0x0, 0x0, 0x0, 0x0, 0x0, 0x0, 0x0, 0x0, 0x0, 0x0, 0x0, 0x0, 0x0, 0x0, 0x0, 0x0, 0x0, 0x0
    .long 0x907c00, 0x141f00, 0xbf7000, 0x10010111, 0x251c00, 0xfffffc00, 0x0, 0x0, 0x1301c00, 0x4a0700, 0x14e7000, 0x2000103, 0x4d0400, 0xffffff80, 0x0, 0x0, 0x0, 0x0, 0x0, 0x0, 0x0, 0x0, 0x0, 0x0, 0x0, 0x0, 0x0, 0x0, 0x0, 0x0, 0x0, 0x0, 0x0, 0x0, 0x0, 0x0, 0x0, 0x0, 0x0, 0x0
    .long 0x18a7000, 0x539c00, 0x1c0c000, 0xf010110, 0x639c00, 0xfffffc40, 0x0, 0x0, 0x1567000, 0x539c00, 0x1c0c000, 0x2000103, 0x569c00, 0xffffff80, 0x0, 0x0, 0x0, 0x0, 0x0, 0x0, 0x0, 0x0, 0x0, 0x0, 0x0, 0x0, 0x0, 0x0, 0x0, 0x0, 0x0, 0x0, 0x0, 0x0, 0x0, 0x0, 0x0, 0x0, 0x0, 0x0
    .long 0x18a7400, 0x539d00, 0x1c0c000, 0xf010110, 0x639c00, 0xfffffc40, 0x0, 0x0, 0x1567400, 0x539d00, 0x1c0c000, 0x2000103, 0x569c00, 0xffffff80, 0x0, 0x0, 0x0, 0x0, 0x0, 0x0, 0x0, 0x0, 0x0, 0x0, 0x0, 0x0, 0x0, 0x0, 0x0, 0x0, 0x0, 0x0, 0x0, 0x0, 0x0, 0x0, 0x0, 0x0, 0x0, 0x0
    .long 0x18a7800, 0x539e00, 0x1c0c000, 0xf010110, 0x639c00, 0xfffffc40, 0x0, 0x0, 0x1567800, 0x539e00, 0x1c0c000, 0x2000103, 0x569c00, 0xffffff80, 0x0, 0x0, 0x0, 0x0, 0x0, 0x0, 0x0, 0x0, 0x0, 0x0, 0x0, 0x0, 0x0, 0x0, 0x0, 0x0, 0x0, 0x0, 0x0, 0x0, 0x0, 0x0, 0x0, 0x0, 0x0, 0x0
    .long 0x18a7c00, 0x539f00, 0x1c0c000, 0xf010110, 0x639c00, 0xfffffc40, 0x0, 0x0, 0x1567c00, 0x539f00, 0x1c0c000, 0x2000103, 0x569c00, 0xffffff80, 0x0, 0x0, 0x0, 0x0, 0x0, 0x0, 0x0, 0x0, 0x0, 0x0, 0x0, 0x0, 0x0, 0x0, 0x0, 0x0, 0x0, 0x0, 0x0, 0x0, 0x0, 0x0, 0x0, 0x0, 0x0, 0x0
    .long 0x887000, 0x141c00, 0xbf7000, 0xe01010f, 0x231c00, 0xfffffc80, 0x0, 0x0, 0x1341000, 0x4a0400, 0x14e7000, 0x3000104, 0x4e0400, 0xffffff40, 0x0, 0x0, 0x0, 0x0, 0x0, 0x0, 0x0, 0x0, 0x0, 0x0, 0x0, 0x0, 0x0, 0x0, 0x0, 0x0, 0x0, 0x0, 0x0, 0x0, 0x0, 0x0, 0x0, 0x0, 0x0, 0x0
    .long 0x887400, 0x141d00, 0xbf7000, 0xe01010f, 0x231c00, 0xfffffc80, 0x0, 0x0, 0x1341400, 0x4a0500, 0x14e7000, 0x3000104, 0x4e0400, 0xffffff40, 0x0, 0x0, 0x0, 0x0, 0x0, 0x0, 0x0, 0x0, 0x0, 0x0, 0x0, 0x0, 0x0, 0x0, 0x0, 0x0, 0x0, 0x0, 0x0, 0x0, 0x0, 0x0, 0x0, 0x0, 0x0, 0x0
    .long 0x887800, 0x141e00, 0xbf7000, 0xe01010f, 0x231c00, 0xfffffc80, 0x0, 0x0, 0x1341800, 0x4a0600, 0x14e7000, 0x3000104, 0x4e0400, 0xffffff40, 0x0, 0x0, 0x0, 0x0, 0x0, 0x0, 0x0, 0x0, 0x0, 0x0, 0x0, 0x0, 0x0, 0x0, 0x0, 0x0, 0x0, 0x0, 0x0, 0x0, 0x0, 0x0, 0x0, 0x0, 0x0, 0x0
    .long 0x887c00, 0x141f00, 0xbf7000, 0xe01010f, 0x231c00, 0xfffffc80, 0x0, 0x0, 0x1341c00, 0x4a0700, 0x14e7000, 0x3000104, 0x4e0400, 0xffffff40, 0x0, 0x0, 0x0, 0x0, 0x0, 0x0, 0x0, 0x0, 0x0, 0x0, 0x0, 0x0, 0x0, 0x0, 0x0, 0x0, 0x0, 0x0, 0x0, 0x0, 0x0, 0x0, 0x0, 0x0, 0x0, 0x0
    .long 0x403000, 0xe0c00, 0x507000, 0x2020103, 0x110c00, 0xffffff80, 0x0, 0x0, 0x1c07000, 0x539c00, 0x1c0c000, 0x1c80020f, 0x703000, 0x20, 0x0, 0x0, 0x0, 0x0, 0x0, 0x0, 0x0, 0x0, 0x0, 0x0, 0x0, 0x0, 0x0, 0x0, 0x0, 0x0, 0x0, 0x0, 0x0, 0x0, 0x0, 0x0, 0x0, 0x0, 0x0, 0x0
    .long 0x403400, 0xe0d00, 0x507000, 0x2020103, 0x110c00, 0xffffff80, 0x0, 0x0, 0x1c07400, 0x539d00, 0x1c0c000, 0x1c80020f, 0x703000, 0x20, 0x0, 0x0, 0x0, 0x0, 0x0, 0x0, 0x0, 0x0, 0x0, 0x0, 0x0, 0x0, 0x0, 0x0, 0x0, 0x0, 0x0, 0x0, 0x0, 0x0, 0x0, 0x0, 0x0, 0x0, 0x0, 0x0
    .long 0x403800, 0xe0e00, 0x507000, 0x2020103, 0x110c00, 0xffffff80, 0x0, 0x0, 0x1c07800, 0x539e00, 0x1c0c000, 0x1c80020f, 0x703000, 0x20, 0x0, 0x0, 0x0, 0x0, 0x0, 0x0, 0x0, 0x0, 0x0, 0x0, 0x0, 0x0, 0x0, 0x0, 0x0, 0x0, 0x0, 0x0, 0x0, 0x0, 0x0, 0x0, 0x0, 0x0, 0x0, 0x0
    .long 0x403c00, 0xe0f00, 0x507000, 0x2020103, 0x110c00, 0xffffff80, 0x0, 0x0, 0x1c07c00, 0x539f00, 0x1c0c000, 0x1c80020f, 0x703000, 0x20, 0x0, 0x0, 0x0, 0x0, 0x0, 0x0, 0x0, 0x0, 0x0, 0x0, 0x0, 0x0, 0x0, 0x0, 0x0, 0x0, 0x0, 0x0, 0x0, 0x0, 0x0, 0x0, 0x0, 0x0, 0x0, 0x0
    .long 0x8c7000, 0x141c00, 0xbf7000, 0xf010110, 0x241c00, 0xfffffc40, 0x0, 0x0, 0x103a000, 0x3de800, 0x1281000, 0x3000104, 0x41e800, 0xffffff40, 0x0, 0x0, 0x0, 0x0, 0x0, 0x0, 0x0, 0x0, 0x0, 0x0, 0x0, 0x0, 0x0, 0x0, 0x0, 0x0, 0x0, 0x0, 0x0, 0x0, 0x0, 0x0, 0x0, 0x0, 0x0, 0x0
    .long 0x8c7400, 0x141d00, 0xbf7000, 0xf010110, 0x241c00, 0xfffffc40, 0x0, 0x0, 0x103a400, 0x3de900, 0x1281000, 0x3000104, 0x41e800, 0xffffff40, 0x0, 0x0, 0x0, 0x0, 0x0, 0x0, 0x0, 0x0, 0x0, 0x0, 0x0, 0x0, 0x0, 0x0, 0x0, 0x0, 0x0, 0x0, 0x0, 0x0, 0x0, 0x0, 0x0, 0x0, 0x0, 0x0
    .long 0x8c7800, 0x141e00, 0xbf7000, 0xf010110, 0x241c00, 0xfffffc40, 0x0, 0x0, 0x103a800, 0x3dea00, 0x1281000, 0x3000104, 0x41e800, 0xffffff40, 0x0, 0x0, 0x0, 0x0, 0x0, 0x0, 0x0, 0x0, 0x0, 0x0, 0x0, 0x0, 0x0, 0x0, 0x0, 0x0, 0x0, 0x0, 0x0, 0x0, 0x0, 0x0, 0x0, 0x0, 0x0, 0x0
    .long 0x8c7c00, 0x141f00, 0xbf7000, 0xf010110, 0x241c00, 0xfffffc40, 0x0, 0x0, 0x103ac00, 0x3deb00, 0x1281000, 0x3000104, 0x41e800, 0xffffff40, 0x0, 0x0, 0x0, 0x0, 0x0, 0x0, 0x0, 0x0, 0x0, 0x0, 0x0, 0x0, 0x0, 0x0, 0x0, 0x0, 0x0, 0x0, 0x0, 0x0, 0x0, 0x0, 0x0, 0x0, 0x0, 0x0
    .long 0x80000, 0x0, 0x383000, 0x2020103, 0x30000, 0xffffff80, 0x0, 0x0, 0x1be7000, 0x539c00, 0x1c0c000, 0x1c00020f, 0x703000, 0x0, 0x0, 0x0, 0x0, 0x0, 0x0, 0x0, 0x0, 0x0, 0x0, 0x0, 0x0, 0x0, 0x0, 0x0, 0x0, 0x0, 0x0, 0x0, 0x0, 0x0, 0x0, 0x0, 0x0, 0x0, 0x0, 0x0
    .long 0x80400, 0x100, 0x383000, 0x2020103, 0x30000, 0xffffff80, 0x0, 0x0, 0x1be7400, 0x539d00, 0x1c0c000, 0x1c00020f, 0x703000, 0x0, 0x0, 0x0, 0x0, 0x0, 0x0, 0x0, 0x0, 0x0, 0x0, 0x0, 0x0, 0x0, 0x0, 0x0, 0x0, 0x0, 0x0, 0x0, 0x0, 0x0, 0x0, 0x0, 0x0, 0x0, 0x0, 0x0
    .long 0x80800, 0x200, 0x383000, 0x2020103, 0x30000, 0xffffff80, 0x0, 0x0, 0x1be7800, 0x539e00, 0x1c0c000, 0x1c00020f, 0x703000, 0x0, 0x0, 0x0, 0x0, 0x0, 0x0, 0x0, 0x0, 0x0, 0x0, 0x0, 0x0, 0x0, 0x0, 0x0, 0x0, 0x0, 0x0, 0x0, 0x0, 0x0, 0x0, 0x0, 0x0, 0x0, 0x0, 0x0
    .long 0x80c00, 0x300, 0x383000, 0x2020103, 0x30000, 0xffffff80, 0x0, 0x0, 0x1be7c00, 0x539f00, 0x1c0c000, 0x1c00020f, 0x703000, 0x0, 0x0, 0x0, 0x0, 0x0, 0x0, 0x0, 0x0, 0x0, 0x0, 0x0, 0x0, 0x0, 0x0, 0x0, 0x0, 0x0, 0x0, 0x0, 0x0, 0x0, 0x0, 0x0, 0x0, 0x0, 0x0, 0x0
    .long 0x1381000, 0x4a0400, 0x14e7000, 0x4020105, 0x4f0400, 0xffffff00, 0x0, 0x0, 0xbe7000, 0x141c00, 0xbf7000, 0x1b80020e, 0x2fdc00, 0x60, 0x0, 0x0, 0x0, 0x0, 0x0, 0x0, 0x0, 0x0, 0x0, 0x0, 0x0, 0x0, 0x0, 0x0, 0x0, 0x0, 0x0, 0x0, 0x0, 0x0, 0x0, 0x0, 0x0, 0x0, 0x0, 0x0
    .long 0x1381400, 0x4a0500, 0x14e7000, 0x4020105, 0x4f0400, 0xffffff00, 0x0, 0x0, 0xbe7400, 0x141d00, 0xbf7000, 0x1b80020e, 0x2fdc00, 0x60, 0x0, 0x0, 0x0, 0x0, 0x0, 0x0, 0x0, 0x0, 0x0, 0x0, 0x0, 0x0, 0x0, 0x0, 0x0, 0x0, 0x0, 0x0, 0x0, 0x0, 0x0, 0x0, 0x0, 0x0, 0x0, 0x0
    .long 0x1381800, 0x4a0600, 0x14e7000, 0x4020105, 0x4f0400, 0xffffff00, 0x0, 0x0, 0xbe7800, 0x141e00, 0xbf7000, 0x1b80020e, 0x2fdc00, 0x60, 0x0, 0x0, 0x0, 0x0, 0x0, 0x0, 0x0, 0x0, 0x0, 0x0, 0x0, 0x0, 0x0, 0x0, 0x0, 0x0, 0x0, 0x0, 0x0, 0x0, 0x0, 0x0, 0x0, 0x0, 0x0, 0x0
    .long 0x1381c00, 0x4a0700, 0x14e7000, 0x4020105, 0x4f0400, 0xffffff00, 0x0, 0x0, 0xbe7c00, 0x141f00, 0xbf7000, 0x1b80020e, 0x2fdc00, 0x60, 0x0, 0x0, 0x0, 0x0, 0x0, 0x0, 0x0, 0x0, 0x0, 0x0, 0x0, 0x0, 0x0, 0x0, 0x0, 0x0, 0x0, 0x0, 0x0, 0x0, 0x0, 0x0, 0x0, 0x0, 0x0, 0x0
    .long 0x15a7000, 0x539c00, 0x1c0c000, 0x3020104, 0x579c00, 0xffffff40, 0x0, 0x0, 0x1bc7000, 0x539c00, 0x1c0c000, 0x1b80020e, 0x6f9c00, 0x60, 0x0, 0x0, 0x0, 0x0, 0x0, 0x0, 0x0, 0x0, 0x0, 0x0, 0x0, 0x0, 0x0, 0x0, 0x0, 0x0, 0x0, 0x0, 0x0, 0x0, 0x0, 0x0, 0x0, 0x0, 0x0, 0x0
    .long 0x15a7400, 0x539d00, 0x1c0c000, 0x3020104, 0x579c00, 0xffffff40, 0x0, 0x0, 0x1bc7400, 0x539d00, 0x1c0c000, 0x1b80020e, 0x6f9c00, 0x60, 0x0, 0x0, 0x0, 0x0, 0x0, 0x0, 0x0, 0x0, 0x0, 0x0, 0x0, 0x0, 0x0, 0x0, 0x0, 0x0, 0x0, 0x0, 0x0, 0x0, 0x0, 0x0, 0x0, 0x0, 0x0, 0x0
    .long 0x15a7800, 0x539e00, 0x1c0c000, 0x3020104, 0x579c00, 0xffffff40, 0x0, 0x0, 0x1bc7800, 0x539e00, 0x1c0c000, 0x1b80020e, 0x6f9c00, 0x60, 0x0, 0x0, 0x0, 0x0, 0x0, 0x0, 0x0, 0x0, 0x0, 0x0, 0x0, 0x0, 0x0, 0x0, 0x0, 0x0, 0x0, 0x0, 0x0, 0x0, 0x0, 0x0, 0x0, 0x0, 0x0, 0x0
    .long 0x15a7c00, 0x539f00, 0x1c0c000, 0x3020104, 0x579c00, 0xffffff40, 0x0, 0x0, 0x1bc7c00, 0x539f00, 0x1c0c000, 0x1b80020e, 0x6f9c00, 0x60, 0x0, 0x0, 0x0, 0x0, 0x0, 0x0, 0x0, 0x0, 0x0, 0x0, 0x0, 0x0, 0x0, 0x0, 0x0, 0x0, 0x0, 0x0, 0x0, 0x0, 0x0, 0x0, 0x0, 0x0, 0x0, 0x0
    .long 0x107a000, 0x3de800, 0x1281000, 0x4020105, 0x42e800, 0xffffff00, 0x0, 0x0, 0xbc7000, 0x141c00, 0xbf7000, 0x1b00020e, 0x2fdc00, 0x40, 0x0, 0x0, 0x0, 0x0, 0x0, 0x0, 0x0, 0x0, 0x0, 0x0, 0x0, 0x0, 0x0, 0x0, 0x0, 0x0, 0x0, 0x0, 0x0, 0x0, 0x0, 0x0, 0x0, 0x0, 0x0, 0x0
    .long 0x107a400, 0x3de900, 0x1281000, 0x4020105, 0x42e800, 0xffffff00, 0x0, 0x0, 0xbc7400, 0x141d00, 0xbf7000, 0x1b00020e, 0x2fdc00, 0x40, 0x0, 0x0, 0x0, 0x0, 0x0, 0x0, 0x0, 0x0, 0x0, 0x0, 0x0, 0x0, 0x0, 0x0, 0x0, 0x0, 0x0, 0x0, 0x0, 0x0, 0x0, 0x0, 0x0, 0x0, 0x0, 0x0
    .long 0x107a800, 0x3dea00, 0x1281000, 0x4020105, 0x42e800, 0xffffff00, 0x0, 0x0, 0xbc7800, 0x141e00, 0xbf7000, 0x1b00020e, 0x2fdc00, 0x40, 0x0, 0x0, 0x0, 0x0, 0x0, 0x0, 0x0, 0x0, 0x0, 0x0, 0x0, 0x0, 0x0, 0x0, 0x0, 0x0, 0x0, 0x0, 0x0, 0x0, 0x0, 0x0, 0x0, 0x0, 0x0, 0x0
    .long 0x107ac00, 0x3deb00, 0x1281000, 0x4020105, 0x42e800, 0xffffff00, 0x0, 0x0, 0xbc7c00, 0x141f00, 0xbf7000, 0x1b00020e, 0x2fdc00, 0x40, 0x0, 0x0, 0x0, 0x0, 0x0, 0x0, 0x0, 0x0, 0x0, 0x0, 0x0, 0x0, 0x0, 0x0, 0x0, 0x0, 0x0, 0x0, 0x0, 0x0, 0x0, 0x0, 0x0, 0x0, 0x0, 0x0
    .long 0xcb7000, 0x2fdc00, 0xd35000, 0x3020104, 0x33dc00, 0xffffff40, 0x0, 0x0, 0x1ba7000, 0x539c00, 0x1c0c000, 0x1b00020e, 0x6f9c00, 0x40, 0x0, 0x0, 0x0, 0x0, 0x0, 0x0, 0x0, 0x0, 0x0, 0x0, 0x0, 0x0, 0x0, 0x0, 0x0, 0x0, 0x0, 0x0, 0x0, 0x0, 0x0, 0x0, 0x0, 0x0, 0x0, 0x0
    .long 0xcb7400, 0x2fdd00, 0xd35000, 0x3020104, 0x33dc00, 0xffffff40, 0x0, 0x0, 0x1ba7400, 0x539d00, 0x1c0c000, 0x1b00020e, 0x6f9c00, 0x40, 0x0, 0x0, 0x0, 0x0, 0x0, 0x0, 0x0, 0x0, 0x0, 0x0, 0x0, 0x0, 0x0, 0x0, 0x0, 0x0, 0x0, 0x0, 0x0, 0x0, 0x0, 0x0, 0x0, 0x0, 0x0, 0x0
    .long 0xcb7800, 0x2fde00, 0xd35000, 0x3020104, 0x33dc00, 0xffffff40, 0x0, 0x0, 0x1ba7800, 0x539e00, 0x1c0c000, 0x1b00020e, 0x6f9c00, 0x40, 0x0, 0x0, 0x0, 0x0, 0x0, 0x0, 0x0, 0x0, 0x0, 0x0, 0x0, 0x0, 0x0, 0x0, 0x0, 0x0, 0x0, 0x0, 0x0, 0x0, 0x0, 0x0, 0x0, 0x0, 0x0, 0x0
    .long 0xcb7c00, 0x2fdf00, 0xd35000, 0x3020104, 0x33dc00, 0xffffff40, 0x0, 0x0, 0x1ba7c00, 0x539f00, 0x1c0c000, 0x1b00020e, 0x6f9c00, 0x40, 0x0, 0x0, 0x0, 0x0, 0x0, 0x0, 0x0, 0x0, 0x0, 0x0, 0x0, 0x0, 0x0, 0x0, 0x0, 0x0, 0x0, 0x0, 0x0, 0x0, 0x0, 0x0, 0x0, 0x0, 0x0, 0x0
    .long 0xe35000, 0x34d400, 0xf7a000, 0x4020105, 0x39d400, 0xffffff00, 0x0, 0x0, 0xba7000, 0x141c00, 0xbf7000, 0x1a80020e, 0x2f1c00, 0x20, 0x0, 0x0, 0x0, 0x0, 0x0, 0x0, 0x0, 0x0, 0x0, 0x0, 0x0, 0x0, 0x0, 0x0, 0x0, 0x0, 0x0, 0x0, 0x0, 0x0, 0x0, 0x0, 0x0, 0x0, 0x0, 0x0
    .long 0xe35400, 0x34d500, 0xf7a000, 0x4020105, 0x39d400, 0xffffff00, 0x0, 0x0, 0xba7400, 0x141d00, 0xbf7000, 0x1a80020e, 0x2f1c00, 0x20, 0x0, 0x0, 0x0, 0x0, 0x0, 0x0, 0x0, 0x0, 0x0, 0x0, 0x0, 0x0, 0x0, 0x0, 0x0, 0x0, 0x0, 0x0, 0x0, 0x0, 0x0, 0x0, 0x0, 0x0, 0x0, 0x0
    .long 0xe35800, 0x34d600, 0xf7a000, 0x4020105, 0x39d400, 0xffffff00, 0x0, 0x0, 0xba7800, 0x141e00, 0xbf7000, 0x1a80020e, 0x2f1c00, 0x20, 0x0, 0x0, 0x0, 0x0, 0x0, 0x0, 0x0, 0x0, 0x0, 0x0, 0x0, 0x0, 0x0, 0x0, 0x0, 0x0, 0x0, 0x0, 0x0, 0x0, 0x0, 0x0, 0x0, 0x0, 0x0, 0x0
    .long 0xe35c00, 0x34d700, 0xf7a000, 0x4020105, 0x39d400, 0xffffff00, 0x0, 0x0, 0xba7c00, 0x141f00, 0xbf7000, 0x1a80020e, 0x2f1c00, 0x20, 0x0, 0x0, 0x0, 0x0, 0x0, 0x0, 0x0, 0x0, 0x0, 0x0, 0x0, 0x0, 0x0, 0x0, 0x0, 0x0, 0x0, 0x0, 0x0, 0x0, 0x0, 0x0, 0x0, 0x0, 0x0, 0x0
    .long 0x443000, 0xe0c00, 0x507000, 0x3020104, 0x120c00, 0xffffff40, 0x0, 0x0, 0x1b87000, 0x539c00, 0x1c0c000, 0x1a80020e, 0x6e9c00, 0x20, 0x0, 0x0, 0x0, 0x0, 0x0, 0x0, 0x0, 0x0, 0x0, 0x0, 0x0, 0x0, 0x0, 0x0, 0x0, 0x0, 0x0, 0x0, 0x0, 0x0, 0x0, 0x0, 0x0, 0x0, 0x0, 0x0
    .long 0x443400, 0xe0d00, 0x507000, 0x3020104, 0x120c00, 0xffffff40, 0x0, 0x0, 0x1b87400, 0x539d00, 0x1c0c000, 0x1a80020e, 0x6e9c00, 0x20, 0x0, 0x0, 0x0, 0x0, 0x0, 0x0, 0x0, 0x0, 0x0, 0x0, 0x0, 0x0, 0x0, 0x0, 0x0, 0x0, 0x0, 0x0, 0x0, 0x0, 0x0, 0x0, 0x0, 0x0, 0x0, 0x0
    .long 0x443800, 0xe0e00, 0x507000, 0x3020104, 0x120c00, 0xffffff40, 0x0, 0x0, 0x1b87800, 0x539e00, 0x1c0c000, 0x1a80020e, 0x6e9c00, 0x20, 0x0, 0x0, 0x0, 0x0, 0x0, 0x0, 0x0, 0x0, 0x0, 0x0, 0x0, 0x0, 0x0, 0x0, 0x0, 0x0, 0x0, 0x0, 0x0, 0x0, 0x0, 0x0, 0x0, 0x0, 0x0, 0x0
    .long 0x443c00, 0xe0f00, 0x507000, 0x3020104, 0x120c00, 0xffffff40, 0x0, 0x0, 0x1b87c00, 0x539f00, 0x1c0c000, 0x1a80020e, 0x6e9c00, 0x20, 0x0, 0x0, 0x0, 0x0, 0x0, 0x0, 0x0, 0x0, 0x0, 0x0, 0x0, 0x0, 0x0, 0x0, 0x0, 0x0, 0x0, 0x0, 0x0, 0x0, 0x0, 0x0, 0x0, 0x0, 0x0, 0x0
    .long 0x607000, 0x141c00, 0xbf7000, 0x4020105, 0x191c00, 0xffffff00, 0x0, 0x0, 0xb87000, 0x141c00, 0xbf7000, 0x1a00020e, 0x2f1c00, 0x0, 0x0, 0x0, 0x0, 0x0, 0x0, 0x0, 0x0, 0x0, 0x0, 0x0, 0x0, 0x0, 0x0, 0x0, 0x0, 0x0, 0x0, 0x0, 0x0, 0x0, 0x0, 0x0, 0x0, 0x0, 0x0, 0x0
    .long 0x607400, 0x141d00, 0xbf7000, 0x4020105, 0x191c00, 0xffffff00, 0x0, 0x0, 0xb87400, 0x141d00, 0xbf7000, 0x1a00020e, 0x2f1c00, 0x0, 0x0, 0x0, 0x0, 0x0, 0x0, 0x0, 0x0, 0x0, 0x0, 0x0, 0x0, 0x0, 0x0, 0x0, 0x0, 0x0, 0x0, 0x0, 0x0, 0x0, 0x0, 0x0, 0x0, 0x0, 0x0, 0x0
    .long 0x607800, 0x141e00, 0xbf7000, 0x4020105, 0x191c00, 0xffffff00, 0x0, 0x0, 0xb87800, 0x141e00, 0xbf7000, 0x1a00020e, 0x2f1c00, 0x0, 0x0, 0x0, 0x0, 0x0, 0x0, 0x0, 0x0, 0x0, 0x0, 0x0, 0x0, 0x0, 0x0, 0x0, 0x0, 0x0, 0x0, 0x0, 0x0, 0x0, 0x0, 0x0, 0x0, 0x0, 0x0, 0x0
    .long 0x607c00, 0x141f00, 0xbf7000, 0x4020105, 0x191c00, 0xffffff00, 0x0, 0x0, 0xb87c00, 0x141f00, 0xbf7000, 0x1a00020e, 0x2f1c00, 0x0, 0x0, 0x0, 0x0, 0x0, 0x0, 0x0, 0x0, 0x0, 0x0, 0x0, 0x0, 0x0, 0x0, 0x0, 0x0, 0x0, 0x0, 0x0, 0x0, 0x0, 0x0, 0x0, 0x0, 0x0, 0x0, 0x0
    .long 0xc0000, 0x0, 0x383000, 0x3020104, 0x40000, 0xffffff40, 0x0, 0x0, 0x1b67000, 0x539c00, 0x1c0c000, 0x1a00020e, 0x6e9c00, 0x0, 0x0, 0x0, 0x0, 0x0, 0x0, 0x0, 0x0, 0x0, 0x0, 0x0, 0x0, 0x0, 0x0, 0x0, 0x0, 0x0, 0x0, 0x0, 0x0, 0x0, 0x0, 0x0, 0x0, 0x0, 0x0, 0x0
    .long 0xc0400, 0x100, 0x383000, 0x3020104, 0x40000, 0xffffff40, 0x0, 0x0, 0x1b67400, 0x539d00, 0x1c0c000, 0x1a00020e, 0x6e9c00, 0x0, 0x0, 0x0, 0x0, 0x0, 0x0, 0x0, 0x0, 0x0, 0x0, 0x0, 0x0, 0x0, 0x0, 0x0, 0x0, 0x0, 0x0, 0x0, 0x0, 0x0, 0x0, 0x0, 0x0, 0x0, 0x0, 0x0
    .long 0xc0800, 0x200, 0x383000, 0x3020104, 0x40000, 0xffffff40, 0x0, 0x0, 0x1b67800, 0x539e00, 0x1c0c000, 0x1a00020e, 0x6e9c00, 0x0, 0x0, 0x0, 0x0, 0x0, 0x0, 0x0, 0x0, 0x0, 0x0, 0x0, 0x0, 0x0, 0x0, 0x0, 0x0, 0x0, 0x0, 0x0, 0x0, 0x0, 0x0, 0x0, 0x0, 0x0, 0x0, 0x0
    .long 0xc0c00, 0x300, 0x383000, 0x3020104, 0x40000, 0xffffff40, 0x0, 0x0, 0x1b67c00, 0x539f00, 0x1c0c000, 0x1a00020e, 0x6e9c00, 0x0, 0x0, 0x0, 0x0, 0x0, 0x0, 0x0, 0x0, 0x0, 0x0, 0x0, 0x0, 0x0, 0x0, 0x0, 0x0, 0x0, 0x0, 0x0, 0x0, 0x0, 0x0, 0x0, 0x0, 0x0, 0x0, 0x0
    .long 0x13c1000, 0x4a0400, 0x14e7000, 0x5020106, 0x500400, 0xfffffec0, 0x0, 0x0, 0xb67000, 0x141c00, 0xbf7000, 0x1980020d, 0x2e1c00, 0x60, 0x0, 0x0, 0x0, 0x0, 0x0, 0x0, 0x0, 0x0, 0x0, 0x0, 0x0, 0x0, 0x0, 0x0, 0x0, 0x0, 0x0, 0x0, 0x0, 0x0, 0x0, 0x0, 0x0, 0x0, 0x0, 0x0
    .long 0x13c1400, 0x4a0500, 0x14e7000, 0x5020106, 0x500400, 0xfffffec0, 0x0, 0x0, 0xb67400, 0x141d00, 0xbf7000, 0x1980020d, 0x2e1c00, 0x60, 0x0, 0x0, 0x0, 0x0, 0x0, 0x0, 0x0, 0x0, 0x0, 0x0, 0x0, 0x0, 0x0, 0x0, 0x0, 0x0, 0x0, 0x0, 0x0, 0x0, 0x0, 0x0, 0x0, 0x0, 0x0, 0x0
    .long 0x13c1800, 0x4a0600, 0x14e7000, 0x5020106, 0x500400, 0xfffffec0, 0x0, 0x0, 0xb67800, 0x141e00, 0xbf7000, 0x1980020d, 0x2e1c00, 0x60, 0x0, 0x0, 0x0, 0x0, 0x0, 0x0, 0x0, 0x0, 0x0, 0x0, 0x0, 0x0, 0x0, 0x0, 0x0, 0x0, 0x0, 0x0, 0x0, 0x0, 0x0, 0x0, 0x0, 0x0, 0x0, 0x0
    .long 0x13c1c00, 0x4a0700, 0x14e7000, 0x5020106, 0x500400, 0xfffffec0, 0x0, 0x0, 0xb67c00, 0x141f00, 0xbf7000, 0x1980020d, 0x2e1c00, 0x60, 0x0, 0x0, 0x0, 0x0, 0x0, 0x0, 0x0, 0x0, 0x0, 0x0, 0x0, 0x0, 0x0, 0x0, 0x0, 0x0, 0x0, 0x0, 0x0, 0x0, 0x0, 0x0, 0x0, 0x0, 0x0, 0x0
    .long 0x15e7000, 0x539c00, 0x1c0c000, 0x4020105, 0x589c00, 0xffffff00, 0x0, 0x0, 0x1b47000, 0x539c00, 0x1c0c000, 0x1980020d, 0x6d9c00, 0x60, 0x0, 0x0, 0x0, 0x0, 0x0, 0x0, 0x0, 0x0, 0x0, 0x0, 0x0, 0x0, 0x0, 0x0, 0x0, 0x0, 0x0, 0x0, 0x0, 0x0, 0x0, 0x0, 0x0, 0x0, 0x0, 0x0
    .long 0x15e7400, 0x539d00, 0x1c0c000, 0x4020105, 0x589c00, 0xffffff00, 0x0, 0x0, 0x1b47400, 0x539d00, 0x1c0c000, 0x1980020d, 0x6d9c00, 0x60, 0x0, 0x0, 0x0, 0x0, 0x0, 0x0, 0x0, 0x0, 0x0, 0x0, 0x0, 0x0, 0x0, 0x0, 0x0, 0x0, 0x0, 0x0, 0x0, 0x0, 0x0, 0x0, 0x0, 0x0, 0x0, 0x0
    .long 0x15e7800, 0x539e00, 0x1c0c000, 0x4020105, 0x589c00, 0xffffff00, 0x0, 0x0, 0x1b47800, 0x539e00, 0x1c0c000, 0x1980020d, 0x6d9c00, 0x60, 0x0, 0x0, 0x0, 0x0, 0x0, 0x0, 0x0, 0x0, 0x0, 0x0, 0x0, 0x0, 0x0, 0x0, 0x0, 0x0, 0x0, 0x0, 0x0, 0x0, 0x0, 0x0, 0x0, 0x0, 0x0, 0x0
    .long 0x15e7c00, 0x539f00, 0x1c0c000, 0x4020105, 0x589c00, 0xffffff00, 0x0, 0x0, 0x1b47c00, 0x539f00, 0x1c0c000, 0x1980020d, 0x6d9c00, 0x60, 0x0, 0x0, 0x0, 0x0, 0x0, 0x0, 0x0, 0x0, 0x0, 0x0, 0x0, 0x0, 0x0, 0x0, 0x0, 0x0, 0x0, 0x0, 0x0, 0x0, 0x0, 0x0, 0x0, 0x0, 0x0, 0x0
    .long 0x10ba000, 0x3de800, 0x1281000, 0x5020106, 0x43e800, 0xfffffec0, 0x0, 0x0, 0xb47000, 0x141c00, 0xbf7000, 0x1900020d, 0x2e1c00, 0x40, 0x0, 0x0, 0x0, 0x0, 0x0, 0x0, 0x0, 0x0, 0x0, 0x0, 0x0, 0x0, 0x0, 0x0, 0x0, 0x0, 0x0, 0x0, 0x0, 0x0, 0x0, 0x0, 0x0, 0x0, 0x0, 0x0
    .long 0x10ba400, 0x3de900, 0x1281000, 0x5020106, 0x43e800, 0xfffffec0, 0x0, 0x0, 0xb47400, 0x141d00, 0xbf7000, 0x1900020d, 0x2e1c00, 0x40, 0x0, 0x0, 0x0, 0x0, 0x0, 0x0, 0x0, 0x0, 0x0, 0x0, 0x0, 0x0, 0x0, 0x0, 0x0, 0x0, 0x0, 0x0, 0x0, 0x0, 0x0, 0x0, 0x0, 0x0, 0x0, 0x0
    .long 0x10ba800, 0x3dea00, 0x1281000, 0x5020106, 0x43e800, 0xfffffec0, 0x0, 0x0, 0xb47800, 0x141e00, 0xbf7000, 0x1900020d, 0x2e1c00, 0x40, 0x0, 0x0, 0x0, 0x0, 0x0, 0x0, 0x0, 0x0, 0x0, 0x0, 0x0, 0x0, 0x0, 0x0, 0x0, 0x0, 0x0, 0x0, 0x0, 0x0, 0x0, 0x0, 0x0, 0x0, 0x0, 0x0
    .long 0x10bac00, 0x3deb00, 0x1281000, 0x5020106, 0x43e800, 0xfffffec0, 0x0, 0x0, 0xb47c00, 0x141f00, 0xbf7000, 0x1900020d, 0x2e1c00, 0x40, 0x0, 0x0, 0x0, 0x0, 0x0, 0x0, 0x0, 0x0, 0x0, 0x0, 0x0, 0x0, 0x0, 0x0, 0x0, 0x0, 0x0, 0x0, 0x0, 0x0, 0x0, 0x0, 0x0, 0x0, 0x0, 0x0
    .long 0xcf7000, 0x2fdc00, 0xd35000, 0x4020105, 0x34d400, 0xffffff00, 0x0, 0x0, 0x1b27000, 0x539c00, 0x1c0c000, 0x1900020d, 0x6d9c00, 0x40, 0x0, 0x0, 0x0, 0x0, 0x0, 0x0, 0x0, 0x0, 0x0, 0x0, 0x0, 0x0, 0x0, 0x0, 0x0, 0x0, 0x0, 0x0, 0x0, 0x0, 0x0, 0x0, 0x0, 0x0, 0x0, 0x0
    .long 0xcf7400, 0x2fdd00, 0xd35000, 0x4020105, 0x34d400, 0xffffff00, 0x0, 0x0, 0x1b27400, 0x539d00, 0x1c0c000, 0x1900020d, 0x6d9c00, 0x40, 0x0, 0x0, 0x0, 0x0, 0x0, 0x0, 0x0, 0x0, 0x0, 0x0, 0x0, 0x0, 0x0, 0x0, 0x0, 0x0, 0x0, 0x0, 0x0, 0x0, 0x0, 0x0, 0x0, 0x0, 0x0, 0x0
    .long 0xcf7800, 0x2fde00, 0xd35000, 0x4020105, 0x34d400, 0xffffff00, 0x0, 0x0, 0x1b27800, 0x539e00, 0x1c0c000, 0x1900020d, 0x6d9c00, 0x40, 0x0, 0x0, 0x0, 0x0, 0x0, 0x0, 0x0, 0x0, 0x0, 0x0, 0x0, 0x0, 0x0, 0x0, 0x0, 0x0, 0x0, 0x0, 0x0, 0x0, 0x0, 0x0, 0x0, 0x0, 0x0, 0x0
    .long 0xcf7c00, 0x2fdf00, 0xd35000, 0x4020105, 0x34d400, 0xffffff00, 0x0, 0x0, 0x1b27c00, 0x539f00, 0x1c0c000, 0x1900020d, 0x6d9c00, 0x40, 0x0, 0x0, 0x0, 0x0, 0x0, 0x0, 0x0, 0x0, 0x0, 0x0, 0x0, 0x0, 0x0, 0x0, 0x0, 0x0, 0x0, 0x0, 0x0, 0x0, 0x0, 0x0, 0x0, 0x0, 0x0, 0x0
    .long 0xe75000, 0x34d400, 0xf7a000, 0x5020106, 0x3ad400, 0xfffffec0, 0x0, 0x0, 0xb27000, 0x141c00, 0xbf7000, 0x1880020d, 0x2d1c00, 0x20, 0x0, 0x0, 0x0, 0x0, 0x0, 0x0, 0x0, 0x0, 0x0, 0x0, 0x0, 0x0, 0x0, 0x0, 0x0, 0x0, 0x0, 0x0, 0x0, 0x0, 0x0, 0x0, 0x0, 0x0, 0x0, 0x0
    .long 0xe75400, 0x34d500, 0xf7a000, 0x5020106, 0x3ad400, 0xfffffec0, 0x0, 0x0, 0xb27400, 0x141d00, 0xbf7000, 0x1880020d, 0x2d1c00, 0x20, 0x0, 0x0, 0x0, 0x0, 0x0, 0x0, 0x0, 0x0, 0x0, 0x0, 0x0, 0x0, 0x0, 0x0, 0x0, 0x0, 0x0, 0x0, 0x0, 0x0, 0x0, 0x0, 0x0, 0x0, 0x0, 0x0
    .long 0xe75800, 0x34d600, 0xf7a000, 0x5020106, 0x3ad400, 0xfffffec0, 0x0, 0x0, 0xb27800, 0x141e00, 0xbf7000, 0x1880020d, 0x2d1c00, 0x20, 0x0, 0x0, 0x0, 0x0, 0x0, 0x0, 0x0, 0x0, 0x0, 0x0, 0x0, 0x0, 0x0, 0x0, 0x0, 0x0, 0x0, 0x0, 0x0, 0x0, 0x0, 0x0, 0x0, 0x0, 0x0, 0x0
    .long 0xe75c00, 0x34d700, 0xf7a000, 0x5020106, 0x3ad400, 0xfffffec0, 0x0, 0x0, 0xb27c00, 0x141f00, 0xbf7000, 0x1880020d, 0x2d1c00, 0x20, 0x0, 0x0, 0x0, 0x0, 0x0, 0x0, 0x0, 0x0, 0x0, 0x0, 0x0, 0x0, 0x0, 0x0, 0x0, 0x0, 0x0, 0x0, 0x0, 0x0, 0x0, 0x0, 0x0, 0x0, 0x0, 0x0
    .long 0x483000, 0xe0c00, 0x507000, 0x4020105, 0x130c00, 0xffffff00, 0x0, 0x0, 0x1b07000, 0x539c00, 0x1c0c000, 0x1880020d, 0x6c9c00, 0x20, 0x0, 0x0, 0x0, 0x0, 0x0, 0x0, 0x0, 0x0, 0x0, 0x0, 0x0, 0x0, 0x0, 0x0, 0x0, 0x0, 0x0, 0x0, 0x0, 0x0, 0x0, 0x0, 0x0, 0x0, 0x0, 0x0
    .long 0x483400, 0xe0d00, 0x507000, 0x4020105, 0x130c00, 0xffffff00, 0x0, 0x0, 0x1b07400, 0x539d00, 0x1c0c000, 0x1880020d, 0x6c9c00, 0x20, 0x0, 0x0, 0x0, 0x0, 0x0, 0x0, 0x0, 0x0, 0x0, 0x0, 0x0, 0x0, 0x0, 0x0, 0x0, 0x0, 0x0, 0x0, 0x0, 0x0, 0x0, 0x0, 0x0, 0x0, 0x0, 0x0
    .long 0x483800, 0xe0e00, 0x507000, 0x4020105, 0x130c00, 0xffffff00, 0x0, 0x0, 0x1b07800, 0x539e00, 0x1c0c000, 0x1880020d, 0x6c9c00, 0x20, 0x0, 0x0, 0x0, 0x0, 0x0, 0x0, 0x0, 0x0, 0x0, 0x0, 0x0, 0x0, 0x0, 0x0, 0x0, 0x0, 0x0, 0x0, 0x0, 0x0, 0x0, 0x0, 0x0, 0x0, 0x0, 0x0
    .long 0x483c00, 0xe0f00, 0x507000, 0x4020105, 0x130c00, 0xffffff00, 0x0, 0x0, 0x1b07c00, 0x539f00, 0x1c0c000, 0x1880020d, 0x6c9c00, 0x20, 0x0, 0x0, 0x0, 0x0, 0x0, 0x0, 0x0, 0x0, 0x0, 0x0, 0x0, 0x0, 0x0, 0x0, 0x0, 0x0, 0x0, 0x0, 0x0, 0x0, 0x0, 0x0, 0x0, 0x0, 0x0, 0x0
    .long 0x647000, 0x141c00, 0xbf7000, 0x5020106, 0x1a1c00, 0xfffffec0, 0x0, 0x0, 0xb07000, 0x141c00, 0xbf7000, 0x1800020d, 0x2d1c00, 0x0, 0x0, 0x0, 0x0, 0x0, 0x0, 0x0, 0x0, 0x0, 0x0, 0x0, 0x0, 0x0, 0x0, 0x0, 0x0, 0x0, 0x0, 0x0, 0x0, 0x0, 0x0, 0x0, 0x0, 0x0, 0x0, 0x0
    .long 0x647400, 0x141d00, 0xbf7000, 0x5020106, 0x1a1c00, 0xfffffec0, 0x0, 0x0, 0xb07400, 0x141d00, 0xbf7000, 0x1800020d, 0x2d1c00, 0x0, 0x0, 0x0, 0x0, 0x0, 0x0, 0x0, 0x0, 0x0, 0x0, 0x0, 0x0, 0x0, 0x0, 0x0, 0x0, 0x0, 0x0, 0x0, 0x0, 0x0, 0x0, 0x0, 0x0, 0x0, 0x0, 0x0
    .long 0x647800, 0x141e00, 0xbf7000, 0x5020106, 0x1a1c00, 0xfffffec0, 0x0, 0x0, 0xb07800, 0x141e00, 0xbf7000, 0x1800020d, 0x2d1c00, 0x0, 0x0, 0x0, 0x0, 0x0, 0x0, 0x0, 0x0, 0x0, 0x0, 0x0, 0x0, 0x0, 0x0, 0x0, 0x0, 0x0, 0x0, 0x0, 0x0, 0x0, 0x0, 0x0, 0x0, 0x0, 0x0, 0x0
    .long 0x647c00, 0x141f00, 0xbf7000, 0x5020106, 0x1a1c00, 0xfffffec0, 0x0, 0x0, 0xb07c00, 0x141f00, 0xbf7000, 0x1800020d, 0x2d1c00, 0x0, 0x0, 0x0, 0x0, 0x0, 0x0, 0x0, 0x0, 0x0, 0x0, 0x0, 0x0, 0x0, 0x0, 0x0, 0x0, 0x0, 0x0, 0x0, 0x0, 0x0, 0x0, 0x0, 0x0, 0x0, 0x0, 0x0
    .long 0x100000, 0x0, 0x383000, 0x4020105, 0x50000, 0xffffff00, 0x0, 0x0, 0x1ae7000, 0x539c00, 0x1c0c000, 0x1800020d, 0x6c9c00, 0x0, 0x0, 0x0, 0x0, 0x0, 0x0, 0x0, 0x0, 0x0, 0x0, 0x0, 0x0, 0x0, 0x0, 0x0, 0x0, 0x0, 0x0, 0x0, 0x0, 0x0, 0x0, 0x0, 0x0, 0x0, 0x0, 0x0
    .long 0x100400, 0x100, 0x383000, 0x4020105, 0x50000, 0xffffff00, 0x0, 0x0, 0x1ae7400, 0x539d00, 0x1c0c000, 0x1800020d, 0x6c9c00, 0x0, 0x0, 0x0, 0x0, 0x0, 0x0, 0x0, 0x0, 0x0, 0x0, 0x0, 0x0, 0x0, 0x0, 0x0, 0x0, 0x0, 0x0, 0x0, 0x0, 0x0, 0x0, 0x0, 0x0, 0x0, 0x0, 0x0
    .long 0x100800, 0x200, 0x383000, 0x4020105, 0x50000, 0xffffff00, 0x0, 0x0, 0x1ae7800, 0x539e00, 0x1c0c000, 0x1800020d, 0x6c9c00, 0x0, 0x0, 0x0, 0x0, 0x0, 0x0, 0x0, 0x0, 0x0, 0x0, 0x0, 0x0, 0x0, 0x0, 0x0, 0x0, 0x0, 0x0, 0x0, 0x0, 0x0, 0x0, 0x0, 0x0, 0x0, 0x0, 0x0
    .long 0x100c00, 0x300, 0x383000, 0x4020105, 0x50000, 0xffffff00, 0x0, 0x0, 0x1ae7c00, 0x539f00, 0x1c0c000, 0x1800020d, 0x6c9c00, 0x0, 0x0, 0x0, 0x0, 0x0, 0x0, 0x0, 0x0, 0x0, 0x0, 0x0, 0x0, 0x0, 0x0, 0x0, 0x0, 0x0, 0x0, 0x0, 0x0, 0x0, 0x0, 0x0, 0x0, 0x0, 0x0, 0x0
    .long 0x807000, 0x141c00, 0xbf7000, 0xc01010d, 0x211c00, 0xfffffd00, 0x0, 0x0, 0x1401000, 0x4a0400, 0x14e7000, 0x6000107, 0x510400, 0xfffffe80, 0x0, 0x0, 0x0, 0x0, 0x0, 0x0, 0x0, 0x0, 0x0, 0x0, 0x0, 0x0, 0x0, 0x0, 0x0, 0x0, 0x0, 0x0, 0x0, 0x0, 0x0, 0x0, 0x0, 0x0, 0x0, 0x0
    .long 0x807400, 0x141d00, 0xbf7000, 0xc01010d, 0x211c00, 0xfffffd00, 0x0, 0x0, 0x1401400, 0x4a0500, 0x14e7000, 0x6000107, 0x510400, 0xfffffe80, 0x0, 0x0, 0x0, 0x0, 0x0, 0x0, 0x0, 0x0, 0x0, 0x0, 0x0, 0x0, 0x0, 0x0, 0x0, 0x0, 0x0, 0x0, 0x0, 0x0, 0x0, 0x0, 0x0, 0x0, 0x0, 0x0
    .long 0x807800, 0x141e00, 0xbf7000, 0xc01010d, 0x211c00, 0xfffffd00, 0x0, 0x0, 0x1401800, 0x4a0600, 0x14e7000, 0x6000107, 0x510400, 0xfffffe80, 0x0, 0x0, 0x0, 0x0, 0x0, 0x0, 0x0, 0x0, 0x0, 0x0, 0x0, 0x0, 0x0, 0x0, 0x0, 0x0, 0x0, 0x0, 0x0, 0x0, 0x0, 0x0, 0x0, 0x0, 0x0, 0x0
    .long 0x807c00, 0x141f00, 0xbf7000, 0xc01010d, 0x211c00, 0xfffffd00, 0x0, 0x0, 0x1401c00, 0x4a0700, 0x14e7000, 0x6000107, 0x510400, 0xfffffe80, 0x0, 0x0, 0x0, 0x0, 0x0, 0x0, 0x0, 0x0, 0x0, 0x0, 0x0, 0x0, 0x0, 0x0, 0x0, 0x0, 0x0, 0x0, 0x0, 0x0, 0x0, 0x0, 0x0, 0x0, 0x0, 0x0
    .long 0x1627000, 0x539c00, 0x1c0c000, 0x5020106, 0x599c00, 0xfffffec0, 0x0, 0x0, 0x1ac7000, 0x539c00, 0x1c0c000, 0x1780020c, 0x6b9c00, 0x60, 0x0, 0x0, 0x0, 0x0, 0x0, 0x0, 0x0, 0x0, 0x0, 0x0, 0x0, 0x0, 0x0, 0x0, 0x0, 0x0, 0x0, 0x0, 0x0, 0x0, 0x0, 0x0, 0x0, 0x0, 0x0, 0x0
    .long 0x1627400, 0x539d00, 0x1c0c000, 0x5020106, 0x599c00, 0xfffffec0, 0x0, 0x0, 0x1ac7400, 0x539d00, 0x1c0c000, 0x1780020c, 0x6b9c00, 0x60, 0x0, 0x0, 0x0, 0x0, 0x0, 0x0, 0x0, 0x0, 0x0, 0x0, 0x0, 0x0, 0x0, 0x0, 0x0, 0x0, 0x0, 0x0, 0x0, 0x0, 0x0, 0x0, 0x0, 0x0, 0x0, 0x0
    .long 0x1627800, 0x539e00, 0x1c0c000, 0x5020106, 0x599c00, 0xfffffec0, 0x0, 0x0, 0x1ac7800, 0x539e00, 0x1c0c000, 0x1780020c, 0x6b9c00, 0x60, 0x0, 0x0, 0x0, 0x0, 0x0, 0x0, 0x0, 0x0, 0x0, 0x0, 0x0, 0x0, 0x0, 0x0, 0x0, 0x0, 0x0, 0x0, 0x0, 0x0, 0x0, 0x0, 0x0, 0x0, 0x0, 0x0
    .long 0x1627c00, 0x539f00, 0x1c0c000, 0x5020106, 0x599c00, 0xfffffec0, 0x0, 0x0, 0x1ac7c00, 0x539f00, 0x1c0c000, 0x1780020c, 0x6b9c00, 0x60, 0x0, 0x0, 0x0, 0x0, 0x0, 0x0, 0x0, 0x0, 0x0, 0x0, 0x0, 0x0, 0x0, 0x0, 0x0, 0x0, 0x0, 0x0, 0x0, 0x0, 0x0, 0x0, 0x0, 0x0, 0x0, 0x0
    .long 0x10fa000, 0x3de800, 0x1281000, 0x6020107, 0x44e800, 0xfffffe80, 0x0, 0x0, 0xae7000, 0x141c00, 0xbf7000, 0x1780020c, 0x2c1c00, 0x60, 0x0, 0x0, 0x0, 0x0, 0x0, 0x0, 0x0, 0x0, 0x0, 0x0, 0x0, 0x0, 0x0, 0x0, 0x0, 0x0, 0x0, 0x0, 0x0, 0x0, 0x0, 0x0, 0x0, 0x0, 0x0, 0x0
    .long 0x10fa400, 0x3de900, 0x1281000, 0x6020107, 0x44e800, 0xfffffe80, 0x0, 0x0, 0xae7400, 0x141d00, 0xbf7000, 0x1780020c, 0x2c1c00, 0x60, 0x0, 0x0, 0x0, 0x0, 0x0, 0x0, 0x0, 0x0, 0x0, 0x0, 0x0, 0x0, 0x0, 0x0, 0x0, 0x0, 0x0, 0x0, 0x0, 0x0, 0x0, 0x0, 0x0, 0x0, 0x0, 0x0
    .long 0x10fa800, 0x3dea00, 0x1281000, 0x6020107, 0x44e800, 0xfffffe80, 0x0, 0x0, 0xae7800, 0x141e00, 0xbf7000, 0x1780020c, 0x2c1c00, 0x60, 0x0, 0x0, 0x0, 0x0, 0x0, 0x0, 0x0, 0x0, 0x0, 0x0, 0x0, 0x0, 0x0, 0x0, 0x0, 0x0, 0x0, 0x0, 0x0, 0x0, 0x0, 0x0, 0x0, 0x0, 0x0, 0x0
    .long 0x10fac00, 0x3deb00, 0x1281000, 0x6020107, 0x44e800, 0xfffffe80, 0x0, 0x0, 0xae7c00, 0x141f00, 0xbf7000, 0x1780020c, 0x2c1c00, 0x60, 0x0, 0x0, 0x0, 0x0, 0x0, 0x0, 0x0, 0x0, 0x0, 0x0, 0x0, 0x0, 0x0, 0x0, 0x0, 0x0, 0x0, 0x0, 0x0, 0x0, 0x0, 0x0, 0x0, 0x0, 0x0, 0x0
    .long 0x4c3000, 0xe0c00, 0x507000, 0x5020106, 0x140c00, 0xfffffec0, 0x0, 0x0, 0x1aa7000, 0x539c00, 0x1c0c000, 0x1700020c, 0x6b9c00, 0x40, 0x0, 0x0, 0x0, 0x0, 0x0, 0x0, 0x0, 0x0, 0x0, 0x0, 0x0, 0x0, 0x0, 0x0, 0x0, 0x0, 0x0, 0x0, 0x0, 0x0, 0x0, 0x0, 0x0, 0x0, 0x0, 0x0
    .long 0x4c3400, 0xe0d00, 0x507000, 0x5020106, 0x140c00, 0xfffffec0, 0x0, 0x0, 0x1aa7400, 0x539d00, 0x1c0c000, 0x1700020c, 0x6b9c00, 0x40, 0x0, 0x0, 0x0, 0x0, 0x0, 0x0, 0x0, 0x0, 0x0, 0x0, 0x0, 0x0, 0x0, 0x0, 0x0, 0x0, 0x0, 0x0, 0x0, 0x0, 0x0, 0x0, 0x0, 0x0, 0x0, 0x0
    .long 0x4c3800, 0xe0e00, 0x507000, 0x5020106, 0x140c00, 0xfffffec0, 0x0, 0x0, 0x1aa7800, 0x539e00, 0x1c0c000, 0x1700020c, 0x6b9c00, 0x40, 0x0, 0x0, 0x0, 0x0, 0x0, 0x0, 0x0, 0x0, 0x0, 0x0, 0x0, 0x0, 0x0, 0x0, 0x0, 0x0, 0x0, 0x0, 0x0, 0x0, 0x0, 0x0, 0x0, 0x0, 0x0, 0x0
    .long 0x4c3c00, 0xe0f00, 0x507000, 0x5020106, 0x140c00, 0xfffffec0, 0x0, 0x0, 0x1aa7c00, 0x539f00, 0x1c0c000, 0x1700020c, 0x6b9c00, 0x40, 0x0, 0x0, 0x0, 0x0, 0x0, 0x0, 0x0, 0x0, 0x0, 0x0, 0x0, 0x0, 0x0, 0x0, 0x0, 0x0, 0x0, 0x0, 0x0, 0x0, 0x0, 0x0, 0x0, 0x0, 0x0, 0x0
    .long 0xeb5000, 0x34d400, 0xf7a000, 0x6020107, 0x3bd400, 0xfffffe80, 0x0, 0x0, 0xac7000, 0x141c00, 0xbf7000, 0x1700020c, 0x2c1c00, 0x40, 0x0, 0x0, 0x0, 0x0, 0x0, 0x0, 0x0, 0x0, 0x0, 0x0, 0x0, 0x0, 0x0, 0x0, 0x0, 0x0, 0x0, 0x0, 0x0, 0x0, 0x0, 0x0, 0x0, 0x0, 0x0, 0x0
    .long 0xeb5400, 0x34d500, 0xf7a000, 0x6020107, 0x3bd400, 0xfffffe80, 0x0, 0x0, 0xac7400, 0x141d00, 0xbf7000, 0x1700020c, 0x2c1c00, 0x40, 0x0, 0x0, 0x0, 0x0, 0x0, 0x0, 0x0, 0x0, 0x0, 0x0, 0x0, 0x0, 0x0, 0x0, 0x0, 0x0, 0x0, 0x0, 0x0, 0x0, 0x0, 0x0, 0x0, 0x0, 0x0, 0x0
    .long 0xeb5800, 0x34d600, 0xf7a000, 0x6020107, 0x3bd400, 0xfffffe80, 0x0, 0x0, 0xac7800, 0x141e00, 0xbf7000, 0x1700020c, 0x2c1c00, 0x40, 0x0, 0x0, 0x0, 0x0, 0x0, 0x0, 0x0, 0x0, 0x0, 0x0, 0x0, 0x0, 0x0, 0x0, 0x0, 0x0, 0x0, 0x0, 0x0, 0x0, 0x0, 0x0, 0x0, 0x0, 0x0, 0x0
    .long 0xeb5c00, 0x34d700, 0xf7a000, 0x6020107, 0x3bd400, 0xfffffe80, 0x0, 0x0, 0xac7c00, 0x141f00, 0xbf7000, 0x1700020c, 0x2c1c00, 0x40, 0x0, 0x0, 0x0, 0x0, 0x0, 0x0, 0x0, 0x0, 0x0, 0x0, 0x0, 0x0, 0x0, 0x0, 0x0, 0x0, 0x0, 0x0, 0x0, 0x0, 0x0, 0x0, 0x0, 0x0, 0x0, 0x0
    .long 0x140000, 0x0, 0x383000, 0x5020106, 0x60000, 0xfffffec0, 0x0, 0x0, 0x1a87000, 0x539c00, 0x1c0c000, 0x1680020c, 0x6a9c00, 0x20, 0x0, 0x0, 0x0, 0x0, 0x0, 0x0, 0x0, 0x0, 0x0, 0x0, 0x0, 0x0, 0x0, 0x0, 0x0, 0x0, 0x0, 0x0, 0x0, 0x0, 0x0, 0x0, 0x0, 0x0, 0x0, 0x0
    .long 0x140400, 0x100, 0x383000, 0x5020106, 0x60000, 0xfffffec0, 0x0, 0x0, 0x1a87400, 0x539d00, 0x1c0c000, 0x1680020c, 0x6a9c00, 0x20, 0x0, 0x0, 0x0, 0x0, 0x0, 0x0, 0x0, 0x0, 0x0, 0x0, 0x0, 0x0, 0x0, 0x0, 0x0, 0x0, 0x0, 0x0, 0x0, 0x0, 0x0, 0x0, 0x0, 0x0, 0x0, 0x0
    .long 0x140800, 0x200, 0x383000, 0x5020106, 0x60000, 0xfffffec0, 0x0, 0x0, 0x1a87800, 0x539e00, 0x1c0c000, 0x1680020c, 0x6a9c00, 0x20, 0x0, 0x0, 0x0, 0x0, 0x0, 0x0, 0x0, 0x0, 0x0, 0x0, 0x0, 0x0, 0x0, 0x0, 0x0, 0x0, 0x0, 0x0, 0x0, 0x0, 0x0, 0x0, 0x0, 0x0, 0x0, 0x0
    .long 0x140c00, 0x300, 0x383000, 0x5020106, 0x60000, 0xfffffec0, 0x0, 0x0, 0x1a87c00, 0x539f00, 0x1c0c000, 0x1680020c, 0x6a9c00, 0x20, 0x0, 0x0, 0x0, 0x0, 0x0, 0x0, 0x0, 0x0, 0x0, 0x0, 0x0, 0x0, 0x0, 0x0, 0x0, 0x0, 0x0, 0x0, 0x0, 0x0, 0x0, 0x0, 0x0, 0x0, 0x0, 0x0
    .long 0x687000, 0x141c00, 0xbf7000, 0x6020107, 0x1b1c00, 0xfffffe80, 0x0, 0x0, 0xaa7000, 0x141c00, 0xbf7000, 0x1680020c, 0x2b1c00, 0x20, 0x0, 0x0, 0x0, 0x0, 0x0, 0x0, 0x0, 0x0, 0x0, 0x0, 0x0, 0x0, 0x0, 0x0, 0x0, 0x0, 0x0, 0x0, 0x0, 0x0, 0x0, 0x0, 0x0, 0x0, 0x0, 0x0
    .long 0x687400, 0x141d00, 0xbf7000, 0x6020107, 0x1b1c00, 0xfffffe80, 0x0, 0x0, 0xaa7400, 0x141d00, 0xbf7000, 0x1680020c, 0x2b1c00, 0x20, 0x0, 0x0, 0x0, 0x0, 0x0, 0x0, 0x0, 0x0, 0x0, 0x0, 0x0, 0x0, 0x0, 0x0, 0x0, 0x0, 0x0, 0x0, 0x0, 0x0, 0x0, 0x0, 0x0, 0x0, 0x0, 0x0
    .long 0x687800, 0x141e00, 0xbf7000, 0x6020107, 0x1b1c00, 0xfffffe80, 0x0, 0x0, 0xaa7800, 0x141e00, 0xbf7000, 0x1680020c, 0x2b1c00, 0x20, 0x0, 0x0, 0x0, 0x0, 0x0, 0x0, 0x0, 0x0, 0x0, 0x0, 0x0, 0x0, 0x0, 0x0, 0x0, 0x0, 0x0, 0x0, 0x0, 0x0, 0x0, 0x0, 0x0, 0x0, 0x0, 0x0
    .long 0x687c00, 0x141f00, 0xbf7000, 0x6020107, 0x1b1c00, 0xfffffe80, 0x0, 0x0, 0xaa7c00, 0x141f00, 0xbf7000, 0x1680020c, 0x2b1c00, 0x20, 0x0, 0x0, 0x0, 0x0, 0x0, 0x0, 0x0, 0x0, 0x0, 0x0, 0x0, 0x0, 0x0, 0x0, 0x0, 0x0, 0x0, 0x0, 0x0, 0x0, 0x0, 0x0, 0x0, 0x0, 0x0, 0x0
    .long 0x2c0000, 0x0, 0x383000, 0xb01010c, 0xc0000, 0xfffffd40, 0x0, 0x0, 0x1667000, 0x539c00, 0x1c0c000, 0x6000107, 0x5a9c00, 0xfffffe80, 0x0, 0x0, 0x0, 0x0, 0x0, 0x0, 0x0, 0x0, 0x0, 0x0, 0x0, 0x0, 0x0, 0x0, 0x0, 0x0, 0x0, 0x0, 0x0, 0x0, 0x0, 0x0, 0x0, 0x0, 0x0, 0x0
    .long 0x2c0400, 0x100, 0x383000, 0xb01010c, 0xc0000, 0xfffffd40, 0x0, 0x0, 0x1667400, 0x539d00, 0x1c0c000, 0x6000107, 0x5a9c00, 0xfffffe80, 0x0, 0x0, 0x0, 0x0, 0x0, 0x0, 0x0, 0x0, 0x0, 0x0, 0x0, 0x0, 0x0, 0x0, 0x0, 0x0, 0x0, 0x0, 0x0, 0x0, 0x0, 0x0, 0x0, 0x0, 0x0, 0x0
    .long 0x2c0800, 0x200, 0x383000, 0xb01010c, 0xc0000, 0xfffffd40, 0x0, 0x0, 0x1667800, 0x539e00, 0x1c0c000, 0x6000107, 0x5a9c00, 0xfffffe80, 0x0, 0x0, 0x0, 0x0, 0x0, 0x0, 0x0, 0x0, 0x0, 0x0, 0x0, 0x0, 0x0, 0x0, 0x0, 0x0, 0x0, 0x0, 0x0, 0x0, 0x0, 0x0, 0x0, 0x0, 0x0, 0x0
    .long 0x2c0c00, 0x300, 0x383000, 0xb01010c, 0xc0000, 0xfffffd40, 0x0, 0x0, 0x1667c00, 0x539f00, 0x1c0c000, 0x6000107, 0x5a9c00, 0xfffffe80, 0x0, 0x0, 0x0, 0x0, 0x0, 0x0, 0x0, 0x0, 0x0, 0x0, 0x0, 0x0, 0x0, 0x0, 0x0, 0x0, 0x0, 0x0, 0x0, 0x0, 0x0, 0x0, 0x0, 0x0, 0x0, 0x0
    .long 0x14c1000, 0x4a0400, 0x14e7000, 0x901010a, 0x539c00, 0xfffffdc0, 0x0, 0x0, 0x1481000, 0x4a0400, 0x14e7000, 0x8000109, 0x530400, 0xfffffe00, 0x0, 0x0, 0x0, 0x0, 0x0, 0x0, 0x0, 0x0, 0x0, 0x0, 0x0, 0x0, 0x0, 0x0, 0x0, 0x0, 0x0, 0x0, 0x0, 0x0, 0x0, 0x0, 0x0, 0x0, 0x0, 0x0
    .long 0x14c1400, 0x4a0500, 0x14e7000, 0x901010a, 0x539c00, 0xfffffdc0, 0x0, 0x0, 0x1481400, 0x4a0500, 0x14e7000, 0x8000109, 0x530400, 0xfffffe00, 0x0, 0x0, 0x0, 0x0, 0x0, 0x0, 0x0, 0x0, 0x0, 0x0, 0x0, 0x0, 0x0, 0x0, 0x0, 0x0, 0x0, 0x0, 0x0, 0x0, 0x0, 0x0, 0x0, 0x0, 0x0, 0x0
    .long 0x14c1800, 0x4a0600, 0x14e7000, 0x901010a, 0x539c00, 0xfffffdc0, 0x0, 0x0, 0x1481800, 0x4a0600, 0x14e7000, 0x8000109, 0x530400, 0xfffffe00, 0x0, 0x0, 0x0, 0x0, 0x0, 0x0, 0x0, 0x0, 0x0, 0x0, 0x0, 0x0, 0x0, 0x0, 0x0, 0x0, 0x0, 0x0, 0x0, 0x0, 0x0, 0x0, 0x0, 0x0, 0x0, 0x0
    .long 0x14c1c00, 0x4a0700, 0x14e7000, 0x901010a, 0x539c00, 0xfffffdc0, 0x0, 0x0, 0x1481c00, 0x4a0700, 0x14e7000, 0x8000109, 0x530400, 0xfffffe00, 0x0, 0x0, 0x0, 0x0, 0x0, 0x0, 0x0, 0x0, 0x0, 0x0, 0x0, 0x0, 0x0, 0x0, 0x0, 0x0, 0x0, 0x0, 0x0, 0x0, 0x0, 0x0, 0x0, 0x0, 0x0, 0x0
    .long 0x180000, 0x0, 0x383000, 0x6020107, 0x70000, 0xfffffe80, 0x0, 0x0, 0x1a47000, 0x539c00, 0x1c0c000, 0x1580020b, 0x699c00, 0x60, 0x0, 0x0, 0x0, 0x0, 0x0, 0x0, 0x0, 0x0, 0x0, 0x0, 0x0, 0x0, 0x0, 0x0, 0x0, 0x0, 0x0, 0x0, 0x0, 0x0, 0x0, 0x0, 0x0, 0x0, 0x0, 0x0
    .long 0x180400, 0x100, 0x383000, 0x6020107, 0x70000, 0xfffffe80, 0x0, 0x0, 0x1a47400, 0x539d00, 0x1c0c000, 0x1580020b, 0x699c00, 0x60, 0x0, 0x0, 0x0, 0x0, 0x0, 0x0, 0x0, 0x0, 0x0, 0x0, 0x0, 0x0, 0x0, 0x0, 0x0, 0x0, 0x0, 0x0, 0x0, 0x0, 0x0, 0x0, 0x0, 0x0, 0x0, 0x0
    .long 0x180800, 0x200, 0x383000, 0x6020107, 0x70000, 0xfffffe80, 0x0, 0x0, 0x1a47800, 0x539e00, 0x1c0c000, 0x1580020b, 0x699c00, 0x60, 0x0, 0x0, 0x0, 0x0, 0x0, 0x0, 0x0, 0x0, 0x0, 0x0, 0x0, 0x0, 0x0, 0x0, 0x0, 0x0, 0x0, 0x0, 0x0, 0x0, 0x0, 0x0, 0x0, 0x0, 0x0, 0x0
    .long 0x180c00, 0x300, 0x383000, 0x6020107, 0x70000, 0xfffffe80, 0x0, 0x0, 0x1a47c00, 0x539f00, 0x1c0c000, 0x1580020b, 0x699c00, 0x60, 0x0, 0x0, 0x0, 0x0, 0x0, 0x0, 0x0, 0x0, 0x0, 0x0, 0x0, 0x0, 0x0, 0x0, 0x0, 0x0, 0x0, 0x0, 0x0, 0x0, 0x0, 0x0, 0x0, 0x0, 0x0, 0x0
    .long 0x11fa000, 0x3de800, 0x1281000, 0xa01010b, 0x48e800, 0xfffffd80, 0x0, 0x0, 0x117a000, 0x3de800, 0x1281000, 0x8000109, 0x46e800, 0xfffffe00, 0x0, 0x0, 0x0, 0x0, 0x0, 0x0, 0x0, 0x0, 0x0, 0x0, 0x0, 0x0, 0x0, 0x0, 0x0, 0x0, 0x0, 0x0, 0x0, 0x0, 0x0, 0x0, 0x0, 0x0, 0x0, 0x0
    .long 0x11fa400, 0x3de900, 0x1281000, 0xa01010b, 0x48e800, 0xfffffd80, 0x0, 0x0, 0x117a400, 0x3de900, 0x1281000, 0x8000109, 0x46e800, 0xfffffe00, 0x0, 0x0, 0x0, 0x0, 0x0, 0x0, 0x0, 0x0, 0x0, 0x0, 0x0, 0x0, 0x0, 0x0, 0x0, 0x0, 0x0, 0x0, 0x0, 0x0, 0x0, 0x0, 0x0, 0x0, 0x0, 0x0
    .long 0x11fa800, 0x3dea00, 0x1281000, 0xa01010b, 0x48e800, 0xfffffd80, 0x0, 0x0, 0x117a800, 0x3dea00, 0x1281000, 0x8000109, 0x46e800, 0xfffffe00, 0x0, 0x0, 0x0, 0x0, 0x0, 0x0, 0x0, 0x0, 0x0, 0x0, 0x0, 0x0, 0x0, 0x0, 0x0, 0x0, 0x0, 0x0, 0x0, 0x0, 0x0, 0x0, 0x0, 0x0, 0x0, 0x0
    .long 0x11fac00, 0x3deb00, 0x1281000, 0xa01010b, 0x48e800, 0xfffffd80, 0x0, 0x0, 0x117ac00, 0x3deb00, 0x1281000, 0x8000109, 0x46e800, 0xfffffe00, 0x0, 0x0, 0x0, 0x0, 0x0, 0x0, 0x0, 0x0, 0x0, 0x0, 0x0, 0x0, 0x0, 0x0, 0x0, 0x0, 0x0, 0x0, 0x0, 0x0, 0x0, 0x0, 0x0, 0x0, 0x0, 0x0
    .long 0x1767000, 0x539c00, 0x1c0c000, 0xa01010b, 0x5e9c00, 0xfffffd80, 0x0, 0x0, 0x16a7000, 0x539c00, 0x1c0c000, 0x7000108, 0x5b9c00, 0xfffffe40, 0x0, 0x0, 0x0, 0x0, 0x0, 0x0, 0x0, 0x0, 0x0, 0x0, 0x0, 0x0, 0x0, 0x0, 0x0, 0x0, 0x0, 0x0, 0x0, 0x0, 0x0, 0x0, 0x0, 0x0, 0x0, 0x0
    .long 0x1767400, 0x539d00, 0x1c0c000, 0xa01010b, 0x5e9c00, 0xfffffd80, 0x0, 0x0, 0x16a7400, 0x539d00, 0x1c0c000, 0x7000108, 0x5b9c00, 0xfffffe40, 0x0, 0x0, 0x0, 0x0, 0x0, 0x0, 0x0, 0x0, 0x0, 0x0, 0x0, 0x0, 0x0, 0x0, 0x0, 0x0, 0x0, 0x0, 0x0, 0x0, 0x0, 0x0, 0x0, 0x0, 0x0, 0x0
    .long 0x1767800, 0x539e00, 0x1c0c000, 0xa01010b, 0x5e9c00, 0xfffffd80, 0x0, 0x0, 0x16a7800, 0x539e00, 0x1c0c000, 0x7000108, 0x5b9c00, 0xfffffe40, 0x0, 0x0, 0x0, 0x0, 0x0, 0x0, 0x0, 0x0, 0x0, 0x0, 0x0, 0x0, 0x0, 0x0, 0x0, 0x0, 0x0, 0x0, 0x0, 0x0, 0x0, 0x0, 0x0, 0x0, 0x0, 0x0
    .long 0x1767c00, 0x539f00, 0x1c0c000, 0xa01010b, 0x5e9c00, 0xfffffd80, 0x0, 0x0, 0x16a7c00, 0x539f00, 0x1c0c000, 0x7000108, 0x5b9c00, 0xfffffe40, 0x0, 0x0, 0x0, 0x0, 0x0, 0x0, 0x0, 0x0, 0x0, 0x0, 0x0, 0x0, 0x0, 0x0, 0x0, 0x0, 0x0, 0x0, 0x0, 0x0, 0x0, 0x0, 0x0, 0x0, 0x0, 0x0
    .long 0x787000, 0x141c00, 0xbf7000, 0xa01010b, 0x1f1c00, 0xfffffd80, 0x0, 0x0, 0xf35000, 0x34d400, 0xf7a000, 0x8000109, 0x3dd400, 0xfffffe00, 0x0, 0x0, 0x0, 0x0, 0x0, 0x0, 0x0, 0x0, 0x0, 0x0, 0x0, 0x0, 0x0, 0x0, 0x0, 0x0, 0x0, 0x0, 0x0, 0x0, 0x0, 0x0, 0x0, 0x0, 0x0, 0x0
    .long 0x787400, 0x141d00, 0xbf7000, 0xa01010b, 0x1f1c00, 0xfffffd80, 0x0, 0x0, 0xf35400, 0x34d500, 0xf7a000, 0x8000109, 0x3dd400, 0xfffffe00, 0x0, 0x0, 0x0, 0x0, 0x0, 0x0, 0x0, 0x0, 0x0, 0x0, 0x0, 0x0, 0x0, 0x0, 0x0, 0x0, 0x0, 0x0, 0x0, 0x0, 0x0, 0x0, 0x0, 0x0, 0x0, 0x0
    .long 0x787800, 0x141e00, 0xbf7000, 0xa01010b, 0x1f1c00, 0xfffffd80, 0x0, 0x0, 0xf35800, 0x34d600, 0xf7a000, 0x8000109, 0x3dd400, 0xfffffe00, 0x0, 0x0, 0x0, 0x0, 0x0, 0x0, 0x0, 0x0, 0x0, 0x0, 0x0, 0x0, 0x0, 0x0, 0x0, 0x0, 0x0, 0x0, 0x0, 0x0, 0x0, 0x0, 0x0, 0x0, 0x0, 0x0
    .long 0x787c00, 0x141f00, 0xbf7000, 0xa01010b, 0x1f1c00, 0xfffffd80, 0x0, 0x0, 0xf35c00, 0x34d700, 0xf7a000, 0x8000109, 0x3dd400, 0xfffffe00, 0x0, 0x0, 0x0, 0x0, 0x0, 0x0, 0x0, 0x0, 0x0, 0x0, 0x0, 0x0, 0x0, 0x0, 0x0, 0x0, 0x0, 0x0, 0x0, 0x0, 0x0, 0x0, 0x0, 0x0, 0x0, 0x0
    .long 0x1c0000, 0x0, 0x383000, 0x7020108, 0x80000, 0xfffffe40, 0x0, 0x0, 0x1a27000, 0x539c00, 0x1c0c000, 0x1500020b, 0x699c00, 0x40, 0x0, 0x0, 0x0, 0x0, 0x0, 0x0, 0x0, 0x0, 0x0, 0x0, 0x0, 0x0, 0x0, 0x0, 0x0, 0x0, 0x0, 0x0, 0x0, 0x0, 0x0, 0x0, 0x0, 0x0, 0x0, 0x0
    .long 0x1c0400, 0x100, 0x383000, 0x7020108, 0x80000, 0xfffffe40, 0x0, 0x0, 0x1a27400, 0x539d00, 0x1c0c000, 0x1500020b, 0x699c00, 0x40, 0x0, 0x0, 0x0, 0x0, 0x0, 0x0, 0x0, 0x0, 0x0, 0x0, 0x0, 0x0, 0x0, 0x0, 0x0, 0x0, 0x0, 0x0, 0x0, 0x0, 0x0, 0x0, 0x0, 0x0, 0x0, 0x0
    .long 0x1c0800, 0x200, 0x383000, 0x7020108, 0x80000, 0xfffffe40, 0x0, 0x0, 0x1a27800, 0x539e00, 0x1c0c000, 0x1500020b, 0x699c00, 0x40, 0x0, 0x0, 0x0, 0x0, 0x0, 0x0, 0x0, 0x0, 0x0, 0x0, 0x0, 0x0, 0x0, 0x0, 0x0, 0x0, 0x0, 0x0, 0x0, 0x0, 0x0, 0x0, 0x0, 0x0, 0x0, 0x0
    .long 0x1c0c00, 0x300, 0x383000, 0x7020108, 0x80000, 0xfffffe40, 0x0, 0x0, 0x1a27c00, 0x539f00, 0x1c0c000, 0x1500020b, 0x699c00, 0x40, 0x0, 0x0, 0x0, 0x0, 0x0, 0x0, 0x0, 0x0, 0x0, 0x0, 0x0, 0x0, 0x0, 0x0, 0x0, 0x0, 0x0, 0x0, 0x0, 0x0, 0x0, 0x0, 0x0, 0x0, 0x0, 0x0
    .long 0x11ba000, 0x3de800, 0x1281000, 0x901010a, 0x47e800, 0xfffffdc0, 0x0, 0x0, 0x747000, 0x141c00, 0xbf7000, 0x900010a, 0x1e1c00, 0xfffffdc0, 0x0, 0x0, 0x0, 0x0, 0x0, 0x0, 0x0, 0x0, 0x0, 0x0, 0x0, 0x0, 0x0, 0x0, 0x0, 0x0, 0x0, 0x0, 0x0, 0x0, 0x0, 0x0, 0x0, 0x0, 0x0, 0x0
    .long 0x11ba400, 0x3de900, 0x1281000, 0x901010a, 0x47e800, 0xfffffdc0, 0x0, 0x0, 0x747400, 0x141d00, 0xbf7000, 0x900010a, 0x1e1c00, 0xfffffdc0, 0x0, 0x0, 0x0, 0x0, 0x0, 0x0, 0x0, 0x0, 0x0, 0x0, 0x0, 0x0, 0x0, 0x0, 0x0, 0x0, 0x0, 0x0, 0x0, 0x0, 0x0, 0x0, 0x0, 0x0, 0x0, 0x0
    .long 0x11ba800, 0x3dea00, 0x1281000, 0x901010a, 0x47e800, 0xfffffdc0, 0x0, 0x0, 0x747800, 0x141e00, 0xbf7000, 0x900010a, 0x1e1c00, 0xfffffdc0, 0x0, 0x0, 0x0, 0x0, 0x0, 0x0, 0x0, 0x0, 0x0, 0x0, 0x0, 0x0, 0x0, 0x0, 0x0, 0x0, 0x0, 0x0, 0x0, 0x0, 0x0, 0x0, 0x0, 0x0, 0x0, 0x0
    .long 0x11bac00, 0x3deb00, 0x1281000, 0x901010a, 0x47e800, 0xfffffdc0, 0x0, 0x0, 0x747c00, 0x141f00, 0xbf7000, 0x900010a, 0x1e1c00, 0xfffffdc0, 0x0, 0x0, 0x0, 0x0, 0x0, 0x0, 0x0, 0x0, 0x0, 0x0, 0x0, 0x0, 0x0, 0x0, 0x0, 0x0, 0x0, 0x0, 0x0, 0x0, 0x0, 0x0, 0x0, 0x0, 0x0, 0x0
    .long 0x240000, 0x0, 0x383000, 0x901010a, 0xa0000, 0xfffffdc0, 0x0, 0x0, 0x16e7000, 0x539c00, 0x1c0c000, 0x8000109, 0x5c9c00, 0xfffffe00, 0x0, 0x0, 0x0, 0x0, 0x0, 0x0, 0x0, 0x0, 0x0, 0x0, 0x0, 0x0, 0x0, 0x0, 0x0, 0x0, 0x0, 0x0, 0x0, 0x0, 0x0, 0x0, 0x0, 0x0, 0x0, 0x0
    .long 0x240400, 0x100, 0x383000, 0x901010a, 0xa0000, 0xfffffdc0, 0x0, 0x0, 0x16e7400, 0x539d00, 0x1c0c000, 0x8000109, 0x5c9c00, 0xfffffe00, 0x0, 0x0, 0x0, 0x0, 0x0, 0x0, 0x0, 0x0, 0x0, 0x0, 0x0, 0x0, 0x0, 0x0, 0x0, 0x0, 0x0, 0x0, 0x0, 0x0, 0x0, 0x0, 0x0, 0x0, 0x0, 0x0
    .long 0x240800, 0x200, 0x383000, 0x901010a, 0xa0000, 0xfffffdc0, 0x0, 0x0, 0x16e7800, 0x539e00, 0x1c0c000, 0x8000109, 0x5c9c00, 0xfffffe00, 0x0, 0x0, 0x0, 0x0, 0x0, 0x0, 0x0, 0x0, 0x0, 0x0, 0x0, 0x0, 0x0, 0x0, 0x0, 0x0, 0x0, 0x0, 0x0, 0x0, 0x0, 0x0, 0x0, 0x0, 0x0, 0x0
    .long 0x240c00, 0x300, 0x383000, 0x901010a, 0xa0000, 0xfffffdc0, 0x0, 0x0, 0x16e7c00, 0x539f00, 0x1c0c000, 0x8000109, 0x5c9c00, 0xfffffe00, 0x0, 0x0, 0x0, 0x0, 0x0, 0x0, 0x0, 0x0, 0x0, 0x0, 0x0, 0x0, 0x0, 0x0, 0x0, 0x0, 0x0, 0x0, 0x0, 0x0, 0x0, 0x0, 0x0, 0x0, 0x0, 0x0
    .long 0x847000, 0x141c00, 0xbf7000, 0xd02010e, 0x221c00, 0xfffffcc0, 0x0, 0x0, 0xf75000, 0x34d400, 0xf7a000, 0x9000205, 0x3de800, 0x40, 0x0, 0x0, 0x0, 0x0, 0x0, 0x0, 0x0, 0x0, 0x0, 0x0, 0x0, 0x0, 0x0, 0x0, 0x0, 0x0, 0x0, 0x0, 0x0, 0x0, 0x0, 0x0, 0x0, 0x0, 0x0, 0x0
    .long 0x847400, 0x141d00, 0xbf7000, 0xd02010e, 0x221c00, 0xfffffcc0, 0x0, 0x0, 0xf75400, 0x34d500, 0xf7a000, 0x9000205, 0x3de800, 0x40, 0x0, 0x0, 0x0, 0x0, 0x0, 0x0, 0x0, 0x0, 0x0, 0x0, 0x0, 0x0, 0x0, 0x0, 0x0, 0x0, 0x0, 0x0, 0x0, 0x0, 0x0, 0x0, 0x0, 0x0, 0x0, 0x0
    .long 0x847800, 0x141e00, 0xbf7000, 0xd02010e, 0x221c00, 0xfffffcc0, 0x0, 0x0, 0xf75800, 0x34d600, 0xf7a000, 0x9000205, 0x3de800, 0x40, 0x0, 0x0, 0x0, 0x0, 0x0, 0x0, 0x0, 0x0, 0x0, 0x0, 0x0, 0x0, 0x0, 0x0, 0x0, 0x0, 0x0, 0x0, 0x0, 0x0, 0x0, 0x0, 0x0, 0x0, 0x0, 0x0
    .long 0x847c00, 0x141f00, 0xbf7000, 0xd02010e, 0x221c00, 0xfffffcc0, 0x0, 0x0, 0xf75c00, 0x34d700, 0xf7a000, 0x9000205, 0x3de800, 0x40, 0x0, 0x0, 0x0, 0x0, 0x0, 0x0, 0x0, 0x0, 0x0, 0x0, 0x0, 0x0, 0x0, 0x0, 0x0, 0x0, 0x0, 0x0, 0x0, 0x0, 0x0, 0x0, 0x0, 0x0, 0x0, 0x0
    .long 0x280000, 0x0, 0x383000, 0xa02010b, 0xb0000, 0xfffffd80, 0x0, 0x0, 0x380000, 0x0, 0x383000, 0xe000208, 0xe0c00, 0x0, 0x0, 0x0, 0x0, 0x0, 0x0, 0x0, 0x0, 0x0, 0x0, 0x0, 0x0, 0x0, 0x0, 0x0, 0x0, 0x0, 0x0, 0x0, 0x0, 0x0, 0x0, 0x0, 0x0, 0x0, 0x0, 0x0
    .long 0x280400, 0x100, 0x383000, 0xa02010b, 0xb0000, 0xfffffd80, 0x0, 0x0, 0x380400, 0x100, 0x383000, 0xe000208, 0xe0c00, 0x0, 0x0, 0x0, 0x0, 0x0, 0x0, 0x0, 0x0, 0x0, 0x0, 0x0, 0x0, 0x0, 0x0, 0x0, 0x0, 0x0, 0x0, 0x0, 0x0, 0x0, 0x0, 0x0, 0x0, 0x0, 0x0, 0x0
    .long 0x280800, 0x200, 0x383000, 0xa02010b, 0xb0000, 0xfffffd80, 0x0, 0x0, 0x380800, 0x200, 0x383000, 0xe000208, 0xe0c00, 0x0, 0x0, 0x0, 0x0, 0x0, 0x0, 0x0, 0x0, 0x0, 0x0, 0x0, 0x0, 0x0, 0x0, 0x0, 0x0, 0x0, 0x0, 0x0, 0x0, 0x0, 0x0, 0x0, 0x0, 0x0, 0x0, 0x0
    .long 0x280c00, 0x300, 0x383000, 0xa02010b, 0xb0000, 0xfffffd80, 0x0, 0x0, 0x380c00, 0x300, 0x383000, 0xe000208, 0xe0c00, 0x0, 0x0, 0x0, 0x0, 0x0, 0x0, 0x0, 0x0, 0x0, 0x0, 0x0, 0x0, 0x0, 0x0, 0x0, 0x0, 0x0, 0x0, 0x0, 0x0, 0x0, 0x0, 0x0, 0x0, 0x0, 0x0, 0x0
    .long 0x123a000, 0x3de800, 0x1281000, 0xb01010c, 0x49e800, 0xfffffd40, 0x0, 0x0, 0xdf5000, 0x34d400, 0xf7a000, 0x3010104, 0x38d400, 0xffffff40, 0x0, 0x0, 0x1281000, 0x4a0400, 0x14e7000, 0x101, 0x4b0400, 0x0, 0x0, 0x0, 0x0, 0x0, 0x0, 0x0, 0x0, 0x0, 0x0, 0x0, 0x0, 0x0, 0x0, 0x0, 0x0, 0x0, 0x0, 0x0
    .long 0x123a400, 0x3de900, 0x1281000, 0xb01010c, 0x49e800, 0xfffffd40, 0x0, 0x0, 0xdf5400, 0x34d500, 0xf7a000, 0x3010104, 0x38d400, 0xffffff40, 0x0, 0x0, 0x1281400, 0x4a0500, 0x14e7000, 0x101, 0x4b0400, 0x0, 0x0, 0x0, 0x0, 0x0, 0x0, 0x0, 0x0, 0x0, 0x0, 0x0, 0x0, 0x0, 0x0, 0x0, 0x0, 0x0, 0x0, 0x0
    .long 0x123a800, 0x3dea00, 0x1281000, 0xb01010c, 0x49e800, 0xfffffd40, 0x0, 0x0, 0xdf5800, 0x34d600, 0xf7a000, 0x3010104, 0x38d400, 0xffffff40, 0x0, 0x0, 0x1281800, 0x4a0600, 0x14e7000, 0x101, 0x4b0400, 0x0, 0x0, 0x0, 0x0, 0x0, 0x0, 0x0, 0x0, 0x0, 0x0, 0x0, 0x0, 0x0, 0x0, 0x0, 0x0, 0x0, 0x0, 0x0
    .long 0x123ac00, 0x3deb00, 0x1281000, 0xb01010c, 0x49e800, 0xfffffd40, 0x0, 0x0, 0xdf5c00, 0x34d700, 0xf7a000, 0x3010104, 0x38d400, 0xffffff40, 0x0, 0x0, 0x1281c00, 0x4a0700, 0x14e7000, 0x101, 0x4b0400, 0x0, 0x0, 0x0, 0x0, 0x0, 0x0, 0x0, 0x0, 0x0, 0x0, 0x0, 0x0, 0x0, 0x0, 0x0, 0x0, 0x0, 0x0, 0x0
    .long 0x17e7000, 0x539c00, 0x1c0c000, 0xc02010d, 0x609c00, 0xfffffd00, 0x0, 0x0, 0x17c7000, 0x539c00, 0x1c0c000, 0xb800206, 0x5f9c00, 0x60, 0x0, 0x0, 0x0, 0x0, 0x0, 0x0, 0x0, 0x0, 0x0, 0x0, 0x0, 0x0, 0x0, 0x0, 0x0, 0x0, 0x0, 0x0, 0x0, 0x0, 0x0, 0x0, 0x0, 0x0, 0x0, 0x0
    .long 0x17e7400, 0x539d00, 0x1c0c000, 0xc02010d, 0x609c00, 0xfffffd00, 0x0, 0x0, 0x17c7400, 0x539d00, 0x1c0c000, 0xb800206, 0x5f9c00, 0x60, 0x0, 0x0, 0x0, 0x0, 0x0, 0x0, 0x0, 0x0, 0x0, 0x0, 0x0, 0x0, 0x0, 0x0, 0x0, 0x0, 0x0, 0x0, 0x0, 0x0, 0x0, 0x0, 0x0, 0x0, 0x0, 0x0
    .long 0x17e7800, 0x539e00, 0x1c0c000, 0xc02010d, 0x609c00, 0xfffffd00, 0x0, 0x0, 0x17c7800, 0x539e00, 0x1c0c000, 0xb800206, 0x5f9c00, 0x60, 0x0, 0x0, 0x0, 0x0, 0x0, 0x0, 0x0, 0x0, 0x0, 0x0, 0x0, 0x0, 0x0, 0x0, 0x0, 0x0, 0x0, 0x0, 0x0, 0x0, 0x0, 0x0, 0x0, 0x0, 0x0, 0x0
    .long 0x17e7c00, 0x539f00, 0x1c0c000, 0xc02010d, 0x609c00, 0xfffffd00, 0x0, 0x0, 0x17c7c00, 0x539f00, 0x1c0c000, 0xb800206, 0x5f9c00, 0x60, 0x0, 0x0, 0x0, 0x0, 0x0, 0x0, 0x0, 0x0, 0x0, 0x0, 0x0, 0x0, 0x0, 0x0, 0x0, 0x0, 0x0, 0x0, 0x0, 0x0, 0x0, 0x0, 0x0, 0x0, 0x0, 0x0
    .long 0x7c7000, 0x141c00, 0xbf7000, 0xb01010c, 0x201c00, 0xfffffd40, 0x0, 0x0, 0x5c7000, 0x141c00, 0xbf7000, 0x3010104, 0x181c00, 0xffffff40, 0x0, 0x0, 0xf7a000, 0x3de800, 0x1281000, 0x101, 0x3ee800, 0x0, 0x0, 0x0, 0x0, 0x0, 0x0, 0x0, 0x0, 0x0, 0x0, 0x0, 0x0, 0x0, 0x0, 0x0, 0x0, 0x0, 0x0, 0x0
    .long 0x7c7400, 0x141d00, 0xbf7000, 0xb01010c, 0x201c00, 0xfffffd40, 0x0, 0x0, 0x5c7400, 0x141d00, 0xbf7000, 0x3010104, 0x181c00, 0xffffff40, 0x0, 0x0, 0xf7a400, 0x3de900, 0x1281000, 0x101, 0x3ee800, 0x0, 0x0, 0x0, 0x0, 0x0, 0x0, 0x0, 0x0, 0x0, 0x0, 0x0, 0x0, 0x0, 0x0, 0x0, 0x0, 0x0, 0x0, 0x0
    .long 0x7c7800, 0x141e00, 0xbf7000, 0xb01010c, 0x201c00, 0xfffffd40, 0x0, 0x0, 0x5c7800, 0x141e00, 0xbf7000, 0x3010104, 0x181c00, 0xffffff40, 0x0, 0x0, 0xf7a800, 0x3dea00, 0x1281000, 0x101, 0x3ee800, 0x0, 0x0, 0x0, 0x0, 0x0, 0x0, 0x0, 0x0, 0x0, 0x0, 0x0, 0x0, 0x0, 0x0, 0x0, 0x0, 0x0, 0x0, 0x0
    .long 0x7c7c00, 0x141f00, 0xbf7000, 0xb01010c, 0x201c00, 0xfffffd40, 0x0, 0x0, 0x5c7c00, 0x141f00, 0xbf7000, 0x3010104, 0x181c00, 0xffffff40, 0x0, 0x0, 0xf7ac00, 0x3deb00, 0x1281000, 0x101, 0x3ee800, 0x0, 0x0, 0x0, 0x0, 0x0, 0x0, 0x0, 0x0, 0x0, 0x0, 0x0, 0x0, 0x0, 0x0, 0x0, 0x0, 0x0, 0x0, 0x0
    .long 0x1827000, 0x539c00, 0x1c0c000, 0xd02010e, 0x619c00, 0xfffffcc0, 0x0, 0x0, 0x1747000, 0x539c00, 0x1c0c000, 0x9800205, 0x5d9c00, 0x60, 0x0, 0x0, 0x0, 0x0, 0x0, 0x0, 0x0, 0x0, 0x0, 0x0, 0x0, 0x0, 0x0, 0x0, 0x0, 0x0, 0x0, 0x0, 0x0, 0x0, 0x0, 0x0, 0x0, 0x0, 0x0, 0x0
    .long 0x1827400, 0x539d00, 0x1c0c000, 0xd02010e, 0x619c00, 0xfffffcc0, 0x0, 0x0, 0x1747400, 0x539d00, 0x1c0c000, 0x9800205, 0x5d9c00, 0x60, 0x0, 0x0, 0x0, 0x0, 0x0, 0x0, 0x0, 0x0, 0x0, 0x0, 0x0, 0x0, 0x0, 0x0, 0x0, 0x0, 0x0, 0x0, 0x0, 0x0, 0x0, 0x0, 0x0, 0x0, 0x0, 0x0
    .long 0x1827800, 0x539e00, 0x1c0c000, 0xd02010e, 0x619c00, 0xfffffcc0, 0x0, 0x0, 0x1747800, 0x539e00, 0x1c0c000, 0x9800205, 0x5d9c00, 0x60, 0x0, 0x0, 0x0, 0x0, 0x0, 0x0, 0x0, 0x0, 0x0, 0x0, 0x0, 0x0, 0x0, 0x0, 0x0, 0x0, 0x0, 0x0, 0x0, 0x0, 0x0, 0x0, 0x0, 0x0, 0x0, 0x0
    .long 0x1827c00, 0x539f00, 0x1c0c000, 0xd02010e, 0x619c00, 0xfffffcc0, 0x0, 0x0, 0x1747c00, 0x539f00, 0x1c0c000, 0x9800205, 0x5d9c00, 0x60, 0x0, 0x0, 0x0, 0x0, 0x0, 0x0, 0x0, 0x0, 0x0, 0x0, 0x0, 0x0, 0x0, 0x0, 0x0, 0x0, 0x0, 0x0, 0x0, 0x0, 0x0, 0x0, 0x0, 0x0, 0x0, 0x0
    .long 0x1441000, 0x4a0400, 0x14e7000, 0x7010108, 0x520400, 0xfffffe40, 0x0, 0x0, 0x113a000, 0x3de800, 0x1281000, 0x7010108, 0x45e800, 0xfffffe40, 0x0, 0x0, 0xd35000, 0x34d400, 0xf7a000, 0x101, 0x35d400, 0x0, 0x0, 0x0, 0x0, 0x0, 0x0, 0x0, 0x0, 0x0, 0x0, 0x0, 0x0, 0x0, 0x0, 0x0, 0x0, 0x0, 0x0, 0x0
    .long 0x1441400, 0x4a0500, 0x14e7000, 0x7010108, 0x520400, 0xfffffe40, 0x0, 0x0, 0x113a400, 0x3de900, 0x1281000, 0x7010108, 0x45e800, 0xfffffe40, 0x0, 0x0, 0xd35400, 0x34d500, 0xf7a000, 0x101, 0x35d400, 0x0, 0x0, 0x0, 0x0, 0x0, 0x0, 0x0, 0x0, 0x0, 0x0, 0x0, 0x0, 0x0, 0x0, 0x0, 0x0, 0x0, 0x0, 0x0
    .long 0x1441800, 0x4a0600, 0x14e7000, 0x7010108, 0x520400, 0xfffffe40, 0x0, 0x0, 0x113a800, 0x3dea00, 0x1281000, 0x7010108, 0x45e800, 0xfffffe40, 0x0, 0x0, 0xd35800, 0x34d600, 0xf7a000, 0x101, 0x35d400, 0x0, 0x0, 0x0, 0x0, 0x0, 0x0, 0x0, 0x0, 0x0, 0x0, 0x0, 0x0, 0x0, 0x0, 0x0, 0x0, 0x0, 0x0, 0x0
    .long 0x1441c00, 0x4a0700, 0x14e7000, 0x7010108, 0x520400, 0xfffffe40, 0x0, 0x0, 0x113ac00, 0x3deb00, 0x1281000, 0x7010108, 0x45e800, 0xfffffe40, 0x0, 0x0, 0xd35c00, 0x34d700, 0xf7a000, 0x101, 0x35d400, 0x0, 0x0, 0x0, 0x0, 0x0, 0x0, 0x0, 0x0, 0x0, 0x0, 0x0, 0x0, 0x0, 0x0, 0x0, 0x0, 0x0, 0x0, 0x0
    .long 0x340000, 0x0, 0x383000, 0xd02010e, 0xe0000, 0xfffffcc0, 0x0, 0x0, 0x1727000, 0x539c00, 0x1c0c000, 0x9000205, 0x5d9c00, 0x40, 0x0, 0x0, 0x0, 0x0, 0x0, 0x0, 0x0, 0x0, 0x0, 0x0, 0x0, 0x0, 0x0, 0x0, 0x0, 0x0, 0x0, 0x0, 0x0, 0x0, 0x0, 0x0, 0x0, 0x0, 0x0, 0x0
    .long 0x340400, 0x100, 0x383000, 0xd02010e, 0xe0000, 0xfffffcc0, 0x0, 0x0, 0x1727400, 0x539d00, 0x1c0c000, 0x9000205, 0x5d9c00, 0x40, 0x0, 0x0, 0x0, 0x0, 0x0, 0x0, 0x0, 0x0, 0x0, 0x0, 0x0, 0x0, 0x0, 0x0, 0x0, 0x0, 0x0, 0x0, 0x0, 0x0, 0x0, 0x0, 0x0, 0x0, 0x0, 0x0
    .long 0x340800, 0x200, 0x383000, 0xd02010e, 0xe0000, 0xfffffcc0, 0x0, 0x0, 0x1727800, 0x539e00, 0x1c0c000, 0x9000205, 0x5d9c00, 0x40, 0x0, 0x0, 0x0, 0x0, 0x0, 0x0, 0x0, 0x0, 0x0, 0x0, 0x0, 0x0, 0x0, 0x0, 0x0, 0x0, 0x0, 0x0, 0x0, 0x0, 0x0, 0x0, 0x0, 0x0, 0x0, 0x0
    .long 0x340c00, 0x300, 0x383000, 0xd02010e, 0xe0000, 0xfffffcc0, 0x0, 0x0, 0x1727c00, 0x539f00, 0x1c0c000, 0x9000205, 0x5d9c00, 0x40, 0x0, 0x0, 0x0, 0x0, 0x0, 0x0, 0x0, 0x0, 0x0, 0x0, 0x0, 0x0, 0x0, 0x0, 0x0, 0x0, 0x0, 0x0, 0x0, 0x0, 0x0, 0x0, 0x0, 0x0, 0x0, 0x0
    .long 0xffa000, 0x3de800, 0x1281000, 0x2010103, 0x40e800, 0xffffff80, 0x0, 0x0, 0xfba000, 0x3de800, 0x1281000, 0x1020102, 0x3fe800, 0xffffffc0, 0x0, 0x0, 0xa87000, 0x141c00, 0xbf7000, 0x1600020c, 0x2b1c00, 0x0, 0x0, 0x0, 0x0, 0x0, 0x0, 0x0, 0x0, 0x0, 0x0, 0x0, 0x0, 0x0, 0x0, 0x0, 0x0, 0x0, 0x0, 0x0
    .long 0xffa400, 0x3de900, 0x1281000, 0x2010103, 0x40e800, 0xffffff80, 0x0, 0x0, 0xfba400, 0x3de900, 0x1281000, 0x1020102, 0x3fe800, 0xffffffc0, 0x0, 0x0, 0xa87400, 0x141d00, 0xbf7000, 0x1600020c, 0x2b1c00, 0x0, 0x0, 0x0, 0x0, 0x0, 0x0, 0x0, 0x0, 0x0, 0x0, 0x0, 0x0, 0x0, 0x0, 0x0, 0x0, 0x0, 0x0, 0x0
    .long 0xffa800, 0x3dea00, 0x1281000, 0x2010103, 0x40e800, 0xffffff80, 0x0, 0x0, 0xfba800, 0x3dea00, 0x1281000, 0x1020102, 0x3fe800, 0xffffffc0, 0x0, 0x0, 0xa87800, 0x141e00, 0xbf7000, 0x1600020c, 0x2b1c00, 0x0, 0x0, 0x0, 0x0, 0x0, 0x0, 0x0, 0x0, 0x0, 0x0, 0x0, 0x0, 0x0, 0x0, 0x0, 0x0, 0x0, 0x0, 0x0
    .long 0xffac00, 0x3deb00, 0x1281000, 0x2010103, 0x40e800, 0xffffff80, 0x0, 0x0, 0xfbac00, 0x3deb00, 0x1281000, 0x1020102, 0x3fe800, 0xffffffc0, 0x0, 0x0, 0xa87c00, 0x141f00, 0xbf7000, 0x1600020c, 0x2b1c00, 0x0, 0x0, 0x0, 0x0, 0x0, 0x0, 0x0, 0x0, 0x0, 0x0, 0x0, 0x0, 0x0, 0x0, 0x0, 0x0, 0x0, 0x0, 0x0
    .long 0x1867000, 0x539c00, 0x1c0c000, 0xe02010f, 0x629c00, 0xfffffc80, 0x0, 0x0, 0x503000, 0xe0c00, 0x507000, 0x6000204, 0x141c00, 0x0, 0x0, 0x0, 0x0, 0x0, 0x0, 0x0, 0x0, 0x0, 0x0, 0x0, 0x0, 0x0, 0x0, 0x0, 0x0, 0x0, 0x0, 0x0, 0x0, 0x0, 0x0, 0x0, 0x0, 0x0, 0x0, 0x0
    .long 0x1867400, 0x539d00, 0x1c0c000, 0xe02010f, 0x629c00, 0xfffffc80, 0x0, 0x0, 0x503400, 0xe0d00, 0x507000, 0x6000204, 0x141c00, 0x0, 0x0, 0x0, 0x0, 0x0, 0x0, 0x0, 0x0, 0x0, 0x0, 0x0, 0x0, 0x0, 0x0, 0x0, 0x0, 0x0, 0x0, 0x0, 0x0, 0x0, 0x0, 0x0, 0x0, 0x0, 0x0, 0x0
    .long 0x1867800, 0x539e00, 0x1c0c000, 0xe02010f, 0x629c00, 0xfffffc80, 0x0, 0x0, 0x503800, 0xe0e00, 0x507000, 0x6000204, 0x141c00, 0x0, 0x0, 0x0, 0x0, 0x0, 0x0, 0x0, 0x0, 0x0, 0x0, 0x0, 0x0, 0x0, 0x0, 0x0, 0x0, 0x0, 0x0, 0x0, 0x0, 0x0, 0x0, 0x0, 0x0, 0x0, 0x0, 0x0
    .long 0x1867c00, 0x539f00, 0x1c0c000, 0xe02010f, 0x629c00, 0xfffffc80, 0x0, 0x0, 0x503c00, 0xe0f00, 0x507000, 0x6000204, 0x141c00, 0x0, 0x0, 0x0, 0x0, 0x0, 0x0, 0x0, 0x0, 0x0, 0x0, 0x0, 0x0, 0x0, 0x0, 0x0, 0x0, 0x0, 0x0, 0x0, 0x0, 0x0, 0x0, 0x0, 0x0, 0x0, 0x0, 0x0
    .long 0xef5000, 0x34d400, 0xf7a000, 0x7010108, 0x3cd400, 0xfffffe40, 0x0, 0x0, 0xd75000, 0x34d400, 0xf7a000, 0x1020102, 0x36d400, 0xffffffc0, 0x0, 0x0, 0x127a000, 0x3de800, 0x1281000, 0xc000207, 0x4a0400, 0x0, 0x0, 0x0, 0x0, 0x0, 0x0, 0x0, 0x0, 0x0, 0x0, 0x0, 0x0, 0x0, 0x0, 0x0, 0x0, 0x0, 0x0, 0x0
    .long 0xef5400, 0x34d500, 0xf7a000, 0x7010108, 0x3cd400, 0xfffffe40, 0x0, 0x0, 0xd75400, 0x34d500, 0xf7a000, 0x1020102, 0x36d400, 0xffffffc0, 0x0, 0x0, 0x127a400, 0x3de900, 0x1281000, 0xc000207, 0x4a0400, 0x0, 0x0, 0x0, 0x0, 0x0, 0x0, 0x0, 0x0, 0x0, 0x0, 0x0, 0x0, 0x0, 0x0, 0x0, 0x0, 0x0, 0x0, 0x0
    .long 0xef5800, 0x34d600, 0xf7a000, 0x7010108, 0x3cd400, 0xfffffe40, 0x0, 0x0, 0xd75800, 0x34d600, 0xf7a000, 0x1020102, 0x36d400, 0xffffffc0, 0x0, 0x0, 0x127a800, 0x3dea00, 0x1281000, 0xc000207, 0x4a0400, 0x0, 0x0, 0x0, 0x0, 0x0, 0x0, 0x0, 0x0, 0x0, 0x0, 0x0, 0x0, 0x0, 0x0, 0x0, 0x0, 0x0, 0x0, 0x0
    .long 0xef5c00, 0x34d700, 0xf7a000, 0x7010108, 0x3cd400, 0xfffffe40, 0x0, 0x0, 0xd75c00, 0x34d700, 0xf7a000, 0x1020102, 0x36d400, 0xffffffc0, 0x0, 0x0, 0x127ac00, 0x3deb00, 0x1281000, 0xc000207, 0x4a0400, 0x0, 0x0, 0x0, 0x0, 0x0, 0x0, 0x0, 0x0, 0x0, 0x0, 0x0, 0x0, 0x0, 0x0, 0x0, 0x0, 0x0, 0x0, 0x0
    .long 0x300000, 0x0, 0x383000, 0xc01010d, 0xd0000, 0xfffffd00, 0x0, 0x0, 0x1527000, 0x539c00, 0x1c0c000, 0x1010102, 0x559c00, 0xffffffc0, 0x0, 0x0, 0x0, 0x0, 0x383000, 0x101, 0x10000, 0x0, 0x0, 0x0, 0x0, 0x0, 0x0, 0x0, 0x0, 0x0, 0x0, 0x0, 0x0, 0x0, 0x0, 0x0, 0x0, 0x0, 0x0, 0x0
    .long 0x300400, 0x100, 0x383000, 0xc01010d, 0xd0000, 0xfffffd00, 0x0, 0x0, 0x1527400, 0x539d00, 0x1c0c000, 0x1010102, 0x559c00, 0xffffffc0, 0x0, 0x0, 0x400, 0x100, 0x383000, 0x101, 0x10000, 0x0, 0x0, 0x0, 0x0, 0x0, 0x0, 0x0, 0x0, 0x0, 0x0, 0x0, 0x0, 0x0, 0x0, 0x0, 0x0, 0x0, 0x0, 0x0
    .long 0x300800, 0x200, 0x383000, 0xc01010d, 0xd0000, 0xfffffd00, 0x0, 0x0, 0x1527800, 0x539e00, 0x1c0c000, 0x1010102, 0x559c00, 0xffffffc0, 0x0, 0x0, 0x800, 0x200, 0x383000, 0x101, 0x10000, 0x0, 0x0, 0x0, 0x0, 0x0, 0x0, 0x0, 0x0, 0x0, 0x0, 0x0, 0x0, 0x0, 0x0, 0x0, 0x0, 0x0, 0x0, 0x0
    .long 0x300c00, 0x300, 0x383000, 0xc01010d, 0xd0000, 0xfffffd00, 0x0, 0x0, 0x1527c00, 0x539f00, 0x1c0c000, 0x1010102, 0x559c00, 0xffffffc0, 0x0, 0x0, 0xc00, 0x300, 0x383000, 0x101, 0x10000, 0x0, 0x0, 0x0, 0x0, 0x0, 0x0, 0x0, 0x0, 0x0, 0x0, 0x0, 0x0, 0x0, 0x0, 0x0, 0x0, 0x0, 0x0, 0x0
    .long 0x707000, 0x141c00, 0xbf7000, 0x8010109, 0x1d1c00, 0xfffffe00, 0x0, 0x0, 0xdb5000, 0x34d400, 0xf7a000, 0x2010103, 0x37d400, 0xffffff80, 0x0, 0x0, 0x547000, 0x141c00, 0xbf7000, 0x1010102, 0x161c00, 0xffffffc0, 0x0, 0x0, 0x507000, 0x141c00, 0xbf7000, 0x101, 0x151c00, 0x0, 0x0, 0x0, 0x0, 0x0, 0x0, 0x0, 0x0, 0x0, 0x0, 0x0
    .long 0x707400, 0x141d00, 0xbf7000, 0x8010109, 0x1d1c00, 0xfffffe00, 0x0, 0x0, 0xdb5400, 0x34d500, 0xf7a000, 0x2010103, 0x37d400, 0xffffff80, 0x0, 0x0, 0x547400, 0x141d00, 0xbf7000, 0x1010102, 0x161c00, 0xffffffc0, 0x0, 0x0, 0x507400, 0x141d00, 0xbf7000, 0x101, 0x151c00, 0x0, 0x0, 0x0, 0x0, 0x0, 0x0, 0x0, 0x0, 0x0, 0x0, 0x0
    .long 0x707800, 0x141e00, 0xbf7000, 0x8010109, 0x1d1c00, 0xfffffe00, 0x0, 0x0, 0xdb5800, 0x34d600, 0xf7a000, 0x2010103, 0x37d400, 0xffffff80, 0x0, 0x0, 0x547800, 0x141e00, 0xbf7000, 0x1010102, 0x161c00, 0xffffffc0, 0x0, 0x0, 0x507800, 0x141e00, 0xbf7000, 0x101, 0x151c00, 0x0, 0x0, 0x0, 0x0, 0x0, 0x0, 0x0, 0x0, 0x0, 0x0, 0x0
    .long 0x707c00, 0x141f00, 0xbf7000, 0x8010109, 0x1d1c00, 0xfffffe00, 0x0, 0x0, 0xdb5c00, 0x34d700, 0xf7a000, 0x2010103, 0x37d400, 0xffffff80, 0x0, 0x0, 0x547c00, 0x141f00, 0xbf7000, 0x1010102, 0x161c00, 0xffffffc0, 0x0, 0x0, 0x507c00, 0x141f00, 0xbf7000, 0x101, 0x151c00, 0x0, 0x0, 0x0, 0x0, 0x0, 0x0, 0x0, 0x0, 0x0, 0x0, 0x0
    .long 0xc37000, 0x2fdc00, 0xd35000, 0x1010102, 0x31dc00, 0xffffffc0, 0x0, 0x0, 0x3c3000, 0xe0c00, 0x507000, 0x1020102, 0x100c00, 0xffffffc0, 0x0, 0x0, 0x1a67000, 0x539c00, 0x1c0c000, 0x1600020c, 0x6a9c00, 0x0, 0x0, 0x0, 0x0, 0x0, 0x0, 0x0, 0x0, 0x0, 0x0, 0x0, 0x0, 0x0, 0x0, 0x0, 0x0, 0x0, 0x0, 0x0
    .long 0xc37400, 0x2fdd00, 0xd35000, 0x1010102, 0x31dc00, 0xffffffc0, 0x0, 0x0, 0x3c3400, 0xe0d00, 0x507000, 0x1020102, 0x100c00, 0xffffffc0, 0x0, 0x0, 0x1a67400, 0x539d00, 0x1c0c000, 0x1600020c, 0x6a9c00, 0x0, 0x0, 0x0, 0x0, 0x0, 0x0, 0x0, 0x0, 0x0, 0x0, 0x0, 0x0, 0x0, 0x0, 0x0, 0x0, 0x0, 0x0, 0x0
    .long 0xc37800, 0x2fde00, 0xd35000, 0x1010102, 0x31dc00, 0xffffffc0, 0x0, 0x0, 0x3c3800, 0xe0e00, 0x507000, 0x1020102, 0x100c00, 0xffffffc0, 0x0, 0x0, 0x1a67800, 0x539e00, 0x1c0c000, 0x1600020c, 0x6a9c00, 0x0, 0x0, 0x0, 0x0, 0x0, 0x0, 0x0, 0x0, 0x0, 0x0, 0x0, 0x0, 0x0, 0x0, 0x0, 0x0, 0x0, 0x0, 0x0
    .long 0xc37c00, 0x2fdf00, 0xd35000, 0x1010102, 0x31dc00, 0xffffffc0, 0x0, 0x0, 0x3c3c00, 0xe0f00, 0x507000, 0x1020102, 0x100c00, 0xffffffc0, 0x0, 0x0, 0x1a67c00, 0x539f00, 0x1c0c000, 0x1600020c, 0x6a9c00, 0x0, 0x0, 0x0, 0x0, 0x0, 0x0, 0x0, 0x0, 0x0, 0x0, 0x0, 0x0, 0x0, 0x0, 0x0, 0x0, 0x0, 0x0, 0x0
    .long 0x6c7000, 0x141c00, 0xbf7000, 0x7010108, 0x1c1c00, 0xfffffe40, 0x0, 0x0, 0xc77000, 0x2fdc00, 0xd35000, 0x2010103, 0x32dc00, 0xffffff80, 0x0, 0x0, 0x587000, 0x141c00, 0xbf7000, 0x2010103, 0x171c00, 0xffffff80, 0x0, 0x0, 0x383000, 0xe0c00, 0x507000, 0x101, 0xf0c00, 0x0, 0x0, 0x0, 0x0, 0x0, 0x0, 0x0, 0x0, 0x0, 0x0, 0x0
    .long 0x6c7400, 0x141d00, 0xbf7000, 0x7010108, 0x1c1c00, 0xfffffe40, 0x0, 0x0, 0xc77400, 0x2fdd00, 0xd35000, 0x2010103, 0x32dc00, 0xffffff80, 0x0, 0x0, 0x587400, 0x141d00, 0xbf7000, 0x2010103, 0x171c00, 0xffffff80, 0x0, 0x0, 0x383400, 0xe0d00, 0x507000, 0x101, 0xf0c00, 0x0, 0x0, 0x0, 0x0, 0x0, 0x0, 0x0, 0x0, 0x0, 0x0, 0x0
    .long 0x6c7800, 0x141e00, 0xbf7000, 0x7010108, 0x1c1c00, 0xfffffe40, 0x0, 0x0, 0xc77800, 0x2fde00, 0xd35000, 0x2010103, 0x32dc00, 0xffffff80, 0x0, 0x0, 0x587800, 0x141e00, 0xbf7000, 0x2010103, 0x171c00, 0xffffff80, 0x0, 0x0, 0x383800, 0xe0e00, 0x507000, 0x101, 0xf0c00, 0x0, 0x0, 0x0, 0x0, 0x0, 0x0, 0x0, 0x0, 0x0, 0x0, 0x0
    .long 0x6c7c00, 0x141f00, 0xbf7000, 0x7010108, 0x1c1c00, 0xfffffe40, 0x0, 0x0, 0xc77c00, 0x2fdf00, 0xd35000, 0x2010103, 0x32dc00, 0xffffff80, 0x0, 0x0, 0x587c00, 0x141f00, 0xbf7000, 0x2010103, 0x171c00, 0xffffff80, 0x0, 0x0, 0x383c00, 0xe0f00, 0x507000, 0x101, 0xf0c00, 0x0, 0x0, 0x0, 0x0, 0x0, 0x0, 0x0, 0x0, 0x0, 0x0, 0x0
    .long 0x200000, 0x0, 0x383000, 0x8010109, 0x90000, 0xfffffe00, 0x0, 0x0, 0x40000, 0x0, 0x383000, 0x1020102, 0x20000, 0xffffffc0, 0x0, 0x0, 0x17a7000, 0x539c00, 0x1c0c000, 0xb000206, 0x5f9c00, 0x40, 0x0, 0x0, 0x0, 0x0, 0x0, 0x0, 0x0, 0x0, 0x0, 0x0, 0x0, 0x0, 0x0, 0x0, 0x0, 0x0, 0x0, 0x0
    .long 0x200400, 0x100, 0x383000, 0x8010109, 0x90000, 0xfffffe00, 0x0, 0x0, 0x40400, 0x100, 0x383000, 0x1020102, 0x20000, 0xffffffc0, 0x0, 0x0, 0x17a7400, 0x539d00, 0x1c0c000, 0xb000206, 0x5f9c00, 0x40, 0x0, 0x0, 0x0, 0x0, 0x0, 0x0, 0x0, 0x0, 0x0, 0x0, 0x0, 0x0, 0x0, 0x0, 0x0, 0x0, 0x0, 0x0
    .long 0x200800, 0x200, 0x383000, 0x8010109, 0x90000, 0xfffffe00, 0x0, 0x0, 0x40800, 0x200, 0x383000, 0x1020102, 0x20000, 0xffffffc0, 0x0, 0x0, 0x17a7800, 0x539e00, 0x1c0c000, 0xb000206, 0x5f9c00, 0x40, 0x0, 0x0, 0x0, 0x0, 0x0, 0x0, 0x0, 0x0, 0x0, 0x0, 0x0, 0x0, 0x0, 0x0, 0x0, 0x0, 0x0, 0x0
    .long 0x200c00, 0x300, 0x383000, 0x8010109, 0x90000, 0xfffffe00, 0x0, 0x0, 0x40c00, 0x300, 0x383000, 0x1020102, 0x20000, 0xffffffc0, 0x0, 0x0, 0x17a7c00, 0x539f00, 0x1c0c000, 0xb000206, 0x5f9c00, 0x40, 0x0, 0x0, 0x0, 0x0, 0x0, 0x0, 0x0, 0x0, 0x0, 0x0, 0x0, 0x0, 0x0, 0x0, 0x0, 0x0, 0x0, 0x0
.size sched_table, 40960
.section .rodata,"a"
.p2align 6
.amdhsa_kernel standalone__ragged_sequences_varlen_flash_attn__ragged_kernel
  .amdhsa_next_free_vgpr 512
  .amdhsa_next_free_sgpr 102
  .amdhsa_accum_offset 256
  .amdhsa_group_segment_fixed_size 0
  .amdhsa_kernarg_size 56
  .amdhsa_user_sgpr_count 2
  .amdhsa_user_sgpr_kernarg_segment_ptr 1
  .amdhsa_system_sgpr_workgroup_id_x 1
.end_amdhsa_kernel
```
